```python
import torch

def _softmax(x, axis=-1):
    return torch.softmax(x, dim=axis)

def _gelu(x):
    return torch.nn.functional.gelu(x, approximate='tanh')

def _silu(x):
    return torch.nn.functional.silu(x)

def _sigmoid(x):
    return torch.sigmoid(x)

def _layernorm(x, axis=-1, eps=1e-05):
    m = x.mean(dim=axis, keepdim=True)
    v = x.var(dim=axis, keepdim=True, unbiased=False)
    return (x - m) / torch.sqrt(v + eps)

def _scatter_add(tgt, idx, src, axis=0):
    return tgt.clone().index_add_(axis, idx, src)

def _segment_sum(src, seg, n):
    out = torch.zeros((n,) + src.shape[1:], dtype=src.dtype)
    return out.index_add_(0, seg, src)

def _pad(x, pw):
    flat = tuple((v for pair in reversed(pw) for v in pair))
    return torch.nn.functional.pad(x, flat)
kernel_name = 'adaLN_cond__sliding_local_dilated__mixer_gmlp__prompt'

def setup_inputs():

    _w = lambda a: (lambda t: t.to(torch.bfloat16) if t.is_floating_point() else t)(torch.as_tensor(a))

    def _A_setup():
        B, S, D = (1, 2048, 576)
        return {'x': _w((lambda *s: torch.randn(*s, dtype=torch.bfloat16) * 0.05)(B, S, D)), 'wqkv': _w((lambda *s: torch.randn(*s, dtype=torch.bfloat16) * 0.05)(D, 3 * D)), 'wo': _w((lambda *s: torch.randn(*s, dtype=torch.bfloat16) * 0.05)(D, D))}
    _A_in = _A_setup()

    def _B_setup():
        B, S, D, F = (1, 2048, 576, 4608)
        Fh = F // 2
        return {'x': _w((lambda *s: torch.randn(*s, dtype=torch.bfloat16) * 0.05)(B, S, D)), 'w_in': _w((lambda *s: torch.randn(*s, dtype=torch.bfloat16) * 0.4)(D, 2 * Fh)), 'w_sp': _w(0.01 * (lambda *s: torch.randn(*s, dtype=torch.bfloat16) * 0.4)(S, S)), 'b_sp': _w(1.0 + 0.01 * (lambda *s: torch.randn(*s, dtype=torch.bfloat16) * 0.05)(S)), 'w_out': _w((lambda *s: torch.randn(*s, dtype=torch.bfloat16) * 0.05)(Fh, D))}
    _B_in = _B_setup()
    return {'A_x': _A_in['x'], 'A_wqkv': _A_in['wqkv'], 'A_wo': _A_in['wo'], 'B_x': _B_in['x'], 'B_w_in': _B_in['w_in'], 'B_w_sp': _B_in['w_sp'], 'B_b_sp': _B_in['b_sp'], 'B_w_out': _B_in['w_out'], 'c': _w((lambda *s: torch.randn(*s, dtype=torch.bfloat16) * 0.1)(1, 576) * 8.0), 'w_mod': _w((lambda *s: torch.randn(*s, dtype=torch.bfloat16) * 0.1)(576, 6 * 576) * 576 ** (-0.5) * 8.0)}

def reference(A_x, A_wqkv, A_wo, B_x, B_w_in, B_w_sp, B_b_sp, B_w_out, c, w_mod):

    def _A_ref(x, wqkv, wo):
        B, S, D = x.shape
        H = 32
        Dh = D // H
        W, dil = (8, 2)
        qkv = (lambda x, *d: x.permute(*d))((x @ wqkv).reshape(B, S, 3, H, Dh), 2, 0, 3, 1, 4)
        q, k, v = (qkv[0], qkv[1], qkv[2])
        scale = Dh ** (-0.5)
        pos = torch.arange(S)
        off = torch.arange(W) * dil
        idx = pos[:, None] - off[None, :]
        mask = idx >= 0
        idx_c = torch.where(mask, idx, 0).reshape(-1)
        kg = k[:, :, idx_c, :].reshape(B, H, S, W, Dh)
        vg = v[:, :, idx_c, :].reshape(B, H, S, W, Dh)
        logits = torch.einsum('bhsd,bhswd->bhsw', q, kg) * scale
        logits = torch.where(mask[None, None, :, :], logits, -1000000000.0)
        attn = _softmax(logits, axis=-1)
        o = torch.einsum('bhsw,bhswd->bhsd', attn, vg)
        return (lambda x, *d: x.permute(*d))(o, 0, 2, 1, 3).reshape(B, S, D) @ wo

    def _B_ref(x, w_in, w_sp, b_sp, w_out):
        B, S, D = x.shape
        F = w_in.shape[-1]
        Fh = F // 2
        z = _gelu(torch.einsum('bsd,df->bsf', x, w_in))
        z1 = z[..., :Fh].clone()
        z2 = _layernorm(z[..., Fh:], axis=-1)
        g = torch.einsum('ts,bsf->btf', w_sp, z2) + b_sp[None, :, None]
        return torch.einsum('bsf,fd->bsd', z1 * g, w_out)
    x = A_x
    mod = (_silu(c) @ w_mod).reshape(c.shape[0], 6, 1, -1)
    sa, ca, ga, sb, cb, gb = (mod[:, 0].clone(), mod[:, 1].clone(), mod[:, 2].clone(), mod[:, 3].clone(), mod[:, 4].clone(), mod[:, 5].clone())
    h = _layernorm(x, axis=-1) * (1 + ca) + sa
    x = x + ga * _A_ref(h, A_wqkv, A_wo)
    h = _layernorm(x, axis=-1) * (1 + cb) + sb
    x = x + gb * _B_ref(h, B_w_in, B_w_sp, B_b_sp, B_w_out)
    return x
```

```asm
; @launch kernel=k0_kernel grid=(256,1,1) block=(448,1,1) lds=13376
; @launch kernel=k1_kernel grid=(256,1,1) block=(512,1,1) lds=151808
; @launch kernel=kb_kernel grid=(256,1,1) block=(256,1,1) lds=158720
.amdgcn_target "amdgcn-amd-amdhsa--gfx950"
.text
.globl k0_kernel
.p2align 8
.type k0_kernel,@function
k0_kernel:
    s_load_dwordx4 s[4:7], s[0:1], 0
    s_load_dwordx4 s[20:23], s[0:1], 64
    s_load_dwordx2 s[24:25], s[0:1], 96
    s_cmp_ge_u32 s2, 256
    s_cbranch_scc1 L0_end
    s_cmp_lt_u32 s2, 216
    s_cbranch_scc1 L0_nt
    v_cmp_gt_u32 vcc, 256, v0
    s_cbranch_vccz L0_nt
    s_sub_u32 s31, s2, 216
    s_lshr_b32 s31, s31, 3
    s_lshl_b32 s31, s31, 8
    v_add_u32 v3, s31, v0
    s_getpc_b64 s[40:41]
Lpc_k0_kernel_1:
    s_add_u32 s40, s40, k0_kernel-Lpc_k0_kernel_1
    s_addc_u32 s41, s41, (k0_kernel-Lpc_k0_kernel_1)>>32
    v_lshlrev_b32 v2, 7, v3
    v_min_u32 v2, code_end-k0_kernel-4, v2
    global_load_dword v63, v2, s[40:41]
L0_nt:
    v_lshrrev_b32 v2, 6, v0
    v_and_b32 v1, 63, v0
    v_mov_b32 v3, 0
    v_mov_b32 v4, 13312
    v_readfirstlane_b32 s30, v2
    ds_write_b32 v4, v3
    s_cmp_ge_u32 s30, 6
    s_cbranch_scc1 L0_tile
    s_cmp_ge_u32 s30, 4
    s_cbranch_scc1 L0_ln
    s_lshr_b32 s26, s2, 2
    s_and_b32 s27, s2, 3
    v_lshrrev_b32 v2, 3, v0
    v_and_b32 v3, 7, v0
    v_mul_u32_u24 v4, 6912, v2
    v_lshl_add_u32 v4, v3, 4, v4
    v_lshlrev_b32 v5, 1, v2
    s_mul_i32 s28, s27, 995328
    s_lshl_b32 s29, s26, 7
    s_add_u32 s28, s28, s29
    s_mul_i32 s29, s27, 288
    v_mov_b32 v40, 0
    v_mov_b32 v41, 0
    v_mov_b32 v42, 0
    v_mov_b32 v43, 0
    v_mov_b32 v44, 0
    v_mov_b32 v45, 0
    v_mov_b32 v46, 0
    v_mov_b32 v47, 0
    s_waitcnt lgkmcnt(0)
    s_cmp_ge_u32 s26, 54
    s_cbranch_scc1 L0_bar_end
    s_mov_b32 s8, s22
    s_and_b32 s9, s23, 0xffff
    s_mov_b32 s10, 0x3cc000
    s_mov_b32 s11, 0x00020000
    s_mov_b32 s32, s20
    s_and_b32 s33, s21, 0xffff
    s_mov_b32 s34, 0x480
    s_mov_b32 s35, 0x00020000
    buffer_load_ushort v8, v5, s[32:35], s29 offen offset:0
    buffer_load_ushort v9, v5, s[32:35], s29 offen offset:64
    buffer_load_ushort v10, v5, s[32:35], s29 offen offset:128
    buffer_load_ushort v11, v5, s[32:35], s29 offen offset:192
    buffer_load_ushort v12, v5, s[32:35], s29 offen offset:256
    buffer_load_dwordx4 v[16:19], v4, s[8:11], s28 offen nt
    s_add_u32 s28, s28, 221184
    buffer_load_dwordx4 v[20:23], v4, s[8:11], s28 offen nt
    s_add_u32 s28, s28, 221184
    buffer_load_dwordx4 v[24:27], v4, s[8:11], s28 offen nt
    s_add_u32 s28, s28, 221184
    buffer_load_dwordx4 v[28:31], v4, s[8:11], s28 offen nt
    s_add_u32 s28, s28, 221184
    s_cmp_ge_u32 s30, 2
    s_cselect_b32 s10, 0, s10
    buffer_load_dwordx4 v[32:35], v4, s[8:11], s28 offen nt
    s_barrier
    s_mov_b32 s12, s24
    s_and_b32 s13, s25, 0xffff
    s_mov_b32 s14, 0x10000000
    s_mov_b32 s15, 0x00020000
    s_mov_b32 s28, 0xbfb8aa3b
    v_lshrrev_b32 v2, 4, v0
    v_lshlrev_b32 v2, 8, v2
    v_lshl_add_u32 v2, v3, 5, v2
    v_add_u32 v2, 9216, v2
    s_waitcnt vmcnt(5)
    v_lshlrev_b32 v8, 16, v8
    v_lshlrev_b32 v9, 16, v9
    v_lshlrev_b32 v10, 16, v10
    v_lshlrev_b32 v11, 16, v11
    v_lshlrev_b32 v12, 16, v12
    v_mul_f32 v48, s28, v8
    v_mul_f32 v49, s28, v9
    v_mul_f32 v50, s28, v10
    v_mul_f32 v51, s28, v11
    v_mul_f32 v52, s28, v12
    v_exp_f32 v48, v48
    v_exp_f32 v49, v49
    v_exp_f32 v50, v50
    v_exp_f32 v51, v51
    v_exp_f32 v52, v52
    v_add_f32 v48, 1.0, v48
    v_add_f32 v49, 1.0, v49
    v_add_f32 v50, 1.0, v50
    v_add_f32 v51, 1.0, v51
    v_add_f32 v52, 1.0, v52
    v_rcp_f32 v48, v48
    v_rcp_f32 v49, v49
    v_rcp_f32 v50, v50
    v_rcp_f32 v51, v51
    v_rcp_f32 v52, v52
    v_mul_f32 v8, v8, v48
    v_mul_f32 v9, v9, v49
    v_mul_f32 v10, v10, v50
    v_mul_f32 v11, v11, v51
    v_mul_f32 v12, v12, v52
    v_cvt_pk_bf16_f32 v8, v8, 0
    v_cvt_pk_bf16_f32 v9, v9, 0
    v_cvt_pk_bf16_f32 v10, v10, 0
    v_cvt_pk_bf16_f32 v11, v11, 0
    v_cvt_pk_bf16_f32 v12, v12, 0
    v_lshlrev_b32 v48, 16, v8
    v_lshlrev_b32 v49, 16, v9
    v_lshlrev_b32 v50, 16, v10
    v_lshlrev_b32 v51, 16, v11
    v_lshlrev_b32 v52, 16, v12
    s_waitcnt vmcnt(4)
    v_dot2_f32_bf16 v40, v16, v8, v40
    v_dot2_f32_bf16 v41, v16, v48, v41
    v_dot2_f32_bf16 v42, v17, v8, v42
    v_dot2_f32_bf16 v43, v17, v48, v43
    v_dot2_f32_bf16 v44, v18, v8, v44
    v_dot2_f32_bf16 v45, v18, v48, v45
    v_dot2_f32_bf16 v46, v19, v8, v46
    v_dot2_f32_bf16 v47, v19, v48, v47
    s_waitcnt vmcnt(3)
    v_dot2_f32_bf16 v40, v20, v9, v40
    v_dot2_f32_bf16 v41, v20, v49, v41
    v_dot2_f32_bf16 v42, v21, v9, v42
    v_dot2_f32_bf16 v43, v21, v49, v43
    v_dot2_f32_bf16 v44, v22, v9, v44
    v_dot2_f32_bf16 v45, v22, v49, v45
    v_dot2_f32_bf16 v46, v23, v9, v46
    v_dot2_f32_bf16 v47, v23, v49, v47
    s_waitcnt vmcnt(2)
    v_dot2_f32_bf16 v40, v24, v10, v40
    v_dot2_f32_bf16 v41, v24, v50, v41
    v_dot2_f32_bf16 v42, v25, v10, v42
    v_dot2_f32_bf16 v43, v25, v50, v43
    v_dot2_f32_bf16 v44, v26, v10, v44
    v_dot2_f32_bf16 v45, v26, v50, v45
    v_dot2_f32_bf16 v46, v27, v10, v46
    v_dot2_f32_bf16 v47, v27, v50, v47
    s_waitcnt vmcnt(1)
    v_dot2_f32_bf16 v40, v28, v11, v40
    v_dot2_f32_bf16 v41, v28, v51, v41
    v_dot2_f32_bf16 v42, v29, v11, v42
    v_dot2_f32_bf16 v43, v29, v51, v43
    v_dot2_f32_bf16 v44, v30, v11, v44
    v_dot2_f32_bf16 v45, v30, v51, v45
    v_dot2_f32_bf16 v46, v31, v11, v46
    v_dot2_f32_bf16 v47, v31, v51, v47
    s_waitcnt vmcnt(0)
    v_dot2_f32_bf16 v40, v32, v12, v40
    v_dot2_f32_bf16 v41, v32, v52, v41
    v_dot2_f32_bf16 v42, v33, v12, v42
    v_dot2_f32_bf16 v43, v33, v52, v43
    v_dot2_f32_bf16 v44, v34, v12, v44
    v_dot2_f32_bf16 v45, v34, v52, v45
    v_dot2_f32_bf16 v46, v35, v12, v46
    v_dot2_f32_bf16 v47, v35, v52, v47
    v_and_b32 v6, 8, v0
    v_cmp_eq_u32 vcc, 0, v6
    v_mov_b32 v6, 1
    v_mov_b32 v7, 13312
    v_add_f32_dpp v40, v40, v40 row_ror:8 row_mask:0xf bank_mask:0xf
    v_add_f32_dpp v41, v41, v41 row_ror:8 row_mask:0xf bank_mask:0xf
    v_add_f32_dpp v42, v42, v42 row_ror:8 row_mask:0xf bank_mask:0xf
    v_add_f32_dpp v43, v43, v43 row_ror:8 row_mask:0xf bank_mask:0xf
    v_add_f32_dpp v44, v44, v44 row_ror:8 row_mask:0xf bank_mask:0xf
    v_add_f32_dpp v45, v45, v45 row_ror:8 row_mask:0xf bank_mask:0xf
    v_add_f32_dpp v46, v46, v46 row_ror:8 row_mask:0xf bank_mask:0xf
    v_add_f32_dpp v47, v47, v47 row_ror:8 row_mask:0xf bank_mask:0xf
    s_and_saveexec_b64 s[36:37], vcc
    ds_write_b128 v2, v[40:43]
    ds_write_b128 v2, v[44:47] offset:16
    s_mov_b64 exec, 1
    s_waitcnt lgkmcnt(0)
    ds_add_rtn_u32 v6, v7, v6
    s_mov_b64 exec, -1
    v_lshlrev_b32 v3, 2, v1
    v_add_u32 v2, 9216, v3
    s_mul_i32 s27, s27, 13824
    s_lshl_b32 s26, s26, 8
    s_add_u32 s27, s27, s26
    s_add_u32 s27, s27, 0x104000
    s_waitcnt lgkmcnt(0)
    v_readfirstlane_b32 s36, v6
    s_cmp_lg_u32 s36, 3
    s_cbranch_scc1 L0_end
    ds_read2st64_b32 v[8:9], v2 offset0:0 offset1:1
    ds_read2st64_b32 v[10:11], v2 offset0:2 offset1:3
    ds_read2st64_b32 v[12:13], v2 offset0:4 offset1:5
    ds_read2st64_b32 v[14:15], v2 offset0:6 offset1:7
    ds_read2st64_b32 v[16:17], v2 offset0:8 offset1:9
    ds_read2st64_b32 v[18:19], v2 offset0:10 offset1:11
    ds_read2st64_b32 v[20:21], v2 offset0:12 offset1:13
    ds_read2st64_b32 v[22:23], v2 offset0:14 offset1:15
    s_waitcnt lgkmcnt(4)
    v_pk_add_f32 v[8:9], v[8:9], v[10:11]
    v_pk_add_f32 v[12:13], v[12:13], v[14:15]
    s_waitcnt lgkmcnt(0)
    v_pk_add_f32 v[16:17], v[16:17], v[18:19]
    v_pk_add_f32 v[20:21], v[20:21], v[22:23]
    v_pk_add_f32 v[8:9], v[8:9], v[12:13]
    v_pk_add_f32 v[16:17], v[16:17], v[20:21]
    v_pk_add_f32 v[8:9], v[8:9], v[16:17]
    v_add_f32 v8, v8, v9
    buffer_store_dword v8, v3, s[12:15], s27 offen
    s_branch L0_fin
L0_bar_end:
    s_barrier
    s_branch L0_end
L0_ln:
    s_setprio 3
    v_and_b32 v2, 3, v1
    v_lshrrev_b32 v3, 2, v1
    v_mul_u32_u24 v4, 1152, v2
    v_lshl_add_u32 v4, v3, 4, v4
    s_and_b32 s29, s2, 7
    s_lshl_b32 s29, s29, 5
    s_lshr_b32 s26, s2, 3
    s_add_u32 s29, s29, s26
    s_lshl_b32 s29, s29, 1
    s_add_u32 s29, s29, s30
    s_sub_u32 s29, s29, 4
    s_mul_i32 s26, s29, 4608
    v_mov_b32 v24, 0
    v_mov_b32 v25, 0
    v_mov_b32 v26, 0
    v_mov_b32 v27, 0
    v_mov_b32 v48, -1
    v_mov_b32 v49, -1
    v_mov_b32 v50, -1
    v_mov_b32 v51, -1
    v_lshlrev_b32 v5, 4, v1
    s_waitcnt lgkmcnt(0)
    s_mov_b32 s8, s4
    s_and_b32 s9, s5, 0xffff
    s_mov_b32 s10, 0x240000
    s_mov_b32 s11, 0x00020000
    buffer_load_dwordx4 v[8:11], v4, s[8:11], s26 offen offset:0
    buffer_load_dwordx4 v[12:15], v4, s[8:11], s26 offen offset:256
    buffer_load_dwordx4 v[16:19], v4, s[8:11], s26 offen offset:512
    buffer_load_dwordx4 v[20:23], v4, s[8:11], s26 offen offset:768
    s_mov_b32 exec_hi, 0
    buffer_load_dwordx4 v[24:27], v4, s[8:11], s26 offen offset:1024
    s_mov_b32 exec_hi, -1
    s_barrier
    s_mov_b32 s12, s24
    s_and_b32 s13, s25, 0xffff
    s_mov_b32 s14, 0x10000000
    s_mov_b32 s15, 0x00020000
    s_lshl_b32 s27, s2, 10
    s_add_u32 s27, s27, 0x180000
    s_lshl_b32 s28, s2, 9
    s_add_u32 s28, s28, 0x1c0000
    s_cmp_eq_u32 s30, 4
    s_cselect_b32 s27, s27, s28
    s_cselect_b32 exec_hi, -1, 0
    buffer_store_dwordx4 v[48:51], v5, s[12:15], s27 offen
    s_mov_b64 exec, -1
    v_mov_b32 v44, 0
    v_mov_b32 v45, 0
    v_mov_b32 v46, 0
    v_mov_b32 v47, 0
    s_mov_b32 s28, 0x3f803f80
    s_lshr_b32 s26, s29, 2
    s_mul_i32 s26, s26, 18432
    s_and_b32 s27, s29, 3
    s_lshl_b32 s27, s27, 6
    s_add_u32 s26, s26, s27
    s_add_u32 s26, s26, 0x200000
    v_lshlrev_b32 v4, 8, v3
    v_lshl_add_u32 v4, v2, 4, v4
    s_waitcnt vmcnt(5)
    v_dot2_f32_bf16 v44, v8, s28, v44
    v_dot2_f32_bf16 v46, v8, v8, v46
    v_dot2_f32_bf16 v45, v9, s28, v45
    v_dot2_f32_bf16 v47, v9, v9, v47
    v_dot2_f32_bf16 v44, v10, s28, v44
    v_dot2_f32_bf16 v46, v10, v10, v46
    v_dot2_f32_bf16 v45, v11, s28, v45
    v_dot2_f32_bf16 v47, v11, v11, v47
    s_waitcnt vmcnt(4)
    v_dot2_f32_bf16 v44, v12, s28, v44
    v_dot2_f32_bf16 v46, v12, v12, v46
    v_dot2_f32_bf16 v45, v13, s28, v45
    v_dot2_f32_bf16 v47, v13, v13, v47
    v_dot2_f32_bf16 v44, v14, s28, v44
    v_dot2_f32_bf16 v46, v14, v14, v46
    v_dot2_f32_bf16 v45, v15, s28, v45
    v_dot2_f32_bf16 v47, v15, v15, v47
    s_waitcnt vmcnt(3)
    v_dot2_f32_bf16 v44, v16, s28, v44
    v_dot2_f32_bf16 v46, v16, v16, v46
    v_dot2_f32_bf16 v45, v17, s28, v45
    v_dot2_f32_bf16 v47, v17, v17, v47
    v_dot2_f32_bf16 v44, v18, s28, v44
    v_dot2_f32_bf16 v46, v18, v18, v46
    v_dot2_f32_bf16 v45, v19, s28, v45
    v_dot2_f32_bf16 v47, v19, v19, v47
    s_waitcnt vmcnt(2)
    v_dot2_f32_bf16 v44, v20, s28, v44
    v_dot2_f32_bf16 v46, v20, v20, v46
    v_dot2_f32_bf16 v45, v21, s28, v45
    v_dot2_f32_bf16 v47, v21, v21, v47
    v_dot2_f32_bf16 v44, v22, s28, v44
    v_dot2_f32_bf16 v46, v22, v22, v46
    v_dot2_f32_bf16 v45, v23, s28, v45
    v_dot2_f32_bf16 v47, v23, v23, v47
    s_waitcnt vmcnt(1)
    v_dot2_f32_bf16 v44, v24, s28, v44
    v_dot2_f32_bf16 v46, v24, v24, v46
    v_dot2_f32_bf16 v45, v25, s28, v45
    v_dot2_f32_bf16 v47, v25, v25, v47
    v_dot2_f32_bf16 v44, v26, s28, v44
    v_dot2_f32_bf16 v46, v26, v26, v46
    v_dot2_f32_bf16 v45, v27, s28, v45
    v_dot2_f32_bf16 v47, v27, v27, v47
    s_mov_b32 s28, 0xffff0000
    s_nop 1
    v_add_f32 v44, v44, v45
    v_add_f32 v45, v46, v47
    s_nop 1
    v_add_f32_dpp v44, v44, v44 row_ror:4 row_mask:0xf bank_mask:0xf
    v_add_f32_dpp v45, v45, v45 row_ror:4 row_mask:0xf bank_mask:0xf
    s_nop 1
    v_add_f32_dpp v44, v44, v44 row_ror:8 row_mask:0xf bank_mask:0xf
    v_add_f32_dpp v45, v45, v45 row_ror:8 row_mask:0xf bank_mask:0xf
    v_mov_b32 v46, v44
    v_mov_b32 v47, v45
    s_nop 1
    v_permlane16_swap_b32 v44, v46
    v_permlane16_swap_b32 v45, v47
    s_nop 1
    v_add_f32 v44, v44, v46
    v_add_f32 v45, v45, v47
    v_mov_b32 v46, v44
    v_mov_b32 v47, v45
    s_nop 1
    v_permlane32_swap_b32 v44, v46
    v_permlane32_swap_b32 v45, v47
    s_nop 1
    v_add_f32 v44, v44, v46
    v_add_f32 v45, v45, v47
    v_mul_f32 v44, 0x3ae38e39, v44
    v_mul_f32 v45, 0x3ae38e39, v45
    v_fma_f32 v45, -v44, v44, v45
    v_max_f32 v45, 0, v45
    v_cvt_pk_bf16_f32 v45, v45, v45
    v_lshlrev_b32 v45, 16, v45
    v_cvt_pk_bf16_f32 v44, v44, v44
    v_lshlrev_b32 v44, 16, v44
    v_add_f32 v45, 0x3727c5ac, v45
    v_cvt_pk_bf16_f32 v45, v45, v45
    v_lshlrev_b32 v45, 16, v45
    v_sqrt_f32 v45, v45
    s_nop 0
    v_cvt_pk_bf16_f32 v45, v45, v45
    v_lshlrev_b32 v45, 16, v45
    v_rcp_f32 v45, v45
    s_nop 0
    v_mul_f32 v44, -v44, v45
    v_lshlrev_b32 v52, 16, v8
    v_and_b32 v53, s28, v8
    v_pk_fma_f32 v[52:53], v[52:53], v[44:45], v[44:45] op_sel:[0,1,0] op_sel_hi:[1,1,0]
    v_cvt_pk_f16_f32 v8, v52, v53
    v_lshlrev_b32 v54, 16, v9
    v_and_b32 v55, s28, v9
    v_pk_fma_f32 v[54:55], v[54:55], v[44:45], v[44:45] op_sel:[0,1,0] op_sel_hi:[1,1,0]
    v_cvt_pk_f16_f32 v9, v54, v55
    v_lshlrev_b32 v52, 16, v10
    v_and_b32 v53, s28, v10
    v_pk_fma_f32 v[52:53], v[52:53], v[44:45], v[44:45] op_sel:[0,1,0] op_sel_hi:[1,1,0]
    v_cvt_pk_f16_f32 v10, v52, v53
    v_lshlrev_b32 v54, 16, v11
    v_and_b32 v55, s28, v11
    v_pk_fma_f32 v[54:55], v[54:55], v[44:45], v[44:45] op_sel:[0,1,0] op_sel_hi:[1,1,0]
    v_cvt_pk_f16_f32 v11, v54, v55
    buffer_store_dwordx4 v[8:11], v4, s[12:15], s26 offen
    s_add_u32 s26, s26, 4096
    v_lshlrev_b32 v52, 16, v12
    v_and_b32 v53, s28, v12
    v_pk_fma_f32 v[52:53], v[52:53], v[44:45], v[44:45] op_sel:[0,1,0] op_sel_hi:[1,1,0]
    v_cvt_pk_f16_f32 v12, v52, v53
    v_lshlrev_b32 v54, 16, v13
    v_and_b32 v55, s28, v13
    v_pk_fma_f32 v[54:55], v[54:55], v[44:45], v[44:45] op_sel:[0,1,0] op_sel_hi:[1,1,0]
    v_cvt_pk_f16_f32 v13, v54, v55
    v_lshlrev_b32 v52, 16, v14
    v_and_b32 v53, s28, v14
    v_pk_fma_f32 v[52:53], v[52:53], v[44:45], v[44:45] op_sel:[0,1,0] op_sel_hi:[1,1,0]
    v_cvt_pk_f16_f32 v14, v52, v53
    v_lshlrev_b32 v54, 16, v15
    v_and_b32 v55, s28, v15
    v_pk_fma_f32 v[54:55], v[54:55], v[44:45], v[44:45] op_sel:[0,1,0] op_sel_hi:[1,1,0]
    v_cvt_pk_f16_f32 v15, v54, v55
    buffer_store_dwordx4 v[12:15], v4, s[12:15], s26 offen
    s_add_u32 s26, s26, 4096
    v_lshlrev_b32 v52, 16, v16
    v_and_b32 v53, s28, v16
    v_pk_fma_f32 v[52:53], v[52:53], v[44:45], v[44:45] op_sel:[0,1,0] op_sel_hi:[1,1,0]
    v_cvt_pk_f16_f32 v16, v52, v53
    v_lshlrev_b32 v54, 16, v17
    v_and_b32 v55, s28, v17
    v_pk_fma_f32 v[54:55], v[54:55], v[44:45], v[44:45] op_sel:[0,1,0] op_sel_hi:[1,1,0]
    v_cvt_pk_f16_f32 v17, v54, v55
    v_lshlrev_b32 v52, 16, v18
    v_and_b32 v53, s28, v18
    v_pk_fma_f32 v[52:53], v[52:53], v[44:45], v[44:45] op_sel:[0,1,0] op_sel_hi:[1,1,0]
    v_cvt_pk_f16_f32 v18, v52, v53
    v_lshlrev_b32 v54, 16, v19
    v_and_b32 v55, s28, v19
    v_pk_fma_f32 v[54:55], v[54:55], v[44:45], v[44:45] op_sel:[0,1,0] op_sel_hi:[1,1,0]
    v_cvt_pk_f16_f32 v19, v54, v55
    buffer_store_dwordx4 v[16:19], v4, s[12:15], s26 offen
    s_add_u32 s26, s26, 4096
    v_lshlrev_b32 v52, 16, v20
    v_and_b32 v53, s28, v20
    v_pk_fma_f32 v[52:53], v[52:53], v[44:45], v[44:45] op_sel:[0,1,0] op_sel_hi:[1,1,0]
    v_cvt_pk_f16_f32 v20, v52, v53
    v_lshlrev_b32 v54, 16, v21
    v_and_b32 v55, s28, v21
    v_pk_fma_f32 v[54:55], v[54:55], v[44:45], v[44:45] op_sel:[0,1,0] op_sel_hi:[1,1,0]
    v_cvt_pk_f16_f32 v21, v54, v55
    v_lshlrev_b32 v52, 16, v22
    v_and_b32 v53, s28, v22
    v_pk_fma_f32 v[52:53], v[52:53], v[44:45], v[44:45] op_sel:[0,1,0] op_sel_hi:[1,1,0]
    v_cvt_pk_f16_f32 v22, v52, v53
    v_lshlrev_b32 v54, 16, v23
    v_and_b32 v55, s28, v23
    v_pk_fma_f32 v[54:55], v[54:55], v[44:45], v[44:45] op_sel:[0,1,0] op_sel_hi:[1,1,0]
    v_cvt_pk_f16_f32 v23, v54, v55
    buffer_store_dwordx4 v[20:23], v4, s[12:15], s26 offen
    s_add_u32 s26, s26, 4096
    v_lshlrev_b32 v52, 16, v24
    v_and_b32 v53, s28, v24
    v_pk_fma_f32 v[52:53], v[52:53], v[44:45], v[44:45] op_sel:[0,1,0] op_sel_hi:[1,1,0]
    v_cvt_pk_f16_f32 v24, v52, v53
    v_lshlrev_b32 v54, 16, v25
    v_and_b32 v55, s28, v25
    v_pk_fma_f32 v[54:55], v[54:55], v[44:45], v[44:45] op_sel:[0,1,0] op_sel_hi:[1,1,0]
    v_cvt_pk_f16_f32 v25, v54, v55
    v_lshlrev_b32 v52, 16, v26
    v_and_b32 v53, s28, v26
    v_pk_fma_f32 v[52:53], v[52:53], v[44:45], v[44:45] op_sel:[0,1,0] op_sel_hi:[1,1,0]
    v_cvt_pk_f16_f32 v26, v52, v53
    v_lshlrev_b32 v54, 16, v27
    v_and_b32 v55, s28, v27
    v_pk_fma_f32 v[54:55], v[54:55], v[44:45], v[44:45] op_sel:[0,1,0] op_sel_hi:[1,1,0]
    v_cvt_pk_f16_f32 v27, v54, v55
    s_mov_b32 exec_hi, 0
    buffer_store_dwordx4 v[24:27], v4, s[12:15], s26 offen
    s_add_u32 s26, s26, 4096
    s_branch L0_fin
L0_tile:
    s_mov_b32 s27, 3456
    s_mov_b32 s28, 4
    s_mov_b32 s37, 0
    s_mul_i32 s40, s2, 21846
    s_lshr_b32 s40, s40, 16
    s_mul_i32 s41, s40, 3
    s_sub_u32 s41, s2, s41
    s_add_u32 s42, s41, 1
    s_cmp_eq_u32 s41, 2
    s_cselect_b32 s42, 0, s42
    s_mul_i32 s42, s42, 1152
    s_mul_i32 s32, s40, 27648
    s_add_u32 s32, s32, s42
    v_add_u32 v16, 0, v1
    v_mul_u32_u24 v17, 911, v16
    v_lshrrev_b32 v17, 16, v17
    v_mul_u32_u24 v18, 72, v17
    v_sub_u32 v16, v16, v18
    v_lshrrev_b32 v18, 2, v17
    v_and_b32 v17, 3, v17
    v_mad_u32_u24 v17, v18, s28, v17
    v_mul_u32_u24 v17, s27, v17
    v_lshl_add_u32 v4, v16, 4, v17
    v_add_u32 v16, 64, v1
    v_mul_u32_u24 v17, 911, v16
    v_lshrrev_b32 v17, 16, v17
    v_mul_u32_u24 v18, 72, v17
    v_sub_u32 v16, v16, v18
    v_lshrrev_b32 v18, 2, v17
    v_and_b32 v17, 3, v17
    v_mad_u32_u24 v17, v18, s28, v17
    v_mul_u32_u24 v17, s27, v17
    v_lshl_add_u32 v5, v16, 4, v17
    v_add_u32 v16, 128, v1
    v_mul_u32_u24 v17, 911, v16
    v_lshrrev_b32 v17, 16, v17
    v_mul_u32_u24 v18, 72, v17
    v_sub_u32 v16, v16, v18
    v_lshrrev_b32 v18, 2, v17
    v_and_b32 v17, 3, v17
    v_mad_u32_u24 v17, v18, s28, v17
    v_mul_u32_u24 v17, s27, v17
    v_lshl_add_u32 v6, v16, 4, v17
    v_add_u32 v16, 192, v1
    v_mul_u32_u24 v17, 911, v16
    v_lshrrev_b32 v17, 16, v17
    v_mul_u32_u24 v18, 72, v17
    v_sub_u32 v16, v16, v18
    v_lshrrev_b32 v18, 2, v17
    v_and_b32 v17, 3, v17
    v_mad_u32_u24 v17, v18, s28, v17
    v_mul_u32_u24 v17, s27, v17
    v_lshl_add_u32 v7, v16, 4, v17
    v_add_u32 v16, 256, v1
    v_mul_u32_u24 v17, 911, v16
    v_lshrrev_b32 v17, 16, v17
    v_mul_u32_u24 v18, 72, v17
    v_sub_u32 v16, v16, v18
    v_lshrrev_b32 v18, 2, v17
    v_and_b32 v17, 3, v17
    v_mad_u32_u24 v17, v18, s28, v17
    v_mul_u32_u24 v17, s27, v17
    v_lshl_add_u32 v8, v16, 4, v17
    v_add_u32 v16, 320, v1
    v_mul_u32_u24 v17, 911, v16
    v_lshrrev_b32 v17, 16, v17
    v_mul_u32_u24 v18, 72, v17
    v_sub_u32 v16, v16, v18
    v_lshrrev_b32 v18, 2, v17
    v_and_b32 v17, 3, v17
    v_mad_u32_u24 v17, v18, s28, v17
    v_mul_u32_u24 v17, s27, v17
    v_lshl_add_u32 v9, v16, 4, v17
    v_add_u32 v16, 384, v1
    v_mul_u32_u24 v17, 911, v16
    v_lshrrev_b32 v17, 16, v17
    v_mul_u32_u24 v18, 72, v17
    v_sub_u32 v16, v16, v18
    v_lshrrev_b32 v18, 2, v17
    v_and_b32 v17, 3, v17
    v_mad_u32_u24 v17, v18, s28, v17
    v_mul_u32_u24 v17, s27, v17
    v_lshl_add_u32 v10, v16, 4, v17
    v_add_u32 v16, 448, v1
    v_mul_u32_u24 v17, 911, v16
    v_lshrrev_b32 v17, 16, v17
    v_mul_u32_u24 v18, 72, v17
    v_sub_u32 v16, v16, v18
    v_lshrrev_b32 v18, 2, v17
    v_and_b32 v17, 3, v17
    v_mad_u32_u24 v17, v18, s28, v17
    v_mul_u32_u24 v17, s27, v17
    v_lshl_add_u32 v11, v16, 4, v17
    v_add_u32 v16, 512, v1
    v_mul_u32_u24 v17, 911, v16
    v_lshrrev_b32 v17, 16, v17
    v_mul_u32_u24 v18, 72, v17
    v_sub_u32 v16, v16, v18
    v_lshrrev_b32 v18, 2, v17
    v_and_b32 v17, 3, v17
    v_mad_u32_u24 v17, v18, s28, v17
    v_mul_u32_u24 v17, s27, v17
    v_lshl_add_u32 v12, v16, 4, v17
    s_waitcnt lgkmcnt(0)
    s_cmp_ge_u32 s2, 216
    s_cbranch_scc1 L0_bar_end
    s_mov_b32 s8, s6
    s_and_b32 s9, s7, 0xffff
    s_mov_b32 s10, 0x1e6000
    s_mov_b32 s11, 0x00020000
    s_add_u32 m0, s37, 0
    s_nop 0
    buffer_load_dwordx4 v4, s[8:11], s32 offen nt lds
    s_add_u32 m0, s37, 1024
    s_nop 0
    buffer_load_dwordx4 v5, s[8:11], s32 offen nt lds
    s_add_u32 m0, s37, 2048
    s_nop 0
    buffer_load_dwordx4 v6, s[8:11], s32 offen nt lds
    s_add_u32 m0, s37, 3072
    s_nop 0
    buffer_load_dwordx4 v7, s[8:11], s32 offen nt lds
    s_add_u32 m0, s37, 4096
    s_nop 0
    buffer_load_dwordx4 v8, s[8:11], s32 offen nt lds
    s_add_u32 m0, s37, 5120
    s_nop 0
    buffer_load_dwordx4 v9, s[8:11], s32 offen nt lds
    s_add_u32 m0, s37, 6144
    s_nop 0
    buffer_load_dwordx4 v10, s[8:11], s32 offen nt lds
    s_add_u32 m0, s37, 7168
    s_nop 0
    buffer_load_dwordx4 v11, s[8:11], s32 offen nt lds
    s_add_u32 m0, s37, 8192
    s_nop 0
    buffer_load_dwordx4 v12, s[8:11], s32 offen nt lds
    s_barrier
    s_mov_b32 s12, s24
    s_and_b32 s13, s25, 0xffff
    s_mov_b32 s14, 0x10000000
    s_mov_b32 s15, 0x00020000
    s_mov_b32 s35, 258048
    s_mov_b32 s36, 1032192
    v_bfe_u32 v17, v1, 2, 2
    v_mul_u32_u24 v17, 1152, v17
    v_lshrrev_b32 v18, 4, v1
    v_mul_u32_u24 v19, 144, v18
    v_add3_u32 v17, v17, v19, s37
    v_and_b32 v19, 3, v1
    v_lshl_add_u32 v15, v19, 3, v17
    v_lshl_add_u32 v13, v19, 3, v17
    v_add_u32 v14, 32, v13
    v_mul_lo_u32 v18, v18, s35
    v_and_b32 v19, 15, v1
    v_lshl_add_u32 v16, v19, 4, v18
    s_lshr_b32 s33, s40, 2
    s_mul_i32 s33, s33, 14336
    s_and_b32 s34, s40, 3
    s_lshl_b32 s34, s34, 8
    s_add_u32 s33, s33, s34
    s_add_u32 s33, s33, 0xb00000
    s_lshl_b32 s42, s41, 7
    s_add_u32 s42, s42, 8192
    s_lshl_b32 s43, s41, 12
    s_mov_b32 s38, 0x00ff00ff
    s_cmp_eq_u32 s41, 2
    s_cselect_b32 s42, 13312, s42
    s_cselect_b32 s43, 9216, s43
    s_cselect_b32 s38, -1, s38
    s_mov_b32 s39, s38
    s_add_u32 s34, s33, s42
    s_add_u32 s33, s33, s43
    s_waitcnt vmcnt(0)
    ds_read_b64_tr_b16 v[24:25], v13 offset:0
    ds_read_b64_tr_b16 v[26:27], v13 offset:4608
    ds_read_b64_tr_b16 v[28:29], v14 offset:0
    ds_read_b64_tr_b16 v[30:31], v14 offset:4608
    ds_read_b64_tr_b16 v[32:33], v13 offset:64
    ds_read_b64_tr_b16 v[34:35], v13 offset:4672
    ds_read_b64_tr_b16 v[36:37], v14 offset:64
    ds_read_b64_tr_b16 v[38:39], v14 offset:4672
    ds_read_b64_tr_b16 v[40:41], v15 offset:128
    ds_read_b64_tr_b16 v[42:43], v15 offset:4736
    ds_read_b64_tr_b16 v[44:45], v13 offset:576
    ds_read_b64_tr_b16 v[46:47], v13 offset:5184
    ds_read_b64_tr_b16 v[48:49], v14 offset:576
    ds_read_b64_tr_b16 v[50:51], v14 offset:5184
    ds_read_b64_tr_b16 v[52:53], v13 offset:640
    ds_read_b64_tr_b16 v[54:55], v13 offset:5248
    ds_read_b64_tr_b16 v[56:57], v14 offset:640
    ds_read_b64_tr_b16 v[58:59], v14 offset:5248
    ds_read_b64_tr_b16 v[60:61], v15 offset:704
    ds_read_b64_tr_b16 v[62:63], v15 offset:5312
    s_waitcnt lgkmcnt(15)
    buffer_store_dwordx4 v[24:27], v16, s[12:15], s33 offen offset:0
    s_waitcnt lgkmcnt(15)
    buffer_store_dwordx4 v[28:31], v16, s[12:15], s33 offen offset:1024
    s_waitcnt lgkmcnt(14)
    buffer_store_dwordx4 v[32:35], v16, s[12:15], s33 offen offset:2048
    s_waitcnt lgkmcnt(12)
    buffer_store_dwordx4 v[36:39], v16, s[12:15], s33 offen offset:3072
    s_waitcnt lgkmcnt(10)
    s_mov_b64 exec, s[38:39]
    buffer_store_dwordx4 v[40:43], v16, s[12:15], s34 offen
    s_mov_b64 exec, -1
    s_add_u32 s33, s33, s36
    s_add_u32 s34, s34, s36
    s_waitcnt lgkmcnt(8)
    buffer_store_dwordx4 v[44:47], v16, s[12:15], s33 offen offset:0
    s_waitcnt lgkmcnt(6)
    buffer_store_dwordx4 v[48:51], v16, s[12:15], s33 offen offset:1024
    s_waitcnt lgkmcnt(4)
    buffer_store_dwordx4 v[52:55], v16, s[12:15], s33 offen offset:2048
    s_waitcnt lgkmcnt(2)
    buffer_store_dwordx4 v[56:59], v16, s[12:15], s33 offen offset:3072
    s_waitcnt lgkmcnt(0)
    s_mov_b64 exec, s[38:39]
    buffer_store_dwordx4 v[60:63], v16, s[12:15], s34 offen
    s_mov_b64 exec, -1
L0_fin:
L0_end:
    s_endpgm
.text
.globl k1_kernel
.p2align 8
.type k1_kernel,@function
k1_kernel:
    s_load_dwordx2 s[24:25], s[0:1], 96
    s_cmp_ge_u32 s2, 256
    s_cbranch_scc1 L1_end
    v_lshrrev_b32 v2, 6, v0
    v_and_b32 v1, 63, v0
    s_bfe_u32 s26, s2, 0x20001
    s_lshl_b32 s26, s26, 3
    s_lshr_b32 s27, s2, 5
    s_add_u32 s28, s26, s27
    s_and_b32 s26, s2, 1
    s_lshl_b32 s26, s26, 2
    s_bfe_u32 s27, s2, 0x20003
    s_add_u32 s29, s26, s27
    v_readfirstlane_b32 s30, v2
    v_lshlrev_b32 v2, 4, v1
    s_mov_b32 s33, 115808
    s_cmp_ge_u32 s30, 4
    s_cbranch_scc1 L1_help
    v_add_u32 v128, 0, v2
    v_add_u32 v129, 4096, v2
    v_add_u32 v130, 8192, v2
    v_add_u32 v131, 12288, v2
    s_mul_i32 s34, s29, 258048
    s_add_u32 s34, s34, 0xb00000
    s_mov_b32 s35, 0
    s_mov_b32 s40, 0x00ff00ff
    s_mov_b32 s41, 0x00ff00ff
    v_mov_b32 v132, v2
    v_lshrrev_b32 v4, 4, v1
    s_cmp_eq_u32 s30, 0
    s_cbranch_scc1 L1_w0
    s_cmp_eq_u32 s30, 1
    s_cbranch_scc1 L1_w1
    s_cmp_eq_u32 s30, 2
    s_cbranch_scc1 L1_w2
    s_branch L1_w3
L1_w0:
    s_waitcnt lgkmcnt(0)
    s_add_u32 s26, s24, s34
    s_addc_u32 s27, s25, 0
    s_mov_b32 s16, s26
    s_and_b32 s17, s27, 0xffff
    s_mov_b32 s18, 0x3f000
    s_mov_b32 s19, 0x00020000
    buffer_load_dwordx4 a[0:3], v128, s[16:19], s35 offen offset:0
    buffer_load_dwordx4 a[4:7], v128, s[16:19], s35 offen offset:1024
    buffer_load_dwordx4 a[8:11], v128, s[16:19], s35 offen offset:2048
    s_add_u32 s35, s35, 14336
    v_mov_b32 v8, 0
    v_mov_b32 v9, 0
    v_mov_b32 v10, 0
    v_mov_b32 v11, 0
    v_mov_b32 v12, 0
    v_mov_b32 v13, 0
    v_mov_b32 v14, 0
    v_mov_b32 v15, 0
    v_mov_b32 v16, 0
    v_mov_b32 v17, 0
    v_mov_b32 v18, 0
    v_mov_b32 v19, 0
    v_mov_b32 v20, 0
    v_mov_b32 v21, 0
    v_mov_b32 v22, 0
    v_mov_b32 v23, 0
    v_mov_b32 v24, 0
    v_mov_b32 v25, 0
    v_mov_b32 v26, 0
    v_mov_b32 v27, 0
    v_mov_b32 v28, 0
    v_mov_b32 v29, 0
    v_mov_b32 v30, 0
    v_mov_b32 v31, 0
    v_mov_b32 v32, 0
    v_mov_b32 v33, 0
    v_mov_b32 v34, 0
    v_mov_b32 v35, 0
    v_mov_b32 v36, 0
    v_mov_b32 v37, 0
    v_mov_b32 v38, 0
    v_mov_b32 v39, 0
    v_mov_b32 v40, 0
    v_mov_b32 v41, 0
    v_mov_b32 v42, 0
    v_mov_b32 v43, 0
    v_mov_b32 v44, 0
    v_mov_b32 v45, 0
    v_mov_b32 v46, 0
    v_mov_b32 v47, 0
    v_mov_b32 v48, 0
    v_mov_b32 v49, 0
    v_mov_b32 v50, 0
    v_mov_b32 v51, 0
    v_mov_b32 v52, 0
    v_mov_b32 v53, 0
    v_mov_b32 v54, 0
    v_mov_b32 v55, 0
    v_mov_b32 v56, 0
    v_mov_b32 v57, 0
    v_mov_b32 v58, 0
    v_mov_b32 v59, 0
    v_mov_b32 v60, 0
    v_mov_b32 v61, 0
    v_mov_b32 v62, 0
    v_mov_b32 v63, 0
    v_mov_b32 v64, 0
    v_mov_b32 v65, 0
    v_mov_b32 v66, 0
    v_mov_b32 v67, 0
    s_barrier
    buffer_load_dwordx4 a[16:19], v128, s[16:19], s35 offen offset:0
    buffer_load_dwordx4 a[20:23], v128, s[16:19], s35 offen offset:1024
    buffer_load_dwordx4 a[24:27], v128, s[16:19], s35 offen offset:2048
    s_add_u32 s35, s35, 14336
    buffer_load_dwordx4 a[32:35], v128, s[16:19], s35 offen offset:0
    buffer_load_dwordx4 a[36:39], v128, s[16:19], s35 offen offset:1024
    buffer_load_dwordx4 a[40:43], v128, s[16:19], s35 offen offset:2048
    s_add_u32 s35, s35, 14336
    buffer_load_dwordx4 a[48:51], v128, s[16:19], s35 offen offset:0
    buffer_load_dwordx4 a[52:55], v128, s[16:19], s35 offen offset:1024
    buffer_load_dwordx4 a[56:59], v128, s[16:19], s35 offen offset:2048
    s_add_u32 s35, s35, 14336
    s_mov_b32 s12, s24
    s_and_b32 s13, s25, 0xffff
    s_mov_b32 s14, 0x10000000
    s_mov_b32 s15, 0x00020000
    s_setprio 2
    v_add_u32 v133, 61440, v132
    s_barrier
    ds_read_b128 v[80:83], v132 offset:0
    ds_read_b128 v[84:87], v132 offset:1024
    ds_read_b128 v[88:91], v132 offset:2048
    ds_read_b128 v[92:95], v132 offset:3072
    ds_read_b128 v[96:99], v132 offset:4096
    s_waitcnt vmcnt(9) lgkmcnt(0)
    v_mfma_f32_16x16x32_bf16 v[8:11], a[0:3], v[80:83], v[8:11]
    ds_read_b128 v[100:103], v132 offset:5120
    v_mfma_f32_16x16x32_bf16 v[12:15], a[0:3], v[84:87], v[12:15]
    v_mfma_f32_16x16x32_bf16 v[16:19], a[0:3], v[88:91], v[16:19]
    ds_read_b128 v[104:107], v132 offset:6144
    v_mfma_f32_16x16x32_bf16 v[20:23], a[0:3], v[92:95], v[20:23]
    v_mfma_f32_16x16x32_bf16 v[24:27], a[0:3], v[96:99], v[24:27]
    ds_read_b128 v[108:111], v132 offset:7168
    buffer_load_dwordx4 a[0:3], v128, s[16:19], s35 offen offset:0
    v_mfma_f32_16x16x32_bf16 v[28:31], a[4:7], v[80:83], v[28:31]
    v_mfma_f32_16x16x32_bf16 v[32:35], a[4:7], v[84:87], v[32:35]
    ds_read_b128 v[112:115], v132 offset:8192
    v_mfma_f32_16x16x32_bf16 v[36:39], a[4:7], v[88:91], v[36:39]
    v_mfma_f32_16x16x32_bf16 v[40:43], a[4:7], v[92:95], v[40:43]
    ds_read_b128 v[116:119], v132 offset:9216
    v_mfma_f32_16x16x32_bf16 v[44:47], a[4:7], v[96:99], v[44:47]
    buffer_load_dwordx4 a[4:7], v128, s[16:19], s35 offen offset:1024
    v_mfma_f32_16x16x32_bf16 v[48:51], a[8:11], v[80:83], v[48:51]
    v_mfma_f32_16x16x32_bf16 v[52:55], a[8:11], v[84:87], v[52:55]
    v_mfma_f32_16x16x32_bf16 v[56:59], a[8:11], v[88:91], v[56:59]
    v_mfma_f32_16x16x32_bf16 v[60:63], a[8:11], v[92:95], v[60:63]
    v_mfma_f32_16x16x32_bf16 v[64:67], a[8:11], v[96:99], v[64:67]
    buffer_load_dwordx4 a[8:11], v128, s[16:19], s35 offen offset:2048
    s_add_u32 s35, s35, 14336
    s_waitcnt vmcnt(9) lgkmcnt(0)
    v_mfma_f32_16x16x32_bf16 v[8:11], a[16:19], v[100:103], v[8:11]
    ds_read_b128 v[80:83], v132 offset:10240
    v_mfma_f32_16x16x32_bf16 v[12:15], a[16:19], v[104:107], v[12:15]
    v_mfma_f32_16x16x32_bf16 v[16:19], a[16:19], v[108:111], v[16:19]
    ds_read_b128 v[84:87], v132 offset:11264
    v_mfma_f32_16x16x32_bf16 v[20:23], a[16:19], v[112:115], v[20:23]
    v_mfma_f32_16x16x32_bf16 v[24:27], a[16:19], v[116:119], v[24:27]
    ds_read_b128 v[88:91], v132 offset:12288
    buffer_load_dwordx4 a[16:19], v128, s[16:19], s35 offen offset:0
    v_mfma_f32_16x16x32_bf16 v[28:31], a[20:23], v[100:103], v[28:31]
    v_mfma_f32_16x16x32_bf16 v[32:35], a[20:23], v[104:107], v[32:35]
    ds_read_b128 v[92:95], v132 offset:13312
    v_mfma_f32_16x16x32_bf16 v[36:39], a[20:23], v[108:111], v[36:39]
    v_mfma_f32_16x16x32_bf16 v[40:43], a[20:23], v[112:115], v[40:43]
    ds_read_b128 v[96:99], v132 offset:14336
    v_mfma_f32_16x16x32_bf16 v[44:47], a[20:23], v[116:119], v[44:47]
    buffer_load_dwordx4 a[20:23], v128, s[16:19], s35 offen offset:1024
    v_mfma_f32_16x16x32_bf16 v[48:51], a[24:27], v[100:103], v[48:51]
    v_mfma_f32_16x16x32_bf16 v[52:55], a[24:27], v[104:107], v[52:55]
    v_mfma_f32_16x16x32_bf16 v[56:59], a[24:27], v[108:111], v[56:59]
    v_mfma_f32_16x16x32_bf16 v[60:63], a[24:27], v[112:115], v[60:63]
    v_mfma_f32_16x16x32_bf16 v[64:67], a[24:27], v[116:119], v[64:67]
    buffer_load_dwordx4 a[24:27], v128, s[16:19], s35 offen offset:2048
    s_add_u32 s35, s35, 14336
    s_waitcnt vmcnt(9) lgkmcnt(0)
    v_mfma_f32_16x16x32_bf16 v[8:11], a[32:35], v[80:83], v[8:11]
    ds_read_b128 v[100:103], v132 offset:15360
    v_mfma_f32_16x16x32_bf16 v[12:15], a[32:35], v[84:87], v[12:15]
    v_mfma_f32_16x16x32_bf16 v[16:19], a[32:35], v[88:91], v[16:19]
    ds_read_b128 v[104:107], v132 offset:16384
    v_mfma_f32_16x16x32_bf16 v[20:23], a[32:35], v[92:95], v[20:23]
    v_mfma_f32_16x16x32_bf16 v[24:27], a[32:35], v[96:99], v[24:27]
    ds_read_b128 v[108:111], v132 offset:17408
    buffer_load_dwordx4 a[32:35], v128, s[16:19], s35 offen offset:0
    v_mfma_f32_16x16x32_bf16 v[28:31], a[36:39], v[80:83], v[28:31]
    v_mfma_f32_16x16x32_bf16 v[32:35], a[36:39], v[84:87], v[32:35]
    ds_read_b128 v[112:115], v132 offset:18432
    v_mfma_f32_16x16x32_bf16 v[36:39], a[36:39], v[88:91], v[36:39]
    v_mfma_f32_16x16x32_bf16 v[40:43], a[36:39], v[92:95], v[40:43]
    ds_read_b128 v[116:119], v132 offset:19456
    v_mfma_f32_16x16x32_bf16 v[44:47], a[36:39], v[96:99], v[44:47]
    buffer_load_dwordx4 a[36:39], v128, s[16:19], s35 offen offset:1024
    v_mfma_f32_16x16x32_bf16 v[48:51], a[40:43], v[80:83], v[48:51]
    v_mfma_f32_16x16x32_bf16 v[52:55], a[40:43], v[84:87], v[52:55]
    v_mfma_f32_16x16x32_bf16 v[56:59], a[40:43], v[88:91], v[56:59]
    v_mfma_f32_16x16x32_bf16 v[60:63], a[40:43], v[92:95], v[60:63]
    v_mfma_f32_16x16x32_bf16 v[64:67], a[40:43], v[96:99], v[64:67]
    buffer_load_dwordx4 a[40:43], v128, s[16:19], s35 offen offset:2048
    s_add_u32 s35, s35, 14336
    s_waitcnt vmcnt(9) lgkmcnt(0)
    s_barrier
    v_mfma_f32_16x16x32_bf16 v[8:11], a[48:51], v[100:103], v[8:11]
    ds_read_b128 v[80:83], v132 offset:20480
    v_mfma_f32_16x16x32_bf16 v[12:15], a[48:51], v[104:107], v[12:15]
    v_mfma_f32_16x16x32_bf16 v[16:19], a[48:51], v[108:111], v[16:19]
    ds_read_b128 v[84:87], v132 offset:21504
    v_mfma_f32_16x16x32_bf16 v[20:23], a[48:51], v[112:115], v[20:23]
    v_mfma_f32_16x16x32_bf16 v[24:27], a[48:51], v[116:119], v[24:27]
    ds_read_b128 v[88:91], v132 offset:22528
    buffer_load_dwordx4 a[48:51], v128, s[16:19], s35 offen offset:0
    v_mfma_f32_16x16x32_bf16 v[28:31], a[52:55], v[100:103], v[28:31]
    v_mfma_f32_16x16x32_bf16 v[32:35], a[52:55], v[104:107], v[32:35]
    ds_read_b128 v[92:95], v132 offset:23552
    v_mfma_f32_16x16x32_bf16 v[36:39], a[52:55], v[108:111], v[36:39]
    v_mfma_f32_16x16x32_bf16 v[40:43], a[52:55], v[112:115], v[40:43]
    ds_read_b128 v[96:99], v132 offset:24576
    v_mfma_f32_16x16x32_bf16 v[44:47], a[52:55], v[116:119], v[44:47]
    buffer_load_dwordx4 a[52:55], v128, s[16:19], s35 offen offset:1024
    v_mfma_f32_16x16x32_bf16 v[48:51], a[56:59], v[100:103], v[48:51]
    v_mfma_f32_16x16x32_bf16 v[52:55], a[56:59], v[104:107], v[52:55]
    v_mfma_f32_16x16x32_bf16 v[56:59], a[56:59], v[108:111], v[56:59]
    v_mfma_f32_16x16x32_bf16 v[60:63], a[56:59], v[112:115], v[60:63]
    v_mfma_f32_16x16x32_bf16 v[64:67], a[56:59], v[116:119], v[64:67]
    buffer_load_dwordx4 a[56:59], v128, s[16:19], s35 offen offset:2048
    s_add_u32 s35, s35, 14336
    s_waitcnt vmcnt(9) lgkmcnt(0)
    v_mfma_f32_16x16x32_bf16 v[8:11], a[0:3], v[80:83], v[8:11]
    ds_read_b128 v[100:103], v132 offset:25600
    v_mfma_f32_16x16x32_bf16 v[12:15], a[0:3], v[84:87], v[12:15]
    v_mfma_f32_16x16x32_bf16 v[16:19], a[0:3], v[88:91], v[16:19]
    ds_read_b128 v[104:107], v132 offset:26624
    v_mfma_f32_16x16x32_bf16 v[20:23], a[0:3], v[92:95], v[20:23]
    v_mfma_f32_16x16x32_bf16 v[24:27], a[0:3], v[96:99], v[24:27]
    ds_read_b128 v[108:111], v132 offset:27648
    buffer_load_dwordx4 a[0:3], v128, s[16:19], s35 offen offset:0
    v_mfma_f32_16x16x32_bf16 v[28:31], a[4:7], v[80:83], v[28:31]
    v_mfma_f32_16x16x32_bf16 v[32:35], a[4:7], v[84:87], v[32:35]
    ds_read_b128 v[112:115], v132 offset:28672
    v_mfma_f32_16x16x32_bf16 v[36:39], a[4:7], v[88:91], v[36:39]
    v_mfma_f32_16x16x32_bf16 v[40:43], a[4:7], v[92:95], v[40:43]
    ds_read_b128 v[116:119], v132 offset:29696
    v_mfma_f32_16x16x32_bf16 v[44:47], a[4:7], v[96:99], v[44:47]
    buffer_load_dwordx4 a[4:7], v128, s[16:19], s35 offen offset:1024
    v_mfma_f32_16x16x32_bf16 v[48:51], a[8:11], v[80:83], v[48:51]
    v_mfma_f32_16x16x32_bf16 v[52:55], a[8:11], v[84:87], v[52:55]
    v_mfma_f32_16x16x32_bf16 v[56:59], a[8:11], v[88:91], v[56:59]
    v_mfma_f32_16x16x32_bf16 v[60:63], a[8:11], v[92:95], v[60:63]
    v_mfma_f32_16x16x32_bf16 v[64:67], a[8:11], v[96:99], v[64:67]
    buffer_load_dwordx4 a[8:11], v128, s[16:19], s35 offen offset:2048
    s_add_u32 s35, s35, 14336
    s_waitcnt vmcnt(9) lgkmcnt(0)
    v_mfma_f32_16x16x32_bf16 v[8:11], a[16:19], v[100:103], v[8:11]
    ds_read_b128 v[80:83], v132 offset:30720
    v_mfma_f32_16x16x32_bf16 v[12:15], a[16:19], v[104:107], v[12:15]
    v_mfma_f32_16x16x32_bf16 v[16:19], a[16:19], v[108:111], v[16:19]
    ds_read_b128 v[84:87], v132 offset:31744
    v_mfma_f32_16x16x32_bf16 v[20:23], a[16:19], v[112:115], v[20:23]
    v_mfma_f32_16x16x32_bf16 v[24:27], a[16:19], v[116:119], v[24:27]
    ds_read_b128 v[88:91], v132 offset:32768
    buffer_load_dwordx4 a[16:19], v128, s[16:19], s35 offen offset:0
    v_mfma_f32_16x16x32_bf16 v[28:31], a[20:23], v[100:103], v[28:31]
    v_mfma_f32_16x16x32_bf16 v[32:35], a[20:23], v[104:107], v[32:35]
    ds_read_b128 v[92:95], v132 offset:33792
    v_mfma_f32_16x16x32_bf16 v[36:39], a[20:23], v[108:111], v[36:39]
    v_mfma_f32_16x16x32_bf16 v[40:43], a[20:23], v[112:115], v[40:43]
    ds_read_b128 v[96:99], v132 offset:34816
    v_mfma_f32_16x16x32_bf16 v[44:47], a[20:23], v[116:119], v[44:47]
    buffer_load_dwordx4 a[20:23], v128, s[16:19], s35 offen offset:1024
    v_mfma_f32_16x16x32_bf16 v[48:51], a[24:27], v[100:103], v[48:51]
    v_mfma_f32_16x16x32_bf16 v[52:55], a[24:27], v[104:107], v[52:55]
    v_mfma_f32_16x16x32_bf16 v[56:59], a[24:27], v[108:111], v[56:59]
    v_mfma_f32_16x16x32_bf16 v[60:63], a[24:27], v[112:115], v[60:63]
    v_mfma_f32_16x16x32_bf16 v[64:67], a[24:27], v[116:119], v[64:67]
    buffer_load_dwordx4 a[24:27], v128, s[16:19], s35 offen offset:2048
    s_add_u32 s35, s35, 14336
    s_waitcnt vmcnt(9) lgkmcnt(0)
    v_mfma_f32_16x16x32_bf16 v[8:11], a[32:35], v[80:83], v[8:11]
    ds_read_b128 v[100:103], v132 offset:35840
    v_mfma_f32_16x16x32_bf16 v[12:15], a[32:35], v[84:87], v[12:15]
    v_mfma_f32_16x16x32_bf16 v[16:19], a[32:35], v[88:91], v[16:19]
    ds_read_b128 v[104:107], v132 offset:36864
    v_mfma_f32_16x16x32_bf16 v[20:23], a[32:35], v[92:95], v[20:23]
    v_mfma_f32_16x16x32_bf16 v[24:27], a[32:35], v[96:99], v[24:27]
    ds_read_b128 v[108:111], v132 offset:37888
    buffer_load_dwordx4 a[32:35], v128, s[16:19], s35 offen offset:0
    v_mfma_f32_16x16x32_bf16 v[28:31], a[36:39], v[80:83], v[28:31]
    v_mfma_f32_16x16x32_bf16 v[32:35], a[36:39], v[84:87], v[32:35]
    ds_read_b128 v[112:115], v132 offset:38912
    v_mfma_f32_16x16x32_bf16 v[36:39], a[36:39], v[88:91], v[36:39]
    v_mfma_f32_16x16x32_bf16 v[40:43], a[36:39], v[92:95], v[40:43]
    ds_read_b128 v[116:119], v132 offset:39936
    v_mfma_f32_16x16x32_bf16 v[44:47], a[36:39], v[96:99], v[44:47]
    buffer_load_dwordx4 a[36:39], v128, s[16:19], s35 offen offset:1024
    v_mfma_f32_16x16x32_bf16 v[48:51], a[40:43], v[80:83], v[48:51]
    v_mfma_f32_16x16x32_bf16 v[52:55], a[40:43], v[84:87], v[52:55]
    v_mfma_f32_16x16x32_bf16 v[56:59], a[40:43], v[88:91], v[56:59]
    v_mfma_f32_16x16x32_bf16 v[60:63], a[40:43], v[92:95], v[60:63]
    v_mfma_f32_16x16x32_bf16 v[64:67], a[40:43], v[96:99], v[64:67]
    buffer_load_dwordx4 a[40:43], v128, s[16:19], s35 offen offset:2048
    s_add_u32 s35, s35, 14336
    s_waitcnt vmcnt(9) lgkmcnt(0)
    s_barrier
    v_mfma_f32_16x16x32_bf16 v[8:11], a[48:51], v[100:103], v[8:11]
    ds_read_b128 v[80:83], v132 offset:40960
    v_mfma_f32_16x16x32_bf16 v[12:15], a[48:51], v[104:107], v[12:15]
    v_mfma_f32_16x16x32_bf16 v[16:19], a[48:51], v[108:111], v[16:19]
    ds_read_b128 v[84:87], v132 offset:41984
    v_mfma_f32_16x16x32_bf16 v[20:23], a[48:51], v[112:115], v[20:23]
    v_mfma_f32_16x16x32_bf16 v[24:27], a[48:51], v[116:119], v[24:27]
    ds_read_b128 v[88:91], v132 offset:43008
    buffer_load_dwordx4 a[48:51], v128, s[16:19], s35 offen offset:0
    v_mfma_f32_16x16x32_bf16 v[28:31], a[52:55], v[100:103], v[28:31]
    v_mfma_f32_16x16x32_bf16 v[32:35], a[52:55], v[104:107], v[32:35]
    ds_read_b128 v[92:95], v132 offset:44032
    v_mfma_f32_16x16x32_bf16 v[36:39], a[52:55], v[108:111], v[36:39]
    v_mfma_f32_16x16x32_bf16 v[40:43], a[52:55], v[112:115], v[40:43]
    ds_read_b128 v[96:99], v132 offset:45056
    v_mfma_f32_16x16x32_bf16 v[44:47], a[52:55], v[116:119], v[44:47]
    buffer_load_dwordx4 a[52:55], v128, s[16:19], s35 offen offset:1024
    v_mfma_f32_16x16x32_bf16 v[48:51], a[56:59], v[100:103], v[48:51]
    v_mfma_f32_16x16x32_bf16 v[52:55], a[56:59], v[104:107], v[52:55]
    v_mfma_f32_16x16x32_bf16 v[56:59], a[56:59], v[108:111], v[56:59]
    v_mfma_f32_16x16x32_bf16 v[60:63], a[56:59], v[112:115], v[60:63]
    v_mfma_f32_16x16x32_bf16 v[64:67], a[56:59], v[116:119], v[64:67]
    buffer_load_dwordx4 a[56:59], v128, s[16:19], s35 offen offset:2048
    s_add_u32 s35, s35, 14336
    s_waitcnt vmcnt(9) lgkmcnt(0)
    v_mfma_f32_16x16x32_bf16 v[8:11], a[0:3], v[80:83], v[8:11]
    ds_read_b128 v[100:103], v132 offset:46080
    v_mfma_f32_16x16x32_bf16 v[12:15], a[0:3], v[84:87], v[12:15]
    v_mfma_f32_16x16x32_bf16 v[16:19], a[0:3], v[88:91], v[16:19]
    ds_read_b128 v[104:107], v132 offset:47104
    v_mfma_f32_16x16x32_bf16 v[20:23], a[0:3], v[92:95], v[20:23]
    v_mfma_f32_16x16x32_bf16 v[24:27], a[0:3], v[96:99], v[24:27]
    ds_read_b128 v[108:111], v132 offset:48128
    buffer_load_dwordx4 a[0:3], v128, s[16:19], s35 offen offset:0
    v_mfma_f32_16x16x32_bf16 v[28:31], a[4:7], v[80:83], v[28:31]
    v_mfma_f32_16x16x32_bf16 v[32:35], a[4:7], v[84:87], v[32:35]
    ds_read_b128 v[112:115], v132 offset:49152
    v_mfma_f32_16x16x32_bf16 v[36:39], a[4:7], v[88:91], v[36:39]
    v_mfma_f32_16x16x32_bf16 v[40:43], a[4:7], v[92:95], v[40:43]
    ds_read_b128 v[116:119], v132 offset:50176
    v_mfma_f32_16x16x32_bf16 v[44:47], a[4:7], v[96:99], v[44:47]
    buffer_load_dwordx4 a[4:7], v128, s[16:19], s35 offen offset:1024
    v_mfma_f32_16x16x32_bf16 v[48:51], a[8:11], v[80:83], v[48:51]
    v_mfma_f32_16x16x32_bf16 v[52:55], a[8:11], v[84:87], v[52:55]
    v_mfma_f32_16x16x32_bf16 v[56:59], a[8:11], v[88:91], v[56:59]
    v_mfma_f32_16x16x32_bf16 v[60:63], a[8:11], v[92:95], v[60:63]
    v_mfma_f32_16x16x32_bf16 v[64:67], a[8:11], v[96:99], v[64:67]
    buffer_load_dwordx4 a[8:11], v128, s[16:19], s35 offen offset:2048
    s_add_u32 s35, s35, 14336
    s_waitcnt vmcnt(9) lgkmcnt(0)
    v_mfma_f32_16x16x32_bf16 v[8:11], a[16:19], v[100:103], v[8:11]
    ds_read_b128 v[80:83], v132 offset:51200
    v_mfma_f32_16x16x32_bf16 v[12:15], a[16:19], v[104:107], v[12:15]
    v_mfma_f32_16x16x32_bf16 v[16:19], a[16:19], v[108:111], v[16:19]
    ds_read_b128 v[84:87], v132 offset:52224
    v_mfma_f32_16x16x32_bf16 v[20:23], a[16:19], v[112:115], v[20:23]
    v_mfma_f32_16x16x32_bf16 v[24:27], a[16:19], v[116:119], v[24:27]
    ds_read_b128 v[88:91], v132 offset:53248
    buffer_load_dwordx4 a[16:19], v128, s[16:19], s35 offen offset:0
    v_mfma_f32_16x16x32_bf16 v[28:31], a[20:23], v[100:103], v[28:31]
    v_mfma_f32_16x16x32_bf16 v[32:35], a[20:23], v[104:107], v[32:35]
    ds_read_b128 v[92:95], v132 offset:54272
    v_mfma_f32_16x16x32_bf16 v[36:39], a[20:23], v[108:111], v[36:39]
    v_mfma_f32_16x16x32_bf16 v[40:43], a[20:23], v[112:115], v[40:43]
    ds_read_b128 v[96:99], v132 offset:55296
    v_mfma_f32_16x16x32_bf16 v[44:47], a[20:23], v[116:119], v[44:47]
    buffer_load_dwordx4 a[20:23], v128, s[16:19], s35 offen offset:1024
    v_mfma_f32_16x16x32_bf16 v[48:51], a[24:27], v[100:103], v[48:51]
    v_mfma_f32_16x16x32_bf16 v[52:55], a[24:27], v[104:107], v[52:55]
    v_mfma_f32_16x16x32_bf16 v[56:59], a[24:27], v[108:111], v[56:59]
    v_mfma_f32_16x16x32_bf16 v[60:63], a[24:27], v[112:115], v[60:63]
    v_mfma_f32_16x16x32_bf16 v[64:67], a[24:27], v[116:119], v[64:67]
    buffer_load_dwordx4 a[24:27], v128, s[16:19], s35 offen offset:2048
    s_add_u32 s35, s35, 14336
    s_waitcnt vmcnt(9) lgkmcnt(0)
    v_mfma_f32_16x16x32_bf16 v[8:11], a[32:35], v[80:83], v[8:11]
    ds_read_b128 v[100:103], v132 offset:56320
    v_mfma_f32_16x16x32_bf16 v[12:15], a[32:35], v[84:87], v[12:15]
    v_mfma_f32_16x16x32_bf16 v[16:19], a[32:35], v[88:91], v[16:19]
    ds_read_b128 v[104:107], v132 offset:57344
    v_mfma_f32_16x16x32_bf16 v[20:23], a[32:35], v[92:95], v[20:23]
    v_mfma_f32_16x16x32_bf16 v[24:27], a[32:35], v[96:99], v[24:27]
    ds_read_b128 v[108:111], v132 offset:58368
    buffer_load_dwordx4 a[32:35], v128, s[16:19], s35 offen offset:0
    v_mfma_f32_16x16x32_bf16 v[28:31], a[36:39], v[80:83], v[28:31]
    v_mfma_f32_16x16x32_bf16 v[32:35], a[36:39], v[84:87], v[32:35]
    ds_read_b128 v[112:115], v132 offset:59392
    v_mfma_f32_16x16x32_bf16 v[36:39], a[36:39], v[88:91], v[36:39]
    v_mfma_f32_16x16x32_bf16 v[40:43], a[36:39], v[92:95], v[40:43]
    ds_read_b128 v[116:119], v132 offset:60416
    v_mfma_f32_16x16x32_bf16 v[44:47], a[36:39], v[96:99], v[44:47]
    buffer_load_dwordx4 a[36:39], v128, s[16:19], s35 offen offset:1024
    v_mfma_f32_16x16x32_bf16 v[48:51], a[40:43], v[80:83], v[48:51]
    v_mfma_f32_16x16x32_bf16 v[52:55], a[40:43], v[84:87], v[52:55]
    v_mfma_f32_16x16x32_bf16 v[56:59], a[40:43], v[88:91], v[56:59]
    v_mfma_f32_16x16x32_bf16 v[60:63], a[40:43], v[92:95], v[60:63]
    v_mfma_f32_16x16x32_bf16 v[64:67], a[40:43], v[96:99], v[64:67]
    buffer_load_dwordx4 a[40:43], v128, s[16:19], s35 offen offset:2048
    s_add_u32 s35, s35, 14336
    s_waitcnt vmcnt(9) lgkmcnt(0)
    s_barrier
    v_mfma_f32_16x16x32_bf16 v[8:11], a[48:51], v[100:103], v[8:11]
    ds_read_b128 v[80:83], v133 offset:0
    v_mfma_f32_16x16x32_bf16 v[12:15], a[48:51], v[104:107], v[12:15]
    v_mfma_f32_16x16x32_bf16 v[16:19], a[48:51], v[108:111], v[16:19]
    ds_read_b128 v[84:87], v133 offset:1024
    v_mfma_f32_16x16x32_bf16 v[20:23], a[48:51], v[112:115], v[20:23]
    v_mfma_f32_16x16x32_bf16 v[24:27], a[48:51], v[116:119], v[24:27]
    ds_read_b128 v[88:91], v133 offset:2048
    buffer_load_dwordx4 a[48:51], v128, s[16:19], s35 offen offset:0
    v_mfma_f32_16x16x32_bf16 v[28:31], a[52:55], v[100:103], v[28:31]
    v_mfma_f32_16x16x32_bf16 v[32:35], a[52:55], v[104:107], v[32:35]
    ds_read_b128 v[92:95], v133 offset:3072
    v_mfma_f32_16x16x32_bf16 v[36:39], a[52:55], v[108:111], v[36:39]
    v_mfma_f32_16x16x32_bf16 v[40:43], a[52:55], v[112:115], v[40:43]
    ds_read_b128 v[96:99], v133 offset:4096
    v_mfma_f32_16x16x32_bf16 v[44:47], a[52:55], v[116:119], v[44:47]
    buffer_load_dwordx4 a[52:55], v128, s[16:19], s35 offen offset:1024
    v_mfma_f32_16x16x32_bf16 v[48:51], a[56:59], v[100:103], v[48:51]
    v_mfma_f32_16x16x32_bf16 v[52:55], a[56:59], v[104:107], v[52:55]
    v_mfma_f32_16x16x32_bf16 v[56:59], a[56:59], v[108:111], v[56:59]
    v_mfma_f32_16x16x32_bf16 v[60:63], a[56:59], v[112:115], v[60:63]
    v_mfma_f32_16x16x32_bf16 v[64:67], a[56:59], v[116:119], v[64:67]
    buffer_load_dwordx4 a[56:59], v128, s[16:19], s35 offen offset:2048
    s_add_u32 s35, s35, 14336
    s_waitcnt vmcnt(9) lgkmcnt(0)
    v_mfma_f32_16x16x32_bf16 v[8:11], a[0:3], v[80:83], v[8:11]
    ds_read_b128 v[100:103], v133 offset:5120
    v_mfma_f32_16x16x32_bf16 v[12:15], a[0:3], v[84:87], v[12:15]
    v_mfma_f32_16x16x32_bf16 v[16:19], a[0:3], v[88:91], v[16:19]
    ds_read_b128 v[104:107], v133 offset:6144
    v_mfma_f32_16x16x32_bf16 v[20:23], a[0:3], v[92:95], v[20:23]
    v_mfma_f32_16x16x32_bf16 v[24:27], a[0:3], v[96:99], v[24:27]
    ds_read_b128 v[108:111], v133 offset:7168
    buffer_load_dwordx4 a[0:3], v128, s[16:19], s35 offen offset:0
    v_mfma_f32_16x16x32_bf16 v[28:31], a[4:7], v[80:83], v[28:31]
    v_mfma_f32_16x16x32_bf16 v[32:35], a[4:7], v[84:87], v[32:35]
    ds_read_b128 v[112:115], v133 offset:8192
    v_mfma_f32_16x16x32_bf16 v[36:39], a[4:7], v[88:91], v[36:39]
    v_mfma_f32_16x16x32_bf16 v[40:43], a[4:7], v[92:95], v[40:43]
    ds_read_b128 v[116:119], v133 offset:9216
    v_mfma_f32_16x16x32_bf16 v[44:47], a[4:7], v[96:99], v[44:47]
    buffer_load_dwordx4 a[4:7], v128, s[16:19], s35 offen offset:1024
    v_mfma_f32_16x16x32_bf16 v[48:51], a[8:11], v[80:83], v[48:51]
    v_mfma_f32_16x16x32_bf16 v[52:55], a[8:11], v[84:87], v[52:55]
    v_mfma_f32_16x16x32_bf16 v[56:59], a[8:11], v[88:91], v[56:59]
    v_mfma_f32_16x16x32_bf16 v[60:63], a[8:11], v[92:95], v[60:63]
    v_mfma_f32_16x16x32_bf16 v[64:67], a[8:11], v[96:99], v[64:67]
    buffer_load_dwordx4 a[8:11], v128, s[16:19], s35 offen offset:2048
    s_add_u32 s35, s35, 14336
    s_waitcnt vmcnt(9) lgkmcnt(0)
    v_mfma_f32_16x16x32_bf16 v[8:11], a[16:19], v[100:103], v[8:11]
    ds_read_b128 v[80:83], v133 offset:10240
    v_mfma_f32_16x16x32_bf16 v[12:15], a[16:19], v[104:107], v[12:15]
    v_mfma_f32_16x16x32_bf16 v[16:19], a[16:19], v[108:111], v[16:19]
    ds_read_b128 v[84:87], v133 offset:11264
    v_mfma_f32_16x16x32_bf16 v[20:23], a[16:19], v[112:115], v[20:23]
    v_mfma_f32_16x16x32_bf16 v[24:27], a[16:19], v[116:119], v[24:27]
    ds_read_b128 v[88:91], v133 offset:12288
    buffer_load_dwordx4 a[16:19], v128, s[16:19], s35 offen offset:0
    v_mfma_f32_16x16x32_bf16 v[28:31], a[20:23], v[100:103], v[28:31]
    v_mfma_f32_16x16x32_bf16 v[32:35], a[20:23], v[104:107], v[32:35]
    ds_read_b128 v[92:95], v133 offset:13312
    v_mfma_f32_16x16x32_bf16 v[36:39], a[20:23], v[108:111], v[36:39]
    v_mfma_f32_16x16x32_bf16 v[40:43], a[20:23], v[112:115], v[40:43]
    ds_read_b128 v[96:99], v133 offset:14336
    v_mfma_f32_16x16x32_bf16 v[44:47], a[20:23], v[116:119], v[44:47]
    buffer_load_dwordx4 a[20:23], v128, s[16:19], s35 offen offset:1024
    v_mfma_f32_16x16x32_bf16 v[48:51], a[24:27], v[100:103], v[48:51]
    v_mfma_f32_16x16x32_bf16 v[52:55], a[24:27], v[104:107], v[52:55]
    v_mfma_f32_16x16x32_bf16 v[56:59], a[24:27], v[108:111], v[56:59]
    v_mfma_f32_16x16x32_bf16 v[60:63], a[24:27], v[112:115], v[60:63]
    v_mfma_f32_16x16x32_bf16 v[64:67], a[24:27], v[116:119], v[64:67]
    buffer_load_dwordx4 a[24:27], v128, s[16:19], s35 offen offset:2048
    s_add_u32 s35, s35, 14336
    s_waitcnt vmcnt(9) lgkmcnt(0)
    v_mfma_f32_16x16x32_bf16 v[8:11], a[32:35], v[80:83], v[8:11]
    ds_read_b128 v[100:103], v133 offset:15360
    v_mfma_f32_16x16x32_bf16 v[12:15], a[32:35], v[84:87], v[12:15]
    v_mfma_f32_16x16x32_bf16 v[16:19], a[32:35], v[88:91], v[16:19]
    ds_read_b128 v[104:107], v133 offset:16384
    v_mfma_f32_16x16x32_bf16 v[20:23], a[32:35], v[92:95], v[20:23]
    v_mfma_f32_16x16x32_bf16 v[24:27], a[32:35], v[96:99], v[24:27]
    ds_read_b128 v[108:111], v133 offset:17408
    v_mfma_f32_16x16x32_bf16 v[28:31], a[36:39], v[80:83], v[28:31]
    v_mfma_f32_16x16x32_bf16 v[32:35], a[36:39], v[84:87], v[32:35]
    ds_read_b128 v[112:115], v133 offset:18432
    v_mfma_f32_16x16x32_bf16 v[36:39], a[36:39], v[88:91], v[36:39]
    v_mfma_f32_16x16x32_bf16 v[40:43], a[36:39], v[92:95], v[40:43]
    ds_read_b128 v[116:119], v133 offset:19456
    v_mfma_f32_16x16x32_bf16 v[44:47], a[36:39], v[96:99], v[44:47]
    v_mfma_f32_16x16x32_bf16 v[48:51], a[40:43], v[80:83], v[48:51]
    v_mfma_f32_16x16x32_bf16 v[52:55], a[40:43], v[84:87], v[52:55]
    v_mfma_f32_16x16x32_bf16 v[56:59], a[40:43], v[88:91], v[56:59]
    v_mfma_f32_16x16x32_bf16 v[60:63], a[40:43], v[92:95], v[60:63]
    v_mfma_f32_16x16x32_bf16 v[64:67], a[40:43], v[96:99], v[64:67]
    s_waitcnt vmcnt(6) lgkmcnt(0)
    s_barrier
    v_mfma_f32_16x16x32_bf16 v[8:11], a[48:51], v[100:103], v[8:11]
    ds_read_b128 v[80:83], v133 offset:20480
    v_mfma_f32_16x16x32_bf16 v[12:15], a[48:51], v[104:107], v[12:15]
    v_mfma_f32_16x16x32_bf16 v[16:19], a[48:51], v[108:111], v[16:19]
    ds_read_b128 v[84:87], v133 offset:21504
    v_mfma_f32_16x16x32_bf16 v[20:23], a[48:51], v[112:115], v[20:23]
    v_mfma_f32_16x16x32_bf16 v[24:27], a[48:51], v[116:119], v[24:27]
    ds_read_b128 v[88:91], v133 offset:22528
    v_mfma_f32_16x16x32_bf16 v[28:31], a[52:55], v[100:103], v[28:31]
    v_mfma_f32_16x16x32_bf16 v[32:35], a[52:55], v[104:107], v[32:35]
    ds_read_b128 v[92:95], v133 offset:23552
    v_mfma_f32_16x16x32_bf16 v[36:39], a[52:55], v[108:111], v[36:39]
    v_mfma_f32_16x16x32_bf16 v[40:43], a[52:55], v[112:115], v[40:43]
    ds_read_b128 v[96:99], v133 offset:24576
    v_mfma_f32_16x16x32_bf16 v[44:47], a[52:55], v[116:119], v[44:47]
    v_mfma_f32_16x16x32_bf16 v[48:51], a[56:59], v[100:103], v[48:51]
    v_mfma_f32_16x16x32_bf16 v[52:55], a[56:59], v[104:107], v[52:55]
    v_mfma_f32_16x16x32_bf16 v[56:59], a[56:59], v[108:111], v[56:59]
    v_mfma_f32_16x16x32_bf16 v[60:63], a[56:59], v[112:115], v[60:63]
    v_mfma_f32_16x16x32_bf16 v[64:67], a[56:59], v[116:119], v[64:67]
    v_and_b32 v3, 15, v1
    v_mul_u32_u24 v5, 304, v3
    v_lshl_add_u32 v5, v4, 4, v5
    v_add_u32 v5, 115200, v5
    ds_read_b128 v[100:103], v133 offset:25600
    ds_read_b128 v[104:107], v133 offset:26624
    ds_read_b128 v[108:111], v133 offset:27648
    ds_read_b128 v[112:115], v133 offset:28672
    ds_read_b128 v[116:119], v133 offset:29696
    v_mul_u32_u24 v3, 144, v3
    v_lshl_add_u32 v3, v4, 3, v3
    v_add_u32 v3, 92160, v3
    s_waitcnt vmcnt(0) lgkmcnt(5)
    v_mfma_f32_16x16x32_bf16 v[8:11], a[0:3], v[80:83], v[8:11]
    v_mfma_f32_16x16x32_bf16 v[12:15], a[0:3], v[84:87], v[12:15]
    v_mfma_f32_16x16x32_bf16 v[16:19], a[0:3], v[88:91], v[16:19]
    v_mfma_f32_16x16x32_bf16 v[20:23], a[0:3], v[92:95], v[20:23]
    v_mfma_f32_16x16x32_bf16 v[24:27], a[0:3], v[96:99], v[24:27]
    s_waitcnt lgkmcnt(0)
    v_mfma_f32_16x16x32_bf16 v[8:11], a[16:19], v[100:103], v[8:11]
    v_mfma_f32_16x16x32_bf16 v[12:15], a[16:19], v[104:107], v[12:15]
    v_mfma_f32_16x16x32_bf16 v[16:19], a[16:19], v[108:111], v[16:19]
    v_mfma_f32_16x16x32_bf16 v[20:23], a[16:19], v[112:115], v[20:23]
    v_mfma_f32_16x16x32_bf16 v[24:27], a[16:19], v[116:119], v[24:27]
    v_mfma_f32_16x16x32_bf16 v[28:31], a[4:7], v[80:83], v[28:31]
    v_mfma_f32_16x16x32_bf16 v[32:35], a[4:7], v[84:87], v[32:35]
    v_mfma_f32_16x16x32_bf16 v[36:39], a[4:7], v[88:91], v[36:39]
    v_mfma_f32_16x16x32_bf16 v[40:43], a[4:7], v[92:95], v[40:43]
    v_mfma_f32_16x16x32_bf16 v[44:47], a[4:7], v[96:99], v[44:47]
    v_cvt_pk_bf16_f32 v120, v8, v9
    v_cvt_pk_bf16_f32 v121, v10, v11
    ds_write_b64 v3, v[120:121] offset:0
    v_mfma_f32_16x16x32_bf16 v[28:31], a[20:23], v[100:103], v[28:31]
    v_cvt_pk_bf16_f32 v122, v12, v13
    v_cvt_pk_bf16_f32 v123, v14, v15
    ds_write_b64 v3, v[122:123] offset:2304
    v_mfma_f32_16x16x32_bf16 v[32:35], a[20:23], v[104:107], v[32:35]
    v_cvt_pk_bf16_f32 v124, v16, v17
    v_cvt_pk_bf16_f32 v125, v18, v19
    ds_write_b64 v3, v[124:125] offset:4608
    v_mfma_f32_16x16x32_bf16 v[36:39], a[20:23], v[108:111], v[36:39]
    v_cvt_pk_bf16_f32 v126, v20, v21
    v_cvt_pk_bf16_f32 v127, v22, v23
    ds_write_b64 v3, v[126:127] offset:6912
    v_mfma_f32_16x16x32_bf16 v[40:43], a[20:23], v[112:115], v[40:43]
    v_cvt_pk_bf16_f32 v120, v24, v25
    v_cvt_pk_bf16_f32 v121, v26, v27
    ds_write_b64 v3, v[120:121] offset:9216
    v_mfma_f32_16x16x32_bf16 v[44:47], a[20:23], v[116:119], v[44:47]
    v_mfma_f32_16x16x32_bf16 v[48:51], a[8:11], v[80:83], v[48:51]
    v_mfma_f32_16x16x32_bf16 v[52:55], a[8:11], v[84:87], v[52:55]
    v_mfma_f32_16x16x32_bf16 v[56:59], a[8:11], v[88:91], v[56:59]
    v_mfma_f32_16x16x32_bf16 v[60:63], a[8:11], v[92:95], v[60:63]
    v_mfma_f32_16x16x32_bf16 v[64:67], a[8:11], v[96:99], v[64:67]
    v_cvt_pk_bf16_f32 v120, v28, v29
    v_cvt_pk_bf16_f32 v121, v30, v31
    ds_write_b64 v3, v[120:121] offset:32
    v_mfma_f32_16x16x32_bf16 v[48:51], a[24:27], v[100:103], v[48:51]
    v_cvt_pk_bf16_f32 v122, v32, v33
    v_cvt_pk_bf16_f32 v123, v34, v35
    ds_write_b64 v3, v[122:123] offset:2336
    v_mfma_f32_16x16x32_bf16 v[52:55], a[24:27], v[104:107], v[52:55]
    v_cvt_pk_bf16_f32 v124, v36, v37
    v_cvt_pk_bf16_f32 v125, v38, v39
    ds_write_b64 v3, v[124:125] offset:4640
    v_mfma_f32_16x16x32_bf16 v[56:59], a[24:27], v[108:111], v[56:59]
    v_cvt_pk_bf16_f32 v126, v40, v41
    v_cvt_pk_bf16_f32 v127, v42, v43
    ds_write_b64 v3, v[126:127] offset:6944
    v_mfma_f32_16x16x32_bf16 v[60:63], a[24:27], v[112:115], v[60:63]
    v_cvt_pk_bf16_f32 v120, v44, v45
    v_cvt_pk_bf16_f32 v121, v46, v47
    ds_write_b64 v3, v[120:121] offset:9248
    v_mfma_f32_16x16x32_bf16 v[64:67], a[24:27], v[116:119], v[64:67]
    s_nop 4
    v_cvt_pk_bf16_f32 v120, v48, v49
    v_cvt_pk_bf16_f32 v121, v50, v51
    ds_write_b64 v3, v[120:121] offset:64
    v_cvt_pk_bf16_f32 v122, v52, v53
    v_cvt_pk_bf16_f32 v123, v54, v55
    ds_write_b64 v3, v[122:123] offset:2368
    v_cvt_pk_bf16_f32 v124, v56, v57
    v_cvt_pk_bf16_f32 v125, v58, v59
    ds_write_b64 v3, v[124:125] offset:4672
    v_cvt_pk_bf16_f32 v126, v60, v61
    v_cvt_pk_bf16_f32 v127, v62, v63
    ds_write_b64 v3, v[126:127] offset:6976
    v_cvt_pk_bf16_f32 v120, v64, v65
    v_cvt_pk_bf16_f32 v121, v66, v67
    ds_write_b64 v3, v[120:121] offset:9280
    s_branch L1_att
L1_w1:
    s_waitcnt lgkmcnt(0)
    s_add_u32 s26, s24, s34
    s_addc_u32 s27, s25, 0
    s_mov_b32 s16, s26
    s_and_b32 s17, s27, 0xffff
    s_mov_b32 s18, 0x3f000
    s_mov_b32 s19, 0x00020000
    buffer_load_dwordx4 a[0:3], v128, s[16:19], s35 offen offset:3072
    buffer_load_dwordx4 a[4:7], v129, s[16:19], s35 offen offset:0
    buffer_load_dwordx4 a[8:11], v129, s[16:19], s35 offen offset:1024
    s_add_u32 s35, s35, 14336
    v_mov_b32 v8, 0
    v_mov_b32 v9, 0
    v_mov_b32 v10, 0
    v_mov_b32 v11, 0
    v_mov_b32 v12, 0
    v_mov_b32 v13, 0
    v_mov_b32 v14, 0
    v_mov_b32 v15, 0
    v_mov_b32 v16, 0
    v_mov_b32 v17, 0
    v_mov_b32 v18, 0
    v_mov_b32 v19, 0
    v_mov_b32 v20, 0
    v_mov_b32 v21, 0
    v_mov_b32 v22, 0
    v_mov_b32 v23, 0
    v_mov_b32 v24, 0
    v_mov_b32 v25, 0
    v_mov_b32 v26, 0
    v_mov_b32 v27, 0
    v_mov_b32 v28, 0
    v_mov_b32 v29, 0
    v_mov_b32 v30, 0
    v_mov_b32 v31, 0
    v_mov_b32 v32, 0
    v_mov_b32 v33, 0
    v_mov_b32 v34, 0
    v_mov_b32 v35, 0
    v_mov_b32 v36, 0
    v_mov_b32 v37, 0
    v_mov_b32 v38, 0
    v_mov_b32 v39, 0
    v_mov_b32 v40, 0
    v_mov_b32 v41, 0
    v_mov_b32 v42, 0
    v_mov_b32 v43, 0
    v_mov_b32 v44, 0
    v_mov_b32 v45, 0
    v_mov_b32 v46, 0
    v_mov_b32 v47, 0
    v_mov_b32 v48, 0
    v_mov_b32 v49, 0
    v_mov_b32 v50, 0
    v_mov_b32 v51, 0
    v_mov_b32 v52, 0
    v_mov_b32 v53, 0
    v_mov_b32 v54, 0
    v_mov_b32 v55, 0
    v_mov_b32 v56, 0
    v_mov_b32 v57, 0
    v_mov_b32 v58, 0
    v_mov_b32 v59, 0
    v_mov_b32 v60, 0
    v_mov_b32 v61, 0
    v_mov_b32 v62, 0
    v_mov_b32 v63, 0
    v_mov_b32 v64, 0
    v_mov_b32 v65, 0
    v_mov_b32 v66, 0
    v_mov_b32 v67, 0
    s_barrier
    buffer_load_dwordx4 a[16:19], v128, s[16:19], s35 offen offset:3072
    buffer_load_dwordx4 a[20:23], v129, s[16:19], s35 offen offset:0
    buffer_load_dwordx4 a[24:27], v129, s[16:19], s35 offen offset:1024
    s_add_u32 s35, s35, 14336
    buffer_load_dwordx4 a[32:35], v128, s[16:19], s35 offen offset:3072
    buffer_load_dwordx4 a[36:39], v129, s[16:19], s35 offen offset:0
    buffer_load_dwordx4 a[40:43], v129, s[16:19], s35 offen offset:1024
    s_add_u32 s35, s35, 14336
    buffer_load_dwordx4 a[48:51], v128, s[16:19], s35 offen offset:3072
    buffer_load_dwordx4 a[52:55], v129, s[16:19], s35 offen offset:0
    buffer_load_dwordx4 a[56:59], v129, s[16:19], s35 offen offset:1024
    s_add_u32 s35, s35, 14336
    s_mov_b32 s12, s24
    s_and_b32 s13, s25, 0xffff
    s_mov_b32 s14, 0x10000000
    s_mov_b32 s15, 0x00020000
    s_setprio 2
    v_add_u32 v133, 61440, v132
    s_barrier
    ds_read_b128 v[80:83], v132 offset:0
    ds_read_b128 v[84:87], v132 offset:1024
    ds_read_b128 v[88:91], v132 offset:2048
    ds_read_b128 v[92:95], v132 offset:3072
    ds_read_b128 v[96:99], v132 offset:4096
    s_waitcnt vmcnt(9) lgkmcnt(0)
    v_mfma_f32_16x16x32_bf16 v[8:11], a[0:3], v[80:83], v[8:11]
    ds_read_b128 v[100:103], v132 offset:5120
    v_mfma_f32_16x16x32_bf16 v[12:15], a[0:3], v[84:87], v[12:15]
    v_mfma_f32_16x16x32_bf16 v[16:19], a[0:3], v[88:91], v[16:19]
    ds_read_b128 v[104:107], v132 offset:6144
    v_mfma_f32_16x16x32_bf16 v[20:23], a[0:3], v[92:95], v[20:23]
    v_mfma_f32_16x16x32_bf16 v[24:27], a[0:3], v[96:99], v[24:27]
    ds_read_b128 v[108:111], v132 offset:7168
    buffer_load_dwordx4 a[0:3], v128, s[16:19], s35 offen offset:3072
    v_mfma_f32_16x16x32_bf16 v[28:31], a[4:7], v[80:83], v[28:31]
    v_mfma_f32_16x16x32_bf16 v[32:35], a[4:7], v[84:87], v[32:35]
    ds_read_b128 v[112:115], v132 offset:8192
    v_mfma_f32_16x16x32_bf16 v[36:39], a[4:7], v[88:91], v[36:39]
    v_mfma_f32_16x16x32_bf16 v[40:43], a[4:7], v[92:95], v[40:43]
    ds_read_b128 v[116:119], v132 offset:9216
    v_mfma_f32_16x16x32_bf16 v[44:47], a[4:7], v[96:99], v[44:47]
    buffer_load_dwordx4 a[4:7], v129, s[16:19], s35 offen offset:0
    v_mfma_f32_16x16x32_bf16 v[48:51], a[8:11], v[80:83], v[48:51]
    v_mfma_f32_16x16x32_bf16 v[52:55], a[8:11], v[84:87], v[52:55]
    v_mfma_f32_16x16x32_bf16 v[56:59], a[8:11], v[88:91], v[56:59]
    v_mfma_f32_16x16x32_bf16 v[60:63], a[8:11], v[92:95], v[60:63]
    v_mfma_f32_16x16x32_bf16 v[64:67], a[8:11], v[96:99], v[64:67]
    buffer_load_dwordx4 a[8:11], v129, s[16:19], s35 offen offset:1024
    s_add_u32 s35, s35, 14336
    s_waitcnt vmcnt(9) lgkmcnt(0)
    v_mfma_f32_16x16x32_bf16 v[8:11], a[16:19], v[100:103], v[8:11]
    ds_read_b128 v[80:83], v132 offset:10240
    v_mfma_f32_16x16x32_bf16 v[12:15], a[16:19], v[104:107], v[12:15]
    v_mfma_f32_16x16x32_bf16 v[16:19], a[16:19], v[108:111], v[16:19]
    ds_read_b128 v[84:87], v132 offset:11264
    v_mfma_f32_16x16x32_bf16 v[20:23], a[16:19], v[112:115], v[20:23]
    v_mfma_f32_16x16x32_bf16 v[24:27], a[16:19], v[116:119], v[24:27]
    ds_read_b128 v[88:91], v132 offset:12288
    buffer_load_dwordx4 a[16:19], v128, s[16:19], s35 offen offset:3072
    v_mfma_f32_16x16x32_bf16 v[28:31], a[20:23], v[100:103], v[28:31]
    v_mfma_f32_16x16x32_bf16 v[32:35], a[20:23], v[104:107], v[32:35]
    ds_read_b128 v[92:95], v132 offset:13312
    v_mfma_f32_16x16x32_bf16 v[36:39], a[20:23], v[108:111], v[36:39]
    v_mfma_f32_16x16x32_bf16 v[40:43], a[20:23], v[112:115], v[40:43]
    ds_read_b128 v[96:99], v132 offset:14336
    v_mfma_f32_16x16x32_bf16 v[44:47], a[20:23], v[116:119], v[44:47]
    buffer_load_dwordx4 a[20:23], v129, s[16:19], s35 offen offset:0
    v_mfma_f32_16x16x32_bf16 v[48:51], a[24:27], v[100:103], v[48:51]
    v_mfma_f32_16x16x32_bf16 v[52:55], a[24:27], v[104:107], v[52:55]
    v_mfma_f32_16x16x32_bf16 v[56:59], a[24:27], v[108:111], v[56:59]
    v_mfma_f32_16x16x32_bf16 v[60:63], a[24:27], v[112:115], v[60:63]
    v_mfma_f32_16x16x32_bf16 v[64:67], a[24:27], v[116:119], v[64:67]
    buffer_load_dwordx4 a[24:27], v129, s[16:19], s35 offen offset:1024
    s_add_u32 s35, s35, 14336
    s_waitcnt vmcnt(9) lgkmcnt(0)
    v_mfma_f32_16x16x32_bf16 v[8:11], a[32:35], v[80:83], v[8:11]
    ds_read_b128 v[100:103], v132 offset:15360
    v_mfma_f32_16x16x32_bf16 v[12:15], a[32:35], v[84:87], v[12:15]
    v_mfma_f32_16x16x32_bf16 v[16:19], a[32:35], v[88:91], v[16:19]
    ds_read_b128 v[104:107], v132 offset:16384
    v_mfma_f32_16x16x32_bf16 v[20:23], a[32:35], v[92:95], v[20:23]
    v_mfma_f32_16x16x32_bf16 v[24:27], a[32:35], v[96:99], v[24:27]
    ds_read_b128 v[108:111], v132 offset:17408
    buffer_load_dwordx4 a[32:35], v128, s[16:19], s35 offen offset:3072
    v_mfma_f32_16x16x32_bf16 v[28:31], a[36:39], v[80:83], v[28:31]
    v_mfma_f32_16x16x32_bf16 v[32:35], a[36:39], v[84:87], v[32:35]
    ds_read_b128 v[112:115], v132 offset:18432
    v_mfma_f32_16x16x32_bf16 v[36:39], a[36:39], v[88:91], v[36:39]
    v_mfma_f32_16x16x32_bf16 v[40:43], a[36:39], v[92:95], v[40:43]
    ds_read_b128 v[116:119], v132 offset:19456
    v_mfma_f32_16x16x32_bf16 v[44:47], a[36:39], v[96:99], v[44:47]
    buffer_load_dwordx4 a[36:39], v129, s[16:19], s35 offen offset:0
    v_mfma_f32_16x16x32_bf16 v[48:51], a[40:43], v[80:83], v[48:51]
    v_mfma_f32_16x16x32_bf16 v[52:55], a[40:43], v[84:87], v[52:55]
    v_mfma_f32_16x16x32_bf16 v[56:59], a[40:43], v[88:91], v[56:59]
    v_mfma_f32_16x16x32_bf16 v[60:63], a[40:43], v[92:95], v[60:63]
    v_mfma_f32_16x16x32_bf16 v[64:67], a[40:43], v[96:99], v[64:67]
    buffer_load_dwordx4 a[40:43], v129, s[16:19], s35 offen offset:1024
    s_add_u32 s35, s35, 14336
    s_waitcnt vmcnt(9) lgkmcnt(0)
    s_barrier
    v_mfma_f32_16x16x32_bf16 v[8:11], a[48:51], v[100:103], v[8:11]
    ds_read_b128 v[80:83], v132 offset:20480
    v_mfma_f32_16x16x32_bf16 v[12:15], a[48:51], v[104:107], v[12:15]
    v_mfma_f32_16x16x32_bf16 v[16:19], a[48:51], v[108:111], v[16:19]
    ds_read_b128 v[84:87], v132 offset:21504
    v_mfma_f32_16x16x32_bf16 v[20:23], a[48:51], v[112:115], v[20:23]
    v_mfma_f32_16x16x32_bf16 v[24:27], a[48:51], v[116:119], v[24:27]
    ds_read_b128 v[88:91], v132 offset:22528
    buffer_load_dwordx4 a[48:51], v128, s[16:19], s35 offen offset:3072
    v_mfma_f32_16x16x32_bf16 v[28:31], a[52:55], v[100:103], v[28:31]
    v_mfma_f32_16x16x32_bf16 v[32:35], a[52:55], v[104:107], v[32:35]
    ds_read_b128 v[92:95], v132 offset:23552
    v_mfma_f32_16x16x32_bf16 v[36:39], a[52:55], v[108:111], v[36:39]
    v_mfma_f32_16x16x32_bf16 v[40:43], a[52:55], v[112:115], v[40:43]
    ds_read_b128 v[96:99], v132 offset:24576
    v_mfma_f32_16x16x32_bf16 v[44:47], a[52:55], v[116:119], v[44:47]
    buffer_load_dwordx4 a[52:55], v129, s[16:19], s35 offen offset:0
    v_mfma_f32_16x16x32_bf16 v[48:51], a[56:59], v[100:103], v[48:51]
    v_mfma_f32_16x16x32_bf16 v[52:55], a[56:59], v[104:107], v[52:55]
    v_mfma_f32_16x16x32_bf16 v[56:59], a[56:59], v[108:111], v[56:59]
    v_mfma_f32_16x16x32_bf16 v[60:63], a[56:59], v[112:115], v[60:63]
    v_mfma_f32_16x16x32_bf16 v[64:67], a[56:59], v[116:119], v[64:67]
    buffer_load_dwordx4 a[56:59], v129, s[16:19], s35 offen offset:1024
    s_add_u32 s35, s35, 14336
    s_waitcnt vmcnt(9) lgkmcnt(0)
    v_mfma_f32_16x16x32_bf16 v[8:11], a[0:3], v[80:83], v[8:11]
    ds_read_b128 v[100:103], v132 offset:25600
    v_mfma_f32_16x16x32_bf16 v[12:15], a[0:3], v[84:87], v[12:15]
    v_mfma_f32_16x16x32_bf16 v[16:19], a[0:3], v[88:91], v[16:19]
    ds_read_b128 v[104:107], v132 offset:26624
    v_mfma_f32_16x16x32_bf16 v[20:23], a[0:3], v[92:95], v[20:23]
    v_mfma_f32_16x16x32_bf16 v[24:27], a[0:3], v[96:99], v[24:27]
    ds_read_b128 v[108:111], v132 offset:27648
    buffer_load_dwordx4 a[0:3], v128, s[16:19], s35 offen offset:3072
    v_mfma_f32_16x16x32_bf16 v[28:31], a[4:7], v[80:83], v[28:31]
    v_mfma_f32_16x16x32_bf16 v[32:35], a[4:7], v[84:87], v[32:35]
    ds_read_b128 v[112:115], v132 offset:28672
    v_mfma_f32_16x16x32_bf16 v[36:39], a[4:7], v[88:91], v[36:39]
    v_mfma_f32_16x16x32_bf16 v[40:43], a[4:7], v[92:95], v[40:43]
    ds_read_b128 v[116:119], v132 offset:29696
    v_mfma_f32_16x16x32_bf16 v[44:47], a[4:7], v[96:99], v[44:47]
    buffer_load_dwordx4 a[4:7], v129, s[16:19], s35 offen offset:0
    v_mfma_f32_16x16x32_bf16 v[48:51], a[8:11], v[80:83], v[48:51]
    v_mfma_f32_16x16x32_bf16 v[52:55], a[8:11], v[84:87], v[52:55]
    v_mfma_f32_16x16x32_bf16 v[56:59], a[8:11], v[88:91], v[56:59]
    v_mfma_f32_16x16x32_bf16 v[60:63], a[8:11], v[92:95], v[60:63]
    v_mfma_f32_16x16x32_bf16 v[64:67], a[8:11], v[96:99], v[64:67]
    buffer_load_dwordx4 a[8:11], v129, s[16:19], s35 offen offset:1024
    s_add_u32 s35, s35, 14336
    s_waitcnt vmcnt(9) lgkmcnt(0)
    v_mfma_f32_16x16x32_bf16 v[8:11], a[16:19], v[100:103], v[8:11]
    ds_read_b128 v[80:83], v132 offset:30720
    v_mfma_f32_16x16x32_bf16 v[12:15], a[16:19], v[104:107], v[12:15]
    v_mfma_f32_16x16x32_bf16 v[16:19], a[16:19], v[108:111], v[16:19]
    ds_read_b128 v[84:87], v132 offset:31744
    v_mfma_f32_16x16x32_bf16 v[20:23], a[16:19], v[112:115], v[20:23]
    v_mfma_f32_16x16x32_bf16 v[24:27], a[16:19], v[116:119], v[24:27]
    ds_read_b128 v[88:91], v132 offset:32768
    buffer_load_dwordx4 a[16:19], v128, s[16:19], s35 offen offset:3072
    v_mfma_f32_16x16x32_bf16 v[28:31], a[20:23], v[100:103], v[28:31]
    v_mfma_f32_16x16x32_bf16 v[32:35], a[20:23], v[104:107], v[32:35]
    ds_read_b128 v[92:95], v132 offset:33792
    v_mfma_f32_16x16x32_bf16 v[36:39], a[20:23], v[108:111], v[36:39]
    v_mfma_f32_16x16x32_bf16 v[40:43], a[20:23], v[112:115], v[40:43]
    ds_read_b128 v[96:99], v132 offset:34816
    v_mfma_f32_16x16x32_bf16 v[44:47], a[20:23], v[116:119], v[44:47]
    buffer_load_dwordx4 a[20:23], v129, s[16:19], s35 offen offset:0
    v_mfma_f32_16x16x32_bf16 v[48:51], a[24:27], v[100:103], v[48:51]
    v_mfma_f32_16x16x32_bf16 v[52:55], a[24:27], v[104:107], v[52:55]
    v_mfma_f32_16x16x32_bf16 v[56:59], a[24:27], v[108:111], v[56:59]
    v_mfma_f32_16x16x32_bf16 v[60:63], a[24:27], v[112:115], v[60:63]
    v_mfma_f32_16x16x32_bf16 v[64:67], a[24:27], v[116:119], v[64:67]
    buffer_load_dwordx4 a[24:27], v129, s[16:19], s35 offen offset:1024
    s_add_u32 s35, s35, 14336
    s_waitcnt vmcnt(9) lgkmcnt(0)
    v_mfma_f32_16x16x32_bf16 v[8:11], a[32:35], v[80:83], v[8:11]
    ds_read_b128 v[100:103], v132 offset:35840
    v_mfma_f32_16x16x32_bf16 v[12:15], a[32:35], v[84:87], v[12:15]
    v_mfma_f32_16x16x32_bf16 v[16:19], a[32:35], v[88:91], v[16:19]
    ds_read_b128 v[104:107], v132 offset:36864
    v_mfma_f32_16x16x32_bf16 v[20:23], a[32:35], v[92:95], v[20:23]
    v_mfma_f32_16x16x32_bf16 v[24:27], a[32:35], v[96:99], v[24:27]
    ds_read_b128 v[108:111], v132 offset:37888
    buffer_load_dwordx4 a[32:35], v128, s[16:19], s35 offen offset:3072
    v_mfma_f32_16x16x32_bf16 v[28:31], a[36:39], v[80:83], v[28:31]
    v_mfma_f32_16x16x32_bf16 v[32:35], a[36:39], v[84:87], v[32:35]
    ds_read_b128 v[112:115], v132 offset:38912
    v_mfma_f32_16x16x32_bf16 v[36:39], a[36:39], v[88:91], v[36:39]
    v_mfma_f32_16x16x32_bf16 v[40:43], a[36:39], v[92:95], v[40:43]
    ds_read_b128 v[116:119], v132 offset:39936
    v_mfma_f32_16x16x32_bf16 v[44:47], a[36:39], v[96:99], v[44:47]
    buffer_load_dwordx4 a[36:39], v129, s[16:19], s35 offen offset:0
    v_mfma_f32_16x16x32_bf16 v[48:51], a[40:43], v[80:83], v[48:51]
    v_mfma_f32_16x16x32_bf16 v[52:55], a[40:43], v[84:87], v[52:55]
    v_mfma_f32_16x16x32_bf16 v[56:59], a[40:43], v[88:91], v[56:59]
    v_mfma_f32_16x16x32_bf16 v[60:63], a[40:43], v[92:95], v[60:63]
    v_mfma_f32_16x16x32_bf16 v[64:67], a[40:43], v[96:99], v[64:67]
    buffer_load_dwordx4 a[40:43], v129, s[16:19], s35 offen offset:1024
    s_add_u32 s35, s35, 14336
    s_waitcnt vmcnt(9) lgkmcnt(0)
    s_barrier
    v_mfma_f32_16x16x32_bf16 v[8:11], a[48:51], v[100:103], v[8:11]
    ds_read_b128 v[80:83], v132 offset:40960
    v_mfma_f32_16x16x32_bf16 v[12:15], a[48:51], v[104:107], v[12:15]
    v_mfma_f32_16x16x32_bf16 v[16:19], a[48:51], v[108:111], v[16:19]
    ds_read_b128 v[84:87], v132 offset:41984
    v_mfma_f32_16x16x32_bf16 v[20:23], a[48:51], v[112:115], v[20:23]
    v_mfma_f32_16x16x32_bf16 v[24:27], a[48:51], v[116:119], v[24:27]
    ds_read_b128 v[88:91], v132 offset:43008
    buffer_load_dwordx4 a[48:51], v128, s[16:19], s35 offen offset:3072
    v_mfma_f32_16x16x32_bf16 v[28:31], a[52:55], v[100:103], v[28:31]
    v_mfma_f32_16x16x32_bf16 v[32:35], a[52:55], v[104:107], v[32:35]
    ds_read_b128 v[92:95], v132 offset:44032
    v_mfma_f32_16x16x32_bf16 v[36:39], a[52:55], v[108:111], v[36:39]
    v_mfma_f32_16x16x32_bf16 v[40:43], a[52:55], v[112:115], v[40:43]
    ds_read_b128 v[96:99], v132 offset:45056
    v_mfma_f32_16x16x32_bf16 v[44:47], a[52:55], v[116:119], v[44:47]
    buffer_load_dwordx4 a[52:55], v129, s[16:19], s35 offen offset:0
    v_mfma_f32_16x16x32_bf16 v[48:51], a[56:59], v[100:103], v[48:51]
    v_mfma_f32_16x16x32_bf16 v[52:55], a[56:59], v[104:107], v[52:55]
    v_mfma_f32_16x16x32_bf16 v[56:59], a[56:59], v[108:111], v[56:59]
    v_mfma_f32_16x16x32_bf16 v[60:63], a[56:59], v[112:115], v[60:63]
    v_mfma_f32_16x16x32_bf16 v[64:67], a[56:59], v[116:119], v[64:67]
    buffer_load_dwordx4 a[56:59], v129, s[16:19], s35 offen offset:1024
    s_add_u32 s35, s35, 14336
    s_waitcnt vmcnt(9) lgkmcnt(0)
    v_mfma_f32_16x16x32_bf16 v[8:11], a[0:3], v[80:83], v[8:11]
    ds_read_b128 v[100:103], v132 offset:46080
    v_mfma_f32_16x16x32_bf16 v[12:15], a[0:3], v[84:87], v[12:15]
    v_mfma_f32_16x16x32_bf16 v[16:19], a[0:3], v[88:91], v[16:19]
    ds_read_b128 v[104:107], v132 offset:47104
    v_mfma_f32_16x16x32_bf16 v[20:23], a[0:3], v[92:95], v[20:23]
    v_mfma_f32_16x16x32_bf16 v[24:27], a[0:3], v[96:99], v[24:27]
    ds_read_b128 v[108:111], v132 offset:48128
    buffer_load_dwordx4 a[0:3], v128, s[16:19], s35 offen offset:3072
    v_mfma_f32_16x16x32_bf16 v[28:31], a[4:7], v[80:83], v[28:31]
    v_mfma_f32_16x16x32_bf16 v[32:35], a[4:7], v[84:87], v[32:35]
    ds_read_b128 v[112:115], v132 offset:49152
    v_mfma_f32_16x16x32_bf16 v[36:39], a[4:7], v[88:91], v[36:39]
    v_mfma_f32_16x16x32_bf16 v[40:43], a[4:7], v[92:95], v[40:43]
    ds_read_b128 v[116:119], v132 offset:50176
    v_mfma_f32_16x16x32_bf16 v[44:47], a[4:7], v[96:99], v[44:47]
    buffer_load_dwordx4 a[4:7], v129, s[16:19], s35 offen offset:0
    v_mfma_f32_16x16x32_bf16 v[48:51], a[8:11], v[80:83], v[48:51]
    v_mfma_f32_16x16x32_bf16 v[52:55], a[8:11], v[84:87], v[52:55]
    v_mfma_f32_16x16x32_bf16 v[56:59], a[8:11], v[88:91], v[56:59]
    v_mfma_f32_16x16x32_bf16 v[60:63], a[8:11], v[92:95], v[60:63]
    v_mfma_f32_16x16x32_bf16 v[64:67], a[8:11], v[96:99], v[64:67]
    buffer_load_dwordx4 a[8:11], v129, s[16:19], s35 offen offset:1024
    s_add_u32 s35, s35, 14336
    s_waitcnt vmcnt(9) lgkmcnt(0)
    v_mfma_f32_16x16x32_bf16 v[8:11], a[16:19], v[100:103], v[8:11]
    ds_read_b128 v[80:83], v132 offset:51200
    v_mfma_f32_16x16x32_bf16 v[12:15], a[16:19], v[104:107], v[12:15]
    v_mfma_f32_16x16x32_bf16 v[16:19], a[16:19], v[108:111], v[16:19]
    ds_read_b128 v[84:87], v132 offset:52224
    v_mfma_f32_16x16x32_bf16 v[20:23], a[16:19], v[112:115], v[20:23]
    v_mfma_f32_16x16x32_bf16 v[24:27], a[16:19], v[116:119], v[24:27]
    ds_read_b128 v[88:91], v132 offset:53248
    buffer_load_dwordx4 a[16:19], v128, s[16:19], s35 offen offset:3072
    v_mfma_f32_16x16x32_bf16 v[28:31], a[20:23], v[100:103], v[28:31]
    v_mfma_f32_16x16x32_bf16 v[32:35], a[20:23], v[104:107], v[32:35]
    ds_read_b128 v[92:95], v132 offset:54272
    v_mfma_f32_16x16x32_bf16 v[36:39], a[20:23], v[108:111], v[36:39]
    v_mfma_f32_16x16x32_bf16 v[40:43], a[20:23], v[112:115], v[40:43]
    ds_read_b128 v[96:99], v132 offset:55296
    v_mfma_f32_16x16x32_bf16 v[44:47], a[20:23], v[116:119], v[44:47]
    buffer_load_dwordx4 a[20:23], v129, s[16:19], s35 offen offset:0
    v_mfma_f32_16x16x32_bf16 v[48:51], a[24:27], v[100:103], v[48:51]
    v_mfma_f32_16x16x32_bf16 v[52:55], a[24:27], v[104:107], v[52:55]
    v_mfma_f32_16x16x32_bf16 v[56:59], a[24:27], v[108:111], v[56:59]
    v_mfma_f32_16x16x32_bf16 v[60:63], a[24:27], v[112:115], v[60:63]
    v_mfma_f32_16x16x32_bf16 v[64:67], a[24:27], v[116:119], v[64:67]
    buffer_load_dwordx4 a[24:27], v129, s[16:19], s35 offen offset:1024
    s_add_u32 s35, s35, 14336
    s_waitcnt vmcnt(9) lgkmcnt(0)
    v_mfma_f32_16x16x32_bf16 v[8:11], a[32:35], v[80:83], v[8:11]
    ds_read_b128 v[100:103], v132 offset:56320
    v_mfma_f32_16x16x32_bf16 v[12:15], a[32:35], v[84:87], v[12:15]
    v_mfma_f32_16x16x32_bf16 v[16:19], a[32:35], v[88:91], v[16:19]
    ds_read_b128 v[104:107], v132 offset:57344
    v_mfma_f32_16x16x32_bf16 v[20:23], a[32:35], v[92:95], v[20:23]
    v_mfma_f32_16x16x32_bf16 v[24:27], a[32:35], v[96:99], v[24:27]
    ds_read_b128 v[108:111], v132 offset:58368
    buffer_load_dwordx4 a[32:35], v128, s[16:19], s35 offen offset:3072
    v_mfma_f32_16x16x32_bf16 v[28:31], a[36:39], v[80:83], v[28:31]
    v_mfma_f32_16x16x32_bf16 v[32:35], a[36:39], v[84:87], v[32:35]
    ds_read_b128 v[112:115], v132 offset:59392
    v_mfma_f32_16x16x32_bf16 v[36:39], a[36:39], v[88:91], v[36:39]
    v_mfma_f32_16x16x32_bf16 v[40:43], a[36:39], v[92:95], v[40:43]
    ds_read_b128 v[116:119], v132 offset:60416
    v_mfma_f32_16x16x32_bf16 v[44:47], a[36:39], v[96:99], v[44:47]
    buffer_load_dwordx4 a[36:39], v129, s[16:19], s35 offen offset:0
    v_mfma_f32_16x16x32_bf16 v[48:51], a[40:43], v[80:83], v[48:51]
    v_mfma_f32_16x16x32_bf16 v[52:55], a[40:43], v[84:87], v[52:55]
    v_mfma_f32_16x16x32_bf16 v[56:59], a[40:43], v[88:91], v[56:59]
    v_mfma_f32_16x16x32_bf16 v[60:63], a[40:43], v[92:95], v[60:63]
    v_mfma_f32_16x16x32_bf16 v[64:67], a[40:43], v[96:99], v[64:67]
    buffer_load_dwordx4 a[40:43], v129, s[16:19], s35 offen offset:1024
    s_add_u32 s35, s35, 14336
    s_waitcnt vmcnt(9) lgkmcnt(0)
    s_barrier
    v_mfma_f32_16x16x32_bf16 v[8:11], a[48:51], v[100:103], v[8:11]
    ds_read_b128 v[80:83], v133 offset:0
    v_mfma_f32_16x16x32_bf16 v[12:15], a[48:51], v[104:107], v[12:15]
    v_mfma_f32_16x16x32_bf16 v[16:19], a[48:51], v[108:111], v[16:19]
    ds_read_b128 v[84:87], v133 offset:1024
    v_mfma_f32_16x16x32_bf16 v[20:23], a[48:51], v[112:115], v[20:23]
    v_mfma_f32_16x16x32_bf16 v[24:27], a[48:51], v[116:119], v[24:27]
    ds_read_b128 v[88:91], v133 offset:2048
    buffer_load_dwordx4 a[48:51], v128, s[16:19], s35 offen offset:3072
    v_mfma_f32_16x16x32_bf16 v[28:31], a[52:55], v[100:103], v[28:31]
    v_mfma_f32_16x16x32_bf16 v[32:35], a[52:55], v[104:107], v[32:35]
    ds_read_b128 v[92:95], v133 offset:3072
    v_mfma_f32_16x16x32_bf16 v[36:39], a[52:55], v[108:111], v[36:39]
    v_mfma_f32_16x16x32_bf16 v[40:43], a[52:55], v[112:115], v[40:43]
    ds_read_b128 v[96:99], v133 offset:4096
    v_mfma_f32_16x16x32_bf16 v[44:47], a[52:55], v[116:119], v[44:47]
    buffer_load_dwordx4 a[52:55], v129, s[16:19], s35 offen offset:0
    v_mfma_f32_16x16x32_bf16 v[48:51], a[56:59], v[100:103], v[48:51]
    v_mfma_f32_16x16x32_bf16 v[52:55], a[56:59], v[104:107], v[52:55]
    v_mfma_f32_16x16x32_bf16 v[56:59], a[56:59], v[108:111], v[56:59]
    v_mfma_f32_16x16x32_bf16 v[60:63], a[56:59], v[112:115], v[60:63]
    v_mfma_f32_16x16x32_bf16 v[64:67], a[56:59], v[116:119], v[64:67]
    buffer_load_dwordx4 a[56:59], v129, s[16:19], s35 offen offset:1024
    s_add_u32 s35, s35, 14336
    s_waitcnt vmcnt(9) lgkmcnt(0)
    v_mfma_f32_16x16x32_bf16 v[8:11], a[0:3], v[80:83], v[8:11]
    ds_read_b128 v[100:103], v133 offset:5120
    v_mfma_f32_16x16x32_bf16 v[12:15], a[0:3], v[84:87], v[12:15]
    v_mfma_f32_16x16x32_bf16 v[16:19], a[0:3], v[88:91], v[16:19]
    ds_read_b128 v[104:107], v133 offset:6144
    v_mfma_f32_16x16x32_bf16 v[20:23], a[0:3], v[92:95], v[20:23]
    v_mfma_f32_16x16x32_bf16 v[24:27], a[0:3], v[96:99], v[24:27]
    ds_read_b128 v[108:111], v133 offset:7168
    buffer_load_dwordx4 a[0:3], v128, s[16:19], s35 offen offset:3072
    v_mfma_f32_16x16x32_bf16 v[28:31], a[4:7], v[80:83], v[28:31]
    v_mfma_f32_16x16x32_bf16 v[32:35], a[4:7], v[84:87], v[32:35]
    ds_read_b128 v[112:115], v133 offset:8192
    v_mfma_f32_16x16x32_bf16 v[36:39], a[4:7], v[88:91], v[36:39]
    v_mfma_f32_16x16x32_bf16 v[40:43], a[4:7], v[92:95], v[40:43]
    ds_read_b128 v[116:119], v133 offset:9216
    v_mfma_f32_16x16x32_bf16 v[44:47], a[4:7], v[96:99], v[44:47]
    buffer_load_dwordx4 a[4:7], v129, s[16:19], s35 offen offset:0
    v_mfma_f32_16x16x32_bf16 v[48:51], a[8:11], v[80:83], v[48:51]
    v_mfma_f32_16x16x32_bf16 v[52:55], a[8:11], v[84:87], v[52:55]
    v_mfma_f32_16x16x32_bf16 v[56:59], a[8:11], v[88:91], v[56:59]
    v_mfma_f32_16x16x32_bf16 v[60:63], a[8:11], v[92:95], v[60:63]
    v_mfma_f32_16x16x32_bf16 v[64:67], a[8:11], v[96:99], v[64:67]
    buffer_load_dwordx4 a[8:11], v129, s[16:19], s35 offen offset:1024
    s_add_u32 s35, s35, 14336
    s_waitcnt vmcnt(9) lgkmcnt(0)
    v_mfma_f32_16x16x32_bf16 v[8:11], a[16:19], v[100:103], v[8:11]
    ds_read_b128 v[80:83], v133 offset:10240
    v_mfma_f32_16x16x32_bf16 v[12:15], a[16:19], v[104:107], v[12:15]
    v_mfma_f32_16x16x32_bf16 v[16:19], a[16:19], v[108:111], v[16:19]
    ds_read_b128 v[84:87], v133 offset:11264
    v_mfma_f32_16x16x32_bf16 v[20:23], a[16:19], v[112:115], v[20:23]
    v_mfma_f32_16x16x32_bf16 v[24:27], a[16:19], v[116:119], v[24:27]
    ds_read_b128 v[88:91], v133 offset:12288
    buffer_load_dwordx4 a[16:19], v128, s[16:19], s35 offen offset:3072
    v_mfma_f32_16x16x32_bf16 v[28:31], a[20:23], v[100:103], v[28:31]
    v_mfma_f32_16x16x32_bf16 v[32:35], a[20:23], v[104:107], v[32:35]
    ds_read_b128 v[92:95], v133 offset:13312
    v_mfma_f32_16x16x32_bf16 v[36:39], a[20:23], v[108:111], v[36:39]
    v_mfma_f32_16x16x32_bf16 v[40:43], a[20:23], v[112:115], v[40:43]
    ds_read_b128 v[96:99], v133 offset:14336
    v_mfma_f32_16x16x32_bf16 v[44:47], a[20:23], v[116:119], v[44:47]
    buffer_load_dwordx4 a[20:23], v129, s[16:19], s35 offen offset:0
    v_mfma_f32_16x16x32_bf16 v[48:51], a[24:27], v[100:103], v[48:51]
    v_mfma_f32_16x16x32_bf16 v[52:55], a[24:27], v[104:107], v[52:55]
    v_mfma_f32_16x16x32_bf16 v[56:59], a[24:27], v[108:111], v[56:59]
    v_mfma_f32_16x16x32_bf16 v[60:63], a[24:27], v[112:115], v[60:63]
    v_mfma_f32_16x16x32_bf16 v[64:67], a[24:27], v[116:119], v[64:67]
    buffer_load_dwordx4 a[24:27], v129, s[16:19], s35 offen offset:1024
    s_add_u32 s35, s35, 14336
    s_waitcnt vmcnt(9) lgkmcnt(0)
    v_mfma_f32_16x16x32_bf16 v[8:11], a[32:35], v[80:83], v[8:11]
    ds_read_b128 v[100:103], v133 offset:15360
    v_mfma_f32_16x16x32_bf16 v[12:15], a[32:35], v[84:87], v[12:15]
    v_mfma_f32_16x16x32_bf16 v[16:19], a[32:35], v[88:91], v[16:19]
    ds_read_b128 v[104:107], v133 offset:16384
    v_mfma_f32_16x16x32_bf16 v[20:23], a[32:35], v[92:95], v[20:23]
    v_mfma_f32_16x16x32_bf16 v[24:27], a[32:35], v[96:99], v[24:27]
    ds_read_b128 v[108:111], v133 offset:17408
    v_mfma_f32_16x16x32_bf16 v[28:31], a[36:39], v[80:83], v[28:31]
    v_mfma_f32_16x16x32_bf16 v[32:35], a[36:39], v[84:87], v[32:35]
    ds_read_b128 v[112:115], v133 offset:18432
    v_mfma_f32_16x16x32_bf16 v[36:39], a[36:39], v[88:91], v[36:39]
    v_mfma_f32_16x16x32_bf16 v[40:43], a[36:39], v[92:95], v[40:43]
    ds_read_b128 v[116:119], v133 offset:19456
    v_mfma_f32_16x16x32_bf16 v[44:47], a[36:39], v[96:99], v[44:47]
    v_mfma_f32_16x16x32_bf16 v[48:51], a[40:43], v[80:83], v[48:51]
    v_mfma_f32_16x16x32_bf16 v[52:55], a[40:43], v[84:87], v[52:55]
    v_mfma_f32_16x16x32_bf16 v[56:59], a[40:43], v[88:91], v[56:59]
    v_mfma_f32_16x16x32_bf16 v[60:63], a[40:43], v[92:95], v[60:63]
    v_mfma_f32_16x16x32_bf16 v[64:67], a[40:43], v[96:99], v[64:67]
    s_waitcnt vmcnt(6) lgkmcnt(0)
    s_barrier
    v_mfma_f32_16x16x32_bf16 v[8:11], a[48:51], v[100:103], v[8:11]
    ds_read_b128 v[80:83], v133 offset:20480
    v_mfma_f32_16x16x32_bf16 v[12:15], a[48:51], v[104:107], v[12:15]
    v_mfma_f32_16x16x32_bf16 v[16:19], a[48:51], v[108:111], v[16:19]
    ds_read_b128 v[84:87], v133 offset:21504
    v_mfma_f32_16x16x32_bf16 v[20:23], a[48:51], v[112:115], v[20:23]
    v_mfma_f32_16x16x32_bf16 v[24:27], a[48:51], v[116:119], v[24:27]
    ds_read_b128 v[88:91], v133 offset:22528
    v_mfma_f32_16x16x32_bf16 v[28:31], a[52:55], v[100:103], v[28:31]
    v_mfma_f32_16x16x32_bf16 v[32:35], a[52:55], v[104:107], v[32:35]
    ds_read_b128 v[92:95], v133 offset:23552
    v_mfma_f32_16x16x32_bf16 v[36:39], a[52:55], v[108:111], v[36:39]
    v_mfma_f32_16x16x32_bf16 v[40:43], a[52:55], v[112:115], v[40:43]
    ds_read_b128 v[96:99], v133 offset:24576
    v_mfma_f32_16x16x32_bf16 v[44:47], a[52:55], v[116:119], v[44:47]
    v_mfma_f32_16x16x32_bf16 v[48:51], a[56:59], v[100:103], v[48:51]
    v_mfma_f32_16x16x32_bf16 v[52:55], a[56:59], v[104:107], v[52:55]
    v_mfma_f32_16x16x32_bf16 v[56:59], a[56:59], v[108:111], v[56:59]
    v_mfma_f32_16x16x32_bf16 v[60:63], a[56:59], v[112:115], v[60:63]
    v_mfma_f32_16x16x32_bf16 v[64:67], a[56:59], v[116:119], v[64:67]
    v_and_b32 v3, 15, v1
    v_mul_u32_u24 v5, 304, v3
    v_lshl_add_u32 v5, v4, 4, v5
    v_add_u32 v5, 115200, v5
    ds_read_b128 v[100:103], v133 offset:25600
    ds_read_b128 v[104:107], v133 offset:26624
    ds_read_b128 v[108:111], v133 offset:27648
    ds_read_b128 v[112:115], v133 offset:28672
    ds_read_b128 v[116:119], v133 offset:29696
    v_mul_u32_u24 v3, 144, v3
    v_lshl_add_u32 v3, v4, 3, v3
    v_add_u32 v3, 92160, v3
    s_waitcnt vmcnt(0) lgkmcnt(5)
    v_mfma_f32_16x16x32_bf16 v[8:11], a[0:3], v[80:83], v[8:11]
    v_mfma_f32_16x16x32_bf16 v[12:15], a[0:3], v[84:87], v[12:15]
    v_mfma_f32_16x16x32_bf16 v[16:19], a[0:3], v[88:91], v[16:19]
    v_mfma_f32_16x16x32_bf16 v[20:23], a[0:3], v[92:95], v[20:23]
    v_mfma_f32_16x16x32_bf16 v[24:27], a[0:3], v[96:99], v[24:27]
    s_waitcnt lgkmcnt(0)
    v_mfma_f32_16x16x32_bf16 v[8:11], a[16:19], v[100:103], v[8:11]
    v_mfma_f32_16x16x32_bf16 v[12:15], a[16:19], v[104:107], v[12:15]
    v_mfma_f32_16x16x32_bf16 v[16:19], a[16:19], v[108:111], v[16:19]
    v_mfma_f32_16x16x32_bf16 v[20:23], a[16:19], v[112:115], v[20:23]
    v_mfma_f32_16x16x32_bf16 v[24:27], a[16:19], v[116:119], v[24:27]
    v_mfma_f32_16x16x32_bf16 v[28:31], a[4:7], v[80:83], v[28:31]
    v_mfma_f32_16x16x32_bf16 v[32:35], a[4:7], v[84:87], v[32:35]
    v_mfma_f32_16x16x32_bf16 v[36:39], a[4:7], v[88:91], v[36:39]
    v_mfma_f32_16x16x32_bf16 v[40:43], a[4:7], v[92:95], v[40:43]
    v_mfma_f32_16x16x32_bf16 v[44:47], a[4:7], v[96:99], v[44:47]
    v_cvt_pk_bf16_f32 v120, v8, v9
    v_cvt_pk_bf16_f32 v121, v10, v11
    ds_write_b64 v3, v[120:121] offset:96
    v_mfma_f32_16x16x32_bf16 v[28:31], a[20:23], v[100:103], v[28:31]
    v_cvt_pk_bf16_f32 v122, v12, v13
    v_cvt_pk_bf16_f32 v123, v14, v15
    ds_write_b64 v3, v[122:123] offset:2400
    v_mfma_f32_16x16x32_bf16 v[32:35], a[20:23], v[104:107], v[32:35]
    v_cvt_pk_bf16_f32 v124, v16, v17
    v_cvt_pk_bf16_f32 v125, v18, v19
    ds_write_b64 v3, v[124:125] offset:4704
    v_mfma_f32_16x16x32_bf16 v[36:39], a[20:23], v[108:111], v[36:39]
    v_cvt_pk_bf16_f32 v126, v20, v21
    v_cvt_pk_bf16_f32 v127, v22, v23
    ds_write_b64 v3, v[126:127] offset:7008
    v_mfma_f32_16x16x32_bf16 v[40:43], a[20:23], v[112:115], v[40:43]
    v_cvt_pk_bf16_f32 v120, v24, v25
    v_cvt_pk_bf16_f32 v121, v26, v27
    ds_write_b64 v3, v[120:121] offset:9312
    v_mfma_f32_16x16x32_bf16 v[44:47], a[20:23], v[116:119], v[44:47]
    v_mfma_f32_16x16x32_bf16 v[48:51], a[8:11], v[80:83], v[48:51]
    v_mfma_f32_16x16x32_bf16 v[52:55], a[8:11], v[84:87], v[52:55]
    v_mfma_f32_16x16x32_bf16 v[56:59], a[8:11], v[88:91], v[56:59]
    v_mfma_f32_16x16x32_bf16 v[60:63], a[8:11], v[92:95], v[60:63]
    v_mfma_f32_16x16x32_bf16 v[64:67], a[8:11], v[96:99], v[64:67]
    ds_write_b128 v5, v[28:31] offset:0
    ds_write_b128 v5, v[32:35] offset:4864
    v_mfma_f32_16x16x32_bf16 v[48:51], a[24:27], v[100:103], v[48:51]
    ds_write_b128 v5, v[36:39] offset:9728
    ds_write_b128 v5, v[40:43] offset:14592
    v_mfma_f32_16x16x32_bf16 v[52:55], a[24:27], v[104:107], v[52:55]
    ds_write_b128 v5, v[44:47] offset:19456
    v_mfma_f32_16x16x32_bf16 v[56:59], a[24:27], v[108:111], v[56:59]
    v_mfma_f32_16x16x32_bf16 v[60:63], a[24:27], v[112:115], v[60:63]
    v_mfma_f32_16x16x32_bf16 v[64:67], a[24:27], v[116:119], v[64:67]
    s_nop 4
    ds_write_b128 v5, v[48:51] offset:64
    ds_write_b128 v5, v[52:55] offset:4928
    ds_write_b128 v5, v[56:59] offset:9792
    ds_write_b128 v5, v[60:63] offset:14656
    ds_write_b128 v5, v[64:67] offset:19520
    s_branch L1_att
L1_w2:
    s_waitcnt lgkmcnt(0)
    s_add_u32 s26, s24, s34
    s_addc_u32 s27, s25, 0
    s_mov_b32 s16, s26
    s_and_b32 s17, s27, 0xffff
    s_mov_b32 s18, 0x3f000
    s_mov_b32 s19, 0x00020000
    buffer_load_dwordx4 a[0:3], v129, s[16:19], s35 offen offset:2048
    buffer_load_dwordx4 a[4:7], v129, s[16:19], s35 offen offset:3072
    buffer_load_dwordx4 a[8:11], v130, s[16:19], s35 offen offset:1024
    buffer_load_dwordx4 a[12:15], v130, s[16:19], s35 offen offset:2048
    s_add_u32 s35, s35, 14336
    v_mov_b32 v8, 0
    v_mov_b32 v9, 0
    v_mov_b32 v10, 0
    v_mov_b32 v11, 0
    v_mov_b32 v12, 0
    v_mov_b32 v13, 0
    v_mov_b32 v14, 0
    v_mov_b32 v15, 0
    v_mov_b32 v16, 0
    v_mov_b32 v17, 0
    v_mov_b32 v18, 0
    v_mov_b32 v19, 0
    v_mov_b32 v20, 0
    v_mov_b32 v21, 0
    v_mov_b32 v22, 0
    v_mov_b32 v23, 0
    v_mov_b32 v24, 0
    v_mov_b32 v25, 0
    v_mov_b32 v26, 0
    v_mov_b32 v27, 0
    v_mov_b32 v28, 0
    v_mov_b32 v29, 0
    v_mov_b32 v30, 0
    v_mov_b32 v31, 0
    v_mov_b32 v32, 0
    v_mov_b32 v33, 0
    v_mov_b32 v34, 0
    v_mov_b32 v35, 0
    v_mov_b32 v36, 0
    v_mov_b32 v37, 0
    v_mov_b32 v38, 0
    v_mov_b32 v39, 0
    v_mov_b32 v40, 0
    v_mov_b32 v41, 0
    v_mov_b32 v42, 0
    v_mov_b32 v43, 0
    v_mov_b32 v44, 0
    v_mov_b32 v45, 0
    v_mov_b32 v46, 0
    v_mov_b32 v47, 0
    v_mov_b32 v48, 0
    v_mov_b32 v49, 0
    v_mov_b32 v50, 0
    v_mov_b32 v51, 0
    v_mov_b32 v52, 0
    v_mov_b32 v53, 0
    v_mov_b32 v54, 0
    v_mov_b32 v55, 0
    v_mov_b32 v56, 0
    v_mov_b32 v57, 0
    v_mov_b32 v58, 0
    v_mov_b32 v59, 0
    v_mov_b32 v60, 0
    v_mov_b32 v61, 0
    v_mov_b32 v62, 0
    v_mov_b32 v63, 0
    v_mov_b32 v64, 0
    v_mov_b32 v65, 0
    v_mov_b32 v66, 0
    v_mov_b32 v67, 0
    v_mov_b32 v68, 0
    v_mov_b32 v69, 0
    v_mov_b32 v70, 0
    v_mov_b32 v71, 0
    v_mov_b32 v72, 0
    v_mov_b32 v73, 0
    v_mov_b32 v74, 0
    v_mov_b32 v75, 0
    v_mov_b32 v76, 0
    v_mov_b32 v77, 0
    v_mov_b32 v78, 0
    v_mov_b32 v79, 0
    s_barrier
    buffer_load_dwordx4 a[16:19], v129, s[16:19], s35 offen offset:2048
    buffer_load_dwordx4 a[20:23], v129, s[16:19], s35 offen offset:3072
    buffer_load_dwordx4 a[24:27], v130, s[16:19], s35 offen offset:1024
    buffer_load_dwordx4 a[28:31], v130, s[16:19], s35 offen offset:2048
    s_add_u32 s35, s35, 14336
    buffer_load_dwordx4 a[32:35], v129, s[16:19], s35 offen offset:2048
    buffer_load_dwordx4 a[36:39], v129, s[16:19], s35 offen offset:3072
    buffer_load_dwordx4 a[40:43], v130, s[16:19], s35 offen offset:1024
    buffer_load_dwordx4 a[44:47], v130, s[16:19], s35 offen offset:2048
    s_add_u32 s35, s35, 14336
    buffer_load_dwordx4 a[48:51], v129, s[16:19], s35 offen offset:2048
    buffer_load_dwordx4 a[52:55], v129, s[16:19], s35 offen offset:3072
    buffer_load_dwordx4 a[56:59], v130, s[16:19], s35 offen offset:1024
    buffer_load_dwordx4 a[60:63], v130, s[16:19], s35 offen offset:2048
    s_add_u32 s35, s35, 14336
    s_mov_b32 s12, s24
    s_and_b32 s13, s25, 0xffff
    s_mov_b32 s14, 0x10000000
    s_mov_b32 s15, 0x00020000
    s_setprio 2
    v_add_u32 v133, 61440, v132
    s_barrier
    ds_read_b128 v[80:83], v132 offset:0
    ds_read_b128 v[84:87], v132 offset:1024
    ds_read_b128 v[88:91], v132 offset:2048
    ds_read_b128 v[92:95], v132 offset:3072
    ds_read_b128 v[96:99], v132 offset:4096
    s_waitcnt vmcnt(12) lgkmcnt(0)
    v_mfma_f32_16x16x32_bf16 v[8:11], a[0:3], v[80:83], v[8:11]
    ds_read_b128 v[100:103], v132 offset:5120
    v_mfma_f32_16x16x32_bf16 v[12:15], a[0:3], v[84:87], v[12:15]
    v_mfma_f32_16x16x32_bf16 v[16:19], a[0:3], v[88:91], v[16:19]
    ds_read_b128 v[104:107], v132 offset:6144
    v_mfma_f32_16x16x32_bf16 v[20:23], a[0:3], v[92:95], v[20:23]
    v_mfma_f32_16x16x32_bf16 v[24:27], a[0:3], v[96:99], v[24:27]
    ds_read_b128 v[108:111], v132 offset:7168
    buffer_load_dwordx4 a[0:3], v129, s[16:19], s35 offen offset:2048
    v_mfma_f32_16x16x32_bf16 v[28:31], a[4:7], v[80:83], v[28:31]
    v_mfma_f32_16x16x32_bf16 v[32:35], a[4:7], v[84:87], v[32:35]
    ds_read_b128 v[112:115], v132 offset:8192
    v_mfma_f32_16x16x32_bf16 v[36:39], a[4:7], v[88:91], v[36:39]
    v_mfma_f32_16x16x32_bf16 v[40:43], a[4:7], v[92:95], v[40:43]
    ds_read_b128 v[116:119], v132 offset:9216
    v_mfma_f32_16x16x32_bf16 v[44:47], a[4:7], v[96:99], v[44:47]
    buffer_load_dwordx4 a[4:7], v129, s[16:19], s35 offen offset:3072
    v_mfma_f32_16x16x32_bf16 v[48:51], a[8:11], v[84:87], v[48:51]
    v_mfma_f32_16x16x32_bf16 v[52:55], a[8:11], v[88:91], v[52:55]
    v_mfma_f32_16x16x32_bf16 v[56:59], a[8:11], v[92:95], v[56:59]
    v_mfma_f32_16x16x32_bf16 v[60:63], a[8:11], v[96:99], v[60:63]
    buffer_load_dwordx4 a[8:11], v130, s[16:19], s35 offen offset:1024
    v_mfma_f32_16x16x32_bf16 v[64:67], a[12:15], v[84:87], v[64:67]
    v_mfma_f32_16x16x32_bf16 v[68:71], a[12:15], v[88:91], v[68:71]
    v_mfma_f32_16x16x32_bf16 v[72:75], a[12:15], v[92:95], v[72:75]
    v_mfma_f32_16x16x32_bf16 v[76:79], a[12:15], v[96:99], v[76:79]
    buffer_load_dwordx4 a[12:15], v130, s[16:19], s35 offen offset:2048
    s_add_u32 s35, s35, 14336
    s_waitcnt vmcnt(12) lgkmcnt(0)
    v_mfma_f32_16x16x32_bf16 v[8:11], a[16:19], v[100:103], v[8:11]
    ds_read_b128 v[80:83], v132 offset:10240
    v_mfma_f32_16x16x32_bf16 v[12:15], a[16:19], v[104:107], v[12:15]
    v_mfma_f32_16x16x32_bf16 v[16:19], a[16:19], v[108:111], v[16:19]
    ds_read_b128 v[84:87], v132 offset:11264
    v_mfma_f32_16x16x32_bf16 v[20:23], a[16:19], v[112:115], v[20:23]
    v_mfma_f32_16x16x32_bf16 v[24:27], a[16:19], v[116:119], v[24:27]
    ds_read_b128 v[88:91], v132 offset:12288
    buffer_load_dwordx4 a[16:19], v129, s[16:19], s35 offen offset:2048
    v_mfma_f32_16x16x32_bf16 v[28:31], a[20:23], v[100:103], v[28:31]
    v_mfma_f32_16x16x32_bf16 v[32:35], a[20:23], v[104:107], v[32:35]
    ds_read_b128 v[92:95], v132 offset:13312
    v_mfma_f32_16x16x32_bf16 v[36:39], a[20:23], v[108:111], v[36:39]
    v_mfma_f32_16x16x32_bf16 v[40:43], a[20:23], v[112:115], v[40:43]
    ds_read_b128 v[96:99], v132 offset:14336
    v_mfma_f32_16x16x32_bf16 v[44:47], a[20:23], v[116:119], v[44:47]
    buffer_load_dwordx4 a[20:23], v129, s[16:19], s35 offen offset:3072
    v_mfma_f32_16x16x32_bf16 v[48:51], a[24:27], v[104:107], v[48:51]
    v_mfma_f32_16x16x32_bf16 v[52:55], a[24:27], v[108:111], v[52:55]
    v_mfma_f32_16x16x32_bf16 v[56:59], a[24:27], v[112:115], v[56:59]
    v_mfma_f32_16x16x32_bf16 v[60:63], a[24:27], v[116:119], v[60:63]
    buffer_load_dwordx4 a[24:27], v130, s[16:19], s35 offen offset:1024
    v_mfma_f32_16x16x32_bf16 v[64:67], a[28:31], v[104:107], v[64:67]
    v_mfma_f32_16x16x32_bf16 v[68:71], a[28:31], v[108:111], v[68:71]
    v_mfma_f32_16x16x32_bf16 v[72:75], a[28:31], v[112:115], v[72:75]
    v_mfma_f32_16x16x32_bf16 v[76:79], a[28:31], v[116:119], v[76:79]
    buffer_load_dwordx4 a[28:31], v130, s[16:19], s35 offen offset:2048
    s_add_u32 s35, s35, 14336
    s_waitcnt vmcnt(12) lgkmcnt(0)
    v_mfma_f32_16x16x32_bf16 v[8:11], a[32:35], v[80:83], v[8:11]
    ds_read_b128 v[100:103], v132 offset:15360
    v_mfma_f32_16x16x32_bf16 v[12:15], a[32:35], v[84:87], v[12:15]
    v_mfma_f32_16x16x32_bf16 v[16:19], a[32:35], v[88:91], v[16:19]
    ds_read_b128 v[104:107], v132 offset:16384
    v_mfma_f32_16x16x32_bf16 v[20:23], a[32:35], v[92:95], v[20:23]
    v_mfma_f32_16x16x32_bf16 v[24:27], a[32:35], v[96:99], v[24:27]
    ds_read_b128 v[108:111], v132 offset:17408
    buffer_load_dwordx4 a[32:35], v129, s[16:19], s35 offen offset:2048
    v_mfma_f32_16x16x32_bf16 v[28:31], a[36:39], v[80:83], v[28:31]
    v_mfma_f32_16x16x32_bf16 v[32:35], a[36:39], v[84:87], v[32:35]
    ds_read_b128 v[112:115], v132 offset:18432
    v_mfma_f32_16x16x32_bf16 v[36:39], a[36:39], v[88:91], v[36:39]
    v_mfma_f32_16x16x32_bf16 v[40:43], a[36:39], v[92:95], v[40:43]
    ds_read_b128 v[116:119], v132 offset:19456
    v_mfma_f32_16x16x32_bf16 v[44:47], a[36:39], v[96:99], v[44:47]
    buffer_load_dwordx4 a[36:39], v129, s[16:19], s35 offen offset:3072
    v_mfma_f32_16x16x32_bf16 v[48:51], a[40:43], v[84:87], v[48:51]
    v_mfma_f32_16x16x32_bf16 v[52:55], a[40:43], v[88:91], v[52:55]
    v_mfma_f32_16x16x32_bf16 v[56:59], a[40:43], v[92:95], v[56:59]
    v_mfma_f32_16x16x32_bf16 v[60:63], a[40:43], v[96:99], v[60:63]
    buffer_load_dwordx4 a[40:43], v130, s[16:19], s35 offen offset:1024
    v_mfma_f32_16x16x32_bf16 v[64:67], a[44:47], v[84:87], v[64:67]
    v_mfma_f32_16x16x32_bf16 v[68:71], a[44:47], v[88:91], v[68:71]
    v_mfma_f32_16x16x32_bf16 v[72:75], a[44:47], v[92:95], v[72:75]
    v_mfma_f32_16x16x32_bf16 v[76:79], a[44:47], v[96:99], v[76:79]
    buffer_load_dwordx4 a[44:47], v130, s[16:19], s35 offen offset:2048
    s_add_u32 s35, s35, 14336
    s_waitcnt vmcnt(12) lgkmcnt(0)
    s_barrier
    v_mfma_f32_16x16x32_bf16 v[8:11], a[48:51], v[100:103], v[8:11]
    ds_read_b128 v[80:83], v132 offset:20480
    v_mfma_f32_16x16x32_bf16 v[12:15], a[48:51], v[104:107], v[12:15]
    v_mfma_f32_16x16x32_bf16 v[16:19], a[48:51], v[108:111], v[16:19]
    ds_read_b128 v[84:87], v132 offset:21504
    v_mfma_f32_16x16x32_bf16 v[20:23], a[48:51], v[112:115], v[20:23]
    v_mfma_f32_16x16x32_bf16 v[24:27], a[48:51], v[116:119], v[24:27]
    ds_read_b128 v[88:91], v132 offset:22528
    buffer_load_dwordx4 a[48:51], v129, s[16:19], s35 offen offset:2048
    v_mfma_f32_16x16x32_bf16 v[28:31], a[52:55], v[100:103], v[28:31]
    v_mfma_f32_16x16x32_bf16 v[32:35], a[52:55], v[104:107], v[32:35]
    ds_read_b128 v[92:95], v132 offset:23552
    v_mfma_f32_16x16x32_bf16 v[36:39], a[52:55], v[108:111], v[36:39]
    v_mfma_f32_16x16x32_bf16 v[40:43], a[52:55], v[112:115], v[40:43]
    ds_read_b128 v[96:99], v132 offset:24576
    v_mfma_f32_16x16x32_bf16 v[44:47], a[52:55], v[116:119], v[44:47]
    buffer_load_dwordx4 a[52:55], v129, s[16:19], s35 offen offset:3072
    v_mfma_f32_16x16x32_bf16 v[48:51], a[56:59], v[104:107], v[48:51]
    v_mfma_f32_16x16x32_bf16 v[52:55], a[56:59], v[108:111], v[52:55]
    v_mfma_f32_16x16x32_bf16 v[56:59], a[56:59], v[112:115], v[56:59]
    v_mfma_f32_16x16x32_bf16 v[60:63], a[56:59], v[116:119], v[60:63]
    buffer_load_dwordx4 a[56:59], v130, s[16:19], s35 offen offset:1024
    v_mfma_f32_16x16x32_bf16 v[64:67], a[60:63], v[104:107], v[64:67]
    v_mfma_f32_16x16x32_bf16 v[68:71], a[60:63], v[108:111], v[68:71]
    v_mfma_f32_16x16x32_bf16 v[72:75], a[60:63], v[112:115], v[72:75]
    v_mfma_f32_16x16x32_bf16 v[76:79], a[60:63], v[116:119], v[76:79]
    buffer_load_dwordx4 a[60:63], v130, s[16:19], s35 offen offset:2048
    s_add_u32 s35, s35, 14336
    s_waitcnt vmcnt(12) lgkmcnt(0)
    v_mfma_f32_16x16x32_bf16 v[8:11], a[0:3], v[80:83], v[8:11]
    ds_read_b128 v[100:103], v132 offset:25600
    v_mfma_f32_16x16x32_bf16 v[12:15], a[0:3], v[84:87], v[12:15]
    v_mfma_f32_16x16x32_bf16 v[16:19], a[0:3], v[88:91], v[16:19]
    ds_read_b128 v[104:107], v132 offset:26624
    v_mfma_f32_16x16x32_bf16 v[20:23], a[0:3], v[92:95], v[20:23]
    v_mfma_f32_16x16x32_bf16 v[24:27], a[0:3], v[96:99], v[24:27]
    ds_read_b128 v[108:111], v132 offset:27648
    buffer_load_dwordx4 a[0:3], v129, s[16:19], s35 offen offset:2048
    v_mfma_f32_16x16x32_bf16 v[28:31], a[4:7], v[80:83], v[28:31]
    v_mfma_f32_16x16x32_bf16 v[32:35], a[4:7], v[84:87], v[32:35]
    ds_read_b128 v[112:115], v132 offset:28672
    v_mfma_f32_16x16x32_bf16 v[36:39], a[4:7], v[88:91], v[36:39]
    v_mfma_f32_16x16x32_bf16 v[40:43], a[4:7], v[92:95], v[40:43]
    ds_read_b128 v[116:119], v132 offset:29696
    v_mfma_f32_16x16x32_bf16 v[44:47], a[4:7], v[96:99], v[44:47]
    buffer_load_dwordx4 a[4:7], v129, s[16:19], s35 offen offset:3072
    v_mfma_f32_16x16x32_bf16 v[48:51], a[8:11], v[84:87], v[48:51]
    v_mfma_f32_16x16x32_bf16 v[52:55], a[8:11], v[88:91], v[52:55]
    v_mfma_f32_16x16x32_bf16 v[56:59], a[8:11], v[92:95], v[56:59]
    v_mfma_f32_16x16x32_bf16 v[60:63], a[8:11], v[96:99], v[60:63]
    buffer_load_dwordx4 a[8:11], v130, s[16:19], s35 offen offset:1024
    v_mfma_f32_16x16x32_bf16 v[64:67], a[12:15], v[84:87], v[64:67]
    v_mfma_f32_16x16x32_bf16 v[68:71], a[12:15], v[88:91], v[68:71]
    v_mfma_f32_16x16x32_bf16 v[72:75], a[12:15], v[92:95], v[72:75]
    v_mfma_f32_16x16x32_bf16 v[76:79], a[12:15], v[96:99], v[76:79]
    buffer_load_dwordx4 a[12:15], v130, s[16:19], s35 offen offset:2048
    s_add_u32 s35, s35, 14336
    s_waitcnt vmcnt(12) lgkmcnt(0)
    v_mfma_f32_16x16x32_bf16 v[8:11], a[16:19], v[100:103], v[8:11]
    ds_read_b128 v[80:83], v132 offset:30720
    v_mfma_f32_16x16x32_bf16 v[12:15], a[16:19], v[104:107], v[12:15]
    v_mfma_f32_16x16x32_bf16 v[16:19], a[16:19], v[108:111], v[16:19]
    ds_read_b128 v[84:87], v132 offset:31744
    v_mfma_f32_16x16x32_bf16 v[20:23], a[16:19], v[112:115], v[20:23]
    v_mfma_f32_16x16x32_bf16 v[24:27], a[16:19], v[116:119], v[24:27]
    ds_read_b128 v[88:91], v132 offset:32768
    buffer_load_dwordx4 a[16:19], v129, s[16:19], s35 offen offset:2048
    v_mfma_f32_16x16x32_bf16 v[28:31], a[20:23], v[100:103], v[28:31]
    v_mfma_f32_16x16x32_bf16 v[32:35], a[20:23], v[104:107], v[32:35]
    ds_read_b128 v[92:95], v132 offset:33792
    v_mfma_f32_16x16x32_bf16 v[36:39], a[20:23], v[108:111], v[36:39]
    v_mfma_f32_16x16x32_bf16 v[40:43], a[20:23], v[112:115], v[40:43]
    ds_read_b128 v[96:99], v132 offset:34816
    v_mfma_f32_16x16x32_bf16 v[44:47], a[20:23], v[116:119], v[44:47]
    buffer_load_dwordx4 a[20:23], v129, s[16:19], s35 offen offset:3072
    v_mfma_f32_16x16x32_bf16 v[48:51], a[24:27], v[104:107], v[48:51]
    v_mfma_f32_16x16x32_bf16 v[52:55], a[24:27], v[108:111], v[52:55]
    v_mfma_f32_16x16x32_bf16 v[56:59], a[24:27], v[112:115], v[56:59]
    v_mfma_f32_16x16x32_bf16 v[60:63], a[24:27], v[116:119], v[60:63]
    buffer_load_dwordx4 a[24:27], v130, s[16:19], s35 offen offset:1024
    v_mfma_f32_16x16x32_bf16 v[64:67], a[28:31], v[104:107], v[64:67]
    v_mfma_f32_16x16x32_bf16 v[68:71], a[28:31], v[108:111], v[68:71]
    v_mfma_f32_16x16x32_bf16 v[72:75], a[28:31], v[112:115], v[72:75]
    v_mfma_f32_16x16x32_bf16 v[76:79], a[28:31], v[116:119], v[76:79]
    buffer_load_dwordx4 a[28:31], v130, s[16:19], s35 offen offset:2048
    s_add_u32 s35, s35, 14336
    s_waitcnt vmcnt(12) lgkmcnt(0)
    v_mfma_f32_16x16x32_bf16 v[8:11], a[32:35], v[80:83], v[8:11]
    ds_read_b128 v[100:103], v132 offset:35840
    v_mfma_f32_16x16x32_bf16 v[12:15], a[32:35], v[84:87], v[12:15]
    v_mfma_f32_16x16x32_bf16 v[16:19], a[32:35], v[88:91], v[16:19]
    ds_read_b128 v[104:107], v132 offset:36864
    v_mfma_f32_16x16x32_bf16 v[20:23], a[32:35], v[92:95], v[20:23]
    v_mfma_f32_16x16x32_bf16 v[24:27], a[32:35], v[96:99], v[24:27]
    ds_read_b128 v[108:111], v132 offset:37888
    buffer_load_dwordx4 a[32:35], v129, s[16:19], s35 offen offset:2048
    v_mfma_f32_16x16x32_bf16 v[28:31], a[36:39], v[80:83], v[28:31]
    v_mfma_f32_16x16x32_bf16 v[32:35], a[36:39], v[84:87], v[32:35]
    ds_read_b128 v[112:115], v132 offset:38912
    v_mfma_f32_16x16x32_bf16 v[36:39], a[36:39], v[88:91], v[36:39]
    v_mfma_f32_16x16x32_bf16 v[40:43], a[36:39], v[92:95], v[40:43]
    ds_read_b128 v[116:119], v132 offset:39936
    v_mfma_f32_16x16x32_bf16 v[44:47], a[36:39], v[96:99], v[44:47]
    buffer_load_dwordx4 a[36:39], v129, s[16:19], s35 offen offset:3072
    v_mfma_f32_16x16x32_bf16 v[48:51], a[40:43], v[84:87], v[48:51]
    v_mfma_f32_16x16x32_bf16 v[52:55], a[40:43], v[88:91], v[52:55]
    v_mfma_f32_16x16x32_bf16 v[56:59], a[40:43], v[92:95], v[56:59]
    v_mfma_f32_16x16x32_bf16 v[60:63], a[40:43], v[96:99], v[60:63]
    buffer_load_dwordx4 a[40:43], v130, s[16:19], s35 offen offset:1024
    v_mfma_f32_16x16x32_bf16 v[64:67], a[44:47], v[84:87], v[64:67]
    v_mfma_f32_16x16x32_bf16 v[68:71], a[44:47], v[88:91], v[68:71]
    v_mfma_f32_16x16x32_bf16 v[72:75], a[44:47], v[92:95], v[72:75]
    v_mfma_f32_16x16x32_bf16 v[76:79], a[44:47], v[96:99], v[76:79]
    buffer_load_dwordx4 a[44:47], v130, s[16:19], s35 offen offset:2048
    s_add_u32 s35, s35, 14336
    s_waitcnt vmcnt(12) lgkmcnt(0)
    s_barrier
    v_mfma_f32_16x16x32_bf16 v[8:11], a[48:51], v[100:103], v[8:11]
    ds_read_b128 v[80:83], v132 offset:40960
    v_mfma_f32_16x16x32_bf16 v[12:15], a[48:51], v[104:107], v[12:15]
    v_mfma_f32_16x16x32_bf16 v[16:19], a[48:51], v[108:111], v[16:19]
    ds_read_b128 v[84:87], v132 offset:41984
    v_mfma_f32_16x16x32_bf16 v[20:23], a[48:51], v[112:115], v[20:23]
    v_mfma_f32_16x16x32_bf16 v[24:27], a[48:51], v[116:119], v[24:27]
    ds_read_b128 v[88:91], v132 offset:43008
    buffer_load_dwordx4 a[48:51], v129, s[16:19], s35 offen offset:2048
    v_mfma_f32_16x16x32_bf16 v[28:31], a[52:55], v[100:103], v[28:31]
    v_mfma_f32_16x16x32_bf16 v[32:35], a[52:55], v[104:107], v[32:35]
    ds_read_b128 v[92:95], v132 offset:44032
    v_mfma_f32_16x16x32_bf16 v[36:39], a[52:55], v[108:111], v[36:39]
    v_mfma_f32_16x16x32_bf16 v[40:43], a[52:55], v[112:115], v[40:43]
    ds_read_b128 v[96:99], v132 offset:45056
    v_mfma_f32_16x16x32_bf16 v[44:47], a[52:55], v[116:119], v[44:47]
    buffer_load_dwordx4 a[52:55], v129, s[16:19], s35 offen offset:3072
    v_mfma_f32_16x16x32_bf16 v[48:51], a[56:59], v[104:107], v[48:51]
    v_mfma_f32_16x16x32_bf16 v[52:55], a[56:59], v[108:111], v[52:55]
    v_mfma_f32_16x16x32_bf16 v[56:59], a[56:59], v[112:115], v[56:59]
    v_mfma_f32_16x16x32_bf16 v[60:63], a[56:59], v[116:119], v[60:63]
    buffer_load_dwordx4 a[56:59], v130, s[16:19], s35 offen offset:1024
    v_mfma_f32_16x16x32_bf16 v[64:67], a[60:63], v[104:107], v[64:67]
    v_mfma_f32_16x16x32_bf16 v[68:71], a[60:63], v[108:111], v[68:71]
    v_mfma_f32_16x16x32_bf16 v[72:75], a[60:63], v[112:115], v[72:75]
    v_mfma_f32_16x16x32_bf16 v[76:79], a[60:63], v[116:119], v[76:79]
    buffer_load_dwordx4 a[60:63], v130, s[16:19], s35 offen offset:2048
    s_add_u32 s35, s35, 14336
    s_waitcnt vmcnt(12) lgkmcnt(0)
    v_mfma_f32_16x16x32_bf16 v[8:11], a[0:3], v[80:83], v[8:11]
    ds_read_b128 v[100:103], v132 offset:46080
    v_mfma_f32_16x16x32_bf16 v[12:15], a[0:3], v[84:87], v[12:15]
    v_mfma_f32_16x16x32_bf16 v[16:19], a[0:3], v[88:91], v[16:19]
    ds_read_b128 v[104:107], v132 offset:47104
    v_mfma_f32_16x16x32_bf16 v[20:23], a[0:3], v[92:95], v[20:23]
    v_mfma_f32_16x16x32_bf16 v[24:27], a[0:3], v[96:99], v[24:27]
    ds_read_b128 v[108:111], v132 offset:48128
    buffer_load_dwordx4 a[0:3], v129, s[16:19], s35 offen offset:2048
    v_mfma_f32_16x16x32_bf16 v[28:31], a[4:7], v[80:83], v[28:31]
    v_mfma_f32_16x16x32_bf16 v[32:35], a[4:7], v[84:87], v[32:35]
    ds_read_b128 v[112:115], v132 offset:49152
    v_mfma_f32_16x16x32_bf16 v[36:39], a[4:7], v[88:91], v[36:39]
    v_mfma_f32_16x16x32_bf16 v[40:43], a[4:7], v[92:95], v[40:43]
    ds_read_b128 v[116:119], v132 offset:50176
    v_mfma_f32_16x16x32_bf16 v[44:47], a[4:7], v[96:99], v[44:47]
    buffer_load_dwordx4 a[4:7], v129, s[16:19], s35 offen offset:3072
    v_mfma_f32_16x16x32_bf16 v[48:51], a[8:11], v[84:87], v[48:51]
    v_mfma_f32_16x16x32_bf16 v[52:55], a[8:11], v[88:91], v[52:55]
    v_mfma_f32_16x16x32_bf16 v[56:59], a[8:11], v[92:95], v[56:59]
    v_mfma_f32_16x16x32_bf16 v[60:63], a[8:11], v[96:99], v[60:63]
    buffer_load_dwordx4 a[8:11], v130, s[16:19], s35 offen offset:1024
    v_mfma_f32_16x16x32_bf16 v[64:67], a[12:15], v[84:87], v[64:67]
    v_mfma_f32_16x16x32_bf16 v[68:71], a[12:15], v[88:91], v[68:71]
    v_mfma_f32_16x16x32_bf16 v[72:75], a[12:15], v[92:95], v[72:75]
    v_mfma_f32_16x16x32_bf16 v[76:79], a[12:15], v[96:99], v[76:79]
    buffer_load_dwordx4 a[12:15], v130, s[16:19], s35 offen offset:2048
    s_add_u32 s35, s35, 14336
    s_waitcnt vmcnt(12) lgkmcnt(0)
    v_mfma_f32_16x16x32_bf16 v[8:11], a[16:19], v[100:103], v[8:11]
    ds_read_b128 v[80:83], v132 offset:51200
    v_mfma_f32_16x16x32_bf16 v[12:15], a[16:19], v[104:107], v[12:15]
    v_mfma_f32_16x16x32_bf16 v[16:19], a[16:19], v[108:111], v[16:19]
    ds_read_b128 v[84:87], v132 offset:52224
    v_mfma_f32_16x16x32_bf16 v[20:23], a[16:19], v[112:115], v[20:23]
    v_mfma_f32_16x16x32_bf16 v[24:27], a[16:19], v[116:119], v[24:27]
    ds_read_b128 v[88:91], v132 offset:53248
    buffer_load_dwordx4 a[16:19], v129, s[16:19], s35 offen offset:2048
    v_mfma_f32_16x16x32_bf16 v[28:31], a[20:23], v[100:103], v[28:31]
    v_mfma_f32_16x16x32_bf16 v[32:35], a[20:23], v[104:107], v[32:35]
    ds_read_b128 v[92:95], v132 offset:54272
    v_mfma_f32_16x16x32_bf16 v[36:39], a[20:23], v[108:111], v[36:39]
    v_mfma_f32_16x16x32_bf16 v[40:43], a[20:23], v[112:115], v[40:43]
    ds_read_b128 v[96:99], v132 offset:55296
    v_mfma_f32_16x16x32_bf16 v[44:47], a[20:23], v[116:119], v[44:47]
    buffer_load_dwordx4 a[20:23], v129, s[16:19], s35 offen offset:3072
    v_mfma_f32_16x16x32_bf16 v[48:51], a[24:27], v[104:107], v[48:51]
    v_mfma_f32_16x16x32_bf16 v[52:55], a[24:27], v[108:111], v[52:55]
    v_mfma_f32_16x16x32_bf16 v[56:59], a[24:27], v[112:115], v[56:59]
    v_mfma_f32_16x16x32_bf16 v[60:63], a[24:27], v[116:119], v[60:63]
    buffer_load_dwordx4 a[24:27], v130, s[16:19], s35 offen offset:1024
    v_mfma_f32_16x16x32_bf16 v[64:67], a[28:31], v[104:107], v[64:67]
    v_mfma_f32_16x16x32_bf16 v[68:71], a[28:31], v[108:111], v[68:71]
    v_mfma_f32_16x16x32_bf16 v[72:75], a[28:31], v[112:115], v[72:75]
    v_mfma_f32_16x16x32_bf16 v[76:79], a[28:31], v[116:119], v[76:79]
    buffer_load_dwordx4 a[28:31], v130, s[16:19], s35 offen offset:2048
    s_add_u32 s35, s35, 14336
    s_waitcnt vmcnt(12) lgkmcnt(0)
    v_mfma_f32_16x16x32_bf16 v[8:11], a[32:35], v[80:83], v[8:11]
    ds_read_b128 v[100:103], v132 offset:56320
    v_mfma_f32_16x16x32_bf16 v[12:15], a[32:35], v[84:87], v[12:15]
    v_mfma_f32_16x16x32_bf16 v[16:19], a[32:35], v[88:91], v[16:19]
    ds_read_b128 v[104:107], v132 offset:57344
    v_mfma_f32_16x16x32_bf16 v[20:23], a[32:35], v[92:95], v[20:23]
    v_mfma_f32_16x16x32_bf16 v[24:27], a[32:35], v[96:99], v[24:27]
    ds_read_b128 v[108:111], v132 offset:58368
    buffer_load_dwordx4 a[32:35], v129, s[16:19], s35 offen offset:2048
    v_mfma_f32_16x16x32_bf16 v[28:31], a[36:39], v[80:83], v[28:31]
    v_mfma_f32_16x16x32_bf16 v[32:35], a[36:39], v[84:87], v[32:35]
    ds_read_b128 v[112:115], v132 offset:59392
    v_mfma_f32_16x16x32_bf16 v[36:39], a[36:39], v[88:91], v[36:39]
    v_mfma_f32_16x16x32_bf16 v[40:43], a[36:39], v[92:95], v[40:43]
    ds_read_b128 v[116:119], v132 offset:60416
    v_mfma_f32_16x16x32_bf16 v[44:47], a[36:39], v[96:99], v[44:47]
    buffer_load_dwordx4 a[36:39], v129, s[16:19], s35 offen offset:3072
    v_mfma_f32_16x16x32_bf16 v[48:51], a[40:43], v[84:87], v[48:51]
    v_mfma_f32_16x16x32_bf16 v[52:55], a[40:43], v[88:91], v[52:55]
    v_mfma_f32_16x16x32_bf16 v[56:59], a[40:43], v[92:95], v[56:59]
    v_mfma_f32_16x16x32_bf16 v[60:63], a[40:43], v[96:99], v[60:63]
    buffer_load_dwordx4 a[40:43], v130, s[16:19], s35 offen offset:1024
    v_mfma_f32_16x16x32_bf16 v[64:67], a[44:47], v[84:87], v[64:67]
    v_mfma_f32_16x16x32_bf16 v[68:71], a[44:47], v[88:91], v[68:71]
    v_mfma_f32_16x16x32_bf16 v[72:75], a[44:47], v[92:95], v[72:75]
    v_mfma_f32_16x16x32_bf16 v[76:79], a[44:47], v[96:99], v[76:79]
    buffer_load_dwordx4 a[44:47], v130, s[16:19], s35 offen offset:2048
    s_add_u32 s35, s35, 14336
    s_waitcnt vmcnt(12) lgkmcnt(0)
    s_barrier
    v_mfma_f32_16x16x32_bf16 v[8:11], a[48:51], v[100:103], v[8:11]
    ds_read_b128 v[80:83], v133 offset:0
    v_mfma_f32_16x16x32_bf16 v[12:15], a[48:51], v[104:107], v[12:15]
    v_mfma_f32_16x16x32_bf16 v[16:19], a[48:51], v[108:111], v[16:19]
    ds_read_b128 v[84:87], v133 offset:1024
    v_mfma_f32_16x16x32_bf16 v[20:23], a[48:51], v[112:115], v[20:23]
    v_mfma_f32_16x16x32_bf16 v[24:27], a[48:51], v[116:119], v[24:27]
    ds_read_b128 v[88:91], v133 offset:2048
    buffer_load_dwordx4 a[48:51], v129, s[16:19], s35 offen offset:2048
    v_mfma_f32_16x16x32_bf16 v[28:31], a[52:55], v[100:103], v[28:31]
    v_mfma_f32_16x16x32_bf16 v[32:35], a[52:55], v[104:107], v[32:35]
    ds_read_b128 v[92:95], v133 offset:3072
    v_mfma_f32_16x16x32_bf16 v[36:39], a[52:55], v[108:111], v[36:39]
    v_mfma_f32_16x16x32_bf16 v[40:43], a[52:55], v[112:115], v[40:43]
    ds_read_b128 v[96:99], v133 offset:4096
    v_mfma_f32_16x16x32_bf16 v[44:47], a[52:55], v[116:119], v[44:47]
    buffer_load_dwordx4 a[52:55], v129, s[16:19], s35 offen offset:3072
    v_mfma_f32_16x16x32_bf16 v[48:51], a[56:59], v[104:107], v[48:51]
    v_mfma_f32_16x16x32_bf16 v[52:55], a[56:59], v[108:111], v[52:55]
    v_mfma_f32_16x16x32_bf16 v[56:59], a[56:59], v[112:115], v[56:59]
    v_mfma_f32_16x16x32_bf16 v[60:63], a[56:59], v[116:119], v[60:63]
    buffer_load_dwordx4 a[56:59], v130, s[16:19], s35 offen offset:1024
    v_mfma_f32_16x16x32_bf16 v[64:67], a[60:63], v[104:107], v[64:67]
    v_mfma_f32_16x16x32_bf16 v[68:71], a[60:63], v[108:111], v[68:71]
    v_mfma_f32_16x16x32_bf16 v[72:75], a[60:63], v[112:115], v[72:75]
    v_mfma_f32_16x16x32_bf16 v[76:79], a[60:63], v[116:119], v[76:79]
    buffer_load_dwordx4 a[60:63], v130, s[16:19], s35 offen offset:2048
    s_add_u32 s35, s35, 14336
    s_waitcnt vmcnt(12) lgkmcnt(0)
    v_mfma_f32_16x16x32_bf16 v[8:11], a[0:3], v[80:83], v[8:11]
    ds_read_b128 v[100:103], v133 offset:5120
    v_mfma_f32_16x16x32_bf16 v[12:15], a[0:3], v[84:87], v[12:15]
    v_mfma_f32_16x16x32_bf16 v[16:19], a[0:3], v[88:91], v[16:19]
    ds_read_b128 v[104:107], v133 offset:6144
    v_mfma_f32_16x16x32_bf16 v[20:23], a[0:3], v[92:95], v[20:23]
    v_mfma_f32_16x16x32_bf16 v[24:27], a[0:3], v[96:99], v[24:27]
    ds_read_b128 v[108:111], v133 offset:7168
    buffer_load_dwordx4 a[0:3], v129, s[16:19], s35 offen offset:2048
    v_mfma_f32_16x16x32_bf16 v[28:31], a[4:7], v[80:83], v[28:31]
    v_mfma_f32_16x16x32_bf16 v[32:35], a[4:7], v[84:87], v[32:35]
    ds_read_b128 v[112:115], v133 offset:8192
    v_mfma_f32_16x16x32_bf16 v[36:39], a[4:7], v[88:91], v[36:39]
    v_mfma_f32_16x16x32_bf16 v[40:43], a[4:7], v[92:95], v[40:43]
    ds_read_b128 v[116:119], v133 offset:9216
    v_mfma_f32_16x16x32_bf16 v[44:47], a[4:7], v[96:99], v[44:47]
    buffer_load_dwordx4 a[4:7], v129, s[16:19], s35 offen offset:3072
    v_mfma_f32_16x16x32_bf16 v[48:51], a[8:11], v[84:87], v[48:51]
    v_mfma_f32_16x16x32_bf16 v[52:55], a[8:11], v[88:91], v[52:55]
    v_mfma_f32_16x16x32_bf16 v[56:59], a[8:11], v[92:95], v[56:59]
    v_mfma_f32_16x16x32_bf16 v[60:63], a[8:11], v[96:99], v[60:63]
    buffer_load_dwordx4 a[8:11], v130, s[16:19], s35 offen offset:1024
    v_mfma_f32_16x16x32_bf16 v[64:67], a[12:15], v[84:87], v[64:67]
    v_mfma_f32_16x16x32_bf16 v[68:71], a[12:15], v[88:91], v[68:71]
    v_mfma_f32_16x16x32_bf16 v[72:75], a[12:15], v[92:95], v[72:75]
    v_mfma_f32_16x16x32_bf16 v[76:79], a[12:15], v[96:99], v[76:79]
    buffer_load_dwordx4 a[12:15], v130, s[16:19], s35 offen offset:2048
    s_add_u32 s35, s35, 14336
    s_waitcnt vmcnt(12) lgkmcnt(0)
    v_mfma_f32_16x16x32_bf16 v[8:11], a[16:19], v[100:103], v[8:11]
    ds_read_b128 v[80:83], v133 offset:10240
    v_mfma_f32_16x16x32_bf16 v[12:15], a[16:19], v[104:107], v[12:15]
    v_mfma_f32_16x16x32_bf16 v[16:19], a[16:19], v[108:111], v[16:19]
    ds_read_b128 v[84:87], v133 offset:11264
    v_mfma_f32_16x16x32_bf16 v[20:23], a[16:19], v[112:115], v[20:23]
    v_mfma_f32_16x16x32_bf16 v[24:27], a[16:19], v[116:119], v[24:27]
    ds_read_b128 v[88:91], v133 offset:12288
    buffer_load_dwordx4 a[16:19], v129, s[16:19], s35 offen offset:2048
    v_mfma_f32_16x16x32_bf16 v[28:31], a[20:23], v[100:103], v[28:31]
    v_mfma_f32_16x16x32_bf16 v[32:35], a[20:23], v[104:107], v[32:35]
    ds_read_b128 v[92:95], v133 offset:13312
    v_mfma_f32_16x16x32_bf16 v[36:39], a[20:23], v[108:111], v[36:39]
    v_mfma_f32_16x16x32_bf16 v[40:43], a[20:23], v[112:115], v[40:43]
    ds_read_b128 v[96:99], v133 offset:14336
    v_mfma_f32_16x16x32_bf16 v[44:47], a[20:23], v[116:119], v[44:47]
    buffer_load_dwordx4 a[20:23], v129, s[16:19], s35 offen offset:3072
    v_mfma_f32_16x16x32_bf16 v[48:51], a[24:27], v[104:107], v[48:51]
    v_mfma_f32_16x16x32_bf16 v[52:55], a[24:27], v[108:111], v[52:55]
    v_mfma_f32_16x16x32_bf16 v[56:59], a[24:27], v[112:115], v[56:59]
    v_mfma_f32_16x16x32_bf16 v[60:63], a[24:27], v[116:119], v[60:63]
    buffer_load_dwordx4 a[24:27], v130, s[16:19], s35 offen offset:1024
    v_mfma_f32_16x16x32_bf16 v[64:67], a[28:31], v[104:107], v[64:67]
    v_mfma_f32_16x16x32_bf16 v[68:71], a[28:31], v[108:111], v[68:71]
    v_mfma_f32_16x16x32_bf16 v[72:75], a[28:31], v[112:115], v[72:75]
    v_mfma_f32_16x16x32_bf16 v[76:79], a[28:31], v[116:119], v[76:79]
    buffer_load_dwordx4 a[28:31], v130, s[16:19], s35 offen offset:2048
    s_add_u32 s35, s35, 14336
    s_waitcnt vmcnt(12) lgkmcnt(0)
    v_mfma_f32_16x16x32_bf16 v[8:11], a[32:35], v[80:83], v[8:11]
    ds_read_b128 v[100:103], v133 offset:15360
    v_mfma_f32_16x16x32_bf16 v[12:15], a[32:35], v[84:87], v[12:15]
    v_mfma_f32_16x16x32_bf16 v[16:19], a[32:35], v[88:91], v[16:19]
    ds_read_b128 v[104:107], v133 offset:16384
    v_mfma_f32_16x16x32_bf16 v[20:23], a[32:35], v[92:95], v[20:23]
    v_mfma_f32_16x16x32_bf16 v[24:27], a[32:35], v[96:99], v[24:27]
    ds_read_b128 v[108:111], v133 offset:17408
    v_mfma_f32_16x16x32_bf16 v[28:31], a[36:39], v[80:83], v[28:31]
    v_mfma_f32_16x16x32_bf16 v[32:35], a[36:39], v[84:87], v[32:35]
    ds_read_b128 v[112:115], v133 offset:18432
    v_mfma_f32_16x16x32_bf16 v[36:39], a[36:39], v[88:91], v[36:39]
    v_mfma_f32_16x16x32_bf16 v[40:43], a[36:39], v[92:95], v[40:43]
    ds_read_b128 v[116:119], v133 offset:19456
    v_mfma_f32_16x16x32_bf16 v[44:47], a[36:39], v[96:99], v[44:47]
    v_mfma_f32_16x16x32_bf16 v[48:51], a[40:43], v[84:87], v[48:51]
    v_mfma_f32_16x16x32_bf16 v[52:55], a[40:43], v[88:91], v[52:55]
    v_mfma_f32_16x16x32_bf16 v[56:59], a[40:43], v[92:95], v[56:59]
    v_mfma_f32_16x16x32_bf16 v[60:63], a[40:43], v[96:99], v[60:63]
    v_mfma_f32_16x16x32_bf16 v[64:67], a[44:47], v[84:87], v[64:67]
    v_mfma_f32_16x16x32_bf16 v[68:71], a[44:47], v[88:91], v[68:71]
    v_mfma_f32_16x16x32_bf16 v[72:75], a[44:47], v[92:95], v[72:75]
    v_mfma_f32_16x16x32_bf16 v[76:79], a[44:47], v[96:99], v[76:79]
    s_waitcnt vmcnt(8) lgkmcnt(0)
    s_barrier
    v_mfma_f32_16x16x32_bf16 v[8:11], a[48:51], v[100:103], v[8:11]
    ds_read_b128 v[80:83], v133 offset:20480
    v_mfma_f32_16x16x32_bf16 v[12:15], a[48:51], v[104:107], v[12:15]
    v_mfma_f32_16x16x32_bf16 v[16:19], a[48:51], v[108:111], v[16:19]
    ds_read_b128 v[84:87], v133 offset:21504
    v_mfma_f32_16x16x32_bf16 v[20:23], a[48:51], v[112:115], v[20:23]
    v_mfma_f32_16x16x32_bf16 v[24:27], a[48:51], v[116:119], v[24:27]
    ds_read_b128 v[88:91], v133 offset:22528
    v_mfma_f32_16x16x32_bf16 v[28:31], a[52:55], v[100:103], v[28:31]
    v_mfma_f32_16x16x32_bf16 v[32:35], a[52:55], v[104:107], v[32:35]
    ds_read_b128 v[92:95], v133 offset:23552
    v_mfma_f32_16x16x32_bf16 v[36:39], a[52:55], v[108:111], v[36:39]
    v_mfma_f32_16x16x32_bf16 v[40:43], a[52:55], v[112:115], v[40:43]
    ds_read_b128 v[96:99], v133 offset:24576
    v_mfma_f32_16x16x32_bf16 v[44:47], a[52:55], v[116:119], v[44:47]
    v_mfma_f32_16x16x32_bf16 v[48:51], a[56:59], v[104:107], v[48:51]
    v_mfma_f32_16x16x32_bf16 v[52:55], a[56:59], v[108:111], v[52:55]
    v_mfma_f32_16x16x32_bf16 v[56:59], a[56:59], v[112:115], v[56:59]
    v_mfma_f32_16x16x32_bf16 v[60:63], a[56:59], v[116:119], v[60:63]
    v_mfma_f32_16x16x32_bf16 v[64:67], a[60:63], v[104:107], v[64:67]
    v_mfma_f32_16x16x32_bf16 v[68:71], a[60:63], v[108:111], v[68:71]
    v_mfma_f32_16x16x32_bf16 v[72:75], a[60:63], v[112:115], v[72:75]
    v_mfma_f32_16x16x32_bf16 v[76:79], a[60:63], v[116:119], v[76:79]
    v_and_b32 v3, 15, v1
    v_mul_u32_u24 v5, 304, v3
    v_lshl_add_u32 v5, v4, 4, v5
    v_add_u32 v5, 115200, v5
    ds_read_b128 v[100:103], v133 offset:25600
    ds_read_b128 v[104:107], v133 offset:26624
    ds_read_b128 v[108:111], v133 offset:27648
    ds_read_b128 v[112:115], v133 offset:28672
    ds_read_b128 v[116:119], v133 offset:29696
    v_mul_u32_u24 v3, 144, v3
    v_lshl_add_u32 v3, v4, 3, v3
    v_add_u32 v3, 92160, v3
    s_waitcnt vmcnt(0) lgkmcnt(5)
    v_mfma_f32_16x16x32_bf16 v[8:11], a[0:3], v[80:83], v[8:11]
    v_mfma_f32_16x16x32_bf16 v[12:15], a[0:3], v[84:87], v[12:15]
    v_mfma_f32_16x16x32_bf16 v[16:19], a[0:3], v[88:91], v[16:19]
    v_mfma_f32_16x16x32_bf16 v[20:23], a[0:3], v[92:95], v[20:23]
    v_mfma_f32_16x16x32_bf16 v[24:27], a[0:3], v[96:99], v[24:27]
    s_waitcnt lgkmcnt(0)
    v_mfma_f32_16x16x32_bf16 v[8:11], a[16:19], v[100:103], v[8:11]
    v_mfma_f32_16x16x32_bf16 v[12:15], a[16:19], v[104:107], v[12:15]
    v_mfma_f32_16x16x32_bf16 v[16:19], a[16:19], v[108:111], v[16:19]
    v_mfma_f32_16x16x32_bf16 v[20:23], a[16:19], v[112:115], v[20:23]
    v_mfma_f32_16x16x32_bf16 v[24:27], a[16:19], v[116:119], v[24:27]
    v_mfma_f32_16x16x32_bf16 v[28:31], a[4:7], v[80:83], v[28:31]
    v_mfma_f32_16x16x32_bf16 v[32:35], a[4:7], v[84:87], v[32:35]
    v_mfma_f32_16x16x32_bf16 v[36:39], a[4:7], v[88:91], v[36:39]
    v_mfma_f32_16x16x32_bf16 v[40:43], a[4:7], v[92:95], v[40:43]
    v_mfma_f32_16x16x32_bf16 v[44:47], a[4:7], v[96:99], v[44:47]
    ds_write_b128 v5, v[8:11] offset:128
    ds_write_b128 v5, v[12:15] offset:4992
    v_mfma_f32_16x16x32_bf16 v[28:31], a[20:23], v[100:103], v[28:31]
    ds_write_b128 v5, v[16:19] offset:9856
    ds_write_b128 v5, v[20:23] offset:14720
    v_mfma_f32_16x16x32_bf16 v[32:35], a[20:23], v[104:107], v[32:35]
    ds_write_b128 v5, v[24:27] offset:19584
    v_mfma_f32_16x16x32_bf16 v[36:39], a[20:23], v[108:111], v[36:39]
    v_mfma_f32_16x16x32_bf16 v[40:43], a[20:23], v[112:115], v[40:43]
    v_mfma_f32_16x16x32_bf16 v[44:47], a[20:23], v[116:119], v[44:47]
    v_mfma_f32_16x16x32_bf16 v[48:51], a[8:11], v[84:87], v[48:51]
    v_mfma_f32_16x16x32_bf16 v[52:55], a[8:11], v[88:91], v[52:55]
    v_mfma_f32_16x16x32_bf16 v[56:59], a[8:11], v[92:95], v[56:59]
    v_mfma_f32_16x16x32_bf16 v[60:63], a[8:11], v[96:99], v[60:63]
    v_mfma_f32_16x16x32_bf16 v[48:51], a[24:27], v[104:107], v[48:51]
    ds_write_b128 v5, v[28:31] offset:192
    ds_write_b128 v5, v[32:35] offset:5056
    v_mfma_f32_16x16x32_bf16 v[52:55], a[24:27], v[108:111], v[52:55]
    ds_write_b128 v5, v[36:39] offset:9920
    ds_write_b128 v5, v[40:43] offset:14784
    v_mfma_f32_16x16x32_bf16 v[56:59], a[24:27], v[112:115], v[56:59]
    ds_write_b128 v5, v[44:47] offset:19648
    v_mfma_f32_16x16x32_bf16 v[60:63], a[24:27], v[116:119], v[60:63]
    v_mfma_f32_16x16x32_bf16 v[64:67], a[12:15], v[84:87], v[64:67]
    v_mfma_f32_16x16x32_bf16 v[68:71], a[12:15], v[88:91], v[68:71]
    v_mfma_f32_16x16x32_bf16 v[72:75], a[12:15], v[92:95], v[72:75]
    v_mfma_f32_16x16x32_bf16 v[76:79], a[12:15], v[96:99], v[76:79]
    v_mfma_f32_16x16x32_bf16 v[64:67], a[28:31], v[104:107], v[64:67]
    v_cvt_pk_bf16_f32 v122, v48, v49
    v_cvt_pk_bf16_f32 v123, v50, v51
    ds_write_b64 v3, v[122:123] offset:13824
    v_mfma_f32_16x16x32_bf16 v[68:71], a[28:31], v[108:111], v[68:71]
    v_cvt_pk_bf16_f32 v124, v52, v53
    v_cvt_pk_bf16_f32 v125, v54, v55
    ds_write_b64 v3, v[124:125] offset:16128
    v_mfma_f32_16x16x32_bf16 v[72:75], a[28:31], v[112:115], v[72:75]
    v_cvt_pk_bf16_f32 v126, v56, v57
    v_cvt_pk_bf16_f32 v127, v58, v59
    ds_write_b64 v3, v[126:127] offset:18432
    v_mfma_f32_16x16x32_bf16 v[76:79], a[28:31], v[116:119], v[76:79]
    v_cvt_pk_bf16_f32 v120, v60, v61
    v_cvt_pk_bf16_f32 v121, v62, v63
    ds_write_b64 v3, v[120:121] offset:20736
    s_nop 4
    v_cvt_pk_bf16_f32 v122, v64, v65
    v_cvt_pk_bf16_f32 v123, v66, v67
    ds_write_b64 v3, v[122:123] offset:13856
    v_cvt_pk_bf16_f32 v124, v68, v69
    v_cvt_pk_bf16_f32 v125, v70, v71
    ds_write_b64 v3, v[124:125] offset:16160
    v_cvt_pk_bf16_f32 v126, v72, v73
    v_cvt_pk_bf16_f32 v127, v74, v75
    ds_write_b64 v3, v[126:127] offset:18464
    v_cvt_pk_bf16_f32 v120, v76, v77
    v_cvt_pk_bf16_f32 v121, v78, v79
    ds_write_b64 v3, v[120:121] offset:20768
    s_branch L1_att
L1_w3:
    s_waitcnt lgkmcnt(0)
    s_add_u32 s26, s24, s34
    s_addc_u32 s27, s25, 0
    s_mov_b32 s16, s26
    s_and_b32 s17, s27, 0xffff
    s_mov_b32 s18, 0x3f000
    s_mov_b32 s19, 0x00020000
    buffer_load_dwordx4 a[0:3], v130, s[16:19], s35 offen offset:0
    buffer_load_dwordx4 a[4:7], v130, s[16:19], s35 offen offset:3072
    buffer_load_dwordx4 a[8:11], v131, s[16:19], s35 offen offset:0
    s_mov_b64 exec, s[40:41]
    buffer_load_dwordx4 a[12:15], v131, s[16:19], s35 offen offset:1024
    s_mov_b64 exec, -1
    s_add_u32 s35, s35, 14336
    v_mov_b32 v8, 0
    v_mov_b32 v9, 0
    v_mov_b32 v10, 0
    v_mov_b32 v11, 0
    v_mov_b32 v12, 0
    v_mov_b32 v13, 0
    v_mov_b32 v14, 0
    v_mov_b32 v15, 0
    v_mov_b32 v16, 0
    v_mov_b32 v17, 0
    v_mov_b32 v18, 0
    v_mov_b32 v19, 0
    v_mov_b32 v20, 0
    v_mov_b32 v21, 0
    v_mov_b32 v22, 0
    v_mov_b32 v23, 0
    v_mov_b32 v24, 0
    v_mov_b32 v25, 0
    v_mov_b32 v26, 0
    v_mov_b32 v27, 0
    v_mov_b32 v28, 0
    v_mov_b32 v29, 0
    v_mov_b32 v30, 0
    v_mov_b32 v31, 0
    v_mov_b32 v32, 0
    v_mov_b32 v33, 0
    v_mov_b32 v34, 0
    v_mov_b32 v35, 0
    v_mov_b32 v36, 0
    v_mov_b32 v37, 0
    v_mov_b32 v38, 0
    v_mov_b32 v39, 0
    v_mov_b32 v40, 0
    v_mov_b32 v41, 0
    v_mov_b32 v42, 0
    v_mov_b32 v43, 0
    v_mov_b32 v44, 0
    v_mov_b32 v45, 0
    v_mov_b32 v46, 0
    v_mov_b32 v47, 0
    v_mov_b32 v48, 0
    v_mov_b32 v49, 0
    v_mov_b32 v50, 0
    v_mov_b32 v51, 0
    v_mov_b32 v52, 0
    v_mov_b32 v53, 0
    v_mov_b32 v54, 0
    v_mov_b32 v55, 0
    v_mov_b32 v56, 0
    v_mov_b32 v57, 0
    v_mov_b32 v58, 0
    v_mov_b32 v59, 0
    v_mov_b32 v60, 0
    v_mov_b32 v61, 0
    v_mov_b32 v62, 0
    v_mov_b32 v63, 0
    v_mov_b32 v64, 0
    v_mov_b32 v65, 0
    v_mov_b32 v66, 0
    v_mov_b32 v67, 0
    v_mov_b32 v68, 0
    v_mov_b32 v69, 0
    v_mov_b32 v70, 0
    v_mov_b32 v71, 0
    v_mov_b32 v72, 0
    v_mov_b32 v73, 0
    v_mov_b32 v74, 0
    v_mov_b32 v75, 0
    s_barrier
    buffer_load_dwordx4 a[16:19], v130, s[16:19], s35 offen offset:0
    buffer_load_dwordx4 a[20:23], v130, s[16:19], s35 offen offset:3072
    buffer_load_dwordx4 a[24:27], v131, s[16:19], s35 offen offset:0
    s_mov_b64 exec, s[40:41]
    buffer_load_dwordx4 a[28:31], v131, s[16:19], s35 offen offset:1024
    s_mov_b64 exec, -1
    s_add_u32 s35, s35, 14336
    buffer_load_dwordx4 a[32:35], v130, s[16:19], s35 offen offset:0
    buffer_load_dwordx4 a[36:39], v130, s[16:19], s35 offen offset:3072
    buffer_load_dwordx4 a[40:43], v131, s[16:19], s35 offen offset:0
    s_mov_b64 exec, s[40:41]
    buffer_load_dwordx4 a[44:47], v131, s[16:19], s35 offen offset:1024
    s_mov_b64 exec, -1
    s_add_u32 s35, s35, 14336
    buffer_load_dwordx4 a[48:51], v130, s[16:19], s35 offen offset:0
    buffer_load_dwordx4 a[52:55], v130, s[16:19], s35 offen offset:3072
    buffer_load_dwordx4 a[56:59], v131, s[16:19], s35 offen offset:0
    s_mov_b64 exec, s[40:41]
    buffer_load_dwordx4 a[60:63], v131, s[16:19], s35 offen offset:1024
    s_mov_b64 exec, -1
    s_add_u32 s35, s35, 14336
    s_mov_b32 s12, s24
    s_and_b32 s13, s25, 0xffff
    s_mov_b32 s14, 0x10000000
    s_mov_b32 s15, 0x00020000
    s_setprio 2
    v_add_u32 v133, 61440, v132
    s_barrier
    ds_read_b128 v[80:83], v132 offset:0
    ds_read_b128 v[84:87], v132 offset:1024
    ds_read_b128 v[88:91], v132 offset:2048
    ds_read_b128 v[92:95], v132 offset:3072
    ds_read_b128 v[96:99], v132 offset:4096
    s_waitcnt vmcnt(12) lgkmcnt(0)
    v_mfma_f32_16x16x32_bf16 v[8:11], a[0:3], v[80:83], v[8:11]
    ds_read_b128 v[100:103], v132 offset:5120
    v_mfma_f32_16x16x32_bf16 v[12:15], a[0:3], v[84:87], v[12:15]
    v_mfma_f32_16x16x32_bf16 v[16:19], a[0:3], v[88:91], v[16:19]
    ds_read_b128 v[104:107], v132 offset:6144
    v_mfma_f32_16x16x32_bf16 v[20:23], a[0:3], v[92:95], v[20:23]
    v_mfma_f32_16x16x32_bf16 v[24:27], a[0:3], v[96:99], v[24:27]
    ds_read_b128 v[108:111], v132 offset:7168
    buffer_load_dwordx4 a[0:3], v130, s[16:19], s35 offen offset:0
    v_mfma_f32_16x16x32_bf16 v[28:31], a[4:7], v[84:87], v[28:31]
    v_mfma_f32_16x16x32_bf16 v[32:35], a[4:7], v[88:91], v[32:35]
    ds_read_b128 v[112:115], v132 offset:8192
    v_mfma_f32_16x16x32_bf16 v[36:39], a[4:7], v[92:95], v[36:39]
    v_mfma_f32_16x16x32_bf16 v[40:43], a[4:7], v[96:99], v[40:43]
    ds_read_b128 v[116:119], v132 offset:9216
    buffer_load_dwordx4 a[4:7], v130, s[16:19], s35 offen offset:3072
    v_mfma_f32_16x16x32_bf16 v[44:47], a[8:11], v[84:87], v[44:47]
    v_mfma_f32_16x16x32_bf16 v[48:51], a[8:11], v[88:91], v[48:51]
    v_mfma_f32_16x16x32_bf16 v[52:55], a[8:11], v[92:95], v[52:55]
    v_mfma_f32_16x16x32_bf16 v[56:59], a[8:11], v[96:99], v[56:59]
    buffer_load_dwordx4 a[8:11], v131, s[16:19], s35 offen offset:0
    v_mfma_f32_16x16x32_bf16 v[60:63], a[12:15], v[84:87], v[60:63]
    v_mfma_f32_16x16x32_bf16 v[64:67], a[12:15], v[88:91], v[64:67]
    v_mfma_f32_16x16x32_bf16 v[68:71], a[12:15], v[92:95], v[68:71]
    v_mfma_f32_16x16x32_bf16 v[72:75], a[12:15], v[96:99], v[72:75]
    s_mov_b64 exec, s[40:41]
    buffer_load_dwordx4 a[12:15], v131, s[16:19], s35 offen offset:1024
    s_mov_b64 exec, -1
    s_add_u32 s35, s35, 14336
    s_waitcnt vmcnt(12) lgkmcnt(0)
    v_mfma_f32_16x16x32_bf16 v[8:11], a[16:19], v[100:103], v[8:11]
    ds_read_b128 v[80:83], v132 offset:10240
    v_mfma_f32_16x16x32_bf16 v[12:15], a[16:19], v[104:107], v[12:15]
    v_mfma_f32_16x16x32_bf16 v[16:19], a[16:19], v[108:111], v[16:19]
    ds_read_b128 v[84:87], v132 offset:11264
    v_mfma_f32_16x16x32_bf16 v[20:23], a[16:19], v[112:115], v[20:23]
    v_mfma_f32_16x16x32_bf16 v[24:27], a[16:19], v[116:119], v[24:27]
    ds_read_b128 v[88:91], v132 offset:12288
    buffer_load_dwordx4 a[16:19], v130, s[16:19], s35 offen offset:0
    v_mfma_f32_16x16x32_bf16 v[28:31], a[20:23], v[104:107], v[28:31]
    v_mfma_f32_16x16x32_bf16 v[32:35], a[20:23], v[108:111], v[32:35]
    ds_read_b128 v[92:95], v132 offset:13312
    v_mfma_f32_16x16x32_bf16 v[36:39], a[20:23], v[112:115], v[36:39]
    v_mfma_f32_16x16x32_bf16 v[40:43], a[20:23], v[116:119], v[40:43]
    ds_read_b128 v[96:99], v132 offset:14336
    buffer_load_dwordx4 a[20:23], v130, s[16:19], s35 offen offset:3072
    v_mfma_f32_16x16x32_bf16 v[44:47], a[24:27], v[104:107], v[44:47]
    v_mfma_f32_16x16x32_bf16 v[48:51], a[24:27], v[108:111], v[48:51]
    v_mfma_f32_16x16x32_bf16 v[52:55], a[24:27], v[112:115], v[52:55]
    v_mfma_f32_16x16x32_bf16 v[56:59], a[24:27], v[116:119], v[56:59]
    buffer_load_dwordx4 a[24:27], v131, s[16:19], s35 offen offset:0
    v_mfma_f32_16x16x32_bf16 v[60:63], a[28:31], v[104:107], v[60:63]
    v_mfma_f32_16x16x32_bf16 v[64:67], a[28:31], v[108:111], v[64:67]
    v_mfma_f32_16x16x32_bf16 v[68:71], a[28:31], v[112:115], v[68:71]
    v_mfma_f32_16x16x32_bf16 v[72:75], a[28:31], v[116:119], v[72:75]
    s_mov_b64 exec, s[40:41]
    buffer_load_dwordx4 a[28:31], v131, s[16:19], s35 offen offset:1024
    s_mov_b64 exec, -1
    s_add_u32 s35, s35, 14336
    s_waitcnt vmcnt(12) lgkmcnt(0)
    v_mfma_f32_16x16x32_bf16 v[8:11], a[32:35], v[80:83], v[8:11]
    ds_read_b128 v[100:103], v132 offset:15360
    v_mfma_f32_16x16x32_bf16 v[12:15], a[32:35], v[84:87], v[12:15]
    v_mfma_f32_16x16x32_bf16 v[16:19], a[32:35], v[88:91], v[16:19]
    ds_read_b128 v[104:107], v132 offset:16384
    v_mfma_f32_16x16x32_bf16 v[20:23], a[32:35], v[92:95], v[20:23]
    v_mfma_f32_16x16x32_bf16 v[24:27], a[32:35], v[96:99], v[24:27]
    ds_read_b128 v[108:111], v132 offset:17408
    buffer_load_dwordx4 a[32:35], v130, s[16:19], s35 offen offset:0
    v_mfma_f32_16x16x32_bf16 v[28:31], a[36:39], v[84:87], v[28:31]
    v_mfma_f32_16x16x32_bf16 v[32:35], a[36:39], v[88:91], v[32:35]
    ds_read_b128 v[112:115], v132 offset:18432
    v_mfma_f32_16x16x32_bf16 v[36:39], a[36:39], v[92:95], v[36:39]
    v_mfma_f32_16x16x32_bf16 v[40:43], a[36:39], v[96:99], v[40:43]
    ds_read_b128 v[116:119], v132 offset:19456
    buffer_load_dwordx4 a[36:39], v130, s[16:19], s35 offen offset:3072
    v_mfma_f32_16x16x32_bf16 v[44:47], a[40:43], v[84:87], v[44:47]
    v_mfma_f32_16x16x32_bf16 v[48:51], a[40:43], v[88:91], v[48:51]
    v_mfma_f32_16x16x32_bf16 v[52:55], a[40:43], v[92:95], v[52:55]
    v_mfma_f32_16x16x32_bf16 v[56:59], a[40:43], v[96:99], v[56:59]
    buffer_load_dwordx4 a[40:43], v131, s[16:19], s35 offen offset:0
    v_mfma_f32_16x16x32_bf16 v[60:63], a[44:47], v[84:87], v[60:63]
    v_mfma_f32_16x16x32_bf16 v[64:67], a[44:47], v[88:91], v[64:67]
    v_mfma_f32_16x16x32_bf16 v[68:71], a[44:47], v[92:95], v[68:71]
    v_mfma_f32_16x16x32_bf16 v[72:75], a[44:47], v[96:99], v[72:75]
    s_mov_b64 exec, s[40:41]
    buffer_load_dwordx4 a[44:47], v131, s[16:19], s35 offen offset:1024
    s_mov_b64 exec, -1
    s_add_u32 s35, s35, 14336
    s_waitcnt vmcnt(12) lgkmcnt(0)
    s_barrier
    v_mfma_f32_16x16x32_bf16 v[8:11], a[48:51], v[100:103], v[8:11]
    ds_read_b128 v[80:83], v132 offset:20480
    v_mfma_f32_16x16x32_bf16 v[12:15], a[48:51], v[104:107], v[12:15]
    v_mfma_f32_16x16x32_bf16 v[16:19], a[48:51], v[108:111], v[16:19]
    ds_read_b128 v[84:87], v132 offset:21504
    v_mfma_f32_16x16x32_bf16 v[20:23], a[48:51], v[112:115], v[20:23]
    v_mfma_f32_16x16x32_bf16 v[24:27], a[48:51], v[116:119], v[24:27]
    ds_read_b128 v[88:91], v132 offset:22528
    buffer_load_dwordx4 a[48:51], v130, s[16:19], s35 offen offset:0
    v_mfma_f32_16x16x32_bf16 v[28:31], a[52:55], v[104:107], v[28:31]
    v_mfma_f32_16x16x32_bf16 v[32:35], a[52:55], v[108:111], v[32:35]
    ds_read_b128 v[92:95], v132 offset:23552
    v_mfma_f32_16x16x32_bf16 v[36:39], a[52:55], v[112:115], v[36:39]
    v_mfma_f32_16x16x32_bf16 v[40:43], a[52:55], v[116:119], v[40:43]
    ds_read_b128 v[96:99], v132 offset:24576
    buffer_load_dwordx4 a[52:55], v130, s[16:19], s35 offen offset:3072
    v_mfma_f32_16x16x32_bf16 v[44:47], a[56:59], v[104:107], v[44:47]
    v_mfma_f32_16x16x32_bf16 v[48:51], a[56:59], v[108:111], v[48:51]
    v_mfma_f32_16x16x32_bf16 v[52:55], a[56:59], v[112:115], v[52:55]
    v_mfma_f32_16x16x32_bf16 v[56:59], a[56:59], v[116:119], v[56:59]
    buffer_load_dwordx4 a[56:59], v131, s[16:19], s35 offen offset:0
    v_mfma_f32_16x16x32_bf16 v[60:63], a[60:63], v[104:107], v[60:63]
    v_mfma_f32_16x16x32_bf16 v[64:67], a[60:63], v[108:111], v[64:67]
    v_mfma_f32_16x16x32_bf16 v[68:71], a[60:63], v[112:115], v[68:71]
    v_mfma_f32_16x16x32_bf16 v[72:75], a[60:63], v[116:119], v[72:75]
    s_mov_b64 exec, s[40:41]
    buffer_load_dwordx4 a[60:63], v131, s[16:19], s35 offen offset:1024
    s_mov_b64 exec, -1
    s_add_u32 s35, s35, 14336
    s_waitcnt vmcnt(12) lgkmcnt(0)
    v_mfma_f32_16x16x32_bf16 v[8:11], a[0:3], v[80:83], v[8:11]
    ds_read_b128 v[100:103], v132 offset:25600
    v_mfma_f32_16x16x32_bf16 v[12:15], a[0:3], v[84:87], v[12:15]
    v_mfma_f32_16x16x32_bf16 v[16:19], a[0:3], v[88:91], v[16:19]
    ds_read_b128 v[104:107], v132 offset:26624
    v_mfma_f32_16x16x32_bf16 v[20:23], a[0:3], v[92:95], v[20:23]
    v_mfma_f32_16x16x32_bf16 v[24:27], a[0:3], v[96:99], v[24:27]
    ds_read_b128 v[108:111], v132 offset:27648
    buffer_load_dwordx4 a[0:3], v130, s[16:19], s35 offen offset:0
    v_mfma_f32_16x16x32_bf16 v[28:31], a[4:7], v[84:87], v[28:31]
    v_mfma_f32_16x16x32_bf16 v[32:35], a[4:7], v[88:91], v[32:35]
    ds_read_b128 v[112:115], v132 offset:28672
    v_mfma_f32_16x16x32_bf16 v[36:39], a[4:7], v[92:95], v[36:39]
    v_mfma_f32_16x16x32_bf16 v[40:43], a[4:7], v[96:99], v[40:43]
    ds_read_b128 v[116:119], v132 offset:29696
    buffer_load_dwordx4 a[4:7], v130, s[16:19], s35 offen offset:3072
    v_mfma_f32_16x16x32_bf16 v[44:47], a[8:11], v[84:87], v[44:47]
    v_mfma_f32_16x16x32_bf16 v[48:51], a[8:11], v[88:91], v[48:51]
    v_mfma_f32_16x16x32_bf16 v[52:55], a[8:11], v[92:95], v[52:55]
    v_mfma_f32_16x16x32_bf16 v[56:59], a[8:11], v[96:99], v[56:59]
    buffer_load_dwordx4 a[8:11], v131, s[16:19], s35 offen offset:0
    v_mfma_f32_16x16x32_bf16 v[60:63], a[12:15], v[84:87], v[60:63]
    v_mfma_f32_16x16x32_bf16 v[64:67], a[12:15], v[88:91], v[64:67]
    v_mfma_f32_16x16x32_bf16 v[68:71], a[12:15], v[92:95], v[68:71]
    v_mfma_f32_16x16x32_bf16 v[72:75], a[12:15], v[96:99], v[72:75]
    s_mov_b64 exec, s[40:41]
    buffer_load_dwordx4 a[12:15], v131, s[16:19], s35 offen offset:1024
    s_mov_b64 exec, -1
    s_add_u32 s35, s35, 14336
    s_waitcnt vmcnt(12) lgkmcnt(0)
    v_mfma_f32_16x16x32_bf16 v[8:11], a[16:19], v[100:103], v[8:11]
    ds_read_b128 v[80:83], v132 offset:30720
    v_mfma_f32_16x16x32_bf16 v[12:15], a[16:19], v[104:107], v[12:15]
    v_mfma_f32_16x16x32_bf16 v[16:19], a[16:19], v[108:111], v[16:19]
    ds_read_b128 v[84:87], v132 offset:31744
    v_mfma_f32_16x16x32_bf16 v[20:23], a[16:19], v[112:115], v[20:23]
    v_mfma_f32_16x16x32_bf16 v[24:27], a[16:19], v[116:119], v[24:27]
    ds_read_b128 v[88:91], v132 offset:32768
    buffer_load_dwordx4 a[16:19], v130, s[16:19], s35 offen offset:0
    v_mfma_f32_16x16x32_bf16 v[28:31], a[20:23], v[104:107], v[28:31]
    v_mfma_f32_16x16x32_bf16 v[32:35], a[20:23], v[108:111], v[32:35]
    ds_read_b128 v[92:95], v132 offset:33792
    v_mfma_f32_16x16x32_bf16 v[36:39], a[20:23], v[112:115], v[36:39]
    v_mfma_f32_16x16x32_bf16 v[40:43], a[20:23], v[116:119], v[40:43]
    ds_read_b128 v[96:99], v132 offset:34816
    buffer_load_dwordx4 a[20:23], v130, s[16:19], s35 offen offset:3072
    v_mfma_f32_16x16x32_bf16 v[44:47], a[24:27], v[104:107], v[44:47]
    v_mfma_f32_16x16x32_bf16 v[48:51], a[24:27], v[108:111], v[48:51]
    v_mfma_f32_16x16x32_bf16 v[52:55], a[24:27], v[112:115], v[52:55]
    v_mfma_f32_16x16x32_bf16 v[56:59], a[24:27], v[116:119], v[56:59]
    buffer_load_dwordx4 a[24:27], v131, s[16:19], s35 offen offset:0
    v_mfma_f32_16x16x32_bf16 v[60:63], a[28:31], v[104:107], v[60:63]
    v_mfma_f32_16x16x32_bf16 v[64:67], a[28:31], v[108:111], v[64:67]
    v_mfma_f32_16x16x32_bf16 v[68:71], a[28:31], v[112:115], v[68:71]
    v_mfma_f32_16x16x32_bf16 v[72:75], a[28:31], v[116:119], v[72:75]
    s_mov_b64 exec, s[40:41]
    buffer_load_dwordx4 a[28:31], v131, s[16:19], s35 offen offset:1024
    s_mov_b64 exec, -1
    s_add_u32 s35, s35, 14336
    s_waitcnt vmcnt(12) lgkmcnt(0)
    v_mfma_f32_16x16x32_bf16 v[8:11], a[32:35], v[80:83], v[8:11]
    ds_read_b128 v[100:103], v132 offset:35840
    v_mfma_f32_16x16x32_bf16 v[12:15], a[32:35], v[84:87], v[12:15]
    v_mfma_f32_16x16x32_bf16 v[16:19], a[32:35], v[88:91], v[16:19]
    ds_read_b128 v[104:107], v132 offset:36864
    v_mfma_f32_16x16x32_bf16 v[20:23], a[32:35], v[92:95], v[20:23]
    v_mfma_f32_16x16x32_bf16 v[24:27], a[32:35], v[96:99], v[24:27]
    ds_read_b128 v[108:111], v132 offset:37888
    buffer_load_dwordx4 a[32:35], v130, s[16:19], s35 offen offset:0
    v_mfma_f32_16x16x32_bf16 v[28:31], a[36:39], v[84:87], v[28:31]
    v_mfma_f32_16x16x32_bf16 v[32:35], a[36:39], v[88:91], v[32:35]
    ds_read_b128 v[112:115], v132 offset:38912
    v_mfma_f32_16x16x32_bf16 v[36:39], a[36:39], v[92:95], v[36:39]
    v_mfma_f32_16x16x32_bf16 v[40:43], a[36:39], v[96:99], v[40:43]
    ds_read_b128 v[116:119], v132 offset:39936
    buffer_load_dwordx4 a[36:39], v130, s[16:19], s35 offen offset:3072
    v_mfma_f32_16x16x32_bf16 v[44:47], a[40:43], v[84:87], v[44:47]
    v_mfma_f32_16x16x32_bf16 v[48:51], a[40:43], v[88:91], v[48:51]
    v_mfma_f32_16x16x32_bf16 v[52:55], a[40:43], v[92:95], v[52:55]
    v_mfma_f32_16x16x32_bf16 v[56:59], a[40:43], v[96:99], v[56:59]
    buffer_load_dwordx4 a[40:43], v131, s[16:19], s35 offen offset:0
    v_mfma_f32_16x16x32_bf16 v[60:63], a[44:47], v[84:87], v[60:63]
    v_mfma_f32_16x16x32_bf16 v[64:67], a[44:47], v[88:91], v[64:67]
    v_mfma_f32_16x16x32_bf16 v[68:71], a[44:47], v[92:95], v[68:71]
    v_mfma_f32_16x16x32_bf16 v[72:75], a[44:47], v[96:99], v[72:75]
    s_mov_b64 exec, s[40:41]
    buffer_load_dwordx4 a[44:47], v131, s[16:19], s35 offen offset:1024
    s_mov_b64 exec, -1
    s_add_u32 s35, s35, 14336
    s_waitcnt vmcnt(12) lgkmcnt(0)
    s_barrier
    v_mfma_f32_16x16x32_bf16 v[8:11], a[48:51], v[100:103], v[8:11]
    ds_read_b128 v[80:83], v132 offset:40960
    v_mfma_f32_16x16x32_bf16 v[12:15], a[48:51], v[104:107], v[12:15]
    v_mfma_f32_16x16x32_bf16 v[16:19], a[48:51], v[108:111], v[16:19]
    ds_read_b128 v[84:87], v132 offset:41984
    v_mfma_f32_16x16x32_bf16 v[20:23], a[48:51], v[112:115], v[20:23]
    v_mfma_f32_16x16x32_bf16 v[24:27], a[48:51], v[116:119], v[24:27]
    ds_read_b128 v[88:91], v132 offset:43008
    buffer_load_dwordx4 a[48:51], v130, s[16:19], s35 offen offset:0
    v_mfma_f32_16x16x32_bf16 v[28:31], a[52:55], v[104:107], v[28:31]
    v_mfma_f32_16x16x32_bf16 v[32:35], a[52:55], v[108:111], v[32:35]
    ds_read_b128 v[92:95], v132 offset:44032
    v_mfma_f32_16x16x32_bf16 v[36:39], a[52:55], v[112:115], v[36:39]
    v_mfma_f32_16x16x32_bf16 v[40:43], a[52:55], v[116:119], v[40:43]
    ds_read_b128 v[96:99], v132 offset:45056
    buffer_load_dwordx4 a[52:55], v130, s[16:19], s35 offen offset:3072
    v_mfma_f32_16x16x32_bf16 v[44:47], a[56:59], v[104:107], v[44:47]
    v_mfma_f32_16x16x32_bf16 v[48:51], a[56:59], v[108:111], v[48:51]
    v_mfma_f32_16x16x32_bf16 v[52:55], a[56:59], v[112:115], v[52:55]
    v_mfma_f32_16x16x32_bf16 v[56:59], a[56:59], v[116:119], v[56:59]
    buffer_load_dwordx4 a[56:59], v131, s[16:19], s35 offen offset:0
    v_mfma_f32_16x16x32_bf16 v[60:63], a[60:63], v[104:107], v[60:63]
    v_mfma_f32_16x16x32_bf16 v[64:67], a[60:63], v[108:111], v[64:67]
    v_mfma_f32_16x16x32_bf16 v[68:71], a[60:63], v[112:115], v[68:71]
    v_mfma_f32_16x16x32_bf16 v[72:75], a[60:63], v[116:119], v[72:75]
    s_mov_b64 exec, s[40:41]
    buffer_load_dwordx4 a[60:63], v131, s[16:19], s35 offen offset:1024
    s_mov_b64 exec, -1
    s_add_u32 s35, s35, 14336
    s_waitcnt vmcnt(12) lgkmcnt(0)
    v_mfma_f32_16x16x32_bf16 v[8:11], a[0:3], v[80:83], v[8:11]
    ds_read_b128 v[100:103], v132 offset:46080
    v_mfma_f32_16x16x32_bf16 v[12:15], a[0:3], v[84:87], v[12:15]
    v_mfma_f32_16x16x32_bf16 v[16:19], a[0:3], v[88:91], v[16:19]
    ds_read_b128 v[104:107], v132 offset:47104
    v_mfma_f32_16x16x32_bf16 v[20:23], a[0:3], v[92:95], v[20:23]
    v_mfma_f32_16x16x32_bf16 v[24:27], a[0:3], v[96:99], v[24:27]
    ds_read_b128 v[108:111], v132 offset:48128
    buffer_load_dwordx4 a[0:3], v130, s[16:19], s35 offen offset:0
    v_mfma_f32_16x16x32_bf16 v[28:31], a[4:7], v[84:87], v[28:31]
    v_mfma_f32_16x16x32_bf16 v[32:35], a[4:7], v[88:91], v[32:35]
    ds_read_b128 v[112:115], v132 offset:49152
    v_mfma_f32_16x16x32_bf16 v[36:39], a[4:7], v[92:95], v[36:39]
    v_mfma_f32_16x16x32_bf16 v[40:43], a[4:7], v[96:99], v[40:43]
    ds_read_b128 v[116:119], v132 offset:50176
    buffer_load_dwordx4 a[4:7], v130, s[16:19], s35 offen offset:3072
    v_mfma_f32_16x16x32_bf16 v[44:47], a[8:11], v[84:87], v[44:47]
    v_mfma_f32_16x16x32_bf16 v[48:51], a[8:11], v[88:91], v[48:51]
    v_mfma_f32_16x16x32_bf16 v[52:55], a[8:11], v[92:95], v[52:55]
    v_mfma_f32_16x16x32_bf16 v[56:59], a[8:11], v[96:99], v[56:59]
    buffer_load_dwordx4 a[8:11], v131, s[16:19], s35 offen offset:0
    v_mfma_f32_16x16x32_bf16 v[60:63], a[12:15], v[84:87], v[60:63]
    v_mfma_f32_16x16x32_bf16 v[64:67], a[12:15], v[88:91], v[64:67]
    v_mfma_f32_16x16x32_bf16 v[68:71], a[12:15], v[92:95], v[68:71]
    v_mfma_f32_16x16x32_bf16 v[72:75], a[12:15], v[96:99], v[72:75]
    s_mov_b64 exec, s[40:41]
    buffer_load_dwordx4 a[12:15], v131, s[16:19], s35 offen offset:1024
    s_mov_b64 exec, -1
    s_add_u32 s35, s35, 14336
    s_waitcnt vmcnt(12) lgkmcnt(0)
    v_mfma_f32_16x16x32_bf16 v[8:11], a[16:19], v[100:103], v[8:11]
    ds_read_b128 v[80:83], v132 offset:51200
    v_mfma_f32_16x16x32_bf16 v[12:15], a[16:19], v[104:107], v[12:15]
    v_mfma_f32_16x16x32_bf16 v[16:19], a[16:19], v[108:111], v[16:19]
    ds_read_b128 v[84:87], v132 offset:52224
    v_mfma_f32_16x16x32_bf16 v[20:23], a[16:19], v[112:115], v[20:23]
    v_mfma_f32_16x16x32_bf16 v[24:27], a[16:19], v[116:119], v[24:27]
    ds_read_b128 v[88:91], v132 offset:53248
    buffer_load_dwordx4 a[16:19], v130, s[16:19], s35 offen offset:0
    v_mfma_f32_16x16x32_bf16 v[28:31], a[20:23], v[104:107], v[28:31]
    v_mfma_f32_16x16x32_bf16 v[32:35], a[20:23], v[108:111], v[32:35]
    ds_read_b128 v[92:95], v132 offset:54272
    v_mfma_f32_16x16x32_bf16 v[36:39], a[20:23], v[112:115], v[36:39]
    v_mfma_f32_16x16x32_bf16 v[40:43], a[20:23], v[116:119], v[40:43]
    ds_read_b128 v[96:99], v132 offset:55296
    buffer_load_dwordx4 a[20:23], v130, s[16:19], s35 offen offset:3072
    v_mfma_f32_16x16x32_bf16 v[44:47], a[24:27], v[104:107], v[44:47]
    v_mfma_f32_16x16x32_bf16 v[48:51], a[24:27], v[108:111], v[48:51]
    v_mfma_f32_16x16x32_bf16 v[52:55], a[24:27], v[112:115], v[52:55]
    v_mfma_f32_16x16x32_bf16 v[56:59], a[24:27], v[116:119], v[56:59]
    buffer_load_dwordx4 a[24:27], v131, s[16:19], s35 offen offset:0
    v_mfma_f32_16x16x32_bf16 v[60:63], a[28:31], v[104:107], v[60:63]
    v_mfma_f32_16x16x32_bf16 v[64:67], a[28:31], v[108:111], v[64:67]
    v_mfma_f32_16x16x32_bf16 v[68:71], a[28:31], v[112:115], v[68:71]
    v_mfma_f32_16x16x32_bf16 v[72:75], a[28:31], v[116:119], v[72:75]
    s_mov_b64 exec, s[40:41]
    buffer_load_dwordx4 a[28:31], v131, s[16:19], s35 offen offset:1024
    s_mov_b64 exec, -1
    s_add_u32 s35, s35, 14336
    s_waitcnt vmcnt(12) lgkmcnt(0)
    v_mfma_f32_16x16x32_bf16 v[8:11], a[32:35], v[80:83], v[8:11]
    ds_read_b128 v[100:103], v132 offset:56320
    v_mfma_f32_16x16x32_bf16 v[12:15], a[32:35], v[84:87], v[12:15]
    v_mfma_f32_16x16x32_bf16 v[16:19], a[32:35], v[88:91], v[16:19]
    ds_read_b128 v[104:107], v132 offset:57344
    v_mfma_f32_16x16x32_bf16 v[20:23], a[32:35], v[92:95], v[20:23]
    v_mfma_f32_16x16x32_bf16 v[24:27], a[32:35], v[96:99], v[24:27]
    ds_read_b128 v[108:111], v132 offset:58368
    buffer_load_dwordx4 a[32:35], v130, s[16:19], s35 offen offset:0
    v_mfma_f32_16x16x32_bf16 v[28:31], a[36:39], v[84:87], v[28:31]
    v_mfma_f32_16x16x32_bf16 v[32:35], a[36:39], v[88:91], v[32:35]
    ds_read_b128 v[112:115], v132 offset:59392
    v_mfma_f32_16x16x32_bf16 v[36:39], a[36:39], v[92:95], v[36:39]
    v_mfma_f32_16x16x32_bf16 v[40:43], a[36:39], v[96:99], v[40:43]
    ds_read_b128 v[116:119], v132 offset:60416
    buffer_load_dwordx4 a[36:39], v130, s[16:19], s35 offen offset:3072
    v_mfma_f32_16x16x32_bf16 v[44:47], a[40:43], v[84:87], v[44:47]
    v_mfma_f32_16x16x32_bf16 v[48:51], a[40:43], v[88:91], v[48:51]
    v_mfma_f32_16x16x32_bf16 v[52:55], a[40:43], v[92:95], v[52:55]
    v_mfma_f32_16x16x32_bf16 v[56:59], a[40:43], v[96:99], v[56:59]
    buffer_load_dwordx4 a[40:43], v131, s[16:19], s35 offen offset:0
    v_mfma_f32_16x16x32_bf16 v[60:63], a[44:47], v[84:87], v[60:63]
    v_mfma_f32_16x16x32_bf16 v[64:67], a[44:47], v[88:91], v[64:67]
    v_mfma_f32_16x16x32_bf16 v[68:71], a[44:47], v[92:95], v[68:71]
    v_mfma_f32_16x16x32_bf16 v[72:75], a[44:47], v[96:99], v[72:75]
    s_mov_b64 exec, s[40:41]
    buffer_load_dwordx4 a[44:47], v131, s[16:19], s35 offen offset:1024
    s_mov_b64 exec, -1
    s_add_u32 s35, s35, 14336
    s_waitcnt vmcnt(12) lgkmcnt(0)
    s_barrier
    v_mfma_f32_16x16x32_bf16 v[8:11], a[48:51], v[100:103], v[8:11]
    ds_read_b128 v[80:83], v133 offset:0
    v_mfma_f32_16x16x32_bf16 v[12:15], a[48:51], v[104:107], v[12:15]
    v_mfma_f32_16x16x32_bf16 v[16:19], a[48:51], v[108:111], v[16:19]
    ds_read_b128 v[84:87], v133 offset:1024
    v_mfma_f32_16x16x32_bf16 v[20:23], a[48:51], v[112:115], v[20:23]
    v_mfma_f32_16x16x32_bf16 v[24:27], a[48:51], v[116:119], v[24:27]
    ds_read_b128 v[88:91], v133 offset:2048
    buffer_load_dwordx4 a[48:51], v130, s[16:19], s35 offen offset:0
    v_mfma_f32_16x16x32_bf16 v[28:31], a[52:55], v[104:107], v[28:31]
    v_mfma_f32_16x16x32_bf16 v[32:35], a[52:55], v[108:111], v[32:35]
    ds_read_b128 v[92:95], v133 offset:3072
    v_mfma_f32_16x16x32_bf16 v[36:39], a[52:55], v[112:115], v[36:39]
    v_mfma_f32_16x16x32_bf16 v[40:43], a[52:55], v[116:119], v[40:43]
    ds_read_b128 v[96:99], v133 offset:4096
    buffer_load_dwordx4 a[52:55], v130, s[16:19], s35 offen offset:3072
    v_mfma_f32_16x16x32_bf16 v[44:47], a[56:59], v[104:107], v[44:47]
    v_mfma_f32_16x16x32_bf16 v[48:51], a[56:59], v[108:111], v[48:51]
    v_mfma_f32_16x16x32_bf16 v[52:55], a[56:59], v[112:115], v[52:55]
    v_mfma_f32_16x16x32_bf16 v[56:59], a[56:59], v[116:119], v[56:59]
    buffer_load_dwordx4 a[56:59], v131, s[16:19], s35 offen offset:0
    v_mfma_f32_16x16x32_bf16 v[60:63], a[60:63], v[104:107], v[60:63]
    v_mfma_f32_16x16x32_bf16 v[64:67], a[60:63], v[108:111], v[64:67]
    v_mfma_f32_16x16x32_bf16 v[68:71], a[60:63], v[112:115], v[68:71]
    v_mfma_f32_16x16x32_bf16 v[72:75], a[60:63], v[116:119], v[72:75]
    s_mov_b64 exec, s[40:41]
    buffer_load_dwordx4 a[60:63], v131, s[16:19], s35 offen offset:1024
    s_mov_b64 exec, -1
    s_add_u32 s35, s35, 14336
    s_waitcnt vmcnt(12) lgkmcnt(0)
    v_mfma_f32_16x16x32_bf16 v[8:11], a[0:3], v[80:83], v[8:11]
    ds_read_b128 v[100:103], v133 offset:5120
    v_mfma_f32_16x16x32_bf16 v[12:15], a[0:3], v[84:87], v[12:15]
    v_mfma_f32_16x16x32_bf16 v[16:19], a[0:3], v[88:91], v[16:19]
    ds_read_b128 v[104:107], v133 offset:6144
    v_mfma_f32_16x16x32_bf16 v[20:23], a[0:3], v[92:95], v[20:23]
    v_mfma_f32_16x16x32_bf16 v[24:27], a[0:3], v[96:99], v[24:27]
    ds_read_b128 v[108:111], v133 offset:7168
    buffer_load_dwordx4 a[0:3], v130, s[16:19], s35 offen offset:0
    v_mfma_f32_16x16x32_bf16 v[28:31], a[4:7], v[84:87], v[28:31]
    v_mfma_f32_16x16x32_bf16 v[32:35], a[4:7], v[88:91], v[32:35]
    ds_read_b128 v[112:115], v133 offset:8192
    v_mfma_f32_16x16x32_bf16 v[36:39], a[4:7], v[92:95], v[36:39]
    v_mfma_f32_16x16x32_bf16 v[40:43], a[4:7], v[96:99], v[40:43]
    ds_read_b128 v[116:119], v133 offset:9216
    buffer_load_dwordx4 a[4:7], v130, s[16:19], s35 offen offset:3072
    v_mfma_f32_16x16x32_bf16 v[44:47], a[8:11], v[84:87], v[44:47]
    v_mfma_f32_16x16x32_bf16 v[48:51], a[8:11], v[88:91], v[48:51]
    v_mfma_f32_16x16x32_bf16 v[52:55], a[8:11], v[92:95], v[52:55]
    v_mfma_f32_16x16x32_bf16 v[56:59], a[8:11], v[96:99], v[56:59]
    buffer_load_dwordx4 a[8:11], v131, s[16:19], s35 offen offset:0
    v_mfma_f32_16x16x32_bf16 v[60:63], a[12:15], v[84:87], v[60:63]
    v_mfma_f32_16x16x32_bf16 v[64:67], a[12:15], v[88:91], v[64:67]
    v_mfma_f32_16x16x32_bf16 v[68:71], a[12:15], v[92:95], v[68:71]
    v_mfma_f32_16x16x32_bf16 v[72:75], a[12:15], v[96:99], v[72:75]
    s_mov_b64 exec, s[40:41]
    buffer_load_dwordx4 a[12:15], v131, s[16:19], s35 offen offset:1024
    s_mov_b64 exec, -1
    s_add_u32 s35, s35, 14336
    s_waitcnt vmcnt(12) lgkmcnt(0)
    v_mfma_f32_16x16x32_bf16 v[8:11], a[16:19], v[100:103], v[8:11]
    ds_read_b128 v[80:83], v133 offset:10240
    v_mfma_f32_16x16x32_bf16 v[12:15], a[16:19], v[104:107], v[12:15]
    v_mfma_f32_16x16x32_bf16 v[16:19], a[16:19], v[108:111], v[16:19]
    ds_read_b128 v[84:87], v133 offset:11264
    v_mfma_f32_16x16x32_bf16 v[20:23], a[16:19], v[112:115], v[20:23]
    v_mfma_f32_16x16x32_bf16 v[24:27], a[16:19], v[116:119], v[24:27]
    ds_read_b128 v[88:91], v133 offset:12288
    buffer_load_dwordx4 a[16:19], v130, s[16:19], s35 offen offset:0
    v_mfma_f32_16x16x32_bf16 v[28:31], a[20:23], v[104:107], v[28:31]
    v_mfma_f32_16x16x32_bf16 v[32:35], a[20:23], v[108:111], v[32:35]
    ds_read_b128 v[92:95], v133 offset:13312
    v_mfma_f32_16x16x32_bf16 v[36:39], a[20:23], v[112:115], v[36:39]
    v_mfma_f32_16x16x32_bf16 v[40:43], a[20:23], v[116:119], v[40:43]
    ds_read_b128 v[96:99], v133 offset:14336
    buffer_load_dwordx4 a[20:23], v130, s[16:19], s35 offen offset:3072
    v_mfma_f32_16x16x32_bf16 v[44:47], a[24:27], v[104:107], v[44:47]
    v_mfma_f32_16x16x32_bf16 v[48:51], a[24:27], v[108:111], v[48:51]
    v_mfma_f32_16x16x32_bf16 v[52:55], a[24:27], v[112:115], v[52:55]
    v_mfma_f32_16x16x32_bf16 v[56:59], a[24:27], v[116:119], v[56:59]
    buffer_load_dwordx4 a[24:27], v131, s[16:19], s35 offen offset:0
    v_mfma_f32_16x16x32_bf16 v[60:63], a[28:31], v[104:107], v[60:63]
    v_mfma_f32_16x16x32_bf16 v[64:67], a[28:31], v[108:111], v[64:67]
    v_mfma_f32_16x16x32_bf16 v[68:71], a[28:31], v[112:115], v[68:71]
    v_mfma_f32_16x16x32_bf16 v[72:75], a[28:31], v[116:119], v[72:75]
    s_mov_b64 exec, s[40:41]
    buffer_load_dwordx4 a[28:31], v131, s[16:19], s35 offen offset:1024
    s_mov_b64 exec, -1
    s_add_u32 s35, s35, 14336
    s_waitcnt vmcnt(12) lgkmcnt(0)
    v_mfma_f32_16x16x32_bf16 v[8:11], a[32:35], v[80:83], v[8:11]
    ds_read_b128 v[100:103], v133 offset:15360
    v_mfma_f32_16x16x32_bf16 v[12:15], a[32:35], v[84:87], v[12:15]
    v_mfma_f32_16x16x32_bf16 v[16:19], a[32:35], v[88:91], v[16:19]
    ds_read_b128 v[104:107], v133 offset:16384
    v_mfma_f32_16x16x32_bf16 v[20:23], a[32:35], v[92:95], v[20:23]
    v_mfma_f32_16x16x32_bf16 v[24:27], a[32:35], v[96:99], v[24:27]
    ds_read_b128 v[108:111], v133 offset:17408
    v_mfma_f32_16x16x32_bf16 v[28:31], a[36:39], v[84:87], v[28:31]
    v_mfma_f32_16x16x32_bf16 v[32:35], a[36:39], v[88:91], v[32:35]
    ds_read_b128 v[112:115], v133 offset:18432
    v_mfma_f32_16x16x32_bf16 v[36:39], a[36:39], v[92:95], v[36:39]
    v_mfma_f32_16x16x32_bf16 v[40:43], a[36:39], v[96:99], v[40:43]
    ds_read_b128 v[116:119], v133 offset:19456
    v_mfma_f32_16x16x32_bf16 v[44:47], a[40:43], v[84:87], v[44:47]
    v_mfma_f32_16x16x32_bf16 v[48:51], a[40:43], v[88:91], v[48:51]
    v_mfma_f32_16x16x32_bf16 v[52:55], a[40:43], v[92:95], v[52:55]
    v_mfma_f32_16x16x32_bf16 v[56:59], a[40:43], v[96:99], v[56:59]
    v_mfma_f32_16x16x32_bf16 v[60:63], a[44:47], v[84:87], v[60:63]
    v_mfma_f32_16x16x32_bf16 v[64:67], a[44:47], v[88:91], v[64:67]
    v_mfma_f32_16x16x32_bf16 v[68:71], a[44:47], v[92:95], v[68:71]
    v_mfma_f32_16x16x32_bf16 v[72:75], a[44:47], v[96:99], v[72:75]
    s_waitcnt vmcnt(8) lgkmcnt(0)
    s_barrier
    v_mfma_f32_16x16x32_bf16 v[8:11], a[48:51], v[100:103], v[8:11]
    ds_read_b128 v[80:83], v133 offset:20480
    v_mfma_f32_16x16x32_bf16 v[12:15], a[48:51], v[104:107], v[12:15]
    v_mfma_f32_16x16x32_bf16 v[16:19], a[48:51], v[108:111], v[16:19]
    ds_read_b128 v[84:87], v133 offset:21504
    v_mfma_f32_16x16x32_bf16 v[20:23], a[48:51], v[112:115], v[20:23]
    v_mfma_f32_16x16x32_bf16 v[24:27], a[48:51], v[116:119], v[24:27]
    ds_read_b128 v[88:91], v133 offset:22528
    v_mfma_f32_16x16x32_bf16 v[28:31], a[52:55], v[104:107], v[28:31]
    v_mfma_f32_16x16x32_bf16 v[32:35], a[52:55], v[108:111], v[32:35]
    ds_read_b128 v[92:95], v133 offset:23552
    v_mfma_f32_16x16x32_bf16 v[36:39], a[52:55], v[112:115], v[36:39]
    v_mfma_f32_16x16x32_bf16 v[40:43], a[52:55], v[116:119], v[40:43]
    ds_read_b128 v[96:99], v133 offset:24576
    v_mfma_f32_16x16x32_bf16 v[44:47], a[56:59], v[104:107], v[44:47]
    v_mfma_f32_16x16x32_bf16 v[48:51], a[56:59], v[108:111], v[48:51]
    v_mfma_f32_16x16x32_bf16 v[52:55], a[56:59], v[112:115], v[52:55]
    v_mfma_f32_16x16x32_bf16 v[56:59], a[56:59], v[116:119], v[56:59]
    v_mfma_f32_16x16x32_bf16 v[60:63], a[60:63], v[104:107], v[60:63]
    v_mfma_f32_16x16x32_bf16 v[64:67], a[60:63], v[108:111], v[64:67]
    v_mfma_f32_16x16x32_bf16 v[68:71], a[60:63], v[112:115], v[68:71]
    v_mfma_f32_16x16x32_bf16 v[72:75], a[60:63], v[116:119], v[72:75]
    v_and_b32 v3, 15, v1
    v_mul_u32_u24 v5, 304, v3
    v_lshl_add_u32 v5, v4, 4, v5
    v_add_u32 v5, 115200, v5
    ds_read_b128 v[100:103], v133 offset:25600
    ds_read_b128 v[104:107], v133 offset:26624
    ds_read_b128 v[108:111], v133 offset:27648
    ds_read_b128 v[112:115], v133 offset:28672
    ds_read_b128 v[116:119], v133 offset:29696
    v_mul_u32_u24 v3, 144, v3
    v_lshl_add_u32 v3, v4, 3, v3
    v_add_u32 v3, 92160, v3
    s_waitcnt vmcnt(0) lgkmcnt(5)
    v_mfma_f32_16x16x32_bf16 v[8:11], a[0:3], v[80:83], v[8:11]
    v_mfma_f32_16x16x32_bf16 v[12:15], a[0:3], v[84:87], v[12:15]
    v_mfma_f32_16x16x32_bf16 v[16:19], a[0:3], v[88:91], v[16:19]
    v_mfma_f32_16x16x32_bf16 v[20:23], a[0:3], v[92:95], v[20:23]
    v_mfma_f32_16x16x32_bf16 v[24:27], a[0:3], v[96:99], v[24:27]
    s_waitcnt lgkmcnt(0)
    v_mfma_f32_16x16x32_bf16 v[8:11], a[16:19], v[100:103], v[8:11]
    v_mfma_f32_16x16x32_bf16 v[12:15], a[16:19], v[104:107], v[12:15]
    v_mfma_f32_16x16x32_bf16 v[16:19], a[16:19], v[108:111], v[16:19]
    v_mfma_f32_16x16x32_bf16 v[20:23], a[16:19], v[112:115], v[20:23]
    v_mfma_f32_16x16x32_bf16 v[24:27], a[16:19], v[116:119], v[24:27]
    v_mfma_f32_16x16x32_bf16 v[28:31], a[4:7], v[84:87], v[28:31]
    v_mfma_f32_16x16x32_bf16 v[32:35], a[4:7], v[88:91], v[32:35]
    v_mfma_f32_16x16x32_bf16 v[36:39], a[4:7], v[92:95], v[36:39]
    v_mfma_f32_16x16x32_bf16 v[40:43], a[4:7], v[96:99], v[40:43]
    v_mfma_f32_16x16x32_bf16 v[28:31], a[20:23], v[104:107], v[28:31]
    v_cvt_pk_bf16_f32 v120, v8, v9
    v_cvt_pk_bf16_f32 v121, v10, v11
    s_mov_b32 exec_hi, 0
    ds_write_b64 v3, v[120:121] offset:128
    s_mov_b32 exec_hi, -1
    s_mov_b32 exec_lo, 0
    ds_write_b128 v5, v[8:11] offset:224
    s_mov_b64 exec, -1
    v_mfma_f32_16x16x32_bf16 v[32:35], a[20:23], v[108:111], v[32:35]
    v_cvt_pk_bf16_f32 v122, v12, v13
    v_cvt_pk_bf16_f32 v123, v14, v15
    s_mov_b32 exec_hi, 0
    ds_write_b64 v3, v[122:123] offset:2432
    s_mov_b32 exec_hi, -1
    s_mov_b32 exec_lo, 0
    ds_write_b128 v5, v[12:15] offset:5088
    s_mov_b64 exec, -1
    v_mfma_f32_16x16x32_bf16 v[36:39], a[20:23], v[112:115], v[36:39]
    v_cvt_pk_bf16_f32 v124, v16, v17
    v_cvt_pk_bf16_f32 v125, v18, v19
    s_mov_b32 exec_hi, 0
    ds_write_b64 v3, v[124:125] offset:4736
    s_mov_b32 exec_hi, -1
    s_mov_b32 exec_lo, 0
    ds_write_b128 v5, v[16:19] offset:9952
    s_mov_b64 exec, -1
    v_mfma_f32_16x16x32_bf16 v[40:43], a[20:23], v[116:119], v[40:43]
    v_cvt_pk_bf16_f32 v126, v20, v21
    v_cvt_pk_bf16_f32 v127, v22, v23
    s_mov_b32 exec_hi, 0
    ds_write_b64 v3, v[126:127] offset:7040
    s_mov_b32 exec_hi, -1
    s_mov_b32 exec_lo, 0
    ds_write_b128 v5, v[20:23] offset:14816
    s_mov_b64 exec, -1
    v_cvt_pk_bf16_f32 v120, v24, v25
    v_cvt_pk_bf16_f32 v121, v26, v27
    s_mov_b32 exec_hi, 0
    ds_write_b64 v3, v[120:121] offset:9344
    s_mov_b32 exec_hi, -1
    s_mov_b32 exec_lo, 0
    ds_write_b128 v5, v[24:27] offset:19680
    s_mov_b64 exec, -1
    v_mfma_f32_16x16x32_bf16 v[44:47], a[8:11], v[84:87], v[44:47]
    v_mfma_f32_16x16x32_bf16 v[48:51], a[8:11], v[88:91], v[48:51]
    v_mfma_f32_16x16x32_bf16 v[52:55], a[8:11], v[92:95], v[52:55]
    v_mfma_f32_16x16x32_bf16 v[56:59], a[8:11], v[96:99], v[56:59]
    v_mfma_f32_16x16x32_bf16 v[44:47], a[24:27], v[104:107], v[44:47]
    v_cvt_pk_bf16_f32 v122, v28, v29
    v_cvt_pk_bf16_f32 v123, v30, v31
    ds_write_b64 v3, v[122:123] offset:13888
    v_mfma_f32_16x16x32_bf16 v[48:51], a[24:27], v[108:111], v[48:51]
    v_cvt_pk_bf16_f32 v124, v32, v33
    v_cvt_pk_bf16_f32 v125, v34, v35
    ds_write_b64 v3, v[124:125] offset:16192
    v_mfma_f32_16x16x32_bf16 v[52:55], a[24:27], v[112:115], v[52:55]
    v_cvt_pk_bf16_f32 v126, v36, v37
    v_cvt_pk_bf16_f32 v127, v38, v39
    ds_write_b64 v3, v[126:127] offset:18496
    v_mfma_f32_16x16x32_bf16 v[56:59], a[24:27], v[116:119], v[56:59]
    v_cvt_pk_bf16_f32 v120, v40, v41
    v_cvt_pk_bf16_f32 v121, v42, v43
    ds_write_b64 v3, v[120:121] offset:20800
    v_mfma_f32_16x16x32_bf16 v[60:63], a[12:15], v[84:87], v[60:63]
    v_mfma_f32_16x16x32_bf16 v[64:67], a[12:15], v[88:91], v[64:67]
    v_mfma_f32_16x16x32_bf16 v[68:71], a[12:15], v[92:95], v[68:71]
    v_mfma_f32_16x16x32_bf16 v[72:75], a[12:15], v[96:99], v[72:75]
    v_mfma_f32_16x16x32_bf16 v[60:63], a[28:31], v[104:107], v[60:63]
    v_cvt_pk_bf16_f32 v122, v44, v45
    v_cvt_pk_bf16_f32 v123, v46, v47
    ds_write_b64 v3, v[122:123] offset:13920
    v_mfma_f32_16x16x32_bf16 v[64:67], a[28:31], v[108:111], v[64:67]
    v_cvt_pk_bf16_f32 v124, v48, v49
    v_cvt_pk_bf16_f32 v125, v50, v51
    ds_write_b64 v3, v[124:125] offset:16224
    v_mfma_f32_16x16x32_bf16 v[68:71], a[28:31], v[112:115], v[68:71]
    v_cvt_pk_bf16_f32 v126, v52, v53
    v_cvt_pk_bf16_f32 v127, v54, v55
    ds_write_b64 v3, v[126:127] offset:18528
    v_mfma_f32_16x16x32_bf16 v[72:75], a[28:31], v[116:119], v[72:75]
    v_cvt_pk_bf16_f32 v120, v56, v57
    v_cvt_pk_bf16_f32 v121, v58, v59
    ds_write_b64 v3, v[120:121] offset:20832
    s_nop 4
    v_cvt_pk_bf16_f32 v122, v60, v61
    v_cvt_pk_bf16_f32 v123, v62, v63
    s_mov_b32 exec_hi, 0
    ds_write_b64 v3, v[122:123] offset:13952
    s_mov_b64 exec, -1
    v_cvt_pk_bf16_f32 v124, v64, v65
    v_cvt_pk_bf16_f32 v125, v66, v67
    s_mov_b32 exec_hi, 0
    ds_write_b64 v3, v[124:125] offset:16256
    s_mov_b64 exec, -1
    v_cvt_pk_bf16_f32 v126, v68, v69
    v_cvt_pk_bf16_f32 v127, v70, v71
    s_mov_b32 exec_hi, 0
    ds_write_b64 v3, v[126:127] offset:18560
    s_mov_b64 exec, -1
    v_cvt_pk_bf16_f32 v120, v72, v73
    v_cvt_pk_bf16_f32 v121, v74, v75
    s_mov_b32 exec_hi, 0
    ds_write_b64 v3, v[120:121] offset:20864
    s_mov_b64 exec, -1
L1_att:
    v_and_b32 v3, 15, v1
    v_add_u32 v5, 4, v3
    v_bfe_u32 v5, v5, 3, 1
    v_xor_b32 v5, v5, v4
    v_lshlrev_b32 v5, 1, v5
    v_mov_b32 v6, 0x9c
    v_lshrrev_b32 v5, v5, v6
    v_and_b32 v5, 3, v5
    s_lshl_b32 s34, s30, 4
    v_add_u32 v3, s34, v3
    v_mul_u32_u24 v6, 144, v3
    v_mad_u32_u24 v121, v5, 36, v6
    v_lshl_add_u32 v7, v5, 5, v6
    v_and_b32 v121, -8, v121
    v_add_u32 v7, 92448, v7
    v_cmp_eq_u32 s[42:43], 0, v5
    v_cmp_ge_u32 s[44:45], 1, v5
    v_cmp_ge_u32 s[46:47], 2, v5
    v_mul_u32_u24 v6, 304, v3
    v_mul_u32_u24 v119, 72, v5
    v_and_b32 v119, -16, v119
    v_add3_u32 v119, v119, v6, s33
    v_and_b32 v5, 1, v5
    v_cmp_eq_u32 vcc, 1, v5
    s_mov_b64 s[38:39], vcc
    s_lshl_b32 s34, s28, 6
    v_add_u32 v120, s34, v3
    s_waitcnt lgkmcnt(0)
    s_barrier
    ds_read_b128 v[8:11], v7 offset:13536
    ds_read_b128 v[12:15], v7 offset:13552
    ds_read_b128 v[16:19], v7 offset:13568
    ds_read_b128 v[20:23], v7 offset:0
    ds_read_b128 v[24:27], v7 offset:16
    ds_read_b128 v[28:31], v7 offset:32
    ds_read_b128 v[32:35], v7 offset:288
    ds_read_b128 v[36:39], v7 offset:304
    ds_read_b128 v[40:43], v7 offset:320
    ds_read_b128 v[44:47], v7 offset:576
    ds_read_b128 v[48:51], v7 offset:592
    ds_read_b128 v[52:55], v7 offset:608
    ds_read_b128 v[56:59], v7 offset:864
    ds_read_b128 v[60:63], v7 offset:880
    ds_read_b128 v[64:67], v7 offset:896
    s_waitcnt lgkmcnt(6)
    v_cndmask_b32 v8, 0, v8, s[42:43]
    v_cndmask_b32 v17, v17, 0, s[42:43]
    v_cndmask_b32 v9, 0, v9, s[44:45]
    v_cndmask_b32 v18, v18, 0, s[44:45]
    v_cndmask_b32 v10, 0, v10, s[46:47]
    v_cndmask_b32 v19, v19, 0, s[46:47]
    v_dot2_f32_bf16 v100, v8, v20, 0
    v_dot2_f32_bf16 v101, v8, v32, 0
    v_dot2_f32_bf16 v100, v9, v21, v100
    v_dot2_f32_bf16 v101, v9, v33, v101
    ds_read_b128 v[68:71], v7 offset:1152
    v_dot2_f32_bf16 v100, v10, v22, v100
    v_dot2_f32_bf16 v101, v10, v34, v101
    v_dot2_f32_bf16 v100, v11, v23, v100
    v_dot2_f32_bf16 v101, v11, v35, v101
    ds_read_b128 v[72:75], v7 offset:1168
    v_dot2_f32_bf16 v100, v12, v24, v100
    v_dot2_f32_bf16 v101, v12, v36, v101
    v_dot2_f32_bf16 v100, v13, v25, v100
    v_dot2_f32_bf16 v101, v13, v37, v101
    ds_read_b128 v[76:79], v7 offset:1184
    v_dot2_f32_bf16 v100, v14, v26, v100
    v_dot2_f32_bf16 v101, v14, v38, v101
    v_dot2_f32_bf16 v100, v15, v27, v100
    v_dot2_f32_bf16 v101, v15, v39, v101
    ds_read_b128 v[80:83], v7 offset:1440
    v_dot2_f32_bf16 v100, v16, v28, v100
    v_dot2_f32_bf16 v101, v16, v40, v101
    v_dot2_f32_bf16 v100, v17, v29, v100
    v_dot2_f32_bf16 v101, v17, v41, v101
    ds_read_b128 v[84:87], v7 offset:1456
    v_dot2_f32_bf16 v100, v18, v30, v100
    v_dot2_f32_bf16 v101, v18, v42, v101
    v_dot2_f32_bf16 v100, v19, v31, v100
    v_dot2_f32_bf16 v101, v19, v43, v101
    ds_read_b128 v[88:91], v7 offset:1472
    s_waitcnt lgkmcnt(6)
    v_dot2_f32_bf16 v102, v8, v44, 0
    v_dot2_f32_bf16 v103, v8, v56, 0
    v_dot2_f32_bf16 v102, v9, v45, v102
    v_dot2_f32_bf16 v103, v9, v57, v103
    ds_read_b128 v[20:23], v7 offset:1728
    v_dot2_f32_bf16 v102, v10, v46, v102
    v_dot2_f32_bf16 v103, v10, v58, v103
    v_dot2_f32_bf16 v102, v11, v47, v102
    v_dot2_f32_bf16 v103, v11, v59, v103
    ds_read_b128 v[24:27], v7 offset:1744
    v_dot2_f32_bf16 v102, v12, v48, v102
    v_dot2_f32_bf16 v103, v12, v60, v103
    v_dot2_f32_bf16 v102, v13, v49, v102
    v_dot2_f32_bf16 v103, v13, v61, v103
    ds_read_b128 v[28:31], v7 offset:1760
    v_dot2_f32_bf16 v102, v14, v50, v102
    v_dot2_f32_bf16 v103, v14, v62, v103
    v_dot2_f32_bf16 v102, v15, v51, v102
    v_dot2_f32_bf16 v103, v15, v63, v103
    ds_read_b128 v[32:35], v7 offset:2016
    v_dot2_f32_bf16 v102, v16, v52, v102
    v_dot2_f32_bf16 v103, v16, v64, v103
    v_dot2_f32_bf16 v102, v17, v53, v102
    v_dot2_f32_bf16 v103, v17, v65, v103
    ds_read_b128 v[36:39], v7 offset:2032
    v_dot2_f32_bf16 v102, v18, v54, v102
    v_dot2_f32_bf16 v103, v18, v66, v103
    v_dot2_f32_bf16 v102, v19, v55, v102
    v_dot2_f32_bf16 v103, v19, v67, v103
    ds_read_b128 v[40:43], v7 offset:2048
    s_waitcnt lgkmcnt(6)
    v_dot2_f32_bf16 v104, v8, v68, 0
    v_dot2_f32_bf16 v105, v8, v80, 0
    v_dot2_f32_bf16 v104, v9, v69, v104
    v_dot2_f32_bf16 v105, v9, v81, v105
    v_dot2_f32_bf16 v104, v10, v70, v104
    v_dot2_f32_bf16 v105, v10, v82, v105
    v_dot2_f32_bf16 v104, v11, v71, v104
    v_dot2_f32_bf16 v105, v11, v83, v105
    v_dot2_f32_bf16 v104, v12, v72, v104
    v_dot2_f32_bf16 v105, v12, v84, v105
    v_dot2_f32_bf16 v104, v13, v73, v104
    v_dot2_f32_bf16 v105, v13, v85, v105
    v_dot2_f32_bf16 v104, v14, v74, v104
    v_dot2_f32_bf16 v105, v14, v86, v105
    v_dot2_f32_bf16 v104, v15, v75, v104
    v_dot2_f32_bf16 v105, v15, v87, v105
    v_dot2_f32_bf16 v104, v16, v76, v104
    v_dot2_f32_bf16 v105, v16, v88, v105
    v_dot2_f32_bf16 v104, v17, v77, v104
    v_dot2_f32_bf16 v105, v17, v89, v105
    v_dot2_f32_bf16 v104, v18, v78, v104
    v_dot2_f32_bf16 v105, v18, v90, v105
    v_dot2_f32_bf16 v104, v19, v79, v104
    v_dot2_f32_bf16 v105, v19, v91, v105
    s_waitcnt lgkmcnt(0)
    v_dot2_f32_bf16 v106, v8, v20, 0
    v_dot2_f32_bf16 v107, v8, v32, 0
    v_dot2_f32_bf16 v106, v9, v21, v106
    v_dot2_f32_bf16 v107, v9, v33, v107
    v_dot2_f32_bf16 v106, v10, v22, v106
    v_dot2_f32_bf16 v107, v10, v34, v107
    v_dot2_f32_bf16 v106, v11, v23, v106
    v_dot2_f32_bf16 v107, v11, v35, v107
    v_dot2_f32_bf16 v106, v12, v24, v106
    v_dot2_f32_bf16 v107, v12, v36, v107
    v_dot2_f32_bf16 v106, v13, v25, v106
    v_dot2_f32_bf16 v107, v13, v37, v107
    v_dot2_f32_bf16 v106, v14, v26, v106
    v_dot2_f32_bf16 v107, v14, v38, v107
    v_dot2_f32_bf16 v106, v15, v27, v106
    v_dot2_f32_bf16 v107, v15, v39, v107
    v_dot2_f32_bf16 v106, v16, v28, v106
    v_dot2_f32_bf16 v107, v16, v40, v107
    v_dot2_f32_bf16 v106, v17, v29, v106
    v_dot2_f32_bf16 v107, v17, v41, v107
    v_dot2_f32_bf16 v106, v18, v30, v106
    v_dot2_f32_bf16 v107, v18, v42, v107
    v_dot2_f32_bf16 v106, v19, v31, v106
    v_dot2_f32_bf16 v107, v19, v43, v107
    ds_read_b128 v[20:23], v119 offset:0
    ds_read_b128 v[24:27], v119 offset:16
    ds_read_b128 v[28:31], v119 offset:32
    ds_read_b128 v[32:35], v119 offset:48
    ds_read_b128 v[36:39], v119 offset:64
    ds_read_b128 v[40:43], v119 offset:608
    ds_read_b128 v[44:47], v119 offset:624
    ds_read_b128 v[48:51], v119 offset:640
    ds_read_b128 v[52:55], v119 offset:656
    ds_read_b128 v[56:59], v119 offset:672
    s_cmp_lg_u32 s28, 0
    s_cbranch_scc1 L1_nomask
    v_mov_b32 v122, 0xce6e6b28
    v_cmp_le_u32 vcc, 14, v120
    s_nop 1
    v_cndmask_b32 v100, v122, v100, vcc
    v_cmp_le_u32 vcc, 12, v120
    s_nop 1
    v_cndmask_b32 v101, v122, v101, vcc
    v_cmp_le_u32 vcc, 10, v120
    s_nop 1
    v_cndmask_b32 v102, v122, v102, vcc
    v_cmp_le_u32 vcc, 8, v120
    s_nop 1
    v_cndmask_b32 v103, v122, v103, vcc
    v_cmp_le_u32 vcc, 6, v120
    s_nop 1
    v_cndmask_b32 v104, v122, v104, vcc
    v_cmp_le_u32 vcc, 4, v120
    s_nop 1
    v_cndmask_b32 v105, v122, v105, vcc
    v_cmp_le_u32 vcc, 2, v120
    s_nop 1
    v_cndmask_b32 v106, v122, v106, vcc
L1_nomask:
    s_mov_b32 s34, 0x3eae1a93
    v_max3_f32 v108, v100, v101, v102
    v_max3_f32 v109, v103, v104, v105
    v_max3_f32 v108, v108, v106, v107
    v_max_f32 v108, v108, v109
    v_mul_f32 v108, s34, v108
    v_fma_f32 v100, v100, s34, -v108
    v_fma_f32 v101, v101, s34, -v108
    v_fma_f32 v102, v102, s34, -v108
    v_fma_f32 v103, v103, s34, -v108
    v_fma_f32 v104, v104, s34, -v108
    v_fma_f32 v105, v105, s34, -v108
    v_fma_f32 v106, v106, s34, -v108
    v_fma_f32 v107, v107, s34, -v108
    v_exp_f32 v100, v100
    ds_read_b128 v[60:63], v119 offset:1216
    v_exp_f32 v101, v101
    ds_read_b128 v[64:67], v119 offset:1232
    v_exp_f32 v102, v102
    ds_read_b128 v[68:71], v119 offset:1248
    v_exp_f32 v103, v103
    ds_read_b128 v[72:75], v119 offset:1264
    v_exp_f32 v104, v104
    ds_read_b128 v[76:79], v119 offset:1280
    v_exp_f32 v105, v105
    v_exp_f32 v106, v106
    v_exp_f32 v107, v107
    v_add_u32 v121, 61440, v121
    v_pk_add_f32 v[108:109], v[100:101], v[102:103]
    v_pk_add_f32 v[110:111], v[104:105], v[106:107]
    v_pk_add_f32 v[108:109], v[108:109], v[110:111]
    v_add_f32 v108, v108, v109
    v_rcp_f32 v108, v108
    s_waitcnt lgkmcnt(10)
    v_pk_mul_f32 v[124:125], v[20:21], v[100:101] op_sel:[0,0] op_sel_hi:[1,0]
    v_pk_mul_f32 v[126:127], v[22:23], v[100:101] op_sel:[0,0] op_sel_hi:[1,0]
    ds_read_b128 v[80:83], v119 offset:1824
    v_pk_mul_f32 v[128:129], v[24:25], v[100:101] op_sel:[0,0] op_sel_hi:[1,0]
    v_pk_mul_f32 v[130:131], v[26:27], v[100:101] op_sel:[0,0] op_sel_hi:[1,0]
    ds_read_b128 v[84:87], v119 offset:1840
    v_pk_mul_f32 v[132:133], v[28:29], v[100:101] op_sel:[0,0] op_sel_hi:[1,0]
    v_pk_mul_f32 v[134:135], v[30:31], v[100:101] op_sel:[0,0] op_sel_hi:[1,0]
    ds_read_b128 v[88:91], v119 offset:1856
    v_pk_mul_f32 v[136:137], v[32:33], v[100:101] op_sel:[0,0] op_sel_hi:[1,0]
    v_pk_mul_f32 v[138:139], v[34:35], v[100:101] op_sel:[0,0] op_sel_hi:[1,0]
    ds_read_b128 v[92:95], v119 offset:1872
    v_pk_mul_f32 v[140:141], v[36:37], v[100:101] op_sel:[0,0] op_sel_hi:[1,0]
    v_pk_mul_f32 v[142:143], v[38:39], v[100:101] op_sel:[0,0] op_sel_hi:[1,0]
    ds_read_b128 v[96:99], v119 offset:1888
    s_waitcnt lgkmcnt(10)
    v_pk_fma_f32 v[124:125], v[40:41], v[100:101], v[124:125] op_sel:[0,1,0] op_sel_hi:[1,1,1]
    v_pk_fma_f32 v[126:127], v[42:43], v[100:101], v[126:127] op_sel:[0,1,0] op_sel_hi:[1,1,1]
    ds_read_b128 v[20:23], v119 offset:2432
    v_pk_fma_f32 v[128:129], v[44:45], v[100:101], v[128:129] op_sel:[0,1,0] op_sel_hi:[1,1,1]
    v_pk_fma_f32 v[130:131], v[46:47], v[100:101], v[130:131] op_sel:[0,1,0] op_sel_hi:[1,1,1]
    ds_read_b128 v[24:27], v119 offset:2448
    v_pk_fma_f32 v[132:133], v[48:49], v[100:101], v[132:133] op_sel:[0,1,0] op_sel_hi:[1,1,1]
    v_pk_fma_f32 v[134:135], v[50:51], v[100:101], v[134:135] op_sel:[0,1,0] op_sel_hi:[1,1,1]
    ds_read_b128 v[28:31], v119 offset:2464
    v_pk_fma_f32 v[136:137], v[52:53], v[100:101], v[136:137] op_sel:[0,1,0] op_sel_hi:[1,1,1]
    v_pk_fma_f32 v[138:139], v[54:55], v[100:101], v[138:139] op_sel:[0,1,0] op_sel_hi:[1,1,1]
    ds_read_b128 v[32:35], v119 offset:2480
    v_pk_fma_f32 v[140:141], v[56:57], v[100:101], v[140:141] op_sel:[0,1,0] op_sel_hi:[1,1,1]
    v_pk_fma_f32 v[142:143], v[58:59], v[100:101], v[142:143] op_sel:[0,1,0] op_sel_hi:[1,1,1]
    ds_read_b128 v[36:39], v119 offset:2496
    s_waitcnt lgkmcnt(10)
    v_pk_fma_f32 v[124:125], v[60:61], v[102:103], v[124:125] op_sel:[0,0,0] op_sel_hi:[1,0,1]
    v_pk_fma_f32 v[126:127], v[62:63], v[102:103], v[126:127] op_sel:[0,0,0] op_sel_hi:[1,0,1]
    ds_read_b128 v[40:43], v119 offset:3040
    v_pk_fma_f32 v[128:129], v[64:65], v[102:103], v[128:129] op_sel:[0,0,0] op_sel_hi:[1,0,1]
    v_pk_fma_f32 v[130:131], v[66:67], v[102:103], v[130:131] op_sel:[0,0,0] op_sel_hi:[1,0,1]
    ds_read_b128 v[44:47], v119 offset:3056
    v_pk_fma_f32 v[132:133], v[68:69], v[102:103], v[132:133] op_sel:[0,0,0] op_sel_hi:[1,0,1]
    v_pk_fma_f32 v[134:135], v[70:71], v[102:103], v[134:135] op_sel:[0,0,0] op_sel_hi:[1,0,1]
    ds_read_b128 v[48:51], v119 offset:3072
    v_pk_fma_f32 v[136:137], v[72:73], v[102:103], v[136:137] op_sel:[0,0,0] op_sel_hi:[1,0,1]
    v_pk_fma_f32 v[138:139], v[74:75], v[102:103], v[138:139] op_sel:[0,0,0] op_sel_hi:[1,0,1]
    ds_read_b128 v[52:55], v119 offset:3088
    v_pk_fma_f32 v[140:141], v[76:77], v[102:103], v[140:141] op_sel:[0,0,0] op_sel_hi:[1,0,1]
    v_pk_fma_f32 v[142:143], v[78:79], v[102:103], v[142:143] op_sel:[0,0,0] op_sel_hi:[1,0,1]
    ds_read_b128 v[56:59], v119 offset:3104
    s_waitcnt lgkmcnt(10)
    v_pk_fma_f32 v[124:125], v[80:81], v[102:103], v[124:125] op_sel:[0,1,0] op_sel_hi:[1,1,1]
    v_pk_fma_f32 v[126:127], v[82:83], v[102:103], v[126:127] op_sel:[0,1,0] op_sel_hi:[1,1,1]
    ds_read_b128 v[60:63], v119 offset:3648
    v_pk_fma_f32 v[128:129], v[84:85], v[102:103], v[128:129] op_sel:[0,1,0] op_sel_hi:[1,1,1]
    v_pk_fma_f32 v[130:131], v[86:87], v[102:103], v[130:131] op_sel:[0,1,0] op_sel_hi:[1,1,1]
    ds_read_b128 v[64:67], v119 offset:3664
    v_pk_fma_f32 v[132:133], v[88:89], v[102:103], v[132:133] op_sel:[0,1,0] op_sel_hi:[1,1,1]
    v_pk_fma_f32 v[134:135], v[90:91], v[102:103], v[134:135] op_sel:[0,1,0] op_sel_hi:[1,1,1]
    ds_read_b128 v[68:71], v119 offset:3680
    v_pk_fma_f32 v[136:137], v[92:93], v[102:103], v[136:137] op_sel:[0,1,0] op_sel_hi:[1,1,1]
    v_pk_fma_f32 v[138:139], v[94:95], v[102:103], v[138:139] op_sel:[0,1,0] op_sel_hi:[1,1,1]
    ds_read_b128 v[72:75], v119 offset:3696
    v_pk_fma_f32 v[140:141], v[96:97], v[102:103], v[140:141] op_sel:[0,1,0] op_sel_hi:[1,1,1]
    v_pk_fma_f32 v[142:143], v[98:99], v[102:103], v[142:143] op_sel:[0,1,0] op_sel_hi:[1,1,1]
    ds_read_b128 v[76:79], v119 offset:3712
    s_waitcnt lgkmcnt(10)
    v_pk_fma_f32 v[124:125], v[20:21], v[104:105], v[124:125] op_sel:[0,0,0] op_sel_hi:[1,0,1]
    v_pk_fma_f32 v[126:127], v[22:23], v[104:105], v[126:127] op_sel:[0,0,0] op_sel_hi:[1,0,1]
    ds_read_b128 v[80:83], v119 offset:4256
    v_pk_fma_f32 v[128:129], v[24:25], v[104:105], v[128:129] op_sel:[0,0,0] op_sel_hi:[1,0,1]
    v_pk_fma_f32 v[130:131], v[26:27], v[104:105], v[130:131] op_sel:[0,0,0] op_sel_hi:[1,0,1]
    ds_read_b128 v[84:87], v119 offset:4272
    v_pk_fma_f32 v[132:133], v[28:29], v[104:105], v[132:133] op_sel:[0,0,0] op_sel_hi:[1,0,1]
    v_pk_fma_f32 v[134:135], v[30:31], v[104:105], v[134:135] op_sel:[0,0,0] op_sel_hi:[1,0,1]
    ds_read_b128 v[88:91], v119 offset:4288
    v_pk_fma_f32 v[136:137], v[32:33], v[104:105], v[136:137] op_sel:[0,0,0] op_sel_hi:[1,0,1]
    v_pk_fma_f32 v[138:139], v[34:35], v[104:105], v[138:139] op_sel:[0,0,0] op_sel_hi:[1,0,1]
    ds_read_b128 v[92:95], v119 offset:4304
    v_pk_fma_f32 v[140:141], v[36:37], v[104:105], v[140:141] op_sel:[0,0,0] op_sel_hi:[1,0,1]
    v_pk_fma_f32 v[142:143], v[38:39], v[104:105], v[142:143] op_sel:[0,0,0] op_sel_hi:[1,0,1]
    ds_read_b128 v[96:99], v119 offset:4320
    s_waitcnt lgkmcnt(10)
    v_pk_fma_f32 v[124:125], v[40:41], v[104:105], v[124:125] op_sel:[0,1,0] op_sel_hi:[1,1,1]
    v_pk_fma_f32 v[126:127], v[42:43], v[104:105], v[126:127] op_sel:[0,1,0] op_sel_hi:[1,1,1]
    v_pk_fma_f32 v[128:129], v[44:45], v[104:105], v[128:129] op_sel:[0,1,0] op_sel_hi:[1,1,1]
    v_pk_fma_f32 v[130:131], v[46:47], v[104:105], v[130:131] op_sel:[0,1,0] op_sel_hi:[1,1,1]
    v_pk_fma_f32 v[132:133], v[48:49], v[104:105], v[132:133] op_sel:[0,1,0] op_sel_hi:[1,1,1]
    v_pk_fma_f32 v[134:135], v[50:51], v[104:105], v[134:135] op_sel:[0,1,0] op_sel_hi:[1,1,1]
    v_pk_fma_f32 v[136:137], v[52:53], v[104:105], v[136:137] op_sel:[0,1,0] op_sel_hi:[1,1,1]
    v_pk_fma_f32 v[138:139], v[54:55], v[104:105], v[138:139] op_sel:[0,1,0] op_sel_hi:[1,1,1]
    v_pk_fma_f32 v[140:141], v[56:57], v[104:105], v[140:141] op_sel:[0,1,0] op_sel_hi:[1,1,1]
    v_pk_fma_f32 v[142:143], v[58:59], v[104:105], v[142:143] op_sel:[0,1,0] op_sel_hi:[1,1,1]
    s_waitcnt lgkmcnt(5)
    v_pk_fma_f32 v[124:125], v[60:61], v[106:107], v[124:125] op_sel:[0,0,0] op_sel_hi:[1,0,1]
    v_pk_fma_f32 v[126:127], v[62:63], v[106:107], v[126:127] op_sel:[0,0,0] op_sel_hi:[1,0,1]
    v_pk_fma_f32 v[128:129], v[64:65], v[106:107], v[128:129] op_sel:[0,0,0] op_sel_hi:[1,0,1]
    v_pk_fma_f32 v[130:131], v[66:67], v[106:107], v[130:131] op_sel:[0,0,0] op_sel_hi:[1,0,1]
    v_pk_fma_f32 v[132:133], v[68:69], v[106:107], v[132:133] op_sel:[0,0,0] op_sel_hi:[1,0,1]
    v_pk_fma_f32 v[134:135], v[70:71], v[106:107], v[134:135] op_sel:[0,0,0] op_sel_hi:[1,0,1]
    v_pk_fma_f32 v[136:137], v[72:73], v[106:107], v[136:137] op_sel:[0,0,0] op_sel_hi:[1,0,1]
    v_pk_fma_f32 v[138:139], v[74:75], v[106:107], v[138:139] op_sel:[0,0,0] op_sel_hi:[1,0,1]
    v_pk_fma_f32 v[140:141], v[76:77], v[106:107], v[140:141] op_sel:[0,0,0] op_sel_hi:[1,0,1]
    v_pk_fma_f32 v[142:143], v[78:79], v[106:107], v[142:143] op_sel:[0,0,0] op_sel_hi:[1,0,1]
    s_waitcnt lgkmcnt(0)
    v_pk_fma_f32 v[124:125], v[80:81], v[106:107], v[124:125] op_sel:[0,1,0] op_sel_hi:[1,1,1]
    v_pk_fma_f32 v[126:127], v[82:83], v[106:107], v[126:127] op_sel:[0,1,0] op_sel_hi:[1,1,1]
    v_pk_fma_f32 v[128:129], v[84:85], v[106:107], v[128:129] op_sel:[0,1,0] op_sel_hi:[1,1,1]
    v_pk_fma_f32 v[130:131], v[86:87], v[106:107], v[130:131] op_sel:[0,1,0] op_sel_hi:[1,1,1]
    v_pk_fma_f32 v[132:133], v[88:89], v[106:107], v[132:133] op_sel:[0,1,0] op_sel_hi:[1,1,1]
    v_pk_fma_f32 v[134:135], v[90:91], v[106:107], v[134:135] op_sel:[0,1,0] op_sel_hi:[1,1,1]
    v_pk_fma_f32 v[136:137], v[92:93], v[106:107], v[136:137] op_sel:[0,1,0] op_sel_hi:[1,1,1]
    v_pk_fma_f32 v[138:139], v[94:95], v[106:107], v[138:139] op_sel:[0,1,0] op_sel_hi:[1,1,1]
    v_pk_fma_f32 v[140:141], v[96:97], v[106:107], v[140:141] op_sel:[0,1,0] op_sel_hi:[1,1,1]
    v_pk_fma_f32 v[142:143], v[98:99], v[106:107], v[142:143] op_sel:[0,1,0] op_sel_hi:[1,1,1]
    v_pk_mul_f32 v[124:125], v[124:125], v[108:109] op_sel:[0,0] op_sel_hi:[1,0]
    v_pk_mul_f32 v[126:127], v[126:127], v[108:109] op_sel:[0,0] op_sel_hi:[1,0]
    v_pk_mul_f32 v[128:129], v[128:129], v[108:109] op_sel:[0,0] op_sel_hi:[1,0]
    v_pk_mul_f32 v[130:131], v[130:131], v[108:109] op_sel:[0,0] op_sel_hi:[1,0]
    v_pk_mul_f32 v[132:133], v[132:133], v[108:109] op_sel:[0,0] op_sel_hi:[1,0]
    v_pk_mul_f32 v[134:135], v[134:135], v[108:109] op_sel:[0,0] op_sel_hi:[1,0]
    v_pk_mul_f32 v[136:137], v[136:137], v[108:109] op_sel:[0,0] op_sel_hi:[1,0]
    v_pk_mul_f32 v[138:139], v[138:139], v[108:109] op_sel:[0,0] op_sel_hi:[1,0]
    v_pk_mul_f32 v[140:141], v[140:141], v[108:109] op_sel:[0,0] op_sel_hi:[1,0]
    v_pk_mul_f32 v[142:143], v[142:143], v[108:109] op_sel:[0,0] op_sel_hi:[1,0]
    v_cvt_pk_bf16_f32 v8, v124, v125
    v_cvt_pk_bf16_f32 v9, v126, v127
    v_cvt_pk_bf16_f32 v10, v128, v129
    v_cvt_pk_bf16_f32 v11, v130, v131
    v_cvt_pk_bf16_f32 v12, v132, v133
    v_cvt_pk_bf16_f32 v13, v134, v135
    v_cvt_pk_bf16_f32 v14, v136, v137
    v_cvt_pk_bf16_f32 v15, v138, v139
    v_cvt_pk_bf16_f32 v16, v140, v141
    v_cvt_pk_bf16_f32 v17, v142, v143
    ds_write2_b32 v121, v9, v10 offset0:1 offset1:2
    ds_write2_b32 v121, v11, v12 offset0:3 offset1:4
    ds_write2_b32 v121, v13, v14 offset0:5 offset1:6
    ds_write2_b32 v121, v15, v16 offset0:7 offset1:8
    s_mov_b64 exec, s[38:39]
    ds_write_b32 v121, v17 offset:36
    s_not_b64 exec, exec
    ds_write_b32 v121, v8
    s_mov_b64 exec, -1
    v_mul_u32_u24 v3, 144, v3
    v_lshl_add_u32 v3, v4, 4, v3
    s_lshl_b32 s34, s28, 2
    s_add_u32 s34, s34, s30
    s_mul_i32 s34, s34, 18432
    s_mul_i32 s35, s29, 2304
    s_add_u32 s34, s34, s35
    s_add_u32 s34, s34, 0x500000
    s_waitcnt lgkmcnt(0)
    ds_read_b128 v[20:23], v3 offset:61440
    ds_read_b128 v[24:27], v3 offset:61504
    ds_read_b128 v[28:31], v3 offset:61568
    s_waitcnt lgkmcnt(2)
    buffer_store_dwordx4 v[20:23], v2, s[12:15], s34 offen offset:0 sc1
    s_waitcnt lgkmcnt(1)
    buffer_store_dwordx4 v[24:27], v2, s[12:15], s34 offen offset:1024 sc1
    s_waitcnt lgkmcnt(0)
    s_mov_b64 exec, 0xffff
    buffer_store_dwordx4 v[28:31], v2, s[12:15], s34 offen offset:2048 sc1
    s_branch L1_fin
L1_help:
    s_setprio 3
    s_sub_u32 s31, s30, 4
    v_lshrrev_b32 v4, 4, v1
    v_lshlrev_b32 v3, 9, v4
    v_and_b32 v5, 7, v1
    v_lshl_add_u32 v3, v5, 4, v3
    v_bfe_u32 v5, v1, 3, 1
    v_xor_b32 v5, 1, v5
    v_cvt_f32_u32 v7, v5
    v_mul_u32_u24 v5, 2304, v5
    v_add_u32 v3, v3, v5
    v_and_b32 v140, 7, v1
    v_lshl_add_u32 v140, v140, 4, v5
    s_lshl_b32 s33, s28, 2
    s_sub_u32 s33, s33, 1
    s_mul_i32 s33, s33, 18432
    s_lshl_b32 s36, s31, 10
    s_add_u32 s33, s33, s36
    s_mov_b32 s36, 0
    s_add_u32 s34, s33, 0
    v_add_u32 v132, s34, v2
    s_add_u32 s34, s33, 18432
    v_add_u32 v133, s34, v2
    s_add_u32 s34, s33, 36864
    v_add_u32 v134, s34, v2
    s_add_u32 s34, s33, 55296
    v_add_u32 v135, s34, v2
    s_add_u32 s34, s33, 73728
    v_add_u32 v136, s34, v2
    s_lshl_b32 s35, s31, 7
    s_add_u32 s35, s35, 0x104000
    s_mov_b32 s38, 0xffff0000
    s_waitcnt lgkmcnt(0)
    s_mov_b32 s12, s24
    s_and_b32 s13, s25, 0xffff
    s_mov_b32 s14, 0x10000000
    s_mov_b32 s15, 0x00020000
    buffer_load_dwordx4 v[68:71], v3, s[12:15], s35 offen offset:0
    s_add_u32 s35, s35, 13824
    buffer_load_dwordx4 v[72:75], v3, s[12:15], s35 offen offset:0
    s_add_u32 s35, s35, 13824
    buffer_load_dwordx4 v[76:79], v3, s[12:15], s35 offen offset:0
    s_add_u32 s35, s35, 13824
    buffer_load_dwordx4 v[80:83], v3, s[12:15], s35 offen offset:0
    s_sub_u32 s35, s35, 41472
    s_add_u32 s26, s24, 0x200000
    s_addc_u32 s27, s25, 0
    s_mov_b32 s8, s26
    s_and_b32 s9, s27, 0xffff
    s_mov_b32 s10, 0x240000
    s_mov_b32 s11, 0x00020000
    buffer_load_dwordx4 v[8:11], v132, s[8:11], s36 offen
    buffer_load_dwordx4 v[12:15], v133, s[8:11], s36 offen
    buffer_load_dwordx4 v[16:19], v134, s[8:11], s36 offen
    buffer_load_dwordx4 v[20:23], v135, s[8:11], s36 offen
    buffer_load_dwordx4 v[24:27], v136, s[8:11], s36 offen
    s_add_u32 s36, s36, 4096
    s_barrier
    s_mul_i32 s33, s31, 3072
    s_add_u32 s33, s33, 139520
    v_lshl_add_u32 v137, v4, 5, s33
    v_add_u32 v6, s33, v2
    s_mul_i32 s33, s31, 5120
    v_add_u32 v138, s33, v2
    buffer_load_dwordx4 v[28:31], v132, s[8:11], s36 offen
    buffer_load_dwordx4 v[32:35], v133, s[8:11], s36 offen
    s_waitcnt vmcnt(7)
    v_pk_add_f32 v[68:69], v[68:69], v[72:73]
    v_pk_add_f32 v[76:77], v[76:77], v[80:81]
    v_pk_add_f32 v[70:71], v[70:71], v[74:75]
    v_pk_add_f32 v[78:79], v[78:79], v[82:83]
    v_pk_add_f32 v[68:69], v[68:69], v[76:77]
    v_pk_add_f32 v[70:71], v[70:71], v[78:79]
    v_cvt_pk_bf16_f32 v72, v68, v69
    v_cvt_pk_bf16_f32 v73, v70, v71
    v_lshlrev_b32 v68, 16, v72
    v_and_b32 v69, 0xffff0000, v72
    v_lshlrev_b32 v70, 16, v73
    v_and_b32 v71, 0xffff0000, v73
    v_add_f32 v68, v7, v68
    v_add_f32 v69, v7, v69
    v_add_f32 v70, v7, v70
    v_add_f32 v71, v7, v71
    v_cvt_pk_bf16_f32 v72, v68, v69
    v_cvt_pk_bf16_f32 v73, v70, v71
    v_lshlrev_b32 v68, 16, v72
    v_and_b32 v69, 0xffff0000, v72
    v_lshlrev_b32 v70, 16, v73
    v_and_b32 v71, 0xffff0000, v73
    ds_write_b128 v6, v[68:71] offset:0
    s_waitcnt lgkmcnt(0)
    ds_read_b128 v[84:87], v137 offset:0
    ds_read_b128 v[88:91], v137 offset:16
    ds_read_b128 v[92:95], v137 offset:128
    ds_read_b128 v[96:99], v137 offset:144
    ds_read_b128 v[100:103], v137 offset:256
    ds_read_b128 v[104:107], v137 offset:272
    ds_read_b128 v[108:111], v137 offset:384
    ds_read_b128 v[112:115], v137 offset:400
    s_waitcnt lgkmcnt(4)
    s_waitcnt vmcnt(6)
    v_fma_mix_f32 v116, v8, v84, v92 op_sel:[0,0,0] op_sel_hi:[1,0,0]
    v_fma_mix_f32 v117, v8, v85, v93 op_sel:[1,0,0] op_sel_hi:[1,0,0]
    v_fma_mix_f32 v118, v9, v86, v94 op_sel:[0,0,0] op_sel_hi:[1,0,0]
    v_fma_mix_f32 v119, v9, v87, v95 op_sel:[1,0,0] op_sel_hi:[1,0,0]
    v_fma_mix_f32 v120, v10, v88, v96 op_sel:[0,0,0] op_sel_hi:[1,0,0]
    v_fma_mix_f32 v121, v10, v89, v97 op_sel:[1,0,0] op_sel_hi:[1,0,0]
    v_fma_mix_f32 v122, v11, v90, v98 op_sel:[0,0,0] op_sel_hi:[1,0,0]
    v_fma_mix_f32 v123, v11, v91, v99 op_sel:[1,0,0] op_sel_hi:[1,0,0]
    s_nop 0
    v_cvt_pk_bf16_f32 v124, v116, v117
    v_cvt_pk_bf16_f32 v125, v118, v119
    v_cvt_pk_bf16_f32 v126, v120, v121
    v_cvt_pk_bf16_f32 v127, v122, v123
    ds_write_b128 v138, v[124:127] offset:0
    s_waitcnt vmcnt(5)
    v_fma_mix_f32 v116, v12, v84, v92 op_sel:[0,0,0] op_sel_hi:[1,0,0]
    v_fma_mix_f32 v117, v12, v85, v93 op_sel:[1,0,0] op_sel_hi:[1,0,0]
    v_fma_mix_f32 v118, v13, v86, v94 op_sel:[0,0,0] op_sel_hi:[1,0,0]
    v_fma_mix_f32 v119, v13, v87, v95 op_sel:[1,0,0] op_sel_hi:[1,0,0]
    v_fma_mix_f32 v120, v14, v88, v96 op_sel:[0,0,0] op_sel_hi:[1,0,0]
    v_fma_mix_f32 v121, v14, v89, v97 op_sel:[1,0,0] op_sel_hi:[1,0,0]
    v_fma_mix_f32 v122, v15, v90, v98 op_sel:[0,0,0] op_sel_hi:[1,0,0]
    v_fma_mix_f32 v123, v15, v91, v99 op_sel:[1,0,0] op_sel_hi:[1,0,0]
    s_nop 0
    v_cvt_pk_bf16_f32 v128, v116, v117
    v_cvt_pk_bf16_f32 v129, v118, v119
    v_cvt_pk_bf16_f32 v130, v120, v121
    v_cvt_pk_bf16_f32 v131, v122, v123
    ds_write_b128 v138, v[128:131] offset:1024
    s_waitcnt vmcnt(4)
    v_fma_mix_f32 v116, v16, v84, v92 op_sel:[0,0,0] op_sel_hi:[1,0,0]
    v_fma_mix_f32 v117, v16, v85, v93 op_sel:[1,0,0] op_sel_hi:[1,0,0]
    v_fma_mix_f32 v118, v17, v86, v94 op_sel:[0,0,0] op_sel_hi:[1,0,0]
    v_fma_mix_f32 v119, v17, v87, v95 op_sel:[1,0,0] op_sel_hi:[1,0,0]
    v_fma_mix_f32 v120, v18, v88, v96 op_sel:[0,0,0] op_sel_hi:[1,0,0]
    v_fma_mix_f32 v121, v18, v89, v97 op_sel:[1,0,0] op_sel_hi:[1,0,0]
    v_fma_mix_f32 v122, v19, v90, v98 op_sel:[0,0,0] op_sel_hi:[1,0,0]
    v_fma_mix_f32 v123, v19, v91, v99 op_sel:[1,0,0] op_sel_hi:[1,0,0]
    s_nop 0
    v_cvt_pk_bf16_f32 v124, v116, v117
    v_cvt_pk_bf16_f32 v125, v118, v119
    v_cvt_pk_bf16_f32 v126, v120, v121
    v_cvt_pk_bf16_f32 v127, v122, v123
    ds_write_b128 v138, v[124:127] offset:2048
    s_waitcnt vmcnt(3)
    v_fma_mix_f32 v116, v20, v84, v92 op_sel:[0,0,0] op_sel_hi:[1,0,0]
    v_fma_mix_f32 v117, v20, v85, v93 op_sel:[1,0,0] op_sel_hi:[1,0,0]
    v_fma_mix_f32 v118, v21, v86, v94 op_sel:[0,0,0] op_sel_hi:[1,0,0]
    v_fma_mix_f32 v119, v21, v87, v95 op_sel:[1,0,0] op_sel_hi:[1,0,0]
    v_fma_mix_f32 v120, v22, v88, v96 op_sel:[0,0,0] op_sel_hi:[1,0,0]
    v_fma_mix_f32 v121, v22, v89, v97 op_sel:[1,0,0] op_sel_hi:[1,0,0]
    v_fma_mix_f32 v122, v23, v90, v98 op_sel:[0,0,0] op_sel_hi:[1,0,0]
    v_fma_mix_f32 v123, v23, v91, v99 op_sel:[1,0,0] op_sel_hi:[1,0,0]
    s_nop 0
    v_cvt_pk_bf16_f32 v128, v116, v117
    v_cvt_pk_bf16_f32 v129, v118, v119
    v_cvt_pk_bf16_f32 v130, v120, v121
    v_cvt_pk_bf16_f32 v131, v122, v123
    ds_write_b128 v138, v[128:131] offset:3072
    s_waitcnt vmcnt(2)
    v_fma_mix_f32 v116, v24, v84, v92 op_sel:[0,0,0] op_sel_hi:[1,0,0]
    v_fma_mix_f32 v117, v24, v85, v93 op_sel:[1,0,0] op_sel_hi:[1,0,0]
    v_fma_mix_f32 v118, v25, v86, v94 op_sel:[0,0,0] op_sel_hi:[1,0,0]
    v_fma_mix_f32 v119, v25, v87, v95 op_sel:[1,0,0] op_sel_hi:[1,0,0]
    v_fma_mix_f32 v120, v26, v88, v96 op_sel:[0,0,0] op_sel_hi:[1,0,0]
    v_fma_mix_f32 v121, v26, v89, v97 op_sel:[1,0,0] op_sel_hi:[1,0,0]
    v_fma_mix_f32 v122, v27, v90, v98 op_sel:[0,0,0] op_sel_hi:[1,0,0]
    v_fma_mix_f32 v123, v27, v91, v99 op_sel:[1,0,0] op_sel_hi:[1,0,0]
    s_nop 0
    v_cvt_pk_bf16_f32 v124, v116, v117
    v_cvt_pk_bf16_f32 v125, v118, v119
    v_cvt_pk_bf16_f32 v126, v120, v121
    v_cvt_pk_bf16_f32 v127, v122, v123
    ds_write_b128 v138, v[124:127] offset:4096
    v_add_u32 v138, 20480, v138
    s_waitcnt lgkmcnt(0)
    s_barrier
    s_setprio 0
    s_load_dwordx2 s[4:5], s[0:1], 32
    s_load_dwordx2 s[16:17], s[0:1], 16
    s_load_dwordx2 s[18:19], s[0:1], 56
    s_load_dwordx2 s[20:21], s[0:1], 0
    buffer_load_dwordx4 v[36:39], v134, s[8:11], s36 offen
    buffer_load_dwordx4 v[40:43], v135, s[8:11], s36 offen
    buffer_load_dwordx4 v[44:47], v136, s[8:11], s36 offen
    s_add_u32 s36, s36, 4096
    ds_read_b128 v[84:87], v137 offset:512
    ds_read_b128 v[88:91], v137 offset:528
    ds_read_b128 v[92:95], v137 offset:640
    ds_read_b128 v[96:99], v137 offset:656
    s_waitcnt vmcnt(4)
    v_fma_mix_f32 v116, v28, v100, v108 op_sel:[0,0,0] op_sel_hi:[1,0,0]
    v_fma_mix_f32 v117, v28, v101, v109 op_sel:[1,0,0] op_sel_hi:[1,0,0]
    v_fma_mix_f32 v118, v29, v102, v110 op_sel:[0,0,0] op_sel_hi:[1,0,0]
    v_fma_mix_f32 v119, v29, v103, v111 op_sel:[1,0,0] op_sel_hi:[1,0,0]
    v_fma_mix_f32 v120, v30, v104, v112 op_sel:[0,0,0] op_sel_hi:[1,0,0]
    v_fma_mix_f32 v121, v30, v105, v113 op_sel:[1,0,0] op_sel_hi:[1,0,0]
    v_fma_mix_f32 v122, v31, v106, v114 op_sel:[0,0,0] op_sel_hi:[1,0,0]
    v_fma_mix_f32 v123, v31, v107, v115 op_sel:[1,0,0] op_sel_hi:[1,0,0]
    buffer_load_dwordx4 v[48:51], v132, s[8:11], s36 offen
    buffer_load_dwordx4 v[52:55], v133, s[8:11], s36 offen
    v_cvt_pk_bf16_f32 v124, v116, v117
    v_cvt_pk_bf16_f32 v125, v118, v119
    v_cvt_pk_bf16_f32 v126, v120, v121
    v_cvt_pk_bf16_f32 v127, v122, v123
    ds_write_b128 v138, v[124:127] offset:0
    s_waitcnt vmcnt(5)
    v_fma_mix_f32 v116, v32, v100, v108 op_sel:[0,0,0] op_sel_hi:[1,0,0]
    v_fma_mix_f32 v117, v32, v101, v109 op_sel:[1,0,0] op_sel_hi:[1,0,0]
    v_fma_mix_f32 v118, v33, v102, v110 op_sel:[0,0,0] op_sel_hi:[1,0,0]
    v_fma_mix_f32 v119, v33, v103, v111 op_sel:[1,0,0] op_sel_hi:[1,0,0]
    v_fma_mix_f32 v120, v34, v104, v112 op_sel:[0,0,0] op_sel_hi:[1,0,0]
    v_fma_mix_f32 v121, v34, v105, v113 op_sel:[1,0,0] op_sel_hi:[1,0,0]
    v_fma_mix_f32 v122, v35, v106, v114 op_sel:[0,0,0] op_sel_hi:[1,0,0]
    v_fma_mix_f32 v123, v35, v107, v115 op_sel:[1,0,0] op_sel_hi:[1,0,0]
    buffer_load_dwordx4 v[56:59], v134, s[8:11], s36 offen
    buffer_load_dwordx4 v[60:63], v135, s[8:11], s36 offen
    v_cvt_pk_bf16_f32 v128, v116, v117
    v_cvt_pk_bf16_f32 v129, v118, v119
    v_cvt_pk_bf16_f32 v130, v120, v121
    v_cvt_pk_bf16_f32 v131, v122, v123
    ds_write_b128 v138, v[128:131] offset:1024
    s_waitcnt vmcnt(6)
    v_fma_mix_f32 v116, v36, v100, v108 op_sel:[0,0,0] op_sel_hi:[1,0,0]
    v_fma_mix_f32 v117, v36, v101, v109 op_sel:[1,0,0] op_sel_hi:[1,0,0]
    v_fma_mix_f32 v118, v37, v102, v110 op_sel:[0,0,0] op_sel_hi:[1,0,0]
    v_fma_mix_f32 v119, v37, v103, v111 op_sel:[1,0,0] op_sel_hi:[1,0,0]
    v_fma_mix_f32 v120, v38, v104, v112 op_sel:[0,0,0] op_sel_hi:[1,0,0]
    v_fma_mix_f32 v121, v38, v105, v113 op_sel:[1,0,0] op_sel_hi:[1,0,0]
    v_fma_mix_f32 v122, v39, v106, v114 op_sel:[0,0,0] op_sel_hi:[1,0,0]
    v_fma_mix_f32 v123, v39, v107, v115 op_sel:[1,0,0] op_sel_hi:[1,0,0]
    buffer_load_dwordx4 v[64:67], v136, s[8:11], s36 offen
    s_add_u32 s36, s36, 4096
    s_mov_b64 exec, 0xffff
    buffer_load_dwordx4 v[68:71], v140, s[12:15], s35 offen offset:2048
    s_mov_b64 exec, -1
    s_add_u32 s35, s35, 13824
    v_cvt_pk_bf16_f32 v124, v116, v117
    v_cvt_pk_bf16_f32 v125, v118, v119
    v_cvt_pk_bf16_f32 v126, v120, v121
    v_cvt_pk_bf16_f32 v127, v122, v123
    ds_write_b128 v138, v[124:127] offset:2048
    s_waitcnt vmcnt(7)
    v_fma_mix_f32 v116, v40, v100, v108 op_sel:[0,0,0] op_sel_hi:[1,0,0]
    v_fma_mix_f32 v117, v40, v101, v109 op_sel:[1,0,0] op_sel_hi:[1,0,0]
    v_fma_mix_f32 v118, v41, v102, v110 op_sel:[0,0,0] op_sel_hi:[1,0,0]
    v_fma_mix_f32 v119, v41, v103, v111 op_sel:[1,0,0] op_sel_hi:[1,0,0]
    v_fma_mix_f32 v120, v42, v104, v112 op_sel:[0,0,0] op_sel_hi:[1,0,0]
    v_fma_mix_f32 v121, v42, v105, v113 op_sel:[1,0,0] op_sel_hi:[1,0,0]
    v_fma_mix_f32 v122, v43, v106, v114 op_sel:[0,0,0] op_sel_hi:[1,0,0]
    v_fma_mix_f32 v123, v43, v107, v115 op_sel:[1,0,0] op_sel_hi:[1,0,0]
    s_mov_b64 exec, 0xffff
    buffer_load_dwordx4 v[72:75], v140, s[12:15], s35 offen offset:2048
    s_mov_b64 exec, -1
    s_add_u32 s35, s35, 13824
    s_mov_b64 exec, 0xffff
    buffer_load_dwordx4 v[76:79], v140, s[12:15], s35 offen offset:2048
    s_mov_b64 exec, -1
    s_add_u32 s35, s35, 13824
    v_cvt_pk_bf16_f32 v128, v116, v117
    v_cvt_pk_bf16_f32 v129, v118, v119
    v_cvt_pk_bf16_f32 v130, v120, v121
    v_cvt_pk_bf16_f32 v131, v122, v123
    ds_write_b128 v138, v[128:131] offset:3072
    s_waitcnt vmcnt(8)
    v_fma_mix_f32 v116, v44, v100, v108 op_sel:[0,0,0] op_sel_hi:[1,0,0]
    v_fma_mix_f32 v117, v44, v101, v109 op_sel:[1,0,0] op_sel_hi:[1,0,0]
    v_fma_mix_f32 v118, v45, v102, v110 op_sel:[0,0,0] op_sel_hi:[1,0,0]
    v_fma_mix_f32 v119, v45, v103, v111 op_sel:[1,0,0] op_sel_hi:[1,0,0]
    v_fma_mix_f32 v120, v46, v104, v112 op_sel:[0,0,0] op_sel_hi:[1,0,0]
    v_fma_mix_f32 v121, v46, v105, v113 op_sel:[1,0,0] op_sel_hi:[1,0,0]
    v_fma_mix_f32 v122, v47, v106, v114 op_sel:[0,0,0] op_sel_hi:[1,0,0]
    v_fma_mix_f32 v123, v47, v107, v115 op_sel:[1,0,0] op_sel_hi:[1,0,0]
    s_mov_b64 exec, 0xffff
    buffer_load_dwordx4 v[80:83], v140, s[12:15], s35 offen offset:2048
    s_mov_b64 exec, -1
    s_sub_u32 s35, s35, 41472
    v_cvt_pk_bf16_f32 v124, v116, v117
    v_cvt_pk_bf16_f32 v125, v118, v119
    v_cvt_pk_bf16_f32 v126, v120, v121
    v_cvt_pk_bf16_f32 v127, v122, v123
    ds_write_b128 v138, v[124:127] offset:4096
    v_add_u32 v138, 20480, v138
    s_waitcnt lgkmcnt(0)
    s_barrier
    ds_read_b128 v[100:103], v137 offset:768
    ds_read_b128 v[104:107], v137 offset:784
    ds_read_b128 v[108:111], v137 offset:896
    ds_read_b128 v[112:115], v137 offset:912
    s_waitcnt vmcnt(8)
    v_fma_mix_f32 v116, v48, v84, v92 op_sel:[0,0,0] op_sel_hi:[1,0,0]
    v_fma_mix_f32 v117, v48, v85, v93 op_sel:[1,0,0] op_sel_hi:[1,0,0]
    v_fma_mix_f32 v118, v49, v86, v94 op_sel:[0,0,0] op_sel_hi:[1,0,0]
    v_fma_mix_f32 v119, v49, v87, v95 op_sel:[1,0,0] op_sel_hi:[1,0,0]
    v_fma_mix_f32 v120, v50, v88, v96 op_sel:[0,0,0] op_sel_hi:[1,0,0]
    v_fma_mix_f32 v121, v50, v89, v97 op_sel:[1,0,0] op_sel_hi:[1,0,0]
    v_fma_mix_f32 v122, v51, v90, v98 op_sel:[0,0,0] op_sel_hi:[1,0,0]
    v_fma_mix_f32 v123, v51, v91, v99 op_sel:[1,0,0] op_sel_hi:[1,0,0]
    buffer_load_dwordx4 v[8:11], v132, s[8:11], s36 offen
    v_cvt_pk_bf16_f32 v124, v116, v117
    v_cvt_pk_bf16_f32 v125, v118, v119
    v_cvt_pk_bf16_f32 v126, v120, v121
    v_cvt_pk_bf16_f32 v127, v122, v123
    ds_write_b128 v138, v[124:127] offset:0
    s_waitcnt vmcnt(8)
    v_fma_mix_f32 v116, v52, v84, v92 op_sel:[0,0,0] op_sel_hi:[1,0,0]
    v_fma_mix_f32 v117, v52, v85, v93 op_sel:[1,0,0] op_sel_hi:[1,0,0]
    v_fma_mix_f32 v118, v53, v86, v94 op_sel:[0,0,0] op_sel_hi:[1,0,0]
    v_fma_mix_f32 v119, v53, v87, v95 op_sel:[1,0,0] op_sel_hi:[1,0,0]
    v_fma_mix_f32 v120, v54, v88, v96 op_sel:[0,0,0] op_sel_hi:[1,0,0]
    v_fma_mix_f32 v121, v54, v89, v97 op_sel:[1,0,0] op_sel_hi:[1,0,0]
    v_fma_mix_f32 v122, v55, v90, v98 op_sel:[0,0,0] op_sel_hi:[1,0,0]
    v_fma_mix_f32 v123, v55, v91, v99 op_sel:[1,0,0] op_sel_hi:[1,0,0]
    buffer_load_dwordx4 v[12:15], v133, s[8:11], s36 offen
    v_cvt_pk_bf16_f32 v128, v116, v117
    v_cvt_pk_bf16_f32 v129, v118, v119
    v_cvt_pk_bf16_f32 v130, v120, v121
    v_cvt_pk_bf16_f32 v131, v122, v123
    ds_write_b128 v138, v[128:131] offset:1024
    s_waitcnt vmcnt(8)
    v_fma_mix_f32 v116, v56, v84, v92 op_sel:[0,0,0] op_sel_hi:[1,0,0]
    v_fma_mix_f32 v117, v56, v85, v93 op_sel:[1,0,0] op_sel_hi:[1,0,0]
    v_fma_mix_f32 v118, v57, v86, v94 op_sel:[0,0,0] op_sel_hi:[1,0,0]
    v_fma_mix_f32 v119, v57, v87, v95 op_sel:[1,0,0] op_sel_hi:[1,0,0]
    v_fma_mix_f32 v120, v58, v88, v96 op_sel:[0,0,0] op_sel_hi:[1,0,0]
    v_fma_mix_f32 v121, v58, v89, v97 op_sel:[1,0,0] op_sel_hi:[1,0,0]
    v_fma_mix_f32 v122, v59, v90, v98 op_sel:[0,0,0] op_sel_hi:[1,0,0]
    v_fma_mix_f32 v123, v59, v91, v99 op_sel:[1,0,0] op_sel_hi:[1,0,0]
    buffer_load_dwordx4 v[16:19], v134, s[8:11], s36 offen
    v_cvt_pk_bf16_f32 v124, v116, v117
    v_cvt_pk_bf16_f32 v125, v118, v119
    v_cvt_pk_bf16_f32 v126, v120, v121
    v_cvt_pk_bf16_f32 v127, v122, v123
    ds_write_b128 v138, v[124:127] offset:2048
    s_waitcnt vmcnt(8)
    v_fma_mix_f32 v116, v60, v84, v92 op_sel:[0,0,0] op_sel_hi:[1,0,0]
    v_fma_mix_f32 v117, v60, v85, v93 op_sel:[1,0,0] op_sel_hi:[1,0,0]
    v_fma_mix_f32 v118, v61, v86, v94 op_sel:[0,0,0] op_sel_hi:[1,0,0]
    v_fma_mix_f32 v119, v61, v87, v95 op_sel:[1,0,0] op_sel_hi:[1,0,0]
    v_fma_mix_f32 v120, v62, v88, v96 op_sel:[0,0,0] op_sel_hi:[1,0,0]
    v_fma_mix_f32 v121, v62, v89, v97 op_sel:[1,0,0] op_sel_hi:[1,0,0]
    v_fma_mix_f32 v122, v63, v90, v98 op_sel:[0,0,0] op_sel_hi:[1,0,0]
    v_fma_mix_f32 v123, v63, v91, v99 op_sel:[1,0,0] op_sel_hi:[1,0,0]
    buffer_load_dwordx4 v[20:23], v135, s[8:11], s36 offen
    v_cvt_pk_bf16_f32 v128, v116, v117
    v_cvt_pk_bf16_f32 v129, v118, v119
    v_cvt_pk_bf16_f32 v130, v120, v121
    v_cvt_pk_bf16_f32 v131, v122, v123
    ds_write_b128 v138, v[128:131] offset:3072
    s_waitcnt vmcnt(8)
    v_fma_mix_f32 v116, v64, v84, v92 op_sel:[0,0,0] op_sel_hi:[1,0,0]
    v_fma_mix_f32 v117, v64, v85, v93 op_sel:[1,0,0] op_sel_hi:[1,0,0]
    v_fma_mix_f32 v118, v65, v86, v94 op_sel:[0,0,0] op_sel_hi:[1,0,0]
    v_fma_mix_f32 v119, v65, v87, v95 op_sel:[1,0,0] op_sel_hi:[1,0,0]
    v_fma_mix_f32 v120, v66, v88, v96 op_sel:[0,0,0] op_sel_hi:[1,0,0]
    v_fma_mix_f32 v121, v66, v89, v97 op_sel:[1,0,0] op_sel_hi:[1,0,0]
    v_fma_mix_f32 v122, v67, v90, v98 op_sel:[0,0,0] op_sel_hi:[1,0,0]
    v_fma_mix_f32 v123, v67, v91, v99 op_sel:[1,0,0] op_sel_hi:[1,0,0]
    buffer_load_dwordx4 v[24:27], v136, s[8:11], s36 offen
    s_add_u32 s36, s36, 4096
    v_cvt_pk_bf16_f32 v124, v116, v117
    v_cvt_pk_bf16_f32 v125, v118, v119
    v_cvt_pk_bf16_f32 v126, v120, v121
    v_cvt_pk_bf16_f32 v127, v122, v123
    ds_write_b128 v138, v[124:127] offset:4096
    v_add_u32 v138, 20480, v138
    s_waitcnt vmcnt(5)
    v_pk_add_f32 v[68:69], v[68:69], v[72:73]
    v_pk_add_f32 v[76:77], v[76:77], v[80:81]
    v_pk_add_f32 v[70:71], v[70:71], v[74:75]
    v_pk_add_f32 v[78:79], v[78:79], v[82:83]
    v_pk_add_f32 v[68:69], v[68:69], v[76:77]
    v_pk_add_f32 v[70:71], v[70:71], v[78:79]
    v_cvt_pk_bf16_f32 v72, v68, v69
    v_cvt_pk_bf16_f32 v73, v70, v71
    v_lshlrev_b32 v68, 16, v72
    v_and_b32 v69, 0xffff0000, v72
    v_lshlrev_b32 v70, 16, v73
    v_and_b32 v71, 0xffff0000, v73
    v_add_f32 v68, v7, v68
    v_add_f32 v69, v7, v69
    v_add_f32 v70, v7, v70
    v_add_f32 v71, v7, v71
    v_cvt_pk_bf16_f32 v72, v68, v69
    v_cvt_pk_bf16_f32 v73, v70, v71
    v_lshlrev_b32 v68, 16, v72
    v_and_b32 v69, 0xffff0000, v72
    v_lshlrev_b32 v70, 16, v73
    v_and_b32 v71, 0xffff0000, v73
    ds_write_b128 v6, v[68:71] offset:1024
    s_waitcnt lgkmcnt(0)
    s_barrier
    s_cmp_ge_u32 s31, 2
    s_cbranch_scc0 L1_h4
    s_waitcnt vmcnt(4)
    v_fma_mix_f32 v116, v8, v100, v108 op_sel:[0,0,0] op_sel_hi:[1,0,0]
    v_fma_mix_f32 v117, v8, v101, v109 op_sel:[1,0,0] op_sel_hi:[1,0,0]
    v_fma_mix_f32 v118, v9, v102, v110 op_sel:[0,0,0] op_sel_hi:[1,0,0]
    v_fma_mix_f32 v119, v9, v103, v111 op_sel:[1,0,0] op_sel_hi:[1,0,0]
    v_fma_mix_f32 v120, v10, v104, v112 op_sel:[0,0,0] op_sel_hi:[1,0,0]
    v_fma_mix_f32 v121, v10, v105, v113 op_sel:[1,0,0] op_sel_hi:[1,0,0]
    v_fma_mix_f32 v122, v11, v106, v114 op_sel:[0,0,0] op_sel_hi:[1,0,0]
    v_fma_mix_f32 v123, v11, v107, v115 op_sel:[1,0,0] op_sel_hi:[1,0,0]
    s_nop 0
    v_cvt_pk_bf16_f32 v124, v116, v117
    v_cvt_pk_bf16_f32 v125, v118, v119
    v_cvt_pk_bf16_f32 v126, v120, v121
    v_cvt_pk_bf16_f32 v127, v122, v123
    ds_write_b128 v138, v[124:127] offset:0
    s_waitcnt vmcnt(3)
    v_fma_mix_f32 v116, v12, v100, v108 op_sel:[0,0,0] op_sel_hi:[1,0,0]
    v_fma_mix_f32 v117, v12, v101, v109 op_sel:[1,0,0] op_sel_hi:[1,0,0]
    v_fma_mix_f32 v118, v13, v102, v110 op_sel:[0,0,0] op_sel_hi:[1,0,0]
    v_fma_mix_f32 v119, v13, v103, v111 op_sel:[1,0,0] op_sel_hi:[1,0,0]
    v_fma_mix_f32 v120, v14, v104, v112 op_sel:[0,0,0] op_sel_hi:[1,0,0]
    v_fma_mix_f32 v121, v14, v105, v113 op_sel:[1,0,0] op_sel_hi:[1,0,0]
    v_fma_mix_f32 v122, v15, v106, v114 op_sel:[0,0,0] op_sel_hi:[1,0,0]
    v_fma_mix_f32 v123, v15, v107, v115 op_sel:[1,0,0] op_sel_hi:[1,0,0]
    s_nop 0
    v_cvt_pk_bf16_f32 v128, v116, v117
    v_cvt_pk_bf16_f32 v129, v118, v119
    v_cvt_pk_bf16_f32 v130, v120, v121
    v_cvt_pk_bf16_f32 v131, v122, v123
    ds_write_b128 v138, v[128:131] offset:1024
    s_waitcnt vmcnt(2)
    v_fma_mix_f32 v116, v16, v100, v108 op_sel:[0,0,0] op_sel_hi:[1,0,0]
    v_fma_mix_f32 v117, v16, v101, v109 op_sel:[1,0,0] op_sel_hi:[1,0,0]
    v_fma_mix_f32 v118, v17, v102, v110 op_sel:[0,0,0] op_sel_hi:[1,0,0]
    v_fma_mix_f32 v119, v17, v103, v111 op_sel:[1,0,0] op_sel_hi:[1,0,0]
    v_fma_mix_f32 v120, v18, v104, v112 op_sel:[0,0,0] op_sel_hi:[1,0,0]
    v_fma_mix_f32 v121, v18, v105, v113 op_sel:[1,0,0] op_sel_hi:[1,0,0]
    v_fma_mix_f32 v122, v19, v106, v114 op_sel:[0,0,0] op_sel_hi:[1,0,0]
    v_fma_mix_f32 v123, v19, v107, v115 op_sel:[1,0,0] op_sel_hi:[1,0,0]
    s_nop 0
    v_cvt_pk_bf16_f32 v124, v116, v117
    v_cvt_pk_bf16_f32 v125, v118, v119
    v_cvt_pk_bf16_f32 v126, v120, v121
    v_cvt_pk_bf16_f32 v127, v122, v123
    ds_write_b128 v138, v[124:127] offset:2048
    s_waitcnt vmcnt(1)
    v_fma_mix_f32 v116, v20, v100, v108 op_sel:[0,0,0] op_sel_hi:[1,0,0]
    v_fma_mix_f32 v117, v20, v101, v109 op_sel:[1,0,0] op_sel_hi:[1,0,0]
    v_fma_mix_f32 v118, v21, v102, v110 op_sel:[0,0,0] op_sel_hi:[1,0,0]
    v_fma_mix_f32 v119, v21, v103, v111 op_sel:[1,0,0] op_sel_hi:[1,0,0]
    v_fma_mix_f32 v120, v22, v104, v112 op_sel:[0,0,0] op_sel_hi:[1,0,0]
    v_fma_mix_f32 v121, v22, v105, v113 op_sel:[1,0,0] op_sel_hi:[1,0,0]
    v_fma_mix_f32 v122, v23, v106, v114 op_sel:[0,0,0] op_sel_hi:[1,0,0]
    v_fma_mix_f32 v123, v23, v107, v115 op_sel:[1,0,0] op_sel_hi:[1,0,0]
    s_nop 0
    v_cvt_pk_bf16_f32 v128, v116, v117
    v_cvt_pk_bf16_f32 v129, v118, v119
    v_cvt_pk_bf16_f32 v130, v120, v121
    v_cvt_pk_bf16_f32 v131, v122, v123
    ds_write_b128 v138, v[128:131] offset:3072
    s_waitcnt vmcnt(0)
    v_fma_mix_f32 v116, v24, v100, v108 op_sel:[0,0,0] op_sel_hi:[1,0,0]
    v_fma_mix_f32 v117, v24, v101, v109 op_sel:[1,0,0] op_sel_hi:[1,0,0]
    v_fma_mix_f32 v118, v25, v102, v110 op_sel:[0,0,0] op_sel_hi:[1,0,0]
    v_fma_mix_f32 v119, v25, v103, v111 op_sel:[1,0,0] op_sel_hi:[1,0,0]
    v_fma_mix_f32 v120, v26, v104, v112 op_sel:[0,0,0] op_sel_hi:[1,0,0]
    v_fma_mix_f32 v121, v26, v105, v113 op_sel:[1,0,0] op_sel_hi:[1,0,0]
    v_fma_mix_f32 v122, v27, v106, v114 op_sel:[0,0,0] op_sel_hi:[1,0,0]
    v_fma_mix_f32 v123, v27, v107, v115 op_sel:[1,0,0] op_sel_hi:[1,0,0]
    s_nop 0
    v_cvt_pk_bf16_f32 v124, v116, v117
    v_cvt_pk_bf16_f32 v125, v118, v119
    v_cvt_pk_bf16_f32 v126, v120, v121
    v_cvt_pk_bf16_f32 v127, v122, v123
    ds_write_b128 v138, v[124:127] offset:4096
    v_add_u32 v138, 20480, v138
    s_waitcnt lgkmcnt(0)
    s_barrier
    s_branch L1_ht
L1_h4:
    ds_read_b128 v[84:87], v137 offset:1024
    ds_read_b128 v[88:91], v137 offset:1040
    ds_read_b128 v[92:95], v137 offset:1152
    ds_read_b128 v[96:99], v137 offset:1168
    s_waitcnt vmcnt(4)
    v_fma_mix_f32 v116, v8, v100, v108 op_sel:[0,0,0] op_sel_hi:[1,0,0]
    v_fma_mix_f32 v117, v8, v101, v109 op_sel:[1,0,0] op_sel_hi:[1,0,0]
    v_fma_mix_f32 v118, v9, v102, v110 op_sel:[0,0,0] op_sel_hi:[1,0,0]
    v_fma_mix_f32 v119, v9, v103, v111 op_sel:[1,0,0] op_sel_hi:[1,0,0]
    v_fma_mix_f32 v120, v10, v104, v112 op_sel:[0,0,0] op_sel_hi:[1,0,0]
    v_fma_mix_f32 v121, v10, v105, v113 op_sel:[1,0,0] op_sel_hi:[1,0,0]
    v_fma_mix_f32 v122, v11, v106, v114 op_sel:[0,0,0] op_sel_hi:[1,0,0]
    v_fma_mix_f32 v123, v11, v107, v115 op_sel:[1,0,0] op_sel_hi:[1,0,0]
    buffer_load_dwordx4 v[28:31], v132, s[8:11], s36 offen
    v_cvt_pk_bf16_f32 v124, v116, v117
    v_cvt_pk_bf16_f32 v125, v118, v119
    v_cvt_pk_bf16_f32 v126, v120, v121
    v_cvt_pk_bf16_f32 v127, v122, v123
    ds_write_b128 v138, v[124:127] offset:0
    s_waitcnt vmcnt(4)
    v_fma_mix_f32 v116, v12, v100, v108 op_sel:[0,0,0] op_sel_hi:[1,0,0]
    v_fma_mix_f32 v117, v12, v101, v109 op_sel:[1,0,0] op_sel_hi:[1,0,0]
    v_fma_mix_f32 v118, v13, v102, v110 op_sel:[0,0,0] op_sel_hi:[1,0,0]
    v_fma_mix_f32 v119, v13, v103, v111 op_sel:[1,0,0] op_sel_hi:[1,0,0]
    v_fma_mix_f32 v120, v14, v104, v112 op_sel:[0,0,0] op_sel_hi:[1,0,0]
    v_fma_mix_f32 v121, v14, v105, v113 op_sel:[1,0,0] op_sel_hi:[1,0,0]
    v_fma_mix_f32 v122, v15, v106, v114 op_sel:[0,0,0] op_sel_hi:[1,0,0]
    v_fma_mix_f32 v123, v15, v107, v115 op_sel:[1,0,0] op_sel_hi:[1,0,0]
    buffer_load_dwordx4 v[32:35], v133, s[8:11], s36 offen
    v_cvt_pk_bf16_f32 v128, v116, v117
    v_cvt_pk_bf16_f32 v129, v118, v119
    v_cvt_pk_bf16_f32 v130, v120, v121
    v_cvt_pk_bf16_f32 v131, v122, v123
    ds_write_b128 v138, v[128:131] offset:1024
    s_waitcnt vmcnt(4)
    v_fma_mix_f32 v116, v16, v100, v108 op_sel:[0,0,0] op_sel_hi:[1,0,0]
    v_fma_mix_f32 v117, v16, v101, v109 op_sel:[1,0,0] op_sel_hi:[1,0,0]
    v_fma_mix_f32 v118, v17, v102, v110 op_sel:[0,0,0] op_sel_hi:[1,0,0]
    v_fma_mix_f32 v119, v17, v103, v111 op_sel:[1,0,0] op_sel_hi:[1,0,0]
    v_fma_mix_f32 v120, v18, v104, v112 op_sel:[0,0,0] op_sel_hi:[1,0,0]
    v_fma_mix_f32 v121, v18, v105, v113 op_sel:[1,0,0] op_sel_hi:[1,0,0]
    v_fma_mix_f32 v122, v19, v106, v114 op_sel:[0,0,0] op_sel_hi:[1,0,0]
    v_fma_mix_f32 v123, v19, v107, v115 op_sel:[1,0,0] op_sel_hi:[1,0,0]
    buffer_load_dwordx4 v[36:39], v134, s[8:11], s36 offen
    v_cvt_pk_bf16_f32 v124, v116, v117
    v_cvt_pk_bf16_f32 v125, v118, v119
    v_cvt_pk_bf16_f32 v126, v120, v121
    v_cvt_pk_bf16_f32 v127, v122, v123
    ds_write_b128 v138, v[124:127] offset:2048
    s_waitcnt vmcnt(4)
    v_fma_mix_f32 v116, v20, v100, v108 op_sel:[0,0,0] op_sel_hi:[1,0,0]
    v_fma_mix_f32 v117, v20, v101, v109 op_sel:[1,0,0] op_sel_hi:[1,0,0]
    v_fma_mix_f32 v118, v21, v102, v110 op_sel:[0,0,0] op_sel_hi:[1,0,0]
    v_fma_mix_f32 v119, v21, v103, v111 op_sel:[1,0,0] op_sel_hi:[1,0,0]
    v_fma_mix_f32 v120, v22, v104, v112 op_sel:[0,0,0] op_sel_hi:[1,0,0]
    v_fma_mix_f32 v121, v22, v105, v113 op_sel:[1,0,0] op_sel_hi:[1,0,0]
    v_fma_mix_f32 v122, v23, v106, v114 op_sel:[0,0,0] op_sel_hi:[1,0,0]
    v_fma_mix_f32 v123, v23, v107, v115 op_sel:[1,0,0] op_sel_hi:[1,0,0]
    buffer_load_dwordx4 v[40:43], v135, s[8:11], s36 offen
    v_cvt_pk_bf16_f32 v128, v116, v117
    v_cvt_pk_bf16_f32 v129, v118, v119
    v_cvt_pk_bf16_f32 v130, v120, v121
    v_cvt_pk_bf16_f32 v131, v122, v123
    ds_write_b128 v138, v[128:131] offset:3072
    s_waitcnt vmcnt(4)
    v_fma_mix_f32 v116, v24, v100, v108 op_sel:[0,0,0] op_sel_hi:[1,0,0]
    v_fma_mix_f32 v117, v24, v101, v109 op_sel:[1,0,0] op_sel_hi:[1,0,0]
    v_fma_mix_f32 v118, v25, v102, v110 op_sel:[0,0,0] op_sel_hi:[1,0,0]
    v_fma_mix_f32 v119, v25, v103, v111 op_sel:[1,0,0] op_sel_hi:[1,0,0]
    v_fma_mix_f32 v120, v26, v104, v112 op_sel:[0,0,0] op_sel_hi:[1,0,0]
    v_fma_mix_f32 v121, v26, v105, v113 op_sel:[1,0,0] op_sel_hi:[1,0,0]
    v_fma_mix_f32 v122, v27, v106, v114 op_sel:[0,0,0] op_sel_hi:[1,0,0]
    v_fma_mix_f32 v123, v27, v107, v115 op_sel:[1,0,0] op_sel_hi:[1,0,0]
    buffer_load_dwordx4 v[44:47], v136, s[8:11], s36 offen
    s_add_u32 s36, s36, 4096
    v_cvt_pk_bf16_f32 v124, v116, v117
    v_cvt_pk_bf16_f32 v125, v118, v119
    v_cvt_pk_bf16_f32 v126, v120, v121
    v_cvt_pk_bf16_f32 v127, v122, v123
    ds_write_b128 v138, v[124:127] offset:4096
    v_add_u32 v138, 20480, v138
    s_waitcnt lgkmcnt(0)
    s_barrier
    s_waitcnt vmcnt(4)
    v_fma_mix_f32 v116, v28, v84, v92 op_sel:[0,0,0] op_sel_hi:[1,0,0]
    v_fma_mix_f32 v117, v28, v85, v93 op_sel:[1,0,0] op_sel_hi:[1,0,0]
    v_fma_mix_f32 v118, v29, v86, v94 op_sel:[0,0,0] op_sel_hi:[1,0,0]
    v_fma_mix_f32 v119, v29, v87, v95 op_sel:[1,0,0] op_sel_hi:[1,0,0]
    v_fma_mix_f32 v120, v30, v88, v96 op_sel:[0,0,0] op_sel_hi:[1,0,0]
    v_fma_mix_f32 v121, v30, v89, v97 op_sel:[1,0,0] op_sel_hi:[1,0,0]
    v_fma_mix_f32 v122, v31, v90, v98 op_sel:[0,0,0] op_sel_hi:[1,0,0]
    v_fma_mix_f32 v123, v31, v91, v99 op_sel:[1,0,0] op_sel_hi:[1,0,0]
    s_nop 0
    v_cvt_pk_bf16_f32 v124, v116, v117
    v_cvt_pk_bf16_f32 v125, v118, v119
    v_cvt_pk_bf16_f32 v126, v120, v121
    v_cvt_pk_bf16_f32 v127, v122, v123
    ds_write_b128 v138, v[124:127] offset:0
    s_waitcnt vmcnt(3)
    v_fma_mix_f32 v116, v32, v84, v92 op_sel:[0,0,0] op_sel_hi:[1,0,0]
    v_fma_mix_f32 v117, v32, v85, v93 op_sel:[1,0,0] op_sel_hi:[1,0,0]
    v_fma_mix_f32 v118, v33, v86, v94 op_sel:[0,0,0] op_sel_hi:[1,0,0]
    v_fma_mix_f32 v119, v33, v87, v95 op_sel:[1,0,0] op_sel_hi:[1,0,0]
    v_fma_mix_f32 v120, v34, v88, v96 op_sel:[0,0,0] op_sel_hi:[1,0,0]
    v_fma_mix_f32 v121, v34, v89, v97 op_sel:[1,0,0] op_sel_hi:[1,0,0]
    v_fma_mix_f32 v122, v35, v90, v98 op_sel:[0,0,0] op_sel_hi:[1,0,0]
    v_fma_mix_f32 v123, v35, v91, v99 op_sel:[1,0,0] op_sel_hi:[1,0,0]
    s_nop 0
    v_cvt_pk_bf16_f32 v128, v116, v117
    v_cvt_pk_bf16_f32 v129, v118, v119
    v_cvt_pk_bf16_f32 v130, v120, v121
    v_cvt_pk_bf16_f32 v131, v122, v123
    ds_write_b128 v138, v[128:131] offset:1024
    s_waitcnt vmcnt(2)
    v_fma_mix_f32 v116, v36, v84, v92 op_sel:[0,0,0] op_sel_hi:[1,0,0]
    v_fma_mix_f32 v117, v36, v85, v93 op_sel:[1,0,0] op_sel_hi:[1,0,0]
    v_fma_mix_f32 v118, v37, v86, v94 op_sel:[0,0,0] op_sel_hi:[1,0,0]
    v_fma_mix_f32 v119, v37, v87, v95 op_sel:[1,0,0] op_sel_hi:[1,0,0]
    v_fma_mix_f32 v120, v38, v88, v96 op_sel:[0,0,0] op_sel_hi:[1,0,0]
    v_fma_mix_f32 v121, v38, v89, v97 op_sel:[1,0,0] op_sel_hi:[1,0,0]
    v_fma_mix_f32 v122, v39, v90, v98 op_sel:[0,0,0] op_sel_hi:[1,0,0]
    v_fma_mix_f32 v123, v39, v91, v99 op_sel:[1,0,0] op_sel_hi:[1,0,0]
    s_nop 0
    v_cvt_pk_bf16_f32 v124, v116, v117
    v_cvt_pk_bf16_f32 v125, v118, v119
    v_cvt_pk_bf16_f32 v126, v120, v121
    v_cvt_pk_bf16_f32 v127, v122, v123
    ds_write_b128 v138, v[124:127] offset:2048
    s_waitcnt vmcnt(1)
    v_fma_mix_f32 v116, v40, v84, v92 op_sel:[0,0,0] op_sel_hi:[1,0,0]
    v_fma_mix_f32 v117, v40, v85, v93 op_sel:[1,0,0] op_sel_hi:[1,0,0]
    v_fma_mix_f32 v118, v41, v86, v94 op_sel:[0,0,0] op_sel_hi:[1,0,0]
    v_fma_mix_f32 v119, v41, v87, v95 op_sel:[1,0,0] op_sel_hi:[1,0,0]
    v_fma_mix_f32 v120, v42, v88, v96 op_sel:[0,0,0] op_sel_hi:[1,0,0]
    v_fma_mix_f32 v121, v42, v89, v97 op_sel:[1,0,0] op_sel_hi:[1,0,0]
    v_fma_mix_f32 v122, v43, v90, v98 op_sel:[0,0,0] op_sel_hi:[1,0,0]
    v_fma_mix_f32 v123, v43, v91, v99 op_sel:[1,0,0] op_sel_hi:[1,0,0]
    s_nop 0
    v_cvt_pk_bf16_f32 v128, v116, v117
    v_cvt_pk_bf16_f32 v129, v118, v119
    v_cvt_pk_bf16_f32 v130, v120, v121
    v_cvt_pk_bf16_f32 v131, v122, v123
    ds_write_b128 v138, v[128:131] offset:3072
    s_waitcnt vmcnt(0)
    v_fma_mix_f32 v116, v44, v84, v92 op_sel:[0,0,0] op_sel_hi:[1,0,0]
    v_fma_mix_f32 v117, v44, v85, v93 op_sel:[1,0,0] op_sel_hi:[1,0,0]
    v_fma_mix_f32 v118, v45, v86, v94 op_sel:[0,0,0] op_sel_hi:[1,0,0]
    v_fma_mix_f32 v119, v45, v87, v95 op_sel:[1,0,0] op_sel_hi:[1,0,0]
    v_fma_mix_f32 v120, v46, v88, v96 op_sel:[0,0,0] op_sel_hi:[1,0,0]
    v_fma_mix_f32 v121, v46, v89, v97 op_sel:[1,0,0] op_sel_hi:[1,0,0]
    v_fma_mix_f32 v122, v47, v90, v98 op_sel:[0,0,0] op_sel_hi:[1,0,0]
    v_fma_mix_f32 v123, v47, v91, v99 op_sel:[1,0,0] op_sel_hi:[1,0,0]
    s_nop 0
    v_cvt_pk_bf16_f32 v124, v116, v117
    v_cvt_pk_bf16_f32 v125, v118, v119
    v_cvt_pk_bf16_f32 v126, v120, v121
    v_cvt_pk_bf16_f32 v127, v122, v123
    ds_write_b128 v138, v[124:127] offset:4096
    v_add_u32 v138, 20480, v138
L1_ht:
    s_lshr_b32 s26, s2, 3
    s_lshl_b32 s27, s31, 5
    s_add_u32 s26, s26, s27
    s_and_b32 s27, s2, 7
    s_mul_i32 s37, s31, 9280
    s_cmp_ge_u32 s26, 72
    s_cbranch_scc1 L1_r2
    s_mul_i32 s38, s26, 3641
    s_lshr_b32 s38, s38, 16
    s_mul_i32 s39, s38, 18
    s_sub_u32 s39, s26, s39
    s_and_b32 s40, s27, 3
    s_lshl_b32 s40, s40, 3
    s_lshr_b32 s41, s27, 2
    s_lshl_b32 s41, s41, 2
    s_add_u32 s38, s38, s40
    s_add_u32 s38, s38, s41
    s_lshr_b32 s33, s39, 1
    s_mul_i32 s33, s33, 72
    s_and_b32 s34, s39, 1
    s_lshl_b32 s34, s34, 5
    s_add_u32 s33, s33, s34
    s_sub_u32 s34, s39, 16
    s_mul_i32 s34, s34, 288
    s_add_u32 s34, s34, 64
    s_cmp_ge_u32 s39, 16
    s_cselect_b32 s40, s34, s33
    s_cselect_b32 s41, 72, 8
    v_bfe_u32 v3, v1, 1, 2
    v_mul_u32_u24 v3, s41, v3
    v_and_b32 v5, 1, v1
    v_lshl_add_u32 v3, v5, 2, v3
    v_add_u32 v3, s40, v3
    v_lshlrev_b32 v3, 2, v3
    v_bfe_u32 v5, v1, 3, 1
    v_cvt_f32_u32 v7, v5
    v_mul_u32_u24 v5, 2304, v5
    v_add_u32 v3, v3, v5
    s_mov_b32 s35, 0x105b00
    buffer_load_dwordx4 v[68:71], v3, s[12:15], s35 offen
    s_add_u32 s35, s35, 13824
    buffer_load_dwordx4 v[72:75], v3, s[12:15], s35 offen
    s_add_u32 s35, s35, 13824
    buffer_load_dwordx4 v[76:79], v3, s[12:15], s35 offen
    s_add_u32 s35, s35, 13824
    buffer_load_dwordx4 v[80:83], v3, s[12:15], s35 offen
    s_add_u32 s35, s35, 13824
    s_mov_b32 s8, s4
    s_and_b32 s9, s5, 0xffff
    s_mov_b32 s10, 0x510000
    s_mov_b32 s11, 0x00020000
    s_mul_i32 s42, s41, 9216
    v_add_u32 v3, 0, v1
    v_mul_u32_u24 v5, 3641, v3
    v_lshrrev_b32 v5, 16, v5
    v_mul_u32_u24 v20, 18, v5
    v_sub_u32 v3, v3, v20
    v_and_b32 v20, 7, v5
    v_mul_u32_u24 v20, 9216, v20
    v_lshl_add_u32 v3, v3, 4, v20
    v_lshrrev_b32 v5, 3, v5
    v_mad_u32_u24 v8, v5, s42, v3
    v_add_u32 v3, 64, v1
    v_mul_u32_u24 v5, 3641, v3
    v_lshrrev_b32 v5, 16, v5
    v_mul_u32_u24 v20, 18, v5
    v_sub_u32 v3, v3, v20
    v_and_b32 v20, 7, v5
    v_mul_u32_u24 v20, 9216, v20
    v_lshl_add_u32 v3, v3, 4, v20
    v_lshrrev_b32 v5, 3, v5
    v_mad_u32_u24 v9, v5, s42, v3
    v_add_u32 v3, 128, v1
    v_mul_u32_u24 v5, 3641, v3
    v_lshrrev_b32 v5, 16, v5
    v_mul_u32_u24 v20, 18, v5
    v_sub_u32 v3, v3, v20
    v_and_b32 v20, 7, v5
    v_mul_u32_u24 v20, 9216, v20
    v_lshl_add_u32 v3, v3, 4, v20
    v_lshrrev_b32 v5, 3, v5
    v_mad_u32_u24 v10, v5, s42, v3
    v_add_u32 v3, 192, v1
    v_mul_u32_u24 v5, 3641, v3
    v_lshrrev_b32 v5, 16, v5
    v_mul_u32_u24 v20, 18, v5
    v_sub_u32 v3, v3, v20
    v_and_b32 v20, 7, v5
    v_mul_u32_u24 v20, 9216, v20
    v_lshl_add_u32 v3, v3, 4, v20
    v_lshrrev_b32 v5, 3, v5
    v_mad_u32_u24 v11, v5, s42, v3
    v_add_u32 v3, 256, v1
    v_mul_u32_u24 v5, 3641, v3
    v_lshrrev_b32 v5, 16, v5
    v_mul_u32_u24 v20, 18, v5
    v_sub_u32 v3, v3, v20
    v_and_b32 v20, 7, v5
    v_mul_u32_u24 v20, 9216, v20
    v_lshl_add_u32 v3, v3, 4, v20
    v_lshrrev_b32 v5, 3, v5
    v_mad_u32_u24 v12, v5, s42, v3
    v_add_u32 v3, 320, v1
    v_mul_u32_u24 v5, 3641, v3
    v_lshrrev_b32 v5, 16, v5
    v_mul_u32_u24 v20, 18, v5
    v_sub_u32 v3, v3, v20
    v_and_b32 v20, 7, v5
    v_mul_u32_u24 v20, 9216, v20
    v_lshl_add_u32 v3, v3, 4, v20
    v_lshrrev_b32 v5, 3, v5
    v_mad_u32_u24 v13, v5, s42, v3
    v_add_u32 v3, 384, v1
    v_mul_u32_u24 v5, 3641, v3
    v_lshrrev_b32 v5, 16, v5
    v_mul_u32_u24 v20, 18, v5
    v_sub_u32 v3, v3, v20
    v_and_b32 v20, 7, v5
    v_mul_u32_u24 v20, 9216, v20
    v_lshl_add_u32 v3, v3, 4, v20
    v_lshrrev_b32 v5, 3, v5
    v_mad_u32_u24 v14, v5, s42, v3
    v_add_u32 v3, 448, v1
    v_mul_u32_u24 v5, 3641, v3
    v_lshrrev_b32 v5, 16, v5
    v_mul_u32_u24 v20, 18, v5
    v_sub_u32 v3, v3, v20
    v_and_b32 v20, 7, v5
    v_mul_u32_u24 v20, 9216, v20
    v_lshl_add_u32 v3, v3, 4, v20
    v_lshrrev_b32 v5, 3, v5
    v_mad_u32_u24 v15, v5, s42, v3
    v_add_u32 v3, 512, v1
    v_mul_u32_u24 v5, 3641, v3
    v_lshrrev_b32 v5, 16, v5
    v_mul_u32_u24 v20, 18, v5
    v_sub_u32 v3, v3, v20
    v_and_b32 v20, 7, v5
    v_mul_u32_u24 v20, 9216, v20
    v_lshl_add_u32 v3, v3, 4, v20
    v_lshrrev_b32 v5, 3, v5
    v_mad_u32_u24 v16, v5, s42, v3
    s_lshr_b32 s33, s38, 1
    s_mul_i32 s33, s33, 288
    s_and_b32 s34, s38, 1
    s_cmp_eq_u32 s34, 0
    s_cselect_b32 s34, 4608, 0
    s_add_u32 s33, s33, s34
    s_mul_i32 s34, s40, 9216
    s_add_u32 s33, s33, s34
    s_add_u32 m0, s37, 0
    s_nop 0
    buffer_load_dwordx4 v8, s[8:11], s33 offen nt lds
    s_add_u32 m0, s37, 1024
    s_nop 0
    buffer_load_dwordx4 v9, s[8:11], s33 offen nt lds
    s_add_u32 m0, s37, 2048
    s_nop 0
    buffer_load_dwordx4 v10, s[8:11], s33 offen nt lds
    s_add_u32 m0, s37, 3072
    s_nop 0
    buffer_load_dwordx4 v11, s[8:11], s33 offen nt lds
    s_add_u32 m0, s37, 4096
    s_nop 0
    buffer_load_dwordx4 v12, s[8:11], s33 offen nt lds
    s_add_u32 m0, s37, 5120
    s_nop 0
    buffer_load_dwordx4 v13, s[8:11], s33 offen nt lds
    s_add_u32 m0, s37, 6144
    s_nop 0
    buffer_load_dwordx4 v14, s[8:11], s33 offen nt lds
    s_add_u32 m0, s37, 7168
    s_nop 0
    buffer_load_dwordx4 v15, s[8:11], s33 offen nt lds
    s_add_u32 m0, s37, 8192
    s_nop 0
    buffer_load_dwordx4 v16, s[8:11], s33 offen nt lds
    s_waitcnt lgkmcnt(0)
    s_barrier
    s_waitcnt vmcnt(9)
    v_pk_add_f32 v[68:69], v[68:69], v[72:73]
    v_pk_add_f32 v[76:77], v[76:77], v[80:81]
    v_pk_add_f32 v[70:71], v[70:71], v[74:75]
    v_pk_add_f32 v[78:79], v[78:79], v[82:83]
    v_pk_add_f32 v[68:69], v[68:69], v[76:77]
    v_pk_add_f32 v[70:71], v[70:71], v[78:79]
    v_cvt_pk_bf16_f32 v72, v68, v69
    v_cvt_pk_bf16_f32 v73, v70, v71
    v_lshlrev_b32 v68, 16, v72
    v_and_b32 v69, 0xffff0000, v72
    v_lshlrev_b32 v70, 16, v73
    v_and_b32 v71, 0xffff0000, v73
    v_add_f32 v68, v7, v68
    v_add_f32 v69, v7, v69
    v_add_f32 v70, v7, v70
    v_add_f32 v71, v7, v71
    v_cvt_pk_bf16_f32 v72, v68, v69
    v_cvt_pk_bf16_f32 v73, v70, v71
    v_lshlrev_b32 v68, 16, v72
    v_and_b32 v69, 0xffff0000, v72
    v_lshlrev_b32 v70, 16, v73
    v_and_b32 v71, 0xffff0000, v73
    ds_write_b128 v6, v[68:71] offset:2048
    s_barrier
    s_waitcnt lgkmcnt(0)
    v_and_b32 v20, 15, v1
    v_and_b32 v3, 1, v1
    v_lshl_add_u32 v3, v3, 7, v137
    ds_read_b128 v[24:27], v3 offset:2048
    ds_read_b128 v[28:31], v3 offset:2064
    v_lshlrev_b32 v3, 3, v4
    v_bfe_u32 v5, v1, 2, 2
    v_add_u32 v3, v3, v5
    v_mul_u32_u24 v3, 288, v3
    v_add_u32 v3, s37, v3
    v_and_b32 v5, 3, v1
    v_lshl_add_u32 v21, v5, 4, v3
    v_lshl_add_u32 v22, v5, 3, v3
    v_cmp_gt_u32 vcc, 2, v20
    s_mul_i32 s32, s38, 18
    s_add_u32 s32, s32, s39
    s_mul_i32 s32, s32, 9216
    s_add_u32 s32, s32, 0x1200000
    s_add_u32 s33, s32, 4096
    s_add_u32 s34, s32, 8192
    s_mul_i32 s35, s39, 36864
    s_mul_i32 s36, s38, 576
    s_add_u32 s35, s35, s36
    s_add_u32 s35, s35, 0x2f00000
    v_mul_u32_u24 v23, 18432, v20
    v_lshl_add_u32 v23, v4, 4, v23
    s_waitcnt lgkmcnt(0)
    v_cvt_pk_bf16_f32 v24, v24, v25
    v_cvt_pk_bf16_f32 v25, v26, v27
    v_cvt_pk_bf16_f32 v26, v28, v29
    v_cvt_pk_bf16_f32 v27, v30, v31
    v_cndmask_b32 v24, 0, v24, vcc
    v_cndmask_b32 v25, 0, v25, vcc
    v_cndmask_b32 v26, 0, v26, vcc
    v_cndmask_b32 v27, 0, v27, vcc
    s_waitcnt vmcnt(0)
    ds_read_b64_tr_b16 v[32:33], v21 offset:0
    ds_read_b64_tr_b16 v[34:35], v21 offset:1152
    ds_read_b64_tr_b16 v[36:37], v21 offset:8
    ds_read_b64_tr_b16 v[38:39], v21 offset:1160
    ds_read_b64_tr_b16 v[40:41], v21 offset:64
    ds_read_b64_tr_b16 v[42:43], v21 offset:1216
    ds_read_b64_tr_b16 v[44:45], v21 offset:72
    ds_read_b64_tr_b16 v[46:47], v21 offset:1224
    ds_read_b64_tr_b16 v[48:49], v21 offset:128
    ds_read_b64_tr_b16 v[50:51], v21 offset:1280
    ds_read_b64_tr_b16 v[52:53], v21 offset:136
    ds_read_b64_tr_b16 v[54:55], v21 offset:1288
    ds_read_b64_tr_b16 v[56:57], v21 offset:192
    ds_read_b64_tr_b16 v[58:59], v21 offset:1344
    ds_read_b64_tr_b16 v[60:61], v21 offset:200
    ds_read_b64_tr_b16 v[62:63], v21 offset:1352
    ds_read_b64_tr_b16 v[64:65], v22 offset:256
    ds_read_b64_tr_b16 v[66:67], v22 offset:1408
    s_waitcnt lgkmcnt(14)
    buffer_store_dwordx4 v[32:35], v2, s[12:15], s32 offen offset:0 sc1
    v_mfma_f32_16x16x32_bf16 v[84:87], v[32:35], v[24:27], 0
    s_waitcnt lgkmcnt(14)
    buffer_store_dwordx4 v[36:39], v2, s[12:15], s32 offen offset:1024 sc1
    v_mfma_f32_16x16x32_bf16 v[88:91], v[36:39], v[24:27], 0
    s_waitcnt lgkmcnt(12)
    buffer_store_dwordx4 v[40:43], v2, s[12:15], s32 offen offset:2048 sc1
    v_mfma_f32_16x16x32_bf16 v[92:95], v[40:43], v[24:27], 0
    s_waitcnt lgkmcnt(10)
    buffer_store_dwordx4 v[44:47], v2, s[12:15], s32 offen offset:3072 sc1
    v_mfma_f32_16x16x32_bf16 v[96:99], v[44:47], v[24:27], 0
    s_waitcnt lgkmcnt(8)
    buffer_store_dwordx4 v[48:51], v2, s[12:15], s33 offen offset:0 sc1
    v_mfma_f32_16x16x32_bf16 v[100:103], v[48:51], v[24:27], 0
    s_waitcnt lgkmcnt(6)
    buffer_store_dwordx4 v[52:55], v2, s[12:15], s33 offen offset:1024 sc1
    v_mfma_f32_16x16x32_bf16 v[104:107], v[52:55], v[24:27], 0
    s_waitcnt lgkmcnt(4)
    buffer_store_dwordx4 v[56:59], v2, s[12:15], s33 offen offset:2048 sc1
    v_mfma_f32_16x16x32_bf16 v[108:111], v[56:59], v[24:27], 0
    s_waitcnt lgkmcnt(2)
    buffer_store_dwordx4 v[60:63], v2, s[12:15], s33 offen offset:3072 sc1
    v_mfma_f32_16x16x32_bf16 v[112:115], v[60:63], v[24:27], 0
    s_waitcnt lgkmcnt(0)
    buffer_store_dwordx4 v[64:67], v2, s[12:15], s34 offen offset:0 sc1
    v_mfma_f32_16x16x32_bf16 v[116:119], v[64:67], v[24:27], 0
    s_and_saveexec_b64 s[36:37], vcc
    s_nop 7
    buffer_store_dwordx4 v[84:87], v23, s[12:15], s35 offen offset:0
    buffer_store_dwordx4 v[88:91], v23, s[12:15], s35 offen offset:64
    buffer_store_dwordx4 v[92:95], v23, s[12:15], s35 offen offset:128
    buffer_store_dwordx4 v[96:99], v23, s[12:15], s35 offen offset:192
    buffer_store_dwordx4 v[100:103], v23, s[12:15], s35 offen offset:256
    buffer_store_dwordx4 v[104:107], v23, s[12:15], s35 offen offset:320
    buffer_store_dwordx4 v[108:111], v23, s[12:15], s35 offen offset:384
    buffer_store_dwordx4 v[112:115], v23, s[12:15], s35 offen offset:448
    buffer_store_dwordx4 v[116:119], v23, s[12:15], s35 offen offset:512
    s_branch L1_fin
L1_r2:
    s_cmp_ge_u32 s26, 88
    s_cbranch_scc1 L1_r3
    s_cmp_ge_u32 s26, 88
    s_cbranch_scc1 L1_r2b
    s_cmp_ge_u32 s26, 81
    s_cbranch_scc1 L1_r3
    s_mul_i32 s33, s27, 9
    s_add_u32 s33, s33, s26
    s_sub_u32 s33, s33, 72
    s_mul_i32 s32, s33, 9216
    s_mov_b32 s28, 4
    s_mov_b32 s35, 82944
    s_mov_b32 s34, 0xe00000
    s_lshr_b32 s40, s33, 2
    s_mov_b32 s8, s16
    s_and_b32 s9, s17, 0xffff
    s_mov_b32 s10, 0xa2000
    s_mov_b32 s11, 0x00020000
    s_branch L1_r2c
L1_r2b:
    s_mov_b32 s8, s18
    s_and_b32 s9, s19, 0xffff
    s_mov_b32 s10, 0x288000
    s_mov_b32 s11, 0x00020000
    s_mul_i32 s33, s27, 36
    s_add_u32 s33, s33, s26
    s_sub_u32 s33, s33, 88
    s_lshr_b32 s40, s33, 2
    s_and_b32 s41, s33, 3
    s_mov_b32 s28, 4
    s_mul_i32 s42, s40, 7282
    s_lshr_b32 s42, s42, 16
    s_mul_i32 s43, s42, 9
    s_sub_u32 s43, s40, s43
    s_lshr_b32 s44, s43, 2
    s_mul_i32 s44, s44, 144
    s_and_b32 s45, s43, 3
    s_lshl_b32 s45, s45, 5
    s_add_u32 s44, s44, s45
    s_lshl_b32 s45, s41, 3
    s_add_u32 s44, s44, s45
    s_lshl_b32 s45, s41, 2
    s_add_u32 s45, s45, 128
    s_cmp_eq_u32 s43, 8
    s_cselect_b32 s44, s45, s44
    s_cselect_b32 s28, 144, s28
    s_mul_i32 s32, s42, 288
    s_add_u32 s32, s32, s44
    s_mul_i32 s32, s32, 1152
    s_mov_b32 s35, 331776
    s_mov_b32 s34, 0xf00000
L1_r2c:
    s_lshr_b32 s46, s40, 1
    s_mul_i32 s46, s46, 9216
    s_and_b32 s45, s40, 1
    s_lshl_b32 s47, s45, 7
    s_add_u32 s47, s47, s46
    s_add_u32 s47, s47, 8192
    s_lshl_b32 s45, s45, 12
    s_add_u32 s46, s46, s45
    s_mov_b32 s48, 0x00ff00ff
    s_mov_b32 s49, 0x00ff00ff
    s_mov_b32 s27, 1152
    v_add_u32 v20, 0, v1
    v_mul_u32_u24 v21, 911, v20
    v_lshrrev_b32 v21, 16, v21
    v_mul_u32_u24 v22, 72, v21
    v_sub_u32 v20, v20, v22
    v_lshrrev_b32 v22, 2, v21
    v_and_b32 v21, 3, v21
    v_mad_u32_u24 v21, v22, s28, v21
    v_mul_u32_u24 v21, s27, v21
    v_lshl_add_u32 v8, v20, 4, v21
    v_add_u32 v20, 64, v1
    v_mul_u32_u24 v21, 911, v20
    v_lshrrev_b32 v21, 16, v21
    v_mul_u32_u24 v22, 72, v21
    v_sub_u32 v20, v20, v22
    v_lshrrev_b32 v22, 2, v21
    v_and_b32 v21, 3, v21
    v_mad_u32_u24 v21, v22, s28, v21
    v_mul_u32_u24 v21, s27, v21
    v_lshl_add_u32 v9, v20, 4, v21
    v_add_u32 v20, 128, v1
    v_mul_u32_u24 v21, 911, v20
    v_lshrrev_b32 v21, 16, v21
    v_mul_u32_u24 v22, 72, v21
    v_sub_u32 v20, v20, v22
    v_lshrrev_b32 v22, 2, v21
    v_and_b32 v21, 3, v21
    v_mad_u32_u24 v21, v22, s28, v21
    v_mul_u32_u24 v21, s27, v21
    v_lshl_add_u32 v10, v20, 4, v21
    v_add_u32 v20, 192, v1
    v_mul_u32_u24 v21, 911, v20
    v_lshrrev_b32 v21, 16, v21
    v_mul_u32_u24 v22, 72, v21
    v_sub_u32 v20, v20, v22
    v_lshrrev_b32 v22, 2, v21
    v_and_b32 v21, 3, v21
    v_mad_u32_u24 v21, v22, s28, v21
    v_mul_u32_u24 v21, s27, v21
    v_lshl_add_u32 v11, v20, 4, v21
    v_add_u32 v20, 256, v1
    v_mul_u32_u24 v21, 911, v20
    v_lshrrev_b32 v21, 16, v21
    v_mul_u32_u24 v22, 72, v21
    v_sub_u32 v20, v20, v22
    v_lshrrev_b32 v22, 2, v21
    v_and_b32 v21, 3, v21
    v_mad_u32_u24 v21, v22, s28, v21
    v_mul_u32_u24 v21, s27, v21
    v_lshl_add_u32 v12, v20, 4, v21
    v_add_u32 v20, 320, v1
    v_mul_u32_u24 v21, 911, v20
    v_lshrrev_b32 v21, 16, v21
    v_mul_u32_u24 v22, 72, v21
    v_sub_u32 v20, v20, v22
    v_lshrrev_b32 v22, 2, v21
    v_and_b32 v21, 3, v21
    v_mad_u32_u24 v21, v22, s28, v21
    v_mul_u32_u24 v21, s27, v21
    v_lshl_add_u32 v13, v20, 4, v21
    v_add_u32 v20, 384, v1
    v_mul_u32_u24 v21, 911, v20
    v_lshrrev_b32 v21, 16, v21
    v_mul_u32_u24 v22, 72, v21
    v_sub_u32 v20, v20, v22
    v_lshrrev_b32 v22, 2, v21
    v_and_b32 v21, 3, v21
    v_mad_u32_u24 v21, v22, s28, v21
    v_mul_u32_u24 v21, s27, v21
    v_lshl_add_u32 v14, v20, 4, v21
    v_add_u32 v20, 448, v1
    v_mul_u32_u24 v21, 911, v20
    v_lshrrev_b32 v21, 16, v21
    v_mul_u32_u24 v22, 72, v21
    v_sub_u32 v20, v20, v22
    v_lshrrev_b32 v22, 2, v21
    v_and_b32 v21, 3, v21
    v_mad_u32_u24 v21, v22, s28, v21
    v_mul_u32_u24 v21, s27, v21
    v_lshl_add_u32 v15, v20, 4, v21
    v_add_u32 v20, 512, v1
    v_mul_u32_u24 v21, 911, v20
    v_lshrrev_b32 v21, 16, v21
    v_mul_u32_u24 v22, 72, v21
    v_sub_u32 v20, v20, v22
    v_lshrrev_b32 v22, 2, v21
    v_and_b32 v21, 3, v21
    v_mad_u32_u24 v21, v22, s28, v21
    v_mul_u32_u24 v21, s27, v21
    v_lshl_add_u32 v16, v20, 4, v21
    s_add_u32 m0, s37, 0
    s_nop 0
    buffer_load_dwordx4 v8, s[8:11], s32 offen nt lds
    s_add_u32 m0, s37, 1024
    s_nop 0
    buffer_load_dwordx4 v9, s[8:11], s32 offen nt lds
    s_add_u32 m0, s37, 2048
    s_nop 0
    buffer_load_dwordx4 v10, s[8:11], s32 offen nt lds
    s_add_u32 m0, s37, 3072
    s_nop 0
    buffer_load_dwordx4 v11, s[8:11], s32 offen nt lds
    s_add_u32 m0, s37, 4096
    s_nop 0
    buffer_load_dwordx4 v12, s[8:11], s32 offen nt lds
    s_add_u32 m0, s37, 5120
    s_nop 0
    buffer_load_dwordx4 v13, s[8:11], s32 offen nt lds
    s_add_u32 m0, s37, 6144
    s_nop 0
    buffer_load_dwordx4 v14, s[8:11], s32 offen nt lds
    s_add_u32 m0, s37, 7168
    s_nop 0
    buffer_load_dwordx4 v15, s[8:11], s32 offen nt lds
    s_add_u32 m0, s37, 8192
    s_nop 0
    buffer_load_dwordx4 v16, s[8:11], s32 offen nt lds
    s_waitcnt lgkmcnt(0)
    s_barrier
    s_barrier
    s_lshl_b32 s36, s35, 2
    v_bfe_u32 v21, v1, 2, 2
    v_mul_u32_u24 v21, 1152, v21
    v_lshrrev_b32 v22, 4, v1
    v_mul_u32_u24 v23, 144, v22
    v_add3_u32 v21, v21, v23, s37
    v_and_b32 v23, 3, v1
    v_lshl_add_u32 v19, v23, 3, v21
    v_lshl_add_u32 v17, v23, 4, v21
    v_add_u32 v18, 8, v17
    v_mul_lo_u32 v22, v22, s35
    v_and_b32 v23, 15, v1
    v_lshl_add_u32 v20, v23, 4, v22
    s_and_b32 s41, s33, 3
    s_lshl_b32 s41, s41, 8
    s_add_u32 s41, s41, s34
    s_add_u32 s40, s41, s46
    s_add_u32 s41, s41, s47
    s_waitcnt vmcnt(0)
    ds_read_b64_tr_b16 v[32:33], v17 offset:0
    ds_read_b64_tr_b16 v[34:35], v17 offset:4608
    ds_read_b64_tr_b16 v[36:37], v18 offset:0
    ds_read_b64_tr_b16 v[38:39], v18 offset:4608
    ds_read_b64_tr_b16 v[40:41], v17 offset:64
    ds_read_b64_tr_b16 v[42:43], v17 offset:4672
    ds_read_b64_tr_b16 v[44:45], v18 offset:64
    ds_read_b64_tr_b16 v[46:47], v18 offset:4672
    ds_read_b64_tr_b16 v[48:49], v19 offset:128
    ds_read_b64_tr_b16 v[50:51], v19 offset:4736
    ds_read_b64_tr_b16 v[52:53], v17 offset:576
    ds_read_b64_tr_b16 v[54:55], v17 offset:5184
    ds_read_b64_tr_b16 v[56:57], v18 offset:576
    ds_read_b64_tr_b16 v[58:59], v18 offset:5184
    ds_read_b64_tr_b16 v[60:61], v17 offset:640
    ds_read_b64_tr_b16 v[62:63], v17 offset:5248
    ds_read_b64_tr_b16 v[64:65], v18 offset:640
    ds_read_b64_tr_b16 v[66:67], v18 offset:5248
    ds_read_b64_tr_b16 v[68:69], v19 offset:704
    ds_read_b64_tr_b16 v[70:71], v19 offset:5312
    s_waitcnt lgkmcnt(15)
    buffer_store_dwordx4 v[32:35], v20, s[12:15], s40 offen offset:0 sc1
    s_waitcnt lgkmcnt(15)
    buffer_store_dwordx4 v[36:39], v20, s[12:15], s40 offen offset:1024 sc1
    s_waitcnt lgkmcnt(14)
    buffer_store_dwordx4 v[40:43], v20, s[12:15], s40 offen offset:2048 sc1
    s_waitcnt lgkmcnt(12)
    buffer_store_dwordx4 v[44:47], v20, s[12:15], s40 offen offset:3072 sc1
    s_waitcnt lgkmcnt(10)
    s_mov_b64 exec, s[48:49]
    buffer_store_dwordx4 v[48:51], v20, s[12:15], s41 offen sc1
    s_mov_b64 exec, -1
    s_add_u32 s40, s40, s36
    s_add_u32 s41, s41, s36
    s_waitcnt lgkmcnt(8)
    buffer_store_dwordx4 v[52:55], v20, s[12:15], s40 offen offset:0 sc1
    s_waitcnt lgkmcnt(6)
    buffer_store_dwordx4 v[56:59], v20, s[12:15], s40 offen offset:1024 sc1
    s_waitcnt lgkmcnt(4)
    buffer_store_dwordx4 v[60:63], v20, s[12:15], s40 offen offset:2048 sc1
    s_waitcnt lgkmcnt(2)
    buffer_store_dwordx4 v[64:67], v20, s[12:15], s40 offen offset:3072 sc1
    s_waitcnt lgkmcnt(0)
    s_mov_b64 exec, s[48:49]
    buffer_store_dwordx4 v[68:71], v20, s[12:15], s41 offen sc1
    s_mov_b64 exec, -1
    s_branch L1_fin
L1_r3:
    s_waitcnt lgkmcnt(0)
    s_barrier
    s_mul_i32 s33, s27, 7
    s_add_u32 s33, s33, s26
    s_sub_u32 s33, s33, 81
    s_cmp_ge_u32 s26, 88
    s_cbranch_scc1 L1_r4
    s_cmp_ge_u32 s33, 54
    s_cbranch_scc1 L1_end
    v_lshlrev_b32 v3, 2, v1
    s_lshl_b32 s27, s33, 8
    s_add_u32 s28, s27, 0x104000
    buffer_load_dword v8, v3, s[12:15], s28 offen
    s_add_u32 s28, s28, 13824
    buffer_load_dword v9, v3, s[12:15], s28 offen
    s_add_u32 s28, s28, 13824
    buffer_load_dword v10, v3, s[12:15], s28 offen
    s_add_u32 s28, s28, 13824
    buffer_load_dword v11, v3, s[12:15], s28 offen
    s_add_u32 s28, s28, 13824
    s_mul_i32 s40, s33, 7282
    s_lshr_b32 s40, s40, 16
    s_mov_b32 s41, 0
    s_cmp_eq_u32 s40, 1
    s_cselect_b32 s41, 1.0, s41
    s_cmp_eq_u32 s40, 4
    s_cselect_b32 s41, 1.0, s41
    s_add_u32 s27, s27, 0x100000
    s_barrier
    s_waitcnt vmcnt(0)
    v_add_f32 v8, v8, v9
    v_add_f32 v10, v10, v11
    v_add_f32 v8, v8, v10
    v_cvt_pk_bf16_f32 v8, v8, v8
    v_lshlrev_b32 v8, 16, v8
    v_add_f32 v8, s41, v8
    v_cvt_pk_bf16_f32 v8, v8, v8
    v_lshlrev_b32 v8, 16, v8
    buffer_store_dword v8, v3, s[12:15], s27 offen
    s_branch L1_fin
L1_r4:
    s_cmp_ge_u32 s26, 0
    s_cbranch_scc1 L1_end
    s_mov_b32 s8, s20
    s_and_b32 s9, s21, 0xffff
    s_mov_b32 s10, 0x240000
    s_mov_b32 s11, 0x00020000
    s_mul_i32 s27, s27, 36
    s_add_u32 s27, s27, s26
    s_sub_u32 s27, s27, 88
    s_lshl_b32 s27, s27, 13
    v_lshlrev_b32 v3, 7, v1
    buffer_load_dword v8, v3, s[8:11], s27 offen
    s_barrier
L1_fin:
L1_end:
    s_endpgm
.text
.globl kb_kernel
.p2align 8
.type kb_kernel,@function
kb_kernel:
    s_load_dwordx2 s[24:25], s[0:1], 96
    s_load_dwordx2 s[20:21], s[0:1], 0
    s_load_dwordx4 s[4:7], s[0:1], 40
    s_load_dwordx2 s[22:23], s[0:1], 80
    s_load_dwordx2 s[56:57], s[0:1], 56
    s_cmp_ge_u32 s2, 256
    s_cbranch_scc1 LB_end
    v_lshrrev_b32 v2, 6, v0
    v_and_b32 v1, 63, v0
    s_bfe_u32 s26, s2, 0x20001
    s_lshl_b32 s26, s26, 3
    s_lshr_b32 s27, s2, 5
    s_add_u32 s28, s26, s27
    s_and_b32 s26, s2, 1
    s_lshl_b32 s26, s26, 2
    s_bfe_u32 s27, s2, 0x20003
    s_add_u32 s29, s26, s27
    v_readfirstlane_b32 s30, v2
    v_lshlrev_b32 v2, 4, v1
    s_and_b32 s42, s2, 7
    s_lshr_b32 s43, s2, 3
    s_lshr_b32 s44, s42, 2
    s_lshl_b32 s44, s44, 3
    s_lshr_b32 s45, s43, 2
    s_add_u32 s46, s44, s45
    s_and_b32 s44, s42, 3
    s_lshl_b32 s44, s44, 2
    s_and_b32 s45, s43, 3
    s_add_u32 s47, s44, s45
    s_lshl_b32 s63, s28, 3
    s_add_u32 s63, s63, s29
    s_mov_b32 s64, -1
    s_mov_b32 s65, 0
    s_mul_i32 s55, s30, 4608
    s_mul_i32 s54, s47, 331776
    s_add_u32 s54, s54, s55
    s_add_u32 s54, s54, 0x1200000
    s_lshl_b32 s31, s28, 2
    s_add_u32 s31, s31, s30
    s_mul_i32 s32, s31, 18432
    s_add_u32 s32, s32, 0x500000
    s_mul_i32 s34, s29, 82944
    s_add_u32 s34, s34, 0xe00000
    s_mov_b32 s33, s55
    v_add_u32 v11, 55296, v2
    v_lshrrev_b32 v4, 4, v1
    v_and_b32 v3, 15, v1
    s_mul_i32 s42, s31, 18432
    s_mul_i32 s43, s29, 144
    s_add_u32 s42, s42, s43
    s_mul_i32 s40, s30, 2304
    s_add_u32 s40, s40, 145408
    v_add_u32 v5, 0, v1
    v_mul_u32_u24 v6, 7282, v5
    v_lshrrev_b32 v6, 16, v6
    v_mul_u32_u24 v6, 1008, v6
    v_lshl_add_u32 v180, v5, 4, v6
    v_add_u32 v5, 64, v1
    v_mul_u32_u24 v6, 7282, v5
    v_lshrrev_b32 v6, 16, v6
    v_mul_u32_u24 v6, 1008, v6
    v_lshl_add_u32 v181, v5, 4, v6
    v_add_u32 v5, 128, v1
    v_mul_u32_u24 v6, 7282, v5
    v_lshrrev_b32 v6, 16, v6
    v_mul_u32_u24 v6, 1008, v6
    v_lshl_add_u32 v182, v5, 4, v6
    v_lshrrev_b32 v5, 5, v1
    v_mul_u32_u24 v5, 4096, v5
    v_add_u32 v183, v5, v2
    s_lshl_b32 s41, s30, 10
    s_add_u32 s41, s41, 154624
    s_mul_i32 s38, s29, 288
    s_add_u32 s38, s38, 0x101200
    v_mul_u32_u24 v5, 36864, v4
    v_lshl_add_u32 v184, v3, 4, v5
    s_mul_i32 s39, s63, 144
    s_add_u32 s39, s39, 0x2f00000
    s_waitcnt lgkmcnt(0)
    s_mov_b32 s12, s24
    s_and_b32 s13, s25, 0xffff
    s_mov_b32 s14, 0x10000000
    s_mov_b32 s15, 0x00020000
    s_add_u32 s26, s24, s34
    s_addc_u32 s27, s25, 0
    s_mov_b32 s16, s26
    s_and_b32 s17, s27, 0xffff
    s_mov_b32 s18, 0x14400
    s_mov_b32 s19, 0x00020000
    s_mov_b32 s8, s20
    s_and_b32 s9, s21, 0xffff
    s_mov_b32 s10, 0x240000
    s_mov_b32 s11, 0x00020000
    buffer_load_dwordx4 a[0:3], v2, s[12:15], s32 offen offset:0
    buffer_load_dwordx4 a[4:7], v2, s[12:15], s32 offen offset:1024
    buffer_load_dwordx4 a[8:11], v2, s[12:15], s32 offen offset:2048
    buffer_load_dwordx4 a[12:15], v2, s[12:15], s32 offen offset:3072
    s_add_u32 s32, s32, 4096
    s_add_u32 m0, s55, 0
    s_mov_b64 exec, s[64:65]
    buffer_load_dwordx4 v2, s[16:19], s33 offen lds
    s_mov_b64 exec, -1
    buffer_load_dwordx4 v2, s[16:19], s33 offen offset:512 lds
    buffer_load_dwordx4 v2, s[16:19], s33 offen offset:1536 lds
    buffer_load_dwordx4 v2, s[16:19], s33 offen offset:2560 lds
    buffer_load_dwordx4 v2, s[16:19], s33 offen offset:3584 lds
    s_add_u32 s33, s33, 18432
    buffer_load_dwordx4 a[16:19], v2, s[12:15], s32 offen offset:0
    buffer_load_dwordx4 a[20:23], v2, s[12:15], s32 offen offset:1024
    buffer_load_dwordx4 a[24:27], v2, s[12:15], s32 offen offset:2048
    buffer_load_dwordx4 a[28:31], v2, s[12:15], s32 offen offset:3072
    s_add_u32 s32, s32, 4096
    s_add_u32 m0, s55, 18432
    s_mov_b64 exec, s[64:65]
    buffer_load_dwordx4 v2, s[16:19], s33 offen lds
    s_mov_b64 exec, -1
    buffer_load_dwordx4 v2, s[16:19], s33 offen offset:512 lds
    buffer_load_dwordx4 v2, s[16:19], s33 offen offset:1536 lds
    buffer_load_dwordx4 v2, s[16:19], s33 offen offset:2560 lds
    buffer_load_dwordx4 v2, s[16:19], s33 offen offset:3584 lds
    s_add_u32 s33, s33, 18432
    v_mov_b32 v238, 0
    v_mov_b32 v239, 0
    v_mov_b32 v240, 0
    v_mov_b32 v241, 0
    v_mov_b32 v242, 0
    v_mov_b32 v243, 0
    v_mov_b32 v244, 0
    v_mov_b32 v245, 0
    v_mov_b32 v246, 0
    s_mov_b32 s61, 0
    s_cmp_lt_u32 s30, 2
    s_cbranch_scc1 LB_wo
    s_sub_u32 s26, s30, 2
    s_lshl_b32 s27, s26, 8
    s_add_u32 s60, s27, s2
    s_cmp_ge_u32 s60, 288
    s_cbranch_scc1 LB_wo
    s_mul_i32 s61, s26, 18432
    s_sub_u32 s61, 55296, s61
    s_lshr_b32 s50, s60, 2
    s_and_b32 s51, s60, 3
    s_mov_b32 s27, 4
    s_sub_u32 s60, s50, 32
    s_max_i32 s60, s60, 0
    s_mul_i32 s52, s60, 13108
    s_lshr_b32 s52, s52, 16
    s_mul_i32 s53, s52, 5
    s_sub_u32 s53, s60, s53
    s_lshr_b32 s58, s53, 1
    s_mul_i32 s58, s58, 144
    s_and_b32 s59, s53, 1
    s_lshl_b32 s59, s59, 5
    s_add_u32 s58, s58, s59
    s_lshl_b32 s59, s51, 3
    s_add_u32 s58, s58, s59
    s_add_u32 s58, s58, 64
    s_lshl_b32 s59, s51, 2
    s_add_u32 s59, s59, 128
    s_cmp_eq_u32 s53, 4
    s_cselect_b32 s58, s59, s58
    s_cselect_b32 s27, 144, s27
    s_mul_i32 s60, s52, 288
    s_add_u32 s60, s60, s58
    s_lshr_b32 s58, s50, 1
    s_mul_i32 s58, s58, 144
    s_and_b32 s59, s50, 1
    s_lshl_b32 s59, s59, 5
    s_add_u32 s58, s58, s59
    s_lshl_b32 s59, s51, 3
    s_add_u32 s58, s58, s59
    s_cmp_lt_u32 s50, 32
    s_cselect_b32 s60, s58, s60
    s_mul_i32 s60, s60, 1152
    s_mov_b32 s26, 1152
    v_add_u32 v250, 0, v1
    v_mul_u32_u24 v251, 911, v250
    v_lshrrev_b32 v251, 16, v251
    v_mul_u32_u24 v252, 72, v251
    v_sub_u32 v250, v250, v252
    v_lshrrev_b32 v252, 2, v251
    v_and_b32 v251, 3, v251
    v_mad_u32_u24 v251, v252, s27, v251
    v_mul_u32_u24 v251, s26, v251
    v_lshl_add_u32 v238, v250, 4, v251
    v_add_u32 v250, 64, v1
    v_mul_u32_u24 v251, 911, v250
    v_lshrrev_b32 v251, 16, v251
    v_mul_u32_u24 v252, 72, v251
    v_sub_u32 v250, v250, v252
    v_lshrrev_b32 v252, 2, v251
    v_and_b32 v251, 3, v251
    v_mad_u32_u24 v251, v252, s27, v251
    v_mul_u32_u24 v251, s26, v251
    v_lshl_add_u32 v239, v250, 4, v251
    v_add_u32 v250, 128, v1
    v_mul_u32_u24 v251, 911, v250
    v_lshrrev_b32 v251, 16, v251
    v_mul_u32_u24 v252, 72, v251
    v_sub_u32 v250, v250, v252
    v_lshrrev_b32 v252, 2, v251
    v_and_b32 v251, 3, v251
    v_mad_u32_u24 v251, v252, s27, v251
    v_mul_u32_u24 v251, s26, v251
    v_lshl_add_u32 v240, v250, 4, v251
    v_add_u32 v250, 192, v1
    v_mul_u32_u24 v251, 911, v250
    v_lshrrev_b32 v251, 16, v251
    v_mul_u32_u24 v252, 72, v251
    v_sub_u32 v250, v250, v252
    v_lshrrev_b32 v252, 2, v251
    v_and_b32 v251, 3, v251
    v_mad_u32_u24 v251, v252, s27, v251
    v_mul_u32_u24 v251, s26, v251
    v_lshl_add_u32 v241, v250, 4, v251
    v_add_u32 v250, 256, v1
    v_mul_u32_u24 v251, 911, v250
    v_lshrrev_b32 v251, 16, v251
    v_mul_u32_u24 v252, 72, v251
    v_sub_u32 v250, v250, v252
    v_lshrrev_b32 v252, 2, v251
    v_and_b32 v251, 3, v251
    v_mad_u32_u24 v251, v252, s27, v251
    v_mul_u32_u24 v251, s26, v251
    v_lshl_add_u32 v242, v250, 4, v251
    v_add_u32 v250, 320, v1
    v_mul_u32_u24 v251, 911, v250
    v_lshrrev_b32 v251, 16, v251
    v_mul_u32_u24 v252, 72, v251
    v_sub_u32 v250, v250, v252
    v_lshrrev_b32 v252, 2, v251
    v_and_b32 v251, 3, v251
    v_mad_u32_u24 v251, v252, s27, v251
    v_mul_u32_u24 v251, s26, v251
    v_lshl_add_u32 v243, v250, 4, v251
    v_add_u32 v250, 384, v1
    v_mul_u32_u24 v251, 911, v250
    v_lshrrev_b32 v251, 16, v251
    v_mul_u32_u24 v252, 72, v251
    v_sub_u32 v250, v250, v252
    v_lshrrev_b32 v252, 2, v251
    v_and_b32 v251, 3, v251
    v_mad_u32_u24 v251, v252, s27, v251
    v_mul_u32_u24 v251, s26, v251
    v_lshl_add_u32 v244, v250, 4, v251
    v_add_u32 v250, 448, v1
    v_mul_u32_u24 v251, 911, v250
    v_lshrrev_b32 v251, 16, v251
    v_mul_u32_u24 v252, 72, v251
    v_sub_u32 v250, v250, v252
    v_lshrrev_b32 v252, 2, v251
    v_and_b32 v251, 3, v251
    v_mad_u32_u24 v251, v252, s27, v251
    v_mul_u32_u24 v251, s26, v251
    v_lshl_add_u32 v245, v250, 4, v251
    v_add_u32 v250, 512, v1
    v_mul_u32_u24 v251, 911, v250
    v_lshrrev_b32 v251, 16, v251
    v_mul_u32_u24 v252, 72, v251
    v_sub_u32 v250, v250, v252
    v_lshrrev_b32 v252, 2, v251
    v_and_b32 v251, 3, v251
    v_mad_u32_u24 v251, v252, s27, v251
    v_mul_u32_u24 v251, s26, v251
    v_lshl_add_u32 v246, v250, 4, v251
    s_lshr_b32 s58, s50, 1
    s_mul_i32 s58, s58, 9216
    s_lshl_b32 s51, s51, 8
    s_add_u32 s58, s58, s51
    s_add_u32 s58, s58, 0xf00000
    s_and_b32 s59, s50, 1
    s_lshl_b32 s51, s59, 7
    s_add_u32 s51, s51, s58
    s_add_u32 s51, s51, 8192
    s_lshl_b32 s59, s59, 12
    s_add_u32 s50, s58, s59
    s_mov_b32 s52, 0x00ff00ff
    s_mov_b32 s53, 0x00ff00ff
LB_wo:
    s_waitcnt vmcnt(9)
    s_barrier
    ds_read_b128 v[64:67], v2 offset:0
    ds_read_b128 v[68:71], v2 offset:1024
    ds_read_b128 v[72:75], v2 offset:2048
    ds_read_b128 v[76:79], v2 offset:3072
    ds_read_b128 v[96:99], v2 offset:8192
    ds_read_b128 v[80:83], v2 offset:4096
    ds_read_b128 v[84:87], v2 offset:5120
    ds_read_b128 v[88:91], v2 offset:6144
    ds_read_b128 v[92:95], v2 offset:7168
    s_waitcnt lgkmcnt(7)
    v_mfma_f32_16x16x32_bf16 v[16:19], v[64:67], a[0:3], 0
    ds_read_b128 v[100:103], v2 offset:9216
    v_mfma_f32_16x16x32_bf16 v[20:23], v[68:71], a[0:3], 0
    ds_read_b128 v[104:107], v2 offset:10240
    buffer_load_dwordx4 a[32:35], v2, s[12:15], s32 offen offset:0
    s_waitcnt lgkmcnt(7)
    v_mfma_f32_16x16x32_bf16 v[24:27], v[72:75], a[0:3], 0
    ds_read_b128 v[108:111], v2 offset:11264
    v_mfma_f32_16x16x32_bf16 v[28:31], v[76:79], a[0:3], 0
    ds_read_b128 v[112:115], v2 offset:12288
    buffer_load_dwordx4 a[36:39], v2, s[12:15], s32 offen offset:1024
    s_waitcnt lgkmcnt(7)
    v_mfma_f32_16x16x32_bf16 v[32:35], v[96:99], a[0:3], 0
    ds_read_b128 v[132:135], v2 offset:17408
    v_mfma_f32_16x16x32_bf16 v[16:19], v[80:83], a[4:7], v[16:19]
    ds_read_b128 v[116:119], v2 offset:13312
    buffer_load_dwordx4 a[40:43], v2, s[12:15], s32 offen offset:2048
    s_waitcnt lgkmcnt(7)
    v_mfma_f32_16x16x32_bf16 v[20:23], v[84:87], a[4:7], v[20:23]
    ds_read_b128 v[120:123], v2 offset:14336
    v_mfma_f32_16x16x32_bf16 v[24:27], v[88:91], a[4:7], v[24:27]
    ds_read_b128 v[124:127], v2 offset:15360
    buffer_load_dwordx4 a[44:47], v2, s[12:15], s32 offen offset:3072
    s_add_u32 s32, s32, 4096
    s_waitcnt lgkmcnt(8)
    v_mfma_f32_16x16x32_bf16 v[28:31], v[92:95], a[4:7], v[28:31]
    ds_read_b128 v[128:131], v2 offset:16384
    v_mfma_f32_16x16x32_bf16 v[36:39], v[96:99], a[4:7], 0
    s_add_u32 m0, s55, 36864
    s_mov_b64 exec, s[64:65]
    buffer_load_dwordx4 v2, s[16:19], s33 offen lds
    s_mov_b64 exec, -1
    buffer_load_dwordx4 v2, s[16:19], s33 offen offset:512 lds
    s_waitcnt vmcnt(6)
    s_barrier
    s_waitcnt lgkmcnt(7)
    v_mfma_f32_16x16x32_bf16 v[16:19], v[100:103], a[8:11], v[16:19]
    ds_read_b128 v[64:67], v2 offset:18432
    v_mfma_f32_16x16x32_bf16 v[20:23], v[104:107], a[8:11], v[20:23]
    ds_read_b128 v[68:71], v2 offset:19456
    buffer_load_dwordx4 v2, s[16:19], s33 offen offset:1536 lds
    s_waitcnt lgkmcnt(7)
    v_mfma_f32_16x16x32_bf16 v[24:27], v[108:111], a[8:11], v[24:27]
    ds_read_b128 v[72:75], v2 offset:20480
    v_mfma_f32_16x16x32_bf16 v[28:31], v[112:115], a[8:11], v[28:31]
    ds_read_b128 v[76:79], v2 offset:21504
    buffer_load_dwordx4 v2, s[16:19], s33 offen offset:2560 lds
    s_waitcnt lgkmcnt(7)
    v_mfma_f32_16x16x32_bf16 v[32:35], v[132:135], a[8:11], v[32:35]
    ds_read_b128 v[96:99], v2 offset:26624
    v_mfma_f32_16x16x32_bf16 v[16:19], v[116:119], a[12:15], v[16:19]
    ds_read_b128 v[80:83], v2 offset:22528
    buffer_load_dwordx4 v2, s[16:19], s33 offen offset:3584 lds
    s_add_u32 s33, s33, 18432
    s_waitcnt lgkmcnt(7)
    v_mfma_f32_16x16x32_bf16 v[20:23], v[120:123], a[12:15], v[20:23]
    ds_read_b128 v[84:87], v2 offset:23552
    v_mfma_f32_16x16x32_bf16 v[24:27], v[124:127], a[12:15], v[24:27]
    ds_read_b128 v[88:91], v2 offset:24576
    buffer_load_dwordx4 a[48:51], v2, s[12:15], s32 offen offset:0
    s_waitcnt lgkmcnt(8)
    v_mfma_f32_16x16x32_bf16 v[28:31], v[128:131], a[12:15], v[28:31]
    ds_read_b128 v[92:95], v2 offset:25600
    v_mfma_f32_16x16x32_bf16 v[36:39], v[132:135], a[12:15], v[36:39]
    buffer_load_dwordx4 a[52:55], v2, s[12:15], s32 offen offset:1024
    buffer_load_dwordx4 a[56:59], v2, s[12:15], s32 offen offset:2048
    s_waitcnt lgkmcnt(7)
    v_mfma_f32_16x16x32_bf16 v[16:19], v[64:67], a[16:19], v[16:19]
    ds_read_b128 v[100:103], v2 offset:27648
    v_mfma_f32_16x16x32_bf16 v[20:23], v[68:71], a[16:19], v[20:23]
    ds_read_b128 v[104:107], v2 offset:28672
    buffer_load_dwordx4 a[60:63], v2, s[12:15], s32 offen offset:3072
    s_add_u32 s32, s32, 4096
    s_waitcnt lgkmcnt(7)
    v_mfma_f32_16x16x32_bf16 v[24:27], v[72:75], a[16:19], v[24:27]
    ds_read_b128 v[108:111], v2 offset:29696
    v_mfma_f32_16x16x32_bf16 v[28:31], v[76:79], a[16:19], v[28:31]
    ds_read_b128 v[112:115], v2 offset:30720
    s_add_u32 m0, s55, 55296
    s_mov_b64 exec, s[64:65]
    buffer_load_dwordx4 v2, s[16:19], s33 offen lds
    s_mov_b64 exec, -1
    s_waitcnt lgkmcnt(7)
    v_mfma_f32_16x16x32_bf16 v[32:35], v[96:99], a[16:19], v[32:35]
    ds_read_b128 v[132:135], v2 offset:35840
    v_mfma_f32_16x16x32_bf16 v[16:19], v[80:83], a[20:23], v[16:19]
    ds_read_b128 v[116:119], v2 offset:31744
    buffer_load_dwordx4 v2, s[16:19], s33 offen offset:512 lds
    s_waitcnt lgkmcnt(7)
    v_mfma_f32_16x16x32_bf16 v[20:23], v[84:87], a[20:23], v[20:23]
    ds_read_b128 v[120:123], v2 offset:32768
    v_mfma_f32_16x16x32_bf16 v[24:27], v[88:91], a[20:23], v[24:27]
    ds_read_b128 v[124:127], v2 offset:33792
    buffer_load_dwordx4 v2, s[16:19], s33 offen offset:1536 lds
    s_waitcnt lgkmcnt(8)
    v_mfma_f32_16x16x32_bf16 v[28:31], v[92:95], a[20:23], v[28:31]
    ds_read_b128 v[128:131], v2 offset:34816
    v_mfma_f32_16x16x32_bf16 v[36:39], v[96:99], a[20:23], v[36:39]
    buffer_load_dwordx4 v2, s[16:19], s33 offen offset:2560 lds
    buffer_load_dwordx4 v2, s[16:19], s33 offen offset:3584 lds
    s_add_u32 s33, s33, 18432
    s_waitcnt vmcnt(9)
    s_barrier
    s_waitcnt lgkmcnt(7)
    v_mfma_f32_16x16x32_bf16 v[16:19], v[100:103], a[24:27], v[16:19]
    ds_read_b128 v[64:67], v2 offset:36864
    v_mfma_f32_16x16x32_bf16 v[20:23], v[104:107], a[24:27], v[20:23]
    ds_read_b128 v[68:71], v2 offset:37888
    buffer_load_dwordx4 a[64:67], v2, s[12:15], s32 offen offset:0
    s_waitcnt lgkmcnt(7)
    v_mfma_f32_16x16x32_bf16 v[24:27], v[108:111], a[24:27], v[24:27]
    ds_read_b128 v[72:75], v2 offset:38912
    v_mfma_f32_16x16x32_bf16 v[28:31], v[112:115], a[24:27], v[28:31]
    ds_read_b128 v[76:79], v2 offset:39936
    buffer_load_dwordx4 a[68:71], v2, s[12:15], s32 offen offset:1024
    s_waitcnt lgkmcnt(7)
    v_mfma_f32_16x16x32_bf16 v[32:35], v[132:135], a[24:27], v[32:35]
    ds_read_b128 v[96:99], v2 offset:45056
    v_mfma_f32_16x16x32_bf16 v[16:19], v[116:119], a[28:31], v[16:19]
    ds_read_b128 v[80:83], v2 offset:40960
    s_add_u32 m0, s55, 73728
    s_mov_b64 exec, s[64:65]
    buffer_load_dwordx4 v2, s[16:19], s33 offen lds
    s_mov_b64 exec, -1
    s_waitcnt lgkmcnt(7)
    v_mfma_f32_16x16x32_bf16 v[20:23], v[120:123], a[28:31], v[20:23]
    ds_read_b128 v[84:87], v2 offset:41984
    v_mfma_f32_16x16x32_bf16 v[24:27], v[124:127], a[28:31], v[24:27]
    ds_read_b128 v[88:91], v2 offset:43008
    buffer_load_dwordx4 v2, s[16:19], s33 offen offset:512 lds
    s_waitcnt lgkmcnt(8)
    v_mfma_f32_16x16x32_bf16 v[28:31], v[128:131], a[28:31], v[28:31]
    ds_read_b128 v[92:95], v2 offset:44032
    v_mfma_f32_16x16x32_bf16 v[36:39], v[132:135], a[28:31], v[36:39]
    buffer_load_dwordx4 v2, s[16:19], s33 offen offset:1536 lds
    buffer_load_dwordx4 v2, s[16:19], s33 offen offset:2560 lds
    s_waitcnt lgkmcnt(7)
    v_mfma_f32_16x16x32_bf16 v[16:19], v[64:67], a[32:35], v[16:19]
    ds_read_b128 v[100:103], v2 offset:46080
    v_mfma_f32_16x16x32_bf16 v[20:23], v[68:71], a[32:35], v[20:23]
    ds_read_b128 v[104:107], v2 offset:47104
    buffer_load_dwordx4 v2, s[16:19], s33 offen offset:3584 lds
    s_add_u32 s33, s33, 18432
    s_waitcnt lgkmcnt(7)
    v_mfma_f32_16x16x32_bf16 v[24:27], v[72:75], a[32:35], v[24:27]
    ds_read_b128 v[108:111], v2 offset:48128
    v_mfma_f32_16x16x32_bf16 v[28:31], v[76:79], a[32:35], v[28:31]
    ds_read_b128 v[112:115], v2 offset:49152
    s_add_u32 m0, s40, 0
    s_nop 0
    buffer_load_dwordx4 v180, s[8:11], s42 offen lds
    s_waitcnt lgkmcnt(7)
    v_mfma_f32_16x16x32_bf16 v[32:35], v[96:99], a[32:35], v[32:35]
    ds_read_b128 v[132:135], v2 offset:54272
    v_mfma_f32_16x16x32_bf16 v[16:19], v[80:83], a[36:39], v[16:19]
    ds_read_b128 v[116:119], v2 offset:50176
    s_add_u32 m0, s40, 1024
    s_nop 0
    buffer_load_dwordx4 v181, s[8:11], s42 offen lds
    s_waitcnt lgkmcnt(7)
    v_mfma_f32_16x16x32_bf16 v[20:23], v[84:87], a[36:39], v[20:23]
    ds_read_b128 v[120:123], v2 offset:51200
    v_mfma_f32_16x16x32_bf16 v[24:27], v[88:91], a[36:39], v[24:27]
    ds_read_b128 v[124:127], v2 offset:52224
    s_add_u32 m0, s40, 2048
    s_mov_b64 exec, 0xffff
    buffer_load_dwordx4 v182, s[8:11], s42 offen lds
    s_mov_b64 exec, -1
    s_waitcnt lgkmcnt(8)
    v_mfma_f32_16x16x32_bf16 v[28:31], v[92:95], a[36:39], v[28:31]
    ds_read_b128 v[128:131], v2 offset:53248
    v_mfma_f32_16x16x32_bf16 v[36:39], v[96:99], a[36:39], v[36:39]
    s_mov_b32 m0, s41
    s_nop 0
    buffer_load_dwordx4 v183, s[12:15], s38 offen lds
    buffer_load_dwordx4 v[216:219], v184, s[12:15], s39 offen
    s_add_u32 s39, s39, 147456
    s_waitcnt vmcnt(12)
    s_barrier
    s_waitcnt lgkmcnt(7)
    v_mfma_f32_16x16x32_bf16 v[16:19], v[100:103], a[40:43], v[16:19]
    ds_read_b128 v[64:67], v11 offset:0
    v_mfma_f32_16x16x32_bf16 v[20:23], v[104:107], a[40:43], v[20:23]
    ds_read_b128 v[68:71], v11 offset:1024
    buffer_load_dwordx4 v[220:223], v184, s[12:15], s39 offen
    s_add_u32 s39, s39, 147456
    s_waitcnt lgkmcnt(7)
    v_mfma_f32_16x16x32_bf16 v[24:27], v[108:111], a[40:43], v[24:27]
    ds_read_b128 v[72:75], v11 offset:2048
    v_mfma_f32_16x16x32_bf16 v[28:31], v[112:115], a[40:43], v[28:31]
    ds_read_b128 v[76:79], v11 offset:3072
    buffer_load_dwordx4 v[224:227], v184, s[12:15], s39 offen
    s_add_u32 s39, s39, 147456
    s_waitcnt lgkmcnt(7)
    v_mfma_f32_16x16x32_bf16 v[32:35], v[132:135], a[40:43], v[32:35]
    ds_read_b128 v[96:99], v11 offset:8192
    v_mfma_f32_16x16x32_bf16 v[16:19], v[116:119], a[44:47], v[16:19]
    ds_read_b128 v[80:83], v11 offset:4096
    buffer_load_dwordx4 v[228:231], v184, s[12:15], s39 offen
    s_add_u32 s39, s39, 147456
    s_waitcnt lgkmcnt(7)
    v_mfma_f32_16x16x32_bf16 v[20:23], v[120:123], a[44:47], v[20:23]
    ds_read_b128 v[84:87], v11 offset:5120
    v_mfma_f32_16x16x32_bf16 v[24:27], v[124:127], a[44:47], v[24:27]
    ds_read_b128 v[88:91], v11 offset:6144
    s_mov_b32 exec_hi, 0
    buffer_load_dwordx4 v[232:235], v184, s[12:15], s39 offen
    s_mov_b32 exec_hi, -1
    s_waitcnt lgkmcnt(8)
    v_mfma_f32_16x16x32_bf16 v[28:31], v[128:131], a[44:47], v[28:31]
    ds_read_b128 v[92:95], v11 offset:7168
    v_mfma_f32_16x16x32_bf16 v[36:39], v[132:135], a[44:47], v[36:39]
    s_waitcnt lgkmcnt(7)
    v_mfma_f32_16x16x32_bf16 v[16:19], v[64:67], a[48:51], v[16:19]
    ds_read_b128 v[100:103], v11 offset:9216
    v_mfma_f32_16x16x32_bf16 v[20:23], v[68:71], a[48:51], v[20:23]
    ds_read_b128 v[104:107], v11 offset:10240
    s_waitcnt lgkmcnt(7)
    v_mfma_f32_16x16x32_bf16 v[24:27], v[72:75], a[48:51], v[24:27]
    ds_read_b128 v[108:111], v11 offset:11264
    v_mfma_f32_16x16x32_bf16 v[28:31], v[76:79], a[48:51], v[28:31]
    ds_read_b128 v[112:115], v11 offset:12288
    s_waitcnt lgkmcnt(7)
    v_mfma_f32_16x16x32_bf16 v[32:35], v[96:99], a[48:51], v[32:35]
    ds_read_b128 v[132:135], v11 offset:17408
    v_mfma_f32_16x16x32_bf16 v[16:19], v[80:83], a[52:55], v[16:19]
    ds_read_b128 v[116:119], v11 offset:13312
    s_waitcnt lgkmcnt(7)
    v_mfma_f32_16x16x32_bf16 v[20:23], v[84:87], a[52:55], v[20:23]
    ds_read_b128 v[120:123], v11 offset:14336
    v_mfma_f32_16x16x32_bf16 v[24:27], v[88:91], a[52:55], v[24:27]
    ds_read_b128 v[124:127], v11 offset:15360
    s_waitcnt lgkmcnt(8)
    v_mfma_f32_16x16x32_bf16 v[28:31], v[92:95], a[52:55], v[28:31]
    ds_read_b128 v[128:131], v11 offset:16384
    v_mfma_f32_16x16x32_bf16 v[36:39], v[96:99], a[52:55], v[36:39]
    s_waitcnt vmcnt(9)
    s_barrier
    s_waitcnt lgkmcnt(7)
    v_mfma_f32_16x16x32_bf16 v[16:19], v[100:103], a[56:59], v[16:19]
    ds_read_b128 v[64:67], v11 offset:18432
    v_mfma_f32_16x16x32_bf16 v[20:23], v[104:107], a[56:59], v[20:23]
    ds_read_b128 v[68:71], v11 offset:19456
    s_waitcnt lgkmcnt(7)
    v_mfma_f32_16x16x32_bf16 v[24:27], v[108:111], a[56:59], v[24:27]
    ds_read_b128 v[72:75], v11 offset:20480
    v_mfma_f32_16x16x32_bf16 v[28:31], v[112:115], a[56:59], v[28:31]
    ds_read_b128 v[76:79], v11 offset:21504
    s_waitcnt lgkmcnt(7)
    v_mfma_f32_16x16x32_bf16 v[32:35], v[132:135], a[56:59], v[32:35]
    ds_read_b128 v[96:99], v11 offset:26624
    v_mfma_f32_16x16x32_bf16 v[16:19], v[116:119], a[60:63], v[16:19]
    ds_read_b128 v[80:83], v11 offset:22528
    s_waitcnt lgkmcnt(7)
    v_mfma_f32_16x16x32_bf16 v[20:23], v[120:123], a[60:63], v[20:23]
    ds_read_b128 v[84:87], v11 offset:23552
    v_mfma_f32_16x16x32_bf16 v[24:27], v[124:127], a[60:63], v[24:27]
    ds_read_b128 v[88:91], v11 offset:24576
    s_waitcnt lgkmcnt(8)
    v_mfma_f32_16x16x32_bf16 v[28:31], v[128:131], a[60:63], v[28:31]
    ds_read_b128 v[92:95], v11 offset:25600
    v_mfma_f32_16x16x32_bf16 v[36:39], v[132:135], a[60:63], v[36:39]
    v_mul_u32_u24 v5, 144, v3
    v_add_u32 v5, s40, v5
    v_lshl_add_u32 v6, v4, 3, v5
    v_lshl_add_u32 v5, v4, 4, v5
    v_lshl_add_u32 v8, v4, 5, s41
    v_lshl_add_u32 v9, v4, 4, s41
    s_waitcnt vmcnt(5)
    s_waitcnt lgkmcnt(7)
    v_mfma_f32_16x16x32_bf16 v[16:19], v[64:67], a[64:67], v[16:19]
    ds_read_b128 v[180:183], v5
    v_mfma_f32_16x16x32_bf16 v[20:23], v[68:71], a[64:67], v[20:23]
    ds_read_b128 v[184:187], v5 offset:64
    s_waitcnt lgkmcnt(7)
    v_mfma_f32_16x16x32_bf16 v[24:27], v[72:75], a[64:67], v[24:27]
    ds_read_b64 v[188:189], v6 offset:128
    v_mfma_f32_16x16x32_bf16 v[28:31], v[76:79], a[64:67], v[28:31]
    ds_read_b128 v[140:143], v8 offset:0
    s_waitcnt lgkmcnt(7)
    v_mfma_f32_16x16x32_bf16 v[32:35], v[96:99], a[64:67], v[32:35]
    ds_read_b128 v[144:147], v8 offset:16
    v_mfma_f32_16x16x32_bf16 v[16:19], v[80:83], a[68:71], v[16:19]
    ds_read_b128 v[148:151], v8 offset:128
    s_waitcnt lgkmcnt(7)
    v_mfma_f32_16x16x32_bf16 v[20:23], v[84:87], a[68:71], v[20:23]
    ds_read_b128 v[152:155], v8 offset:144
    v_mfma_f32_16x16x32_bf16 v[24:27], v[88:91], a[68:71], v[24:27]
    ds_read_b128 v[156:159], v9 offset:256
    s_waitcnt lgkmcnt(8)
    v_mfma_f32_16x16x32_bf16 v[28:31], v[92:95], a[68:71], v[28:31]
    ds_read_b128 v[160:163], v8 offset:512
    v_mfma_f32_16x16x32_bf16 v[36:39], v[96:99], a[68:71], v[36:39]
    ds_read_b128 v[164:167], v8 offset:528
    ds_read_b128 v[168:171], v8 offset:640
    ds_read_b128 v[172:175], v8 offset:656
    ds_read_b128 v[176:179], v9 offset:768
    s_barrier
    s_cmp_eq_u32 s61, 0
    s_cbranch_scc1 LB_wo1
    s_mov_b32 s16, s56
    s_and_b32 s17, s57, 0xffff
    s_mov_b32 s18, 0x288000
    s_mov_b32 s19, 0x00020000
    s_add_u32 m0, s61, 0
    s_nop 0
    buffer_load_dwordx4 v238, s[16:19], s60 offen nt lds
    s_add_u32 m0, s61, 1024
    s_nop 0
    buffer_load_dwordx4 v239, s[16:19], s60 offen nt lds
    s_add_u32 m0, s61, 2048
    s_nop 0
    buffer_load_dwordx4 v240, s[16:19], s60 offen nt lds
    s_add_u32 m0, s61, 3072
    s_nop 0
    buffer_load_dwordx4 v241, s[16:19], s60 offen nt lds
    s_add_u32 m0, s61, 4096
    s_nop 0
    buffer_load_dwordx4 v242, s[16:19], s60 offen nt lds
    s_add_u32 m0, s61, 5120
    s_nop 0
    buffer_load_dwordx4 v243, s[16:19], s60 offen nt lds
    s_add_u32 m0, s61, 6144
    s_nop 0
    buffer_load_dwordx4 v244, s[16:19], s60 offen nt lds
    s_add_u32 m0, s61, 7168
    s_nop 0
    buffer_load_dwordx4 v245, s[16:19], s60 offen nt lds
    s_add_u32 m0, s61, 8192
    s_nop 0
    buffer_load_dwordx4 v246, s[16:19], s60 offen nt lds
LB_wo1:
    s_nop 5
    v_mov_b32 v12, v36
    v_mov_b32 v13, v37
    v_mov_b32 v14, v38
    v_mov_b32 v15, v39
    s_nop 0
    v_permlane32_swap_b32 v36, v12
    v_permlane32_swap_b32 v37, v13
    v_permlane32_swap_b32 v38, v14
    v_permlane32_swap_b32 v39, v15
    s_nop 0
    v_pk_add_f32 v[32:33], v[32:33], v[12:13]
    v_pk_add_f32 v[34:35], v[34:35], v[14:15]
    s_mov_b32 s35, 0xffff0000
    s_mov_b32 s36, 0x3f803f80
    s_lshr_b32 s33, s31, 1
    s_mul_i32 s33, s33, 36864
    s_and_b32 s34, s31, 1
    s_lshl_b32 s34, s34, 7
    s_add_u32 s37, s33, s34
    s_lshl_b32 s33, s29, 11
    s_add_u32 s33, s33, s37
    s_add_u32 s38, s33, 0x2c00000
    s_add_u32 s33, s33, 0x800000
    s_lshr_b32 s34, s29, 2
    s_lshl_b32 s34, s34, 10
    s_add_u32 s34, s34, s37
    s_and_b32 s37, s29, 3
    s_lshl_b32 s37, s37, 8
    s_add_u32 s34, s34, s37
    s_add_u32 s39, s34, 0x2c04000
    s_add_u32 s34, s34, 0x804000
    v_bfe_u32 v5, v1, 2, 1
    v_mul_u32_u24 v5, 18432, v5
    v_bfe_u32 v6, v1, 3, 1
    v_lshl_add_u32 v5, v6, 6, v5
    v_and_b32 v6, 3, v1
    v_lshl_add_u32 v5, v6, 4, v5
    v_lshl_add_u32 v6, v4, 3, v5
    v_lshl_add_u32 v5, v4, 8, v5
    v_cmp_gt_u32 vcc, 2, v4
    s_waitcnt lgkmcnt(0)
    v_lshlrev_b32 v8, 16, v180
    v_and_b32 v9, s35, v180
    v_pk_fma_f32 v[8:9], v[16:17], v[140:141], v[8:9]
    v_cvt_pk_bf16_f32 v192, v8, v9
    v_lshlrev_b32 v10, 16, v181
    v_and_b32 v11, s35, v181
    v_pk_fma_f32 v[10:11], v[18:19], v[142:143], v[10:11]
    v_cvt_pk_bf16_f32 v193, v10, v11
    v_lshlrev_b32 v8, 16, v182
    v_and_b32 v9, s35, v182
    v_pk_fma_f32 v[8:9], v[20:21], v[144:145], v[8:9]
    v_cvt_pk_bf16_f32 v194, v8, v9
    v_lshlrev_b32 v10, 16, v183
    v_and_b32 v11, s35, v183
    v_pk_fma_f32 v[10:11], v[22:23], v[146:147], v[10:11]
    v_cvt_pk_bf16_f32 v195, v10, v11
    v_lshlrev_b32 v8, 16, v184
    v_and_b32 v9, s35, v184
    v_pk_fma_f32 v[8:9], v[24:25], v[148:149], v[8:9]
    v_cvt_pk_bf16_f32 v196, v8, v9
    v_lshlrev_b32 v10, 16, v185
    v_and_b32 v11, s35, v185
    v_pk_fma_f32 v[10:11], v[26:27], v[150:151], v[10:11]
    v_cvt_pk_bf16_f32 v197, v10, v11
    v_lshlrev_b32 v8, 16, v186
    v_and_b32 v9, s35, v186
    v_pk_fma_f32 v[8:9], v[28:29], v[152:153], v[8:9]
    v_cvt_pk_bf16_f32 v198, v8, v9
    v_lshlrev_b32 v10, 16, v187
    v_and_b32 v11, s35, v187
    v_pk_fma_f32 v[10:11], v[30:31], v[154:155], v[10:11]
    v_cvt_pk_bf16_f32 v199, v10, v11
    v_lshlrev_b32 v8, 16, v188
    v_and_b32 v9, s35, v188
    v_pk_fma_f32 v[8:9], v[32:33], v[156:157], v[8:9]
    v_cvt_pk_bf16_f32 v200, v8, v9
    v_lshlrev_b32 v10, 16, v189
    v_and_b32 v11, s35, v189
    v_pk_fma_f32 v[10:11], v[34:35], v[158:159], v[10:11]
    v_cvt_pk_bf16_f32 v201, v10, v11
    v_lshlrev_b32 v8, 16, v192
    v_and_b32 v9, s35, v192
    v_pk_mul_f32 v[8:9], v[8:9], v[160:161]
    v_cvt_pk_bf16_f32 v204, v8, v9
    v_lshlrev_b32 v10, 16, v193
    v_and_b32 v11, s35, v193
    v_pk_mul_f32 v[10:11], v[10:11], v[162:163]
    v_cvt_pk_bf16_f32 v205, v10, v11
    v_lshlrev_b32 v8, 16, v194
    v_and_b32 v9, s35, v194
    v_pk_mul_f32 v[8:9], v[8:9], v[164:165]
    v_cvt_pk_bf16_f32 v206, v8, v9
    v_lshlrev_b32 v10, 16, v195
    v_and_b32 v11, s35, v195
    v_pk_mul_f32 v[10:11], v[10:11], v[166:167]
    v_cvt_pk_bf16_f32 v207, v10, v11
    buffer_store_dwordx4 v[204:207], v5, s[12:15], s38 offen sc1
    v_lshlrev_b32 v8, 16, v196
    v_and_b32 v9, s35, v196
    v_pk_mul_f32 v[8:9], v[8:9], v[168:169]
    v_cvt_pk_bf16_f32 v208, v8, v9
    v_lshlrev_b32 v10, 16, v197
    v_and_b32 v11, s35, v197
    v_pk_mul_f32 v[10:11], v[10:11], v[170:171]
    v_cvt_pk_bf16_f32 v209, v10, v11
    v_lshlrev_b32 v8, 16, v198
    v_and_b32 v9, s35, v198
    v_pk_mul_f32 v[8:9], v[8:9], v[172:173]
    v_cvt_pk_bf16_f32 v210, v8, v9
    v_lshlrev_b32 v10, 16, v199
    v_and_b32 v11, s35, v199
    v_pk_mul_f32 v[10:11], v[10:11], v[174:175]
    v_cvt_pk_bf16_f32 v211, v10, v11
    buffer_store_dwordx4 v[208:211], v5, s[12:15], s38 offen offset:1024 sc1
    v_lshlrev_b32 v8, 16, v200
    v_and_b32 v9, s35, v200
    v_pk_mul_f32 v[8:9], v[8:9], v[176:177]
    v_cvt_pk_bf16_f32 v212, v8, v9
    v_lshlrev_b32 v10, 16, v201
    v_and_b32 v11, s35, v201
    v_pk_mul_f32 v[10:11], v[10:11], v[178:179]
    v_cvt_pk_bf16_f32 v213, v10, v11
    s_mov_b32 exec_hi, 0
    buffer_store_dwordx2 v[212:213], v6, s[12:15], s39 offen sc1
    s_mov_b32 exec_hi, -1
    v_cndmask_b32 v12, 0, v200, vcc
    v_cndmask_b32 v13, 0, v201, vcc
    v_dot2_f32_bf16 v10, v12, s36, 0
    v_dot2_f32_bf16 v11, v12, v12, 0
    v_dot2_f32_bf16 v14, v13, s36, 0
    v_dot2_f32_bf16 v15, v13, v13, 0
    v_dot2_f32_bf16 v10, v192, s36, v10
    v_dot2_f32_bf16 v11, v192, v192, v11
    v_dot2_f32_bf16 v14, v193, s36, v14
    v_dot2_f32_bf16 v15, v193, v193, v15
    v_dot2_f32_bf16 v10, v194, s36, v10
    v_dot2_f32_bf16 v11, v194, v194, v11
    v_dot2_f32_bf16 v14, v195, s36, v14
    v_dot2_f32_bf16 v15, v195, v195, v15
    v_dot2_f32_bf16 v10, v196, s36, v10
    v_dot2_f32_bf16 v11, v196, v196, v11
    v_dot2_f32_bf16 v14, v197, s36, v14
    v_dot2_f32_bf16 v15, v197, v197, v15
    v_dot2_f32_bf16 v10, v198, s36, v10
    v_dot2_f32_bf16 v11, v198, v198, v11
    v_dot2_f32_bf16 v14, v199, s36, v14
    v_dot2_f32_bf16 v15, v199, v199, v15
    s_lshl_b32 s37, s63, 9
    s_lshl_b32 s26, s30, 7
    s_add_u32 s37, s37, s26
    s_add_u32 s37, s37, 0x150000
    v_lshlrev_b32 v16, 3, v1
    v_pk_add_f32 v[10:11], v[10:11], v[14:15]
    v_mov_b32 v12, v10
    v_mov_b32 v13, v11
    s_nop 1
    v_permlane16_swap_b32 v10, v12
    v_permlane16_swap_b32 v11, v13
    s_nop 1
    v_add_f32 v10, v10, v12
    v_add_f32 v11, v11, v13
    v_mov_b32 v12, v10
    v_mov_b32 v13, v11
    s_nop 1
    v_permlane32_swap_b32 v10, v12
    v_permlane32_swap_b32 v11, v13
    s_nop 1
    v_add_f32 v10, v10, v12
    v_add_f32 v11, v11, v13
    s_mov_b64 exec, 0xffff
    buffer_store_dwordx2 v[10:11], v16, s[12:15], s37 offen sc1
    s_mov_b64 exec, -1
    s_cmp_lg_u32 s30, 0
    s_cbranch_scc1 LB_nocs
    s_waitcnt vmcnt(4)
    v_cndmask_b32 v232, 0, v232, vcc
    v_cndmask_b32 v233, 0, v233, vcc
    v_cndmask_b32 v234, 0, v234, vcc
    v_cndmask_b32 v235, 0, v235, vcc
    v_pk_add_f32 v[216:217], v[216:217], v[220:221]
    v_pk_add_f32 v[224:225], v[224:225], v[228:229]
    v_pk_add_f32 v[218:219], v[218:219], v[222:223]
    v_pk_add_f32 v[226:227], v[226:227], v[230:231]
    v_pk_add_f32 v[216:217], v[216:217], v[224:225]
    v_pk_add_f32 v[216:217], v[216:217], v[232:233]
    v_pk_add_f32 v[218:219], v[218:219], v[226:227]
    v_pk_add_f32 v[218:219], v[218:219], v[234:235]
    v_mov_b32 v220, v216
    v_mov_b32 v221, v217
    v_mov_b32 v222, v218
    v_mov_b32 v223, v219
    s_nop 1
    v_permlane16_swap_b32 v216, v220
    v_permlane16_swap_b32 v217, v221
    v_permlane16_swap_b32 v218, v222
    v_permlane16_swap_b32 v219, v223
    s_nop 1
    v_add_f32 v216, v216, v220
    v_add_f32 v217, v217, v221
    v_add_f32 v218, v218, v222
    v_add_f32 v219, v219, v223
    v_mov_b32 v220, v216
    v_mov_b32 v221, v217
    v_mov_b32 v222, v218
    v_mov_b32 v223, v219
    s_nop 1
    v_permlane32_swap_b32 v216, v220
    v_permlane32_swap_b32 v217, v221
    v_permlane32_swap_b32 v218, v222
    v_permlane32_swap_b32 v219, v223
    s_nop 1
    v_add_f32 v216, v216, v220
    v_add_f32 v217, v217, v221
    v_add_f32 v218, v218, v222
    v_add_f32 v219, v219, v223
    s_mul_i32 s37, s63, 144
    s_add_u32 s37, s37, 0x112000
    s_mov_b64 exec, 0x1ff
    buffer_store_dwordx4 v[216:219], v2, s[12:15], s37 offen sc1
    s_mov_b64 exec, -1
LB_nocs:
    buffer_store_dwordx4 v[192:195], v5, s[12:15], s33 offen
    buffer_store_dwordx4 v[196:199], v5, s[12:15], s33 offen offset:1024
    s_mov_b32 exec_hi, 0
    buffer_store_dwordx2 v[200:201], v6, s[12:15], s34 offen
    s_mov_b32 exec_hi, -1
    s_add_u32 m0, s55, 65536
    s_add_u32 s62, s54, 0
    s_mov_b64 exec, s[64:65]
    buffer_load_dwordx4 v2, s[12:15], s62 offen lds
    s_mov_b64 exec, -1
    buffer_load_dwordx4 v2, s[12:15], s62 offen offset:512 lds
    buffer_load_dwordx4 v2, s[12:15], s62 offen offset:1536 lds
    buffer_load_dwordx4 v2, s[12:15], s62 offen offset:2560 lds
    buffer_load_dwordx4 v2, s[12:15], s62 offen offset:3584 lds
    s_add_u32 m0, s55, 83968
    s_add_u32 s62, s54, 18432
    s_mov_b64 exec, s[64:65]
    buffer_load_dwordx4 v2, s[12:15], s62 offen lds
    s_mov_b64 exec, -1
    buffer_load_dwordx4 v2, s[12:15], s62 offen offset:512 lds
    buffer_load_dwordx4 v2, s[12:15], s62 offen offset:1536 lds
    buffer_load_dwordx4 v2, s[12:15], s62 offen offset:2560 lds
    buffer_load_dwordx4 v2, s[12:15], s62 offen offset:3584 lds
    s_lshl_b32 s37, s63, 7
    s_add_u32 s37, s37, 0x1c8000
    v_mov_b32 v3, 0
    s_waitcnt vmcnt(13)
    s_barrier
    s_cmp_lg_u32 s30, 0
    s_cbranch_scc1 LB_x_s
    s_mov_b64 exec, 1
    buffer_store_dword v3, v3, s[12:15], s37 offen sc1
    s_mov_b64 exec, -1
LB_x_s:
    s_mov_b32 s28, s46
    s_mov_b32 s29, s47
    v_mov_b32 v6, v2
    v_add_u32 v7, 18432, v2
    v_lshrrev_b32 v22, 4, v1
    v_and_b32 v21, 15, v1
    v_lshlrev_b32 v21, 4, v21
    v_lshl_add_u32 v21, v22, 9, v21
    s_mul_i32 s39, s29, 589824
    s_add_u32 s39, s39, s55
    s_add_u32 s39, s39, 0x1800000
    s_lshl_b32 s44, s28, 2
    s_add_u32 s44, s44, s30
    s_mul_i32 s40, s44, 36864
    s_add_u32 s40, s40, 0x2c00000
    s_lshr_b32 s45, s44, 1
    s_lshl_b32 s45, s45, 12
    s_and_b32 s43, s44, 1
    s_lshl_b32 s43, s43, 8
    s_add_u32 s45, s45, s43
    s_add_u32 s41, s45, 0x150000
    s_lshl_b32 s38, s44, 17
    s_lshl_b32 s33, s30, 12
    s_add_u32 s42, s28, s29
    v_cmp_lt_u32 vcc, 71, v0
    v_lshlrev_b32 v22, 4, v0
    v_mov_b32 v23, 17280
    v_cndmask_b32 v23, 0, v23, vcc
    v_add_u32 v23, v23, v22
    s_mul_i32 s46, s29, 1152
    s_add_u32 s46, s46, 0x112000
    s_lshl_b32 s48, s28, 11
    v_lshlrev_b32 v24, 7, v1
    v_add_u32 v24, s48, v24
    s_mov_b32 s48, 0x1c8000
    v_and_b32 v26, 7, v1
    v_lshlrev_b32 v26, 7, v26
    v_bfe_u32 v25, v1, 3, 1
    v_lshl_add_u32 v26, v25, 14, v26
    s_lshl_b32 s49, s29, 10
    v_add_u32 v26, s49, v26
    v_cmp_gt_u32 vcc, 16, v1
    v_mov_b32 v28, v23
    s_nop 0
    v_cndmask_b32 v24, v26, v24, vcc
    v_lshrrev_b32 v22, 4, v1
    s_lshl_b32 s45, s30, 9
    s_add_u32 s45, s45, 143360
    v_add_u32 v16, 65536, v6
    v_add_u32 v17, 83968, v6
    v_add_u32 v18, 102400, v6
    v_add_u32 v19, 120832, v6
    v_add_u32 v13, 0, v6
    v_add_u32 v14, 18432, v6
    v_add_u32 v15, 36864, v6
    s_add_u32 m0, s55, 102400
    s_add_u32 s62, s54, 36864
    s_mov_b64 exec, s[64:65]
    buffer_load_dwordx4 v2, s[12:15], s62 offen lds
    s_mov_b64 exec, -1
    buffer_load_dwordx4 v2, s[12:15], s62 offen offset:512 lds
    buffer_load_dwordx4 v2, s[12:15], s62 offen offset:1536 lds
    buffer_load_dwordx4 v2, s[12:15], s62 offen offset:2560 lds
    buffer_load_dwordx4 v2, s[12:15], s62 offen offset:3584 lds
    s_add_u32 m0, s55, 120832
    s_add_u32 s62, s54, 55296
    s_mov_b64 exec, s[64:65]
    buffer_load_dwordx4 v2, s[12:15], s62 offen lds
    s_mov_b64 exec, -1
    buffer_load_dwordx4 v2, s[12:15], s62 offen offset:512 lds
    buffer_load_dwordx4 v2, s[12:15], s62 offen offset:1536 lds
    buffer_load_dwordx4 v2, s[12:15], s62 offen offset:2560 lds
    buffer_load_dwordx4 v2, s[12:15], s62 offen offset:3584 lds
    s_add_u32 m0, s55, 0
    s_add_u32 s62, s54, 73728
    s_mov_b64 exec, s[64:65]
    buffer_load_dwordx4 v2, s[12:15], s62 offen lds
    s_mov_b64 exec, -1
    buffer_load_dwordx4 v2, s[12:15], s62 offen offset:512 lds
    buffer_load_dwordx4 v2, s[12:15], s62 offen offset:1536 lds
    buffer_load_dwordx4 v2, s[12:15], s62 offen offset:2560 lds
    buffer_load_dwordx4 v2, s[12:15], s62 offen offset:3584 lds
    s_add_u32 m0, s55, 18432
    s_add_u32 s62, s54, 92160
    s_mov_b64 exec, s[64:65]
    buffer_load_dwordx4 v2, s[12:15], s62 offen lds
    s_mov_b64 exec, -1
    buffer_load_dwordx4 v2, s[12:15], s62 offen offset:512 lds
    buffer_load_dwordx4 v2, s[12:15], s62 offen offset:1536 lds
    buffer_load_dwordx4 v2, s[12:15], s62 offen offset:2560 lds
    buffer_load_dwordx4 v2, s[12:15], s62 offen offset:3584 lds
    s_add_u32 s54, s54, 110592
    v_mov_b32 v208, 0
    s_mov_b32 s37, s61
    s_cmp_eq_u32 s37, 0
    s_cbranch_scc1 LB_wo3
    s_mov_b32 s35, 331776
    s_mov_b32 s36, 1327104
    v_bfe_u32 v209, v1, 2, 2
    v_mul_u32_u24 v209, 1152, v209
    v_lshrrev_b32 v210, 4, v1
    v_mul_u32_u24 v211, 144, v210
    v_add3_u32 v209, v209, v211, s37
    v_and_b32 v211, 3, v1
    v_lshl_add_u32 v207, v211, 3, v209
    v_lshl_add_u32 v205, v211, 4, v209
    v_add_u32 v206, 8, v205
    v_mul_lo_u32 v210, v210, s35
    v_and_b32 v211, 15, v1
    v_lshl_add_u32 v208, v211, 4, v210
    ds_read_b64_tr_b16 v[176:177], v205 offset:0
    ds_read_b64_tr_b16 v[178:179], v205 offset:4608
    ds_read_b64_tr_b16 v[180:181], v206 offset:0
    ds_read_b64_tr_b16 v[182:183], v206 offset:4608
    ds_read_b64_tr_b16 v[184:185], v205 offset:64
    ds_read_b64_tr_b16 v[186:187], v205 offset:4672
    ds_read_b64_tr_b16 v[188:189], v206 offset:64
    ds_read_b64_tr_b16 v[190:191], v206 offset:4672
    ds_read_b64_tr_b16 v[192:193], v207 offset:128
    ds_read_b64_tr_b16 v[194:195], v207 offset:4736
    ds_read_b64_tr_b16 v[224:225], v205 offset:576
    ds_read_b64_tr_b16 v[226:227], v205 offset:5184
    ds_read_b64_tr_b16 v[228:229], v206 offset:576
    ds_read_b64_tr_b16 v[230:231], v206 offset:5184
    ds_read_b64_tr_b16 v[232:233], v205 offset:640
    ds_read_b64_tr_b16 v[234:235], v205 offset:5248
    ds_read_b64_tr_b16 v[236:237], v206 offset:640
    ds_read_b64_tr_b16 v[238:239], v206 offset:5248
    ds_read_b64_tr_b16 v[240:241], v207 offset:704
    ds_read_b64_tr_b16 v[242:243], v207 offset:5312
    s_waitcnt lgkmcnt(0)
LB_wo3:
    s_cmp_lg_u32 s30, 1
    s_cbranch_scc1 LB_x_2
    s_mov_b32 s43, 0x4000
    s_mov_b32 exec_lo, 0xffffffff
    s_mov_b32 exec_hi, 0
    s_branch LB_x_1
LB_x_0:
    s_sleep 4
LB_x_1:
    buffer_load_dword v25, v24, s[12:15], s48 offen sc1
    s_waitcnt vmcnt(0)
    v_cmp_eq_u32 vcc, -1, v25
    s_sub_u32 s43, s43, 1
    s_cmp_eq_u32 s43, 0
    s_cbranch_vccz LB_x_3
    s_cbranch_scc0 LB_x_0
LB_x_3:
    s_mov_b64 exec, -1
LB_x_2:
    s_barrier
    v_and_b32 v24, 15, v1
    buffer_load_dwordx4 a[0:3], v6, s[12:15], s40 offen offset:0 sc1
    buffer_load_dwordx4 a[4:7], v7, s[12:15], s40 offen offset:0 sc1
    buffer_load_dwordx4 a[8:11], v6, s[12:15], s40 offen offset:1024 sc1
    buffer_load_dwordx4 a[12:15], v7, s[12:15], s40 offen offset:1024 sc1
    buffer_load_dwordx4 a[16:19], v6, s[12:15], s40 offen offset:2048 sc1
    buffer_load_dwordx4 a[20:23], v7, s[12:15], s40 offen offset:2048 sc1
    buffer_load_dwordx4 a[24:27], v6, s[12:15], s40 offen offset:3072 sc1
    buffer_load_dwordx4 a[28:31], v7, s[12:15], s40 offen offset:3072 sc1
    s_add_u32 s40, s40, 4096
    buffer_load_dwordx4 v[216:219], v21, s[12:15], s41 offen offset:0 sc1
    buffer_load_dwordx4 v[220:223], v21, s[12:15], s41 offen offset:2048 sc1
    s_lshl_b32 s43, s30, 10
    s_add_u32 m0, s43, 139264
    s_nop 0
    buffer_load_dwordx4 v28, s[12:15], s46 offen sc1 lds
    buffer_load_dwordx4 a[32:35], v6, s[12:15], s40 offen offset:0 sc1
    buffer_load_dwordx4 a[36:39], v7, s[12:15], s40 offen offset:0 sc1
    buffer_load_dwordx4 a[40:43], v6, s[12:15], s40 offen offset:1024 sc1
    buffer_load_dwordx4 a[44:47], v7, s[12:15], s40 offen offset:1024 sc1
    s_waitcnt vmcnt(11)
    s_barrier
    ds_read_b128 a[144:147], v16 offset:0
    ds_read_b128 a[148:151], v16 offset:1024
    ds_read_b128 a[152:155], v16 offset:2048
    ds_read_b128 a[156:159], v16 offset:3072
    ds_read_b128 a[160:163], v16 offset:4096
    ds_read_b128 a[164:167], v16 offset:5120
    ds_read_b128 a[168:171], v16 offset:6144
    ds_read_b128 a[172:175], v16 offset:7168
    ds_read_b128 a[176:179], v16 offset:8192
    s_mov_b32 s8, s4
    s_and_b32 s9, s5, 0xffff
    s_mov_b32 s10, 0x800000
    s_mov_b32 s11, 0x00020000
    s_mov_b32 s16, s6
    s_and_b32 s17, s7, 0xffff
    s_mov_b32 s18, 0x1000
    s_mov_b32 s19, 0x00020000
    s_add_u32 s43, s42, 0
    s_and_b32 s43, s43, 3
    s_lshl_b32 s56, s43, 7
    s_mul_i32 s60, s43, 18432
    s_add_u32 s43, s42, 1
    s_and_b32 s43, s43, 3
    s_lshl_b32 s57, s43, 7
    s_mul_i32 s61, s43, 18432
    s_add_u32 s43, s42, 2
    s_and_b32 s43, s43, 3
    s_lshl_b32 s58, s43, 7
    s_mul_i32 s62, s43, 18432
    s_add_u32 s43, s42, 3
    s_and_b32 s43, s43, 3
    s_lshl_b32 s59, s43, 7
    s_mul_i32 s63, s43, 18432
    s_waitcnt lgkmcnt(0)
    v_mfma_f32_16x16x32_bf16 v[32:35], a[0:3], a[144:147], 0
    ds_read_b128 a[180:183], v16 offset:9216
    v_lshrrev_b32 v20, 3, v1
    v_mfma_f32_16x16x32_bf16 v[36:39], a[4:7], a[144:147], 0
    buffer_load_dwordx4 a[48:51], v6, s[12:15], s40 offen offset:2048 sc1
    v_mfma_f32_16x16x32_bf16 v[40:43], a[0:3], a[148:151], 0
    ds_read_b128 a[184:187], v16 offset:10240
    v_lshrrev_b32 v21, 5, v1
    v_mfma_f32_16x16x32_bf16 v[44:47], a[4:7], a[148:151], 0
    ds_read_b128 a[188:191], v16 offset:11264
    v_mfma_f32_16x16x32_bf16 v[48:51], a[0:3], a[152:155], 0
    ds_read_b128 a[192:195], v16 offset:12288
    v_lshlrev_b32 v21, 3, v21
    v_mfma_f32_16x16x32_bf16 v[52:55], a[4:7], a[152:155], 0
    buffer_load_dwordx4 a[52:55], v7, s[12:15], s40 offen offset:2048 sc1
    v_mfma_f32_16x16x32_bf16 v[56:59], a[0:3], a[156:159], 0
    ds_read_b128 a[196:199], v16 offset:13312
    v_and_b32 v20, 3, v20
    v_mfma_f32_16x16x32_bf16 v[60:63], a[4:7], a[156:159], 0
    ds_read_b128 a[200:203], v16 offset:14336
    v_mfma_f32_16x16x32_bf16 v[64:67], a[0:3], a[160:163], 0
    ds_read_b128 a[204:207], v16 offset:15360
    v_mfma_f32_16x16x32_bf16 v[68:71], a[4:7], a[160:163], 0
    buffer_load_dwordx4 a[56:59], v6, s[12:15], s40 offen offset:3072 sc1
    v_add_u32 v21, v21, v20
    v_mfma_f32_16x16x32_bf16 v[72:75], a[0:3], a[164:167], 0
    ds_read_b128 a[208:211], v16 offset:16384
    v_mfma_f32_16x16x32_bf16 v[76:79], a[4:7], a[164:167], 0
    ds_read_b128 a[212:215], v16 offset:17408
    v_lshlrev_b32 v21, 12, v21
    v_mfma_f32_16x16x32_bf16 v[80:83], a[0:3], a[168:171], 0
    v_mfma_f32_16x16x32_bf16 v[84:87], a[4:7], a[168:171], 0
    buffer_load_dwordx4 a[60:63], v7, s[12:15], s40 offen offset:3072 sc1
    s_add_u32 s40, s40, 4096
    v_and_b32 v23, 7, v1
    v_mfma_f32_16x16x32_bf16 v[88:91], a[0:3], a[172:175], 0
    v_mfma_f32_16x16x32_bf16 v[92:95], a[4:7], a[172:175], 0
    v_xor_b32 v23, v22, v23
    v_mfma_f32_16x16x32_bf16 v[96:99], a[0:3], a[176:179], 0
    v_mfma_f32_16x16x32_bf16 v[100:103], a[4:7], a[176:179], 0
    s_waitcnt lgkmcnt(0) vmcnt(11)
    s_barrier
    v_mfma_f32_16x16x32_bf16 v[32:35], a[8:11], a[180:183], v[32:35]
    ds_read_b128 a[144:147], v17 offset:0
    v_lshl_add_u32 v2, v23, 4, v21
    v_mfma_f32_16x16x32_bf16 v[36:39], a[12:15], a[180:183], v[36:39]
    buffer_load_dwordx4 a[64:67], v6, s[12:15], s40 offen offset:0 sc1
    v_mfma_f32_16x16x32_bf16 v[40:43], a[8:11], a[184:187], v[40:43]
    ds_read_b128 a[148:151], v17 offset:1024
    v_xor_b32 v23, 4, v23
    v_mfma_f32_16x16x32_bf16 v[44:47], a[12:15], a[184:187], v[44:47]
    ds_read_b128 a[152:155], v17 offset:2048
    v_mfma_f32_16x16x32_bf16 v[48:51], a[8:11], a[188:191], v[48:51]
    ds_read_b128 a[156:159], v17 offset:3072
    v_lshl_add_u32 v21, v23, 4, v21
    v_mfma_f32_16x16x32_bf16 v[52:55], a[12:15], a[188:191], v[52:55]
    buffer_load_dwordx4 a[68:71], v7, s[12:15], s40 offen offset:0 sc1
    v_mfma_f32_16x16x32_bf16 v[56:59], a[8:11], a[192:195], v[56:59]
    ds_read_b128 a[160:163], v17 offset:4096
    v_add_u32 v3, 64512, v21
    v_mfma_f32_16x16x32_bf16 v[60:63], a[12:15], a[192:195], v[60:63]
    ds_read_b128 a[164:167], v17 offset:5120
    v_mfma_f32_16x16x32_bf16 v[64:67], a[8:11], a[196:199], v[64:67]
    ds_read_b128 a[168:171], v17 offset:6144
    v_mfma_f32_16x16x32_bf16 v[68:71], a[12:15], a[196:199], v[68:71]
    buffer_load_dwordx4 a[72:75], v6, s[12:15], s40 offen offset:1024 sc1
    v_add_u32 v4, 14336, v2
    v_mfma_f32_16x16x32_bf16 v[72:75], a[8:11], a[200:203], v[72:75]
    ds_read_b128 a[172:175], v17 offset:7168
    v_mfma_f32_16x16x32_bf16 v[76:79], a[12:15], a[200:203], v[76:79]
    ds_read_b128 a[176:179], v17 offset:8192
    v_add_u32 v5, 14336, v3
    v_mfma_f32_16x16x32_bf16 v[80:83], a[8:11], a[204:207], v[80:83]
    v_mfma_f32_16x16x32_bf16 v[84:87], a[12:15], a[204:207], v[84:87]
    buffer_load_dwordx4 a[76:79], v7, s[12:15], s40 offen offset:1024 sc1
    v_lshrrev_b32 v25, 2, v24
    v_mfma_f32_16x16x32_bf16 v[88:91], a[8:11], a[208:211], v[88:91]
    v_mfma_f32_16x16x32_bf16 v[92:95], a[12:15], a[208:211], v[92:95]
    v_lshlrev_b32 v25, 3, v25
    v_mfma_f32_16x16x32_bf16 v[96:99], a[8:11], a[212:215], v[96:99]
    v_mfma_f32_16x16x32_bf16 v[100:103], a[12:15], a[212:215], v[100:103]
    s_waitcnt lgkmcnt(0)
    v_mfma_f32_16x16x32_bf16 v[32:35], a[16:19], a[144:147], v[32:35]
    ds_read_b128 a[180:183], v17 offset:9216
    v_and_b32 v26, 3, v24
    v_mfma_f32_16x16x32_bf16 v[36:39], a[20:23], a[144:147], v[36:39]
    buffer_load_dwordx4 a[80:83], v6, s[12:15], s40 offen offset:2048 sc1
    v_mfma_f32_16x16x32_bf16 v[40:43], a[16:19], a[148:151], v[40:43]
    ds_read_b128 a[184:187], v17 offset:10240
    v_add_u32 v25, v25, v26
    v_mfma_f32_16x16x32_bf16 v[44:47], a[20:23], a[148:151], v[44:47]
    ds_read_b128 a[188:191], v17 offset:11264
    v_mfma_f32_16x16x32_bf16 v[48:51], a[16:19], a[152:155], v[48:51]
    ds_read_b128 a[192:195], v17 offset:12288
    v_lshl_add_u32 v26, v25, 2, s45
    v_mfma_f32_16x16x32_bf16 v[52:55], a[20:23], a[152:155], v[52:55]
    buffer_load_dwordx4 a[84:87], v7, s[12:15], s40 offen offset:2048 sc1
    v_mfma_f32_16x16x32_bf16 v[56:59], a[16:19], a[156:159], v[56:59]
    ds_read_b128 a[196:199], v17 offset:13312
    s_lshl_b32 s43, s44, 5
    v_mfma_f32_16x16x32_bf16 v[60:63], a[20:23], a[156:159], v[60:63]
    ds_read_b128 a[200:203], v17 offset:14336
    v_mfma_f32_16x16x32_bf16 v[64:67], a[16:19], a[160:163], v[64:67]
    ds_read_b128 a[204:207], v17 offset:15360
    v_mfma_f32_16x16x32_bf16 v[68:71], a[20:23], a[160:163], v[68:71]
    buffer_load_dwordx4 a[88:91], v6, s[12:15], s40 offen offset:3072 sc1
    v_add_u32 v25, s43, v25
    v_mfma_f32_16x16x32_bf16 v[72:75], a[16:19], a[164:167], v[72:75]
    ds_read_b128 a[208:211], v17 offset:16384
    v_mfma_f32_16x16x32_bf16 v[76:79], a[20:23], a[164:167], v[76:79]
    ds_read_b128 a[212:215], v17 offset:17408
    v_lshlrev_b32 v25, 1, v25
    v_mfma_f32_16x16x32_bf16 v[80:83], a[16:19], a[168:171], v[80:83]
    v_mfma_f32_16x16x32_bf16 v[84:87], a[20:23], a[168:171], v[84:87]
    buffer_load_dwordx4 a[92:95], v7, s[12:15], s40 offen offset:3072 sc1
    s_add_u32 s40, s40, 4096
    v_lshlrev_b32 v27, 4, v22
    v_mfma_f32_16x16x32_bf16 v[88:91], a[16:19], a[172:175], v[88:91]
    v_mfma_f32_16x16x32_bf16 v[92:95], a[20:23], a[172:175], v[92:95]
    v_add_u32 v27, 139840, v27
    v_mfma_f32_16x16x32_bf16 v[96:99], a[16:19], a[176:179], v[96:99]
    v_mfma_f32_16x16x32_bf16 v[100:103], a[20:23], a[176:179], v[100:103]
    s_waitcnt lgkmcnt(0) vmcnt(12)
    s_barrier
    v_mfma_f32_16x16x32_bf16 v[32:35], a[24:27], a[180:183], v[32:35]
    ds_read_b128 a[144:147], v18 offset:0
    v_lshrrev_b32 v21, 1, v24
    v_mfma_f32_16x16x32_bf16 v[36:39], a[28:31], a[180:183], v[36:39]
    buffer_load_dwordx4 a[96:99], v6, s[12:15], s40 offen offset:0 sc1
    v_mfma_f32_16x16x32_bf16 v[40:43], a[24:27], a[184:187], v[40:43]
    ds_read_b128 a[148:151], v18 offset:1024
    v_xor_b32 v21, v22, v21
    v_mfma_f32_16x16x32_bf16 v[44:47], a[28:31], a[184:187], v[44:47]
    ds_read_b128 a[152:155], v18 offset:2048
    v_mfma_f32_16x16x32_bf16 v[48:51], a[24:27], a[188:191], v[48:51]
    ds_read_b128 a[156:159], v18 offset:3072
    v_lshlrev_b32 v20, 7, v24
    v_mfma_f32_16x16x32_bf16 v[52:55], a[28:31], a[188:191], v[52:55]
    buffer_load_dwordx4 a[100:103], v7, s[12:15], s40 offen offset:0 sc1
    v_mfma_f32_16x16x32_bf16 v[56:59], a[24:27], a[192:195], v[56:59]
    ds_read_b128 a[160:163], v18 offset:4096
    v_add_u32 v20, s33, v20
    v_mfma_f32_16x16x32_bf16 v[60:63], a[28:31], a[192:195], v[60:63]
    ds_read_b128 a[164:167], v18 offset:5120
    v_mfma_f32_16x16x32_bf16 v[64:67], a[24:27], a[196:199], v[64:67]
    ds_read_b128 a[168:171], v18 offset:6144
    v_mfma_f32_16x16x32_bf16 v[68:71], a[28:31], a[196:199], v[68:71]
    buffer_load_dwordx4 a[104:107], v6, s[12:15], s40 offen offset:1024 sc1
    v_xor_b32 v23, 4, v21
    v_mfma_f32_16x16x32_bf16 v[72:75], a[24:27], a[200:203], v[72:75]
    ds_read_b128 a[172:175], v18 offset:7168
    v_mfma_f32_16x16x32_bf16 v[76:79], a[28:31], a[200:203], v[76:79]
    ds_read_b128 a[176:179], v18 offset:8192
    v_lshlrev_b32 v21, 4, v21
    v_mfma_f32_16x16x32_bf16 v[80:83], a[24:27], a[204:207], v[80:83]
    v_mfma_f32_16x16x32_bf16 v[84:87], a[28:31], a[204:207], v[84:87]
    buffer_load_dwordx4 a[108:111], v7, s[12:15], s40 offen offset:1024 sc1
    v_lshlrev_b32 v23, 4, v23
    v_mfma_f32_16x16x32_bf16 v[88:91], a[24:27], a[208:211], v[88:91]
    v_mfma_f32_16x16x32_bf16 v[92:95], a[28:31], a[208:211], v[92:95]
    v_add_u32 v8, v20, v21
    v_mfma_f32_16x16x32_bf16 v[96:99], a[24:27], a[212:215], v[96:99]
    v_mfma_f32_16x16x32_bf16 v[100:103], a[28:31], a[212:215], v[100:103]
    s_waitcnt lgkmcnt(0)
    v_mfma_f32_16x16x32_bf16 v[32:35], a[32:35], a[144:147], v[32:35]
    ds_read_b128 a[180:183], v18 offset:9216
    v_add_u32 v12, v20, v23
    v_mfma_f32_16x16x32_bf16 v[36:39], a[36:39], a[144:147], v[36:39]
    buffer_load_dwordx4 a[112:115], v6, s[12:15], s40 offen offset:2048 sc1
    v_mfma_f32_16x16x32_bf16 v[40:43], a[32:35], a[148:151], v[40:43]
    ds_read_b128 a[184:187], v18 offset:10240
    v_lshl_add_u32 v20, v22, 5, s45
    v_mfma_f32_16x16x32_bf16 v[44:47], a[36:39], a[148:151], v[44:47]
    ds_read_b128 a[188:191], v18 offset:11264
    v_mfma_f32_16x16x32_bf16 v[48:51], a[32:35], a[152:155], v[48:51]
    ds_read_b128 a[192:195], v18 offset:12288
    v_lshlrev_b32 v21, 2, v24
    v_mfma_f32_16x16x32_bf16 v[52:55], a[36:39], a[152:155], v[52:55]
    buffer_load_dwordx4 a[116:119], v7, s[12:15], s40 offen offset:2048 sc1
    v_mfma_f32_16x16x32_bf16 v[56:59], a[32:35], a[156:159], v[56:59]
    ds_read_b128 a[196:199], v18 offset:13312
    v_add_u32 v21, 139264, v21
    v_mfma_f32_16x16x32_bf16 v[60:63], a[36:39], a[156:159], v[60:63]
    ds_read_b128 a[200:203], v18 offset:14336
    v_mfma_f32_16x16x32_bf16 v[64:67], a[32:35], a[160:163], v[64:67]
    ds_read_b128 a[204:207], v18 offset:15360
    v_mfma_f32_16x16x32_bf16 v[68:71], a[36:39], a[160:163], v[68:71]
    buffer_load_dwordx4 a[120:123], v6, s[12:15], s40 offen offset:3072 sc1
    v_and_b32 v23, 1, v1
    v_mfma_f32_16x16x32_bf16 v[72:75], a[32:35], a[164:167], v[72:75]
    ds_read_b128 a[208:211], v18 offset:16384
    v_mfma_f32_16x16x32_bf16 v[76:79], a[36:39], a[164:167], v[76:79]
    ds_read_b128 a[212:215], v18 offset:17408
    v_lshlrev_b32 v23, 12, v23
    v_mfma_f32_16x16x32_bf16 v[80:83], a[32:35], a[168:171], v[80:83]
    v_mfma_f32_16x16x32_bf16 v[84:87], a[36:39], a[168:171], v[84:87]
    buffer_load_dwordx4 a[124:127], v7, s[12:15], s40 offen offset:3072 sc1
    s_add_u32 s40, s40, 4096
    v_lshrrev_b32 v30, 1, v1
    v_mfma_f32_16x16x32_bf16 v[88:91], a[32:35], a[172:175], v[88:91]
    v_mfma_f32_16x16x32_bf16 v[92:95], a[36:39], a[172:175], v[92:95]
    v_lshl_add_u32 v23, v30, 7, v23
    v_mfma_f32_16x16x32_bf16 v[96:99], a[32:35], a[176:179], v[96:99]
    v_mfma_f32_16x16x32_bf16 v[100:103], a[36:39], a[176:179], v[100:103]
    s_waitcnt lgkmcnt(0) vmcnt(16)
    s_barrier
    v_mfma_f32_16x16x32_bf16 v[32:35], a[40:43], a[180:183], v[32:35]
    ds_read_b128 a[144:147], v19 offset:0
    s_add_u32 m0, s55, 36864
    s_lshl_b32 s47, s28, 4
    v_mfma_f32_16x16x32_bf16 v[36:39], a[44:47], a[180:183], v[36:39]
    s_mov_b64 exec, s[64:65]
    buffer_load_dwordx4 v6, s[12:15], s54 offen lds
    s_mov_b64 exec, -1
    v_mfma_f32_16x16x32_bf16 v[40:43], a[40:43], a[184:187], v[40:43]
    ds_read_b128 a[148:151], v19 offset:1024
    s_add_u32 s47, s47, s29
    v_mfma_f32_16x16x32_bf16 v[44:47], a[44:47], a[184:187], v[44:47]
    ds_read_b128 a[152:155], v19 offset:2048
    v_mfma_f32_16x16x32_bf16 v[48:51], a[40:43], a[188:191], v[48:51]
    ds_read_b128 a[156:159], v19 offset:3072
    s_lshl_b32 s47, s47, 2
    v_mfma_f32_16x16x32_bf16 v[52:55], a[44:47], a[188:191], v[52:55]
    buffer_load_dwordx4 v6, s[12:15], s54 offen offset:512 lds
    v_mfma_f32_16x16x32_bf16 v[56:59], a[40:43], a[192:195], v[56:59]
    ds_read_b128 a[160:163], v19 offset:4096
    s_add_u32 s47, s47, s30
    v_mfma_f32_16x16x32_bf16 v[60:63], a[44:47], a[192:195], v[60:63]
    ds_read_b128 a[164:167], v19 offset:5120
    v_mfma_f32_16x16x32_bf16 v[64:67], a[40:43], a[196:199], v[64:67]
    ds_read_b128 a[168:171], v19 offset:6144
    v_mfma_f32_16x16x32_bf16 v[68:71], a[44:47], a[196:199], v[68:71]
    buffer_load_dwordx4 v6, s[12:15], s54 offen offset:1536 lds
    s_lshl_b32 s47, s47, 13
    v_mfma_f32_16x16x32_bf16 v[72:75], a[40:43], a[200:203], v[72:75]
    ds_read_b128 a[172:175], v19 offset:7168
    v_mfma_f32_16x16x32_bf16 v[76:79], a[44:47], a[200:203], v[76:79]
    ds_read_b128 a[176:179], v19 offset:8192
    v_mov_b32 v210, 0x40135761
    v_mfma_f32_16x16x32_bf16 v[80:83], a[40:43], a[204:207], v[80:83]
    v_mfma_f32_16x16x32_bf16 v[84:87], a[44:47], a[204:207], v[84:87]
    buffer_load_dwordx4 v6, s[12:15], s54 offen offset:2560 lds
    v_mov_b32 v211, 0x40135761
    v_mfma_f32_16x16x32_bf16 v[88:91], a[40:43], a[208:211], v[88:91]
    v_mfma_f32_16x16x32_bf16 v[92:95], a[44:47], a[208:211], v[92:95]
    v_mov_b32 v212, 0x3dd2d3e8
    v_mfma_f32_16x16x32_bf16 v[96:99], a[40:43], a[212:215], v[96:99]
    v_mfma_f32_16x16x32_bf16 v[100:103], a[44:47], a[212:215], v[100:103]
    s_waitcnt lgkmcnt(0)
    v_mfma_f32_16x16x32_bf16 v[32:35], a[48:51], a[144:147], v[32:35]
    ds_read_b128 a[180:183], v19 offset:9216
    v_mov_b32 v213, 0x3dd2d3e8
    v_mfma_f32_16x16x32_bf16 v[36:39], a[52:55], a[144:147], v[36:39]
    buffer_load_dwordx4 v6, s[12:15], s54 offen offset:3584 lds
    s_add_u32 s54, s54, 18432
    v_mfma_f32_16x16x32_bf16 v[40:43], a[48:51], a[148:151], v[40:43]
    ds_read_b128 a[184:187], v19 offset:10240
    v_mov_b32 v214, 1.0
    v_mfma_f32_16x16x32_bf16 v[44:47], a[52:55], a[148:151], v[44:47]
    ds_read_b128 a[188:191], v19 offset:11264
    v_mfma_f32_16x16x32_bf16 v[48:51], a[48:51], a[152:155], v[48:51]
    ds_read_b128 a[192:195], v19 offset:12288
    v_mov_b32 v215, 1.0
    v_mfma_f32_16x16x32_bf16 v[52:55], a[52:55], a[152:155], v[52:55]
    buffer_load_dwordx4 a[128:131], v6, s[12:15], s40 offen offset:0 sc1
    v_mfma_f32_16x16x32_bf16 v[56:59], a[48:51], a[156:159], v[56:59]
    ds_read_b128 a[196:199], v19 offset:13312
    v_add_f32 v216, v216, v220
    v_mfma_f32_16x16x32_bf16 v[60:63], a[52:55], a[156:159], v[60:63]
    ds_read_b128 a[200:203], v19 offset:14336
    v_mfma_f32_16x16x32_bf16 v[64:67], a[48:51], a[160:163], v[64:67]
    ds_read_b128 a[204:207], v19 offset:15360
    v_mfma_f32_16x16x32_bf16 v[68:71], a[52:55], a[160:163], v[68:71]
    buffer_load_dwordx4 a[132:135], v7, s[12:15], s40 offen offset:0 sc1
    v_add_f32 v217, v217, v221
    v_mfma_f32_16x16x32_bf16 v[72:75], a[48:51], a[164:167], v[72:75]
    ds_read_b128 a[208:211], v19 offset:16384
    v_mfma_f32_16x16x32_bf16 v[76:79], a[52:55], a[164:167], v[76:79]
    ds_read_b128 a[212:215], v19 offset:17408
    v_add_f32 v218, v218, v222
    v_mfma_f32_16x16x32_bf16 v[80:83], a[48:51], a[168:171], v[80:83]
    v_mfma_f32_16x16x32_bf16 v[84:87], a[52:55], a[168:171], v[84:87]
    buffer_load_dwordx4 a[136:139], v6, s[12:15], s40 offen offset:1024 sc1
    v_add_f32 v219, v219, v223
    v_mfma_f32_16x16x32_bf16 v[88:91], a[48:51], a[172:175], v[88:91]
    v_mfma_f32_16x16x32_bf16 v[92:95], a[52:55], a[172:175], v[92:95]
    v_and_b32 v30, 1, v22
    v_mfma_f32_16x16x32_bf16 v[96:99], a[48:51], a[176:179], v[96:99]
    v_mfma_f32_16x16x32_bf16 v[100:103], a[52:55], a[176:179], v[100:103]
    s_waitcnt lgkmcnt(0) vmcnt(20)
    s_barrier
    v_mfma_f32_16x16x32_bf16 v[32:35], a[56:59], a[180:183], v[32:35]
    ds_read_b128 a[144:147], v13 offset:0
    v_lshl_add_u32 v30, v24, 1, v30
    v_mfma_f32_16x16x32_bf16 v[36:39], a[60:63], a[180:183], v[36:39]
    buffer_load_dwordx4 a[140:143], v7, s[12:15], s40 offen offset:1024 sc1
    s_add_u32 m0, s55, 65536
    v_mfma_f32_16x16x32_bf16 v[40:43], a[56:59], a[184:187], v[40:43]
    ds_read_b128 a[148:151], v13 offset:1024
    v_permlane16_swap_b32 v216, v218
    v_mfma_f32_16x16x32_bf16 v[44:47], a[60:63], a[184:187], v[44:47]
    ds_read_b128 a[152:155], v13 offset:2048
    v_mfma_f32_16x16x32_bf16 v[48:51], a[56:59], a[188:191], v[48:51]
    ds_read_b128 a[156:159], v13 offset:3072
    v_permlane16_swap_b32 v217, v219
    v_mfma_f32_16x16x32_bf16 v[52:55], a[60:63], a[188:191], v[52:55]
    s_mov_b64 exec, s[64:65]
    buffer_load_dwordx4 v6, s[12:15], s54 offen lds
    s_mov_b64 exec, -1
    v_mfma_f32_16x16x32_bf16 v[56:59], a[56:59], a[192:195], v[56:59]
    ds_read_b128 a[160:163], v13 offset:4096
    v_lshl_add_u32 v30, v30, 2, s45
    v_mfma_f32_16x16x32_bf16 v[60:63], a[60:63], a[192:195], v[60:63]
    ds_read_b128 a[164:167], v13 offset:5120
    v_mfma_f32_16x16x32_bf16 v[64:67], a[56:59], a[196:199], v[64:67]
    ds_read_b128 a[168:171], v13 offset:6144
    v_mfma_f32_16x16x32_bf16 v[68:71], a[60:63], a[196:199], v[68:71]
    buffer_load_dwordx4 v6, s[12:15], s54 offen offset:512 lds
    s_nop 0
    v_mfma_f32_16x16x32_bf16 v[72:75], a[56:59], a[200:203], v[72:75]
    ds_read_b128 a[172:175], v13 offset:7168
    v_mfma_f32_16x16x32_bf16 v[76:79], a[60:63], a[200:203], v[76:79]
    ds_read_b128 a[176:179], v13 offset:8192
    v_add_f32 v216, v216, v218
    v_mfma_f32_16x16x32_bf16 v[80:83], a[56:59], a[204:207], v[80:83]
    v_mfma_f32_16x16x32_bf16 v[84:87], a[60:63], a[204:207], v[84:87]
    buffer_load_dwordx4 v6, s[12:15], s54 offen offset:1536 lds
    v_add_f32 v217, v217, v219
    v_mfma_f32_16x16x32_bf16 v[88:91], a[56:59], a[208:211], v[88:91]
    v_mfma_f32_16x16x32_bf16 v[92:95], a[60:63], a[208:211], v[92:95]
    v_mov_b32 v218, v216
    v_mfma_f32_16x16x32_bf16 v[96:99], a[56:59], a[212:215], v[96:99]
    v_mfma_f32_16x16x32_bf16 v[100:103], a[60:63], a[212:215], v[100:103]
    s_waitcnt lgkmcnt(0)
    v_mfma_f32_16x16x32_bf16 v[32:35], a[64:67], a[144:147], v[32:35]
    ds_read_b128 a[180:183], v13 offset:9216
    v_mov_b32 v219, v217
    v_mfma_f32_16x16x32_bf16 v[36:39], a[68:71], a[144:147], v[36:39]
    buffer_load_dwordx4 v6, s[12:15], s54 offen offset:2560 lds
    v_mfma_f32_16x16x32_bf16 v[40:43], a[64:67], a[148:151], v[40:43]
    ds_read_b128 a[184:187], v13 offset:10240
    s_nop 1
    v_mfma_f32_16x16x32_bf16 v[44:47], a[68:71], a[148:151], v[44:47]
    ds_read_b128 a[188:191], v13 offset:11264
    v_mfma_f32_16x16x32_bf16 v[48:51], a[64:67], a[152:155], v[48:51]
    ds_read_b128 a[192:195], v13 offset:12288
    v_permlane32_swap_b32 v216, v218
    v_mfma_f32_16x16x32_bf16 v[52:55], a[68:71], a[152:155], v[52:55]
    buffer_load_dwordx4 v6, s[12:15], s54 offen offset:3584 lds
    s_add_u32 s54, s54, 18432
    s_add_u32 m0, s55, 83968
    v_mfma_f32_16x16x32_bf16 v[56:59], a[64:67], a[156:159], v[56:59]
    ds_read_b128 a[196:199], v13 offset:13312
    v_permlane32_swap_b32 v217, v219
    v_mfma_f32_16x16x32_bf16 v[60:63], a[68:71], a[156:159], v[60:63]
    ds_read_b128 a[200:203], v13 offset:14336
    v_mfma_f32_16x16x32_bf16 v[64:67], a[64:67], a[160:163], v[64:67]
    ds_read_b128 a[204:207], v13 offset:15360
    v_mfma_f32_16x16x32_bf16 v[68:71], a[68:71], a[160:163], v[68:71]
    s_mov_b64 exec, s[64:65]
    buffer_load_dwordx4 v6, s[12:15], s54 offen lds
    s_mov_b64 exec, -1
    s_nop 1
    v_mfma_f32_16x16x32_bf16 v[72:75], a[64:67], a[164:167], v[72:75]
    ds_read_b128 a[208:211], v13 offset:16384
    v_mfma_f32_16x16x32_bf16 v[76:79], a[68:71], a[164:167], v[76:79]
    ds_read_b128 a[212:215], v13 offset:17408
    v_add_f32 v216, v216, v218
    v_mfma_f32_16x16x32_bf16 v[80:83], a[64:67], a[168:171], v[80:83]
    v_mfma_f32_16x16x32_bf16 v[84:87], a[68:71], a[168:171], v[84:87]
    buffer_load_dwordx4 v6, s[12:15], s54 offen offset:512 lds
    v_add_f32 v217, v217, v219
    v_mfma_f32_16x16x32_bf16 v[88:91], a[64:67], a[172:175], v[88:91]
    v_mfma_f32_16x16x32_bf16 v[92:95], a[68:71], a[172:175], v[92:95]
    v_mul_f32 v216, 0x3ae38e39, v216
    v_mfma_f32_16x16x32_bf16 v[96:99], a[64:67], a[176:179], v[96:99]
    v_mfma_f32_16x16x32_bf16 v[100:103], a[68:71], a[176:179], v[100:103]
    s_waitcnt lgkmcnt(0) vmcnt(24)
    s_barrier
    v_mfma_f32_16x16x32_bf16 v[32:35], a[72:75], a[180:183], v[32:35]
    ds_read_b128 a[144:147], v14 offset:0
    v_mul_f32 v217, 0x3ae38e39, v217
    v_mfma_f32_16x16x32_bf16 v[36:39], a[76:79], a[180:183], v[36:39]
    buffer_load_dwordx4 v6, s[12:15], s54 offen offset:1536 lds
    v_mfma_f32_16x16x32_bf16 v[40:43], a[72:75], a[184:187], v[40:43]
    ds_read_b128 a[148:151], v14 offset:1024
    v_fma_f32 v217, -v216, v216, v217
    v_mfma_f32_16x16x32_bf16 v[44:47], a[76:79], a[184:187], v[44:47]
    ds_read_b128 a[152:155], v14 offset:2048
    v_mfma_f32_16x16x32_bf16 v[48:51], a[72:75], a[188:191], v[48:51]
    ds_read_b128 a[156:159], v14 offset:3072
    v_max_f32 v217, 0, v217
    v_mfma_f32_16x16x32_bf16 v[52:55], a[76:79], a[188:191], v[52:55]
    buffer_load_dwordx4 v6, s[12:15], s54 offen offset:2560 lds
    v_mfma_f32_16x16x32_bf16 v[56:59], a[72:75], a[192:195], v[56:59]
    ds_read_b128 a[160:163], v14 offset:4096
    v_cvt_pk_bf16_f32 v217, v217, v217
    v_mfma_f32_16x16x32_bf16 v[60:63], a[76:79], a[192:195], v[60:63]
    ds_read_b128 a[164:167], v14 offset:5120
    v_mfma_f32_16x16x32_bf16 v[64:67], a[72:75], a[196:199], v[64:67]
    ds_read_b128 a[168:171], v14 offset:6144
    v_mfma_f32_16x16x32_bf16 v[68:71], a[76:79], a[196:199], v[68:71]
    buffer_load_dwordx4 v6, s[12:15], s54 offen offset:3584 lds
    s_add_u32 s54, s54, 18432
    s_add_u32 m0, s55, 102400
    v_lshlrev_b32 v217, 16, v217
    v_mfma_f32_16x16x32_bf16 v[72:75], a[72:75], a[200:203], v[72:75]
    ds_read_b128 a[172:175], v14 offset:7168
    v_mfma_f32_16x16x32_bf16 v[76:79], a[76:79], a[200:203], v[76:79]
    ds_read_b128 a[176:179], v14 offset:8192
    v_cvt_pk_bf16_f32 v216, v216, v216
    v_mfma_f32_16x16x32_bf16 v[80:83], a[72:75], a[204:207], v[80:83]
    v_mfma_f32_16x16x32_bf16 v[84:87], a[76:79], a[204:207], v[84:87]
    s_mov_b64 exec, s[64:65]
    buffer_load_dwordx4 v6, s[12:15], s54 offen lds
    s_mov_b64 exec, -1
    v_lshlrev_b32 v216, 16, v216
    v_mfma_f32_16x16x32_bf16 v[88:91], a[72:75], a[208:211], v[88:91]
    v_mfma_f32_16x16x32_bf16 v[92:95], a[76:79], a[208:211], v[92:95]
    v_add_f32 v217, 0x3727c5ac, v217
    v_mfma_f32_16x16x32_bf16 v[96:99], a[72:75], a[212:215], v[96:99]
    v_mfma_f32_16x16x32_bf16 v[100:103], a[76:79], a[212:215], v[100:103]
    s_waitcnt lgkmcnt(0)
    v_mfma_f32_16x16x32_bf16 v[32:35], a[80:83], a[144:147], v[32:35]
    ds_read_b128 a[180:183], v14 offset:9216
    v_cvt_pk_bf16_f32 v217, v217, v217
    v_mfma_f32_16x16x32_bf16 v[36:39], a[84:87], a[144:147], v[36:39]
    buffer_load_dwordx4 v6, s[12:15], s54 offen offset:512 lds
    v_mfma_f32_16x16x32_bf16 v[40:43], a[80:83], a[148:151], v[40:43]
    ds_read_b128 a[184:187], v14 offset:10240
    v_lshlrev_b32 v217, 16, v217
    v_mfma_f32_16x16x32_bf16 v[44:47], a[84:87], a[148:151], v[44:47]
    ds_read_b128 a[188:191], v14 offset:11264
    v_mfma_f32_16x16x32_bf16 v[48:51], a[80:83], a[152:155], v[48:51]
    ds_read_b128 a[192:195], v14 offset:12288
    v_sqrt_f32 v217, v217
    v_mfma_f32_16x16x32_bf16 v[52:55], a[84:87], a[152:155], v[52:55]
    buffer_load_dwordx4 v6, s[12:15], s54 offen offset:1536 lds
    v_mfma_f32_16x16x32_bf16 v[56:59], a[80:83], a[156:159], v[56:59]
    ds_read_b128 a[196:199], v14 offset:13312
    s_nop 0
    v_mfma_f32_16x16x32_bf16 v[60:63], a[84:87], a[156:159], v[60:63]
    ds_read_b128 a[200:203], v14 offset:14336
    v_mfma_f32_16x16x32_bf16 v[64:67], a[80:83], a[160:163], v[64:67]
    ds_read_b128 a[204:207], v14 offset:15360
    v_mfma_f32_16x16x32_bf16 v[68:71], a[84:87], a[160:163], v[68:71]
    buffer_load_dwordx4 v6, s[12:15], s54 offen offset:2560 lds
    v_cvt_pk_bf16_f32 v217, v217, v217
    v_mfma_f32_16x16x32_bf16 v[72:75], a[80:83], a[164:167], v[72:75]
    ds_read_b128 a[208:211], v14 offset:16384
    v_mfma_f32_16x16x32_bf16 v[76:79], a[84:87], a[164:167], v[76:79]
    ds_read_b128 a[212:215], v14 offset:17408
    v_lshlrev_b32 v217, 16, v217
    v_mfma_f32_16x16x32_bf16 v[80:83], a[80:83], a[168:171], v[80:83]
    v_mfma_f32_16x16x32_bf16 v[84:87], a[84:87], a[168:171], v[84:87]
    buffer_load_dwordx4 v6, s[12:15], s54 offen offset:3584 lds
    s_add_u32 s54, s54, 18432
    v_rcp_f32 v217, v217
    v_mfma_f32_16x16x32_bf16 v[88:91], a[80:83], a[172:175], v[88:91]
    v_mfma_f32_16x16x32_bf16 v[92:95], a[84:87], a[172:175], v[92:95]
    s_nop 0
    v_mfma_f32_16x16x32_bf16 v[96:99], a[80:83], a[176:179], v[96:99]
    v_mfma_f32_16x16x32_bf16 v[100:103], a[84:87], a[176:179], v[100:103]
    s_waitcnt lgkmcnt(0) vmcnt(19)
    s_barrier
    v_mfma_f32_16x16x32_bf16 v[32:35], a[88:91], a[180:183], v[32:35]
    ds_read_b128 a[144:147], v15 offset:0
    v_mul_f32 v216, -v216, v217
    v_mfma_f32_16x16x32_bf16 v[36:39], a[92:95], a[180:183], v[36:39]
    ds_read_b128 a[148:151], v15 offset:1024
    v_mfma_f32_16x16x32_bf16 v[40:43], a[88:91], a[184:187], v[40:43]
    ds_read_b128 a[152:155], v15 offset:2048
    v_mfma_f32_16x16x32_bf16 v[44:47], a[92:95], a[184:187], v[44:47]
    ds_read_b128 a[156:159], v15 offset:3072
    v_mfma_f32_16x16x32_bf16 v[48:51], a[88:91], a[188:191], v[48:51]
    ds_read_b128 a[160:163], v15 offset:4096
    v_mfma_f32_16x16x32_bf16 v[52:55], a[92:95], a[188:191], v[52:55]
    ds_read_b128 a[164:167], v15 offset:5120
    v_mfma_f32_16x16x32_bf16 v[56:59], a[88:91], a[192:195], v[56:59]
    ds_read_b128 a[168:171], v15 offset:6144
    v_mfma_f32_16x16x32_bf16 v[60:63], a[92:95], a[192:195], v[60:63]
    ds_read_b128 a[172:175], v15 offset:7168
    v_mfma_f32_16x16x32_bf16 v[64:67], a[88:91], a[196:199], v[64:67]
    ds_read_b128 a[176:179], v15 offset:8192
    v_mfma_f32_16x16x32_bf16 v[68:71], a[92:95], a[196:199], v[68:71]
    ds_write2_b32 v30, v216, v217 offset0:0 offset1:32
    v_mfma_f32_16x16x32_bf16 v[72:75], a[88:91], a[200:203], v[72:75]
    v_mfma_f32_16x16x32_bf16 v[76:79], a[92:95], a[200:203], v[76:79]
    v_mfma_f32_16x16x32_bf16 v[80:83], a[88:91], a[204:207], v[80:83]
    v_mfma_f32_16x16x32_bf16 v[84:87], a[92:95], a[204:207], v[84:87]
    v_mfma_f32_16x16x32_bf16 v[88:91], a[88:91], a[208:211], v[88:91]
    v_mfma_f32_16x16x32_bf16 v[92:95], a[92:95], a[208:211], v[92:95]
    v_mfma_f32_16x16x32_bf16 v[96:99], a[88:91], a[212:215], v[96:99]
    v_mfma_f32_16x16x32_bf16 v[100:103], a[92:95], a[212:215], v[100:103]
    s_waitcnt lgkmcnt(0)
    s_cmp_eq_u32 s37, 0
    s_cbranch_scc1 LB_wo2
    buffer_store_dwordx4 v[176:179], v208, s[12:15], s50 offen offset:0 sc1
    buffer_store_dwordx4 v[180:183], v208, s[12:15], s50 offen offset:1024 sc1
    buffer_store_dwordx4 v[184:187], v208, s[12:15], s50 offen offset:2048 sc1
    buffer_store_dwordx4 v[188:191], v208, s[12:15], s50 offen offset:3072 sc1
    s_mov_b64 exec, s[52:53]
    buffer_store_dwordx4 v[192:195], v208, s[12:15], s51 offen sc1
    s_mov_b64 exec, -1
    s_add_u32 s50, s50, s36
    s_add_u32 s51, s51, s36
    buffer_store_dwordx4 v[224:227], v208, s[12:15], s50 offen offset:0 sc1
    buffer_store_dwordx4 v[228:231], v208, s[12:15], s50 offen offset:1024 sc1
    buffer_store_dwordx4 v[232:235], v208, s[12:15], s50 offen offset:2048 sc1
    buffer_store_dwordx4 v[236:239], v208, s[12:15], s50 offen offset:3072 sc1
    s_mov_b64 exec, s[52:53]
    buffer_store_dwordx4 v[240:243], v208, s[12:15], s51 offen sc1
    s_mov_b64 exec, -1
LB_wo2:
    v_mfma_f32_16x16x32_bf16 v[32:35], a[96:99], a[144:147], v[32:35]
    ds_read_b128 a[180:183], v15 offset:9216
    v_mfma_f32_16x16x32_bf16 v[36:39], a[100:103], a[144:147], v[36:39]
    ds_read_b128 a[184:187], v15 offset:10240
    v_mfma_f32_16x16x32_bf16 v[40:43], a[96:99], a[148:151], v[40:43]
    ds_read_b128 a[188:191], v15 offset:11264
    v_mfma_f32_16x16x32_bf16 v[44:47], a[100:103], a[148:151], v[44:47]
    ds_read_b128 a[192:195], v15 offset:12288
    v_mfma_f32_16x16x32_bf16 v[48:51], a[96:99], a[152:155], v[48:51]
    ds_read_b128 a[196:199], v15 offset:13312
    v_mfma_f32_16x16x32_bf16 v[52:55], a[100:103], a[152:155], v[52:55]
    ds_read_b128 a[200:203], v15 offset:14336
    v_mfma_f32_16x16x32_bf16 v[56:59], a[96:99], a[156:159], v[56:59]
    ds_read_b128 a[204:207], v15 offset:15360
    v_mfma_f32_16x16x32_bf16 v[60:63], a[100:103], a[156:159], v[60:63]
    ds_read_b128 a[208:211], v15 offset:16384
    v_mfma_f32_16x16x32_bf16 v[64:67], a[96:99], a[160:163], v[64:67]
    ds_read_b128 a[212:215], v15 offset:17408
    v_mfma_f32_16x16x32_bf16 v[68:71], a[100:103], a[160:163], v[68:71]
    v_mfma_f32_16x16x32_bf16 v[72:75], a[96:99], a[164:167], v[72:75]
    v_mfma_f32_16x16x32_bf16 v[76:79], a[100:103], a[164:167], v[76:79]
    v_mfma_f32_16x16x32_bf16 v[80:83], a[96:99], a[168:171], v[80:83]
    v_mfma_f32_16x16x32_bf16 v[84:87], a[100:103], a[168:171], v[84:87]
    v_mfma_f32_16x16x32_bf16 v[88:91], a[96:99], a[172:175], v[88:91]
    v_mfma_f32_16x16x32_bf16 v[92:95], a[100:103], a[172:175], v[92:95]
    v_mfma_f32_16x16x32_bf16 v[96:99], a[96:99], a[176:179], v[96:99]
    v_mfma_f32_16x16x32_bf16 v[100:103], a[100:103], a[176:179], v[100:103]
    s_waitcnt lgkmcnt(0) vmcnt(10)
    s_barrier
    v_mfma_f32_16x16x32_bf16 v[32:35], a[104:107], a[180:183], v[32:35]
    ds_read_b128 a[144:147], v16 offset:0
    v_mfma_f32_16x16x32_bf16 v[36:39], a[108:111], a[180:183], v[36:39]
    ds_read_b128 a[148:151], v16 offset:1024
    v_mfma_f32_16x16x32_bf16 v[40:43], a[104:107], a[184:187], v[40:43]
    ds_read_b128 a[152:155], v16 offset:2048
    v_mfma_f32_16x16x32_bf16 v[44:47], a[108:111], a[184:187], v[44:47]
    ds_read_b128 a[156:159], v16 offset:3072
    v_mfma_f32_16x16x32_bf16 v[48:51], a[104:107], a[188:191], v[48:51]
    ds_read_b128 a[160:163], v16 offset:4096
    v_mfma_f32_16x16x32_bf16 v[52:55], a[108:111], a[188:191], v[52:55]
    ds_read_b128 a[164:167], v16 offset:5120
    v_mfma_f32_16x16x32_bf16 v[56:59], a[104:107], a[192:195], v[56:59]
    ds_read_b128 a[168:171], v16 offset:6144
    v_mfma_f32_16x16x32_bf16 v[60:63], a[108:111], a[192:195], v[60:63]
    ds_read_b128 a[172:175], v16 offset:7168
    v_mfma_f32_16x16x32_bf16 v[64:67], a[104:107], a[196:199], v[64:67]
    ds_read_b128 a[176:179], v16 offset:8192
    v_mfma_f32_16x16x32_bf16 v[68:71], a[108:111], a[196:199], v[68:71]
    v_mfma_f32_16x16x32_bf16 v[72:75], a[104:107], a[200:203], v[72:75]
    v_mfma_f32_16x16x32_bf16 v[76:79], a[108:111], a[200:203], v[76:79]
    v_mfma_f32_16x16x32_bf16 v[80:83], a[104:107], a[204:207], v[80:83]
    v_mfma_f32_16x16x32_bf16 v[84:87], a[108:111], a[204:207], v[84:87]
    v_mfma_f32_16x16x32_bf16 v[88:91], a[104:107], a[208:211], v[88:91]
    v_mfma_f32_16x16x32_bf16 v[92:95], a[108:111], a[208:211], v[92:95]
    v_mfma_f32_16x16x32_bf16 v[96:99], a[104:107], a[212:215], v[96:99]
    v_mfma_f32_16x16x32_bf16 v[100:103], a[108:111], a[212:215], v[100:103]
    s_waitcnt lgkmcnt(0)
    v_mfma_f32_16x16x32_bf16 v[32:35], a[112:115], a[144:147], v[32:35]
    ds_read_b128 a[180:183], v16 offset:9216
    v_mfma_f32_16x16x32_bf16 v[36:39], a[116:119], a[144:147], v[36:39]
    s_getpc_b64 s[50:51]
Lpc_L4_e1_101:
    s_add_u32 s50, s50, L4_e1-Lpc_L4_e1_101
    s_addc_u32 s51, s51, (L4_e1-Lpc_L4_e1_101)>>32
    v_lshlrev_b32 v31, 7, v0
    v_min_u32 v31, L4_loop-L4_e1-4, v31
    global_load_dword v31, v31, s[50:51]
    v_mfma_f32_16x16x32_bf16 v[40:43], a[112:115], a[148:151], v[40:43]
    ds_read_b128 a[184:187], v16 offset:10240
    v_mfma_f32_16x16x32_bf16 v[44:47], a[116:119], a[148:151], v[44:47]
    ds_read_b128 a[188:191], v16 offset:11264
    v_mfma_f32_16x16x32_bf16 v[48:51], a[112:115], a[152:155], v[48:51]
    ds_read_b128 a[192:195], v16 offset:12288
    v_mfma_f32_16x16x32_bf16 v[52:55], a[116:119], a[152:155], v[52:55]
    ds_read_b128 a[196:199], v16 offset:13312
    v_mfma_f32_16x16x32_bf16 v[56:59], a[112:115], a[156:159], v[56:59]
    ds_read_b128 a[200:203], v16 offset:14336
    v_mfma_f32_16x16x32_bf16 v[60:63], a[116:119], a[156:159], v[60:63]
    ds_read_b128 a[204:207], v16 offset:15360
    v_mfma_f32_16x16x32_bf16 v[64:67], a[112:115], a[160:163], v[64:67]
    ds_read_b128 a[208:211], v16 offset:16384
    v_mfma_f32_16x16x32_bf16 v[68:71], a[116:119], a[160:163], v[68:71]
    ds_read_b128 a[212:215], v16 offset:17408
    v_mfma_f32_16x16x32_bf16 v[72:75], a[112:115], a[164:167], v[72:75]
    v_mfma_f32_16x16x32_bf16 v[76:79], a[116:119], a[164:167], v[76:79]
    v_mfma_f32_16x16x32_bf16 v[80:83], a[112:115], a[168:171], v[80:83]
    v_mfma_f32_16x16x32_bf16 v[84:87], a[116:119], a[168:171], v[84:87]
    v_mfma_f32_16x16x32_bf16 v[88:91], a[112:115], a[172:175], v[88:91]
    v_mfma_f32_16x16x32_bf16 v[92:95], a[116:119], a[172:175], v[92:95]
    v_mfma_f32_16x16x32_bf16 v[96:99], a[112:115], a[176:179], v[96:99]
    v_mfma_f32_16x16x32_bf16 v[100:103], a[116:119], a[176:179], v[100:103]
    s_waitcnt lgkmcnt(0) vmcnt(6)
    s_barrier
    v_mfma_f32_16x16x32_bf16 v[32:35], a[120:123], a[180:183], v[32:35]
    ds_read_b128 a[144:147], v17 offset:0
    s_add_u32 m0, s55, 120832
    v_mfma_f32_16x16x32_bf16 v[36:39], a[124:127], a[180:183], v[36:39]
    s_mov_b64 exec, s[64:65]
    buffer_load_dwordx4 v6, s[12:15], s54 offen lds
    s_mov_b64 exec, -1
    v_mfma_f32_16x16x32_bf16 v[40:43], a[120:123], a[184:187], v[40:43]
    ds_read_b128 a[148:151], v17 offset:1024
    v_mfma_f32_16x16x32_bf16 v[44:47], a[124:127], a[184:187], v[44:47]
    ds_read_b128 a[152:155], v17 offset:2048
    v_mfma_f32_16x16x32_bf16 v[48:51], a[120:123], a[188:191], v[48:51]
    ds_read_b128 a[156:159], v17 offset:3072
    v_mfma_f32_16x16x32_bf16 v[52:55], a[124:127], a[188:191], v[52:55]
    buffer_load_dwordx4 v6, s[12:15], s54 offen offset:512 lds
    v_mfma_f32_16x16x32_bf16 v[56:59], a[120:123], a[192:195], v[56:59]
    ds_read_b128 a[160:163], v17 offset:4096
    v_mfma_f32_16x16x32_bf16 v[60:63], a[124:127], a[192:195], v[60:63]
    ds_read_b128 a[164:167], v17 offset:5120
    v_mfma_f32_16x16x32_bf16 v[64:67], a[120:123], a[196:199], v[64:67]
    ds_read_b128 a[168:171], v17 offset:6144
    v_mfma_f32_16x16x32_bf16 v[68:71], a[124:127], a[196:199], v[68:71]
    buffer_load_dwordx4 v6, s[12:15], s54 offen offset:1536 lds
    v_mfma_f32_16x16x32_bf16 v[72:75], a[120:123], a[200:203], v[72:75]
    ds_read_b128 a[172:175], v17 offset:7168
    v_mfma_f32_16x16x32_bf16 v[76:79], a[124:127], a[200:203], v[76:79]
    ds_read_b128 a[176:179], v17 offset:8192
    v_mfma_f32_16x16x32_bf16 v[80:83], a[120:123], a[204:207], v[80:83]
    v_mfma_f32_16x16x32_bf16 v[84:87], a[124:127], a[204:207], v[84:87]
    buffer_load_dwordx4 v6, s[12:15], s54 offen offset:2560 lds
    v_mfma_f32_16x16x32_bf16 v[88:91], a[120:123], a[208:211], v[88:91]
    v_mfma_f32_16x16x32_bf16 v[92:95], a[124:127], a[208:211], v[92:95]
    v_mfma_f32_16x16x32_bf16 v[96:99], a[120:123], a[212:215], v[96:99]
    v_mfma_f32_16x16x32_bf16 v[100:103], a[124:127], a[212:215], v[100:103]
    s_waitcnt lgkmcnt(0)
    v_mfma_f32_16x16x32_bf16 v[32:35], a[128:131], a[144:147], v[32:35]
    ds_read_b128 a[180:183], v17 offset:9216
    v_mfma_f32_16x16x32_bf16 v[36:39], a[132:135], a[144:147], v[36:39]
    buffer_load_dwordx4 v6, s[12:15], s54 offen offset:3584 lds
    s_add_u32 s54, s54, 18432
    s_add_u32 m0, s55, 0
    v_mfma_f32_16x16x32_bf16 v[40:43], a[128:131], a[148:151], v[40:43]
    ds_read_b128 a[184:187], v17 offset:10240
    v_mfma_f32_16x16x32_bf16 v[44:47], a[132:135], a[148:151], v[44:47]
    ds_read_b128 a[188:191], v17 offset:11264
    v_mfma_f32_16x16x32_bf16 v[48:51], a[128:131], a[152:155], v[48:51]
    ds_read_b128 a[192:195], v17 offset:12288
    v_mfma_f32_16x16x32_bf16 v[52:55], a[132:135], a[152:155], v[52:55]
    s_mov_b64 exec, s[64:65]
    buffer_load_dwordx4 v6, s[12:15], s54 offen lds
    s_mov_b64 exec, -1
    v_mfma_f32_16x16x32_bf16 v[56:59], a[128:131], a[156:159], v[56:59]
    ds_read_b128 a[196:199], v17 offset:13312
    v_mfma_f32_16x16x32_bf16 v[60:63], a[132:135], a[156:159], v[60:63]
    ds_read_b128 a[200:203], v17 offset:14336
    v_mfma_f32_16x16x32_bf16 v[64:67], a[128:131], a[160:163], v[64:67]
    ds_read_b128 a[204:207], v17 offset:15360
    v_mfma_f32_16x16x32_bf16 v[68:71], a[132:135], a[160:163], v[68:71]
    buffer_load_dwordx4 v6, s[12:15], s54 offen offset:512 lds
    v_mfma_f32_16x16x32_bf16 v[72:75], a[128:131], a[164:167], v[72:75]
    ds_read_b128 a[208:211], v17 offset:16384
    v_mfma_f32_16x16x32_bf16 v[76:79], a[132:135], a[164:167], v[76:79]
    ds_read_b128 a[212:215], v17 offset:17408
    v_mfma_f32_16x16x32_bf16 v[80:83], a[128:131], a[168:171], v[80:83]
    v_mfma_f32_16x16x32_bf16 v[84:87], a[132:135], a[168:171], v[84:87]
    buffer_load_dwordx4 v6, s[12:15], s54 offen offset:1536 lds
    v_mfma_f32_16x16x32_bf16 v[88:91], a[128:131], a[172:175], v[88:91]
    v_mfma_f32_16x16x32_bf16 v[92:95], a[132:135], a[172:175], v[92:95]
    v_mfma_f32_16x16x32_bf16 v[96:99], a[128:131], a[176:179], v[96:99]
    v_mfma_f32_16x16x32_bf16 v[100:103], a[132:135], a[176:179], v[100:103]
    s_waitcnt lgkmcnt(0) vmcnt(9)
    s_barrier
    v_mfma_f32_16x16x32_bf16 v[32:35], a[136:139], a[180:183], v[32:35]
    ds_read_b128 a[144:147], v18 offset:0
    ds_read_b128 v[176:179], v20 offset:0
    v_mfma_f32_16x16x32_bf16 v[36:39], a[140:143], a[180:183], v[36:39]
    buffer_load_dwordx4 v6, s[12:15], s54 offen offset:2560 lds
    ds_read_b128 v[180:183], v20 offset:16
    v_mfma_f32_16x16x32_bf16 v[40:43], a[136:139], a[184:187], v[40:43]
    ds_read_b128 a[148:151], v18 offset:1024
    ds_read_b128 v[184:187], v20 offset:128
    v_mfma_f32_16x16x32_bf16 v[44:47], a[140:143], a[184:187], v[44:47]
    ds_read_b128 a[152:155], v18 offset:2048
    v_mfma_f32_16x16x32_bf16 v[48:51], a[136:139], a[188:191], v[48:51]
    ds_read_b128 a[156:159], v18 offset:3072
    ds_read_b128 v[188:191], v20 offset:144
    v_mfma_f32_16x16x32_bf16 v[52:55], a[140:143], a[188:191], v[52:55]
    buffer_load_dwordx4 v6, s[12:15], s54 offen offset:3584 lds
    s_add_u32 s54, s54, 18432
    s_add_u32 m0, s55, 18432
    ds_read_b32 v192, v21 offset:1152
    ds_read_b32 v193, v21 offset:0
    v_mfma_f32_16x16x32_bf16 v[56:59], a[136:139], a[192:195], v[56:59]
    ds_read_b128 a[160:163], v18 offset:4096
    ds_read_b32 v194, v21 offset:1216
    ds_read_b32 v195, v21 offset:64
    v_mfma_f32_16x16x32_bf16 v[60:63], a[140:143], a[192:195], v[60:63]
    ds_read_b128 a[164:167], v18 offset:5120
    v_mfma_f32_16x16x32_bf16 v[64:67], a[136:139], a[196:199], v[64:67]
    ds_read_b128 a[168:171], v18 offset:6144
    ds_read_b32 v196, v21 offset:1280
    ds_read_b32 v197, v21 offset:128
    v_mfma_f32_16x16x32_bf16 v[68:71], a[140:143], a[196:199], v[68:71]
    s_mov_b64 exec, s[64:65]
    buffer_load_dwordx4 v6, s[12:15], s54 offen lds
    s_mov_b64 exec, -1
    ds_read_b32 v198, v21 offset:1344
    ds_read_b32 v199, v21 offset:192
    v_mfma_f32_16x16x32_bf16 v[72:75], a[136:139], a[200:203], v[72:75]
    ds_read_b128 a[172:175], v18 offset:7168
    v_mfma_f32_16x16x32_bf16 v[76:79], a[140:143], a[200:203], v[76:79]
    ds_read_b128 a[176:179], v18 offset:8192
    ds_read_b32 v200, v21 offset:1408
    ds_read_b32 v201, v21 offset:256
    v_mfma_f32_16x16x32_bf16 v[80:83], a[136:139], a[204:207], v[80:83]
    ds_read_b32 v202, v21 offset:1472
    ds_read_b32 v203, v21 offset:320
    v_mfma_f32_16x16x32_bf16 v[84:87], a[140:143], a[204:207], v[84:87]
    buffer_load_dwordx4 v6, s[12:15], s54 offen offset:512 lds
    ds_read_b32 v204, v21 offset:1536
    ds_read_b32 v205, v21 offset:384
    v_mfma_f32_16x16x32_bf16 v[88:91], a[136:139], a[208:211], v[88:91]
    v_mfma_f32_16x16x32_bf16 v[92:95], a[140:143], a[208:211], v[92:95]
    ds_read_b32 v206, v21 offset:1600
    ds_read_b32 v207, v21 offset:448
    v_mfma_f32_16x16x32_bf16 v[96:99], a[136:139], a[212:215], v[96:99]
    ds_read_b32 v208, v21 offset:1664
    ds_read_b32 v209, v21 offset:512
    v_mfma_f32_16x16x32_bf16 v[100:103], a[140:143], a[212:215], v[100:103]
    s_waitcnt lgkmcnt(0)
L4_e1:
    v_pk_fma_f32 v[220:221], v[176:177], v[192:193], v[192:193] op_sel:[0,0,1] op_sel_hi:[1,0,1]
    v_pk_fma_f32 v[222:223], v[178:179], v[192:193], v[192:193] op_sel:[0,0,1] op_sel_hi:[1,0,1]
    v_pk_fma_f32 v[32:33], v[32:33], v[184:185], v[220:221]
    v_pk_fma_f32 v[34:35], v[34:35], v[186:187], v[222:223]
    v_pk_mul_f32 v[216:217], v[32:33], v[32:33]
    v_pk_mul_f32 v[218:219], v[34:35], v[34:35]
    v_pk_fma_f32 v[216:217], v[216:217], v[212:213], v[210:211]
    v_pk_fma_f32 v[218:219], v[218:219], v[212:213], v[210:211]
    v_pk_mul_f32 v[216:217], v[216:217], v[32:33]
    v_pk_mul_f32 v[218:219], v[218:219], v[34:35]
    v_exp_f32 v216, v216
    v_exp_f32 v217, v217
    v_exp_f32 v218, v218
    v_exp_f32 v219, v219
    v_pk_add_f32 v[216:217], v[216:217], v[214:215]
    v_pk_add_f32 v[218:219], v[218:219], v[214:215]
    v_rcp_f32 v216, v216
    v_rcp_f32 v217, v217
    v_rcp_f32 v218, v218
    v_rcp_f32 v219, v219
    v_pk_fma_f32 v[32:33], v[32:33], v[216:217], v[32:33] neg_lo:[1,0,0] neg_hi:[1,0,0]
    v_pk_fma_f32 v[34:35], v[34:35], v[218:219], v[34:35] neg_lo:[1,0,0] neg_hi:[1,0,0]
    v_pk_mul_f32 v[240:241], v[32:33], v[32:33]
    v_pk_mul_f32 v[242:243], v[34:35], v[34:35]
    buffer_load_dwordx4 v6, s[12:15], s54 offen offset:1536 lds
    buffer_load_dwordx4 v6, s[12:15], s54 offen offset:2560 lds
    v_pk_fma_f32 v[228:229], v[180:181], v[192:193], v[192:193] op_sel:[0,0,1] op_sel_hi:[1,0,1]
    v_pk_fma_f32 v[230:231], v[182:183], v[192:193], v[192:193] op_sel:[0,0,1] op_sel_hi:[1,0,1]
    v_pk_fma_f32 v[36:37], v[36:37], v[188:189], v[228:229]
    v_pk_fma_f32 v[38:39], v[38:39], v[190:191], v[230:231]
    v_pk_mul_f32 v[224:225], v[36:37], v[36:37]
    v_pk_mul_f32 v[226:227], v[38:39], v[38:39]
    v_pk_fma_f32 v[224:225], v[224:225], v[212:213], v[210:211]
    v_pk_fma_f32 v[226:227], v[226:227], v[212:213], v[210:211]
    v_pk_mul_f32 v[224:225], v[224:225], v[36:37]
    v_pk_mul_f32 v[226:227], v[226:227], v[38:39]
    v_exp_f32 v224, v224
    v_exp_f32 v225, v225
    v_exp_f32 v226, v226
    v_exp_f32 v227, v227
    v_pk_add_f32 v[224:225], v[224:225], v[214:215]
    v_pk_add_f32 v[226:227], v[226:227], v[214:215]
    v_rcp_f32 v224, v224
    v_rcp_f32 v225, v225
    v_rcp_f32 v226, v226
    v_rcp_f32 v227, v227
    v_pk_fma_f32 v[36:37], v[36:37], v[224:225], v[36:37] neg_lo:[1,0,0] neg_hi:[1,0,0]
    v_pk_fma_f32 v[38:39], v[38:39], v[226:227], v[38:39] neg_lo:[1,0,0] neg_hi:[1,0,0]
    v_pk_mul_f32 v[244:245], v[36:37], v[36:37]
    v_pk_mul_f32 v[246:247], v[38:39], v[38:39]
    buffer_load_dwordx4 v6, s[12:15], s54 offen offset:3584 lds
    s_add_u32 s54, s54, 18432
    s_add_u32 m0, s55, 36864
    s_mov_b64 exec, s[64:65]
    buffer_load_dwordx4 v6, s[12:15], s54 offen lds
    s_mov_b64 exec, -1
    v_pk_fma_f32 v[220:221], v[176:177], v[194:195], v[194:195] op_sel:[0,0,1] op_sel_hi:[1,0,1]
    v_pk_fma_f32 v[222:223], v[178:179], v[194:195], v[194:195] op_sel:[0,0,1] op_sel_hi:[1,0,1]
    v_pk_fma_f32 v[40:41], v[40:41], v[184:185], v[220:221]
    v_pk_fma_f32 v[42:43], v[42:43], v[186:187], v[222:223]
    v_pk_mul_f32 v[216:217], v[40:41], v[40:41]
    v_pk_mul_f32 v[218:219], v[42:43], v[42:43]
    v_pk_fma_f32 v[216:217], v[216:217], v[212:213], v[210:211]
    v_pk_fma_f32 v[218:219], v[218:219], v[212:213], v[210:211]
    v_pk_mul_f32 v[216:217], v[216:217], v[40:41]
    v_pk_mul_f32 v[218:219], v[218:219], v[42:43]
    v_exp_f32 v216, v216
    v_exp_f32 v217, v217
    v_exp_f32 v218, v218
    v_exp_f32 v219, v219
    v_pk_add_f32 v[216:217], v[216:217], v[214:215]
    v_pk_add_f32 v[218:219], v[218:219], v[214:215]
    v_rcp_f32 v216, v216
    v_rcp_f32 v217, v217
    v_rcp_f32 v218, v218
    v_rcp_f32 v219, v219
    v_pk_fma_f32 v[40:41], v[40:41], v[216:217], v[40:41] neg_lo:[1,0,0] neg_hi:[1,0,0]
    v_pk_fma_f32 v[42:43], v[42:43], v[218:219], v[42:43] neg_lo:[1,0,0] neg_hi:[1,0,0]
    v_pk_add_f32 v[232:233], v[32:33], v[40:41]
    v_pk_fma_f32 v[240:241], v[40:41], v[40:41], v[240:241]
    v_pk_add_f32 v[234:235], v[34:35], v[42:43]
    v_pk_fma_f32 v[242:243], v[42:43], v[42:43], v[242:243]
    buffer_load_dwordx4 v6, s[12:15], s54 offen offset:512 lds
    buffer_load_dwordx4 v6, s[12:15], s54 offen offset:1536 lds
    v_pk_fma_f32 v[228:229], v[180:181], v[194:195], v[194:195] op_sel:[0,0,1] op_sel_hi:[1,0,1]
    v_pk_fma_f32 v[230:231], v[182:183], v[194:195], v[194:195] op_sel:[0,0,1] op_sel_hi:[1,0,1]
    v_pk_fma_f32 v[44:45], v[44:45], v[188:189], v[228:229]
    v_pk_fma_f32 v[46:47], v[46:47], v[190:191], v[230:231]
    v_pk_mul_f32 v[224:225], v[44:45], v[44:45]
    v_pk_mul_f32 v[226:227], v[46:47], v[46:47]
    v_pk_fma_f32 v[224:225], v[224:225], v[212:213], v[210:211]
    v_pk_fma_f32 v[226:227], v[226:227], v[212:213], v[210:211]
    v_pk_mul_f32 v[224:225], v[224:225], v[44:45]
    v_pk_mul_f32 v[226:227], v[226:227], v[46:47]
    v_exp_f32 v224, v224
    v_exp_f32 v225, v225
    v_exp_f32 v226, v226
    v_exp_f32 v227, v227
    v_pk_add_f32 v[224:225], v[224:225], v[214:215]
    v_pk_add_f32 v[226:227], v[226:227], v[214:215]
    v_rcp_f32 v224, v224
    v_rcp_f32 v225, v225
    v_rcp_f32 v226, v226
    v_rcp_f32 v227, v227
    v_pk_fma_f32 v[44:45], v[44:45], v[224:225], v[44:45] neg_lo:[1,0,0] neg_hi:[1,0,0]
    v_pk_fma_f32 v[46:47], v[46:47], v[226:227], v[46:47] neg_lo:[1,0,0] neg_hi:[1,0,0]
    v_pk_add_f32 v[236:237], v[36:37], v[44:45]
    v_pk_fma_f32 v[244:245], v[44:45], v[44:45], v[244:245]
    v_pk_add_f32 v[238:239], v[38:39], v[46:47]
    v_pk_fma_f32 v[246:247], v[46:47], v[46:47], v[246:247]
    buffer_load_dwordx4 v6, s[12:15], s54 offen offset:2560 lds
    buffer_load_dwordx4 v6, s[12:15], s54 offen offset:3584 lds
    s_add_u32 s54, s54, 18432
    v_pk_fma_f32 v[220:221], v[176:177], v[196:197], v[196:197] op_sel:[0,0,1] op_sel_hi:[1,0,1]
    v_pk_fma_f32 v[222:223], v[178:179], v[196:197], v[196:197] op_sel:[0,0,1] op_sel_hi:[1,0,1]
    v_pk_fma_f32 v[48:49], v[48:49], v[184:185], v[220:221]
    v_pk_fma_f32 v[50:51], v[50:51], v[186:187], v[222:223]
    v_pk_mul_f32 v[216:217], v[48:49], v[48:49]
    v_pk_mul_f32 v[218:219], v[50:51], v[50:51]
    v_pk_fma_f32 v[216:217], v[216:217], v[212:213], v[210:211]
    v_pk_fma_f32 v[218:219], v[218:219], v[212:213], v[210:211]
    v_pk_mul_f32 v[216:217], v[216:217], v[48:49]
    v_pk_mul_f32 v[218:219], v[218:219], v[50:51]
    v_exp_f32 v216, v216
    v_exp_f32 v217, v217
    v_exp_f32 v218, v218
    v_exp_f32 v219, v219
    v_pk_add_f32 v[216:217], v[216:217], v[214:215]
    v_pk_add_f32 v[218:219], v[218:219], v[214:215]
    v_rcp_f32 v216, v216
    v_rcp_f32 v217, v217
    v_rcp_f32 v218, v218
    v_rcp_f32 v219, v219
    v_pk_fma_f32 v[48:49], v[48:49], v[216:217], v[48:49] neg_lo:[1,0,0] neg_hi:[1,0,0]
    v_pk_fma_f32 v[50:51], v[50:51], v[218:219], v[50:51] neg_lo:[1,0,0] neg_hi:[1,0,0]
    v_pk_add_f32 v[232:233], v[232:233], v[48:49]
    v_pk_fma_f32 v[240:241], v[48:49], v[48:49], v[240:241]
    v_pk_add_f32 v[234:235], v[234:235], v[50:51]
    v_pk_fma_f32 v[242:243], v[50:51], v[50:51], v[242:243]
    s_add_u32 m0, s55, 65536
    s_mov_b64 exec, s[64:65]
    buffer_load_dwordx4 v6, s[12:15], s54 offen lds
    s_mov_b64 exec, -1
    buffer_load_dwordx4 v6, s[12:15], s54 offen offset:512 lds
    v_pk_fma_f32 v[228:229], v[180:181], v[196:197], v[196:197] op_sel:[0,0,1] op_sel_hi:[1,0,1]
    v_pk_fma_f32 v[230:231], v[182:183], v[196:197], v[196:197] op_sel:[0,0,1] op_sel_hi:[1,0,1]
    v_pk_fma_f32 v[52:53], v[52:53], v[188:189], v[228:229]
    v_pk_fma_f32 v[54:55], v[54:55], v[190:191], v[230:231]
    v_pk_mul_f32 v[224:225], v[52:53], v[52:53]
    v_pk_mul_f32 v[226:227], v[54:55], v[54:55]
    v_pk_fma_f32 v[224:225], v[224:225], v[212:213], v[210:211]
    v_pk_fma_f32 v[226:227], v[226:227], v[212:213], v[210:211]
    v_pk_mul_f32 v[224:225], v[224:225], v[52:53]
    v_pk_mul_f32 v[226:227], v[226:227], v[54:55]
    v_exp_f32 v224, v224
    v_exp_f32 v225, v225
    v_exp_f32 v226, v226
    v_exp_f32 v227, v227
    v_pk_add_f32 v[224:225], v[224:225], v[214:215]
    v_pk_add_f32 v[226:227], v[226:227], v[214:215]
    v_rcp_f32 v224, v224
    v_rcp_f32 v225, v225
    v_rcp_f32 v226, v226
    v_rcp_f32 v227, v227
    v_pk_fma_f32 v[52:53], v[52:53], v[224:225], v[52:53] neg_lo:[1,0,0] neg_hi:[1,0,0]
    v_pk_fma_f32 v[54:55], v[54:55], v[226:227], v[54:55] neg_lo:[1,0,0] neg_hi:[1,0,0]
    v_pk_add_f32 v[236:237], v[236:237], v[52:53]
    v_pk_fma_f32 v[244:245], v[52:53], v[52:53], v[244:245]
    v_pk_add_f32 v[238:239], v[238:239], v[54:55]
    v_pk_fma_f32 v[246:247], v[54:55], v[54:55], v[246:247]
    buffer_load_dwordx4 v6, s[12:15], s54 offen offset:1536 lds
    buffer_load_dwordx4 v6, s[12:15], s54 offen offset:2560 lds
    v_pk_fma_f32 v[220:221], v[176:177], v[198:199], v[198:199] op_sel:[0,0,1] op_sel_hi:[1,0,1]
    v_pk_fma_f32 v[222:223], v[178:179], v[198:199], v[198:199] op_sel:[0,0,1] op_sel_hi:[1,0,1]
    v_pk_fma_f32 v[56:57], v[56:57], v[184:185], v[220:221]
    v_pk_fma_f32 v[58:59], v[58:59], v[186:187], v[222:223]
    v_pk_mul_f32 v[216:217], v[56:57], v[56:57]
    v_pk_mul_f32 v[218:219], v[58:59], v[58:59]
    v_pk_fma_f32 v[216:217], v[216:217], v[212:213], v[210:211]
    v_pk_fma_f32 v[218:219], v[218:219], v[212:213], v[210:211]
    v_pk_mul_f32 v[216:217], v[216:217], v[56:57]
    v_pk_mul_f32 v[218:219], v[218:219], v[58:59]
    v_exp_f32 v216, v216
    v_exp_f32 v217, v217
    v_exp_f32 v218, v218
    v_exp_f32 v219, v219
    v_pk_add_f32 v[216:217], v[216:217], v[214:215]
    v_pk_add_f32 v[218:219], v[218:219], v[214:215]
    v_rcp_f32 v216, v216
    v_rcp_f32 v217, v217
    v_rcp_f32 v218, v218
    v_rcp_f32 v219, v219
    v_pk_fma_f32 v[56:57], v[56:57], v[216:217], v[56:57] neg_lo:[1,0,0] neg_hi:[1,0,0]
    v_pk_fma_f32 v[58:59], v[58:59], v[218:219], v[58:59] neg_lo:[1,0,0] neg_hi:[1,0,0]
    v_pk_add_f32 v[232:233], v[232:233], v[56:57]
    v_pk_fma_f32 v[240:241], v[56:57], v[56:57], v[240:241]
    v_pk_add_f32 v[234:235], v[234:235], v[58:59]
    v_pk_fma_f32 v[242:243], v[58:59], v[58:59], v[242:243]
    buffer_load_dwordx4 v6, s[12:15], s54 offen offset:3584 lds
    s_add_u32 s54, s54, 18432
    s_add_u32 m0, s55, 83968
    s_mov_b64 exec, s[64:65]
    buffer_load_dwordx4 v6, s[12:15], s54 offen lds
    s_mov_b64 exec, -1
    v_pk_fma_f32 v[228:229], v[180:181], v[198:199], v[198:199] op_sel:[0,0,1] op_sel_hi:[1,0,1]
    v_pk_fma_f32 v[230:231], v[182:183], v[198:199], v[198:199] op_sel:[0,0,1] op_sel_hi:[1,0,1]
    v_pk_fma_f32 v[60:61], v[60:61], v[188:189], v[228:229]
    v_pk_fma_f32 v[62:63], v[62:63], v[190:191], v[230:231]
    v_pk_mul_f32 v[224:225], v[60:61], v[60:61]
    v_pk_mul_f32 v[226:227], v[62:63], v[62:63]
    v_pk_fma_f32 v[224:225], v[224:225], v[212:213], v[210:211]
    v_pk_fma_f32 v[226:227], v[226:227], v[212:213], v[210:211]
    v_pk_mul_f32 v[224:225], v[224:225], v[60:61]
    v_pk_mul_f32 v[226:227], v[226:227], v[62:63]
    v_exp_f32 v224, v224
    v_exp_f32 v225, v225
    v_exp_f32 v226, v226
    v_exp_f32 v227, v227
    v_pk_add_f32 v[224:225], v[224:225], v[214:215]
    v_pk_add_f32 v[226:227], v[226:227], v[214:215]
    v_rcp_f32 v224, v224
    v_rcp_f32 v225, v225
    v_rcp_f32 v226, v226
    v_rcp_f32 v227, v227
    v_pk_fma_f32 v[60:61], v[60:61], v[224:225], v[60:61] neg_lo:[1,0,0] neg_hi:[1,0,0]
    v_pk_fma_f32 v[62:63], v[62:63], v[226:227], v[62:63] neg_lo:[1,0,0] neg_hi:[1,0,0]
    v_pk_add_f32 v[236:237], v[236:237], v[60:61]
    v_pk_fma_f32 v[244:245], v[60:61], v[60:61], v[244:245]
    v_pk_add_f32 v[238:239], v[238:239], v[62:63]
    v_pk_fma_f32 v[246:247], v[62:63], v[62:63], v[246:247]
    buffer_load_dwordx4 v6, s[12:15], s54 offen offset:512 lds
    buffer_load_dwordx4 v6, s[12:15], s54 offen offset:1536 lds
    v_pk_fma_f32 v[220:221], v[176:177], v[200:201], v[200:201] op_sel:[0,0,1] op_sel_hi:[1,0,1]
    v_pk_fma_f32 v[222:223], v[178:179], v[200:201], v[200:201] op_sel:[0,0,1] op_sel_hi:[1,0,1]
    v_pk_fma_f32 v[64:65], v[64:65], v[184:185], v[220:221]
    v_pk_fma_f32 v[66:67], v[66:67], v[186:187], v[222:223]
    v_pk_mul_f32 v[216:217], v[64:65], v[64:65]
    v_pk_mul_f32 v[218:219], v[66:67], v[66:67]
    v_pk_fma_f32 v[216:217], v[216:217], v[212:213], v[210:211]
    v_pk_fma_f32 v[218:219], v[218:219], v[212:213], v[210:211]
    v_pk_mul_f32 v[216:217], v[216:217], v[64:65]
    v_pk_mul_f32 v[218:219], v[218:219], v[66:67]
    v_exp_f32 v216, v216
    v_exp_f32 v217, v217
    v_exp_f32 v218, v218
    v_exp_f32 v219, v219
    v_pk_add_f32 v[216:217], v[216:217], v[214:215]
    v_pk_add_f32 v[218:219], v[218:219], v[214:215]
    v_rcp_f32 v216, v216
    v_rcp_f32 v217, v217
    v_rcp_f32 v218, v218
    v_rcp_f32 v219, v219
    v_pk_fma_f32 v[64:65], v[64:65], v[216:217], v[64:65] neg_lo:[1,0,0] neg_hi:[1,0,0]
    v_pk_fma_f32 v[66:67], v[66:67], v[218:219], v[66:67] neg_lo:[1,0,0] neg_hi:[1,0,0]
    v_pk_add_f32 v[232:233], v[232:233], v[64:65]
    v_pk_fma_f32 v[240:241], v[64:65], v[64:65], v[240:241]
    v_pk_add_f32 v[234:235], v[234:235], v[66:67]
    v_pk_fma_f32 v[242:243], v[66:67], v[66:67], v[242:243]
    buffer_load_dwordx4 v6, s[12:15], s54 offen offset:2560 lds
    buffer_load_dwordx4 v6, s[12:15], s54 offen offset:3584 lds
    s_add_u32 s54, s54, 18432
    v_pk_fma_f32 v[228:229], v[180:181], v[200:201], v[200:201] op_sel:[0,0,1] op_sel_hi:[1,0,1]
    v_pk_fma_f32 v[230:231], v[182:183], v[200:201], v[200:201] op_sel:[0,0,1] op_sel_hi:[1,0,1]
    v_pk_fma_f32 v[68:69], v[68:69], v[188:189], v[228:229]
    v_pk_fma_f32 v[70:71], v[70:71], v[190:191], v[230:231]
    v_pk_mul_f32 v[224:225], v[68:69], v[68:69]
    v_pk_mul_f32 v[226:227], v[70:71], v[70:71]
    v_pk_fma_f32 v[224:225], v[224:225], v[212:213], v[210:211]
    v_pk_fma_f32 v[226:227], v[226:227], v[212:213], v[210:211]
    v_pk_mul_f32 v[224:225], v[224:225], v[68:69]
    v_pk_mul_f32 v[226:227], v[226:227], v[70:71]
    v_exp_f32 v224, v224
    v_exp_f32 v225, v225
    v_exp_f32 v226, v226
    v_exp_f32 v227, v227
    v_pk_add_f32 v[224:225], v[224:225], v[214:215]
    v_pk_add_f32 v[226:227], v[226:227], v[214:215]
    v_rcp_f32 v224, v224
    v_rcp_f32 v225, v225
    v_rcp_f32 v226, v226
    v_rcp_f32 v227, v227
    v_pk_fma_f32 v[68:69], v[68:69], v[224:225], v[68:69] neg_lo:[1,0,0] neg_hi:[1,0,0]
    v_pk_fma_f32 v[70:71], v[70:71], v[226:227], v[70:71] neg_lo:[1,0,0] neg_hi:[1,0,0]
    v_pk_add_f32 v[236:237], v[236:237], v[68:69]
    v_pk_fma_f32 v[244:245], v[68:69], v[68:69], v[244:245]
    v_pk_add_f32 v[238:239], v[238:239], v[70:71]
    v_pk_fma_f32 v[246:247], v[70:71], v[70:71], v[246:247]
    buffer_load_ushort v28, v25, s[16:19], 0 offen
    buffer_load_ushort v29, v25, s[16:19], 0 offen offset:8
    s_mov_b32 exec_lo, 0xffffffff
    s_mov_b32 exec_hi, 0xffffffff
    buffer_load_dword v31, v23, s[8:11], s47 offen
    s_mov_b64 exec, -1
    v_pk_fma_f32 v[220:221], v[176:177], v[202:203], v[202:203] op_sel:[0,0,1] op_sel_hi:[1,0,1]
    v_pk_fma_f32 v[222:223], v[178:179], v[202:203], v[202:203] op_sel:[0,0,1] op_sel_hi:[1,0,1]
    v_pk_fma_f32 v[72:73], v[72:73], v[184:185], v[220:221]
    v_pk_fma_f32 v[74:75], v[74:75], v[186:187], v[222:223]
    v_pk_mul_f32 v[216:217], v[72:73], v[72:73]
    v_pk_mul_f32 v[218:219], v[74:75], v[74:75]
    v_pk_fma_f32 v[216:217], v[216:217], v[212:213], v[210:211]
    v_pk_fma_f32 v[218:219], v[218:219], v[212:213], v[210:211]
    v_pk_mul_f32 v[216:217], v[216:217], v[72:73]
    v_pk_mul_f32 v[218:219], v[218:219], v[74:75]
    v_exp_f32 v216, v216
    v_exp_f32 v217, v217
    v_exp_f32 v218, v218
    v_exp_f32 v219, v219
    v_pk_add_f32 v[216:217], v[216:217], v[214:215]
    v_pk_add_f32 v[218:219], v[218:219], v[214:215]
    v_rcp_f32 v216, v216
    v_rcp_f32 v217, v217
    v_rcp_f32 v218, v218
    v_rcp_f32 v219, v219
    v_pk_fma_f32 v[72:73], v[72:73], v[216:217], v[72:73] neg_lo:[1,0,0] neg_hi:[1,0,0]
    v_pk_fma_f32 v[74:75], v[74:75], v[218:219], v[74:75] neg_lo:[1,0,0] neg_hi:[1,0,0]
    v_pk_add_f32 v[232:233], v[232:233], v[72:73]
    v_pk_fma_f32 v[240:241], v[72:73], v[72:73], v[240:241]
    v_pk_add_f32 v[234:235], v[234:235], v[74:75]
    v_pk_fma_f32 v[242:243], v[74:75], v[74:75], v[242:243]
    v_pk_fma_f32 v[228:229], v[180:181], v[202:203], v[202:203] op_sel:[0,0,1] op_sel_hi:[1,0,1]
    v_pk_fma_f32 v[230:231], v[182:183], v[202:203], v[202:203] op_sel:[0,0,1] op_sel_hi:[1,0,1]
    v_pk_fma_f32 v[76:77], v[76:77], v[188:189], v[228:229]
    v_pk_fma_f32 v[78:79], v[78:79], v[190:191], v[230:231]
    v_pk_mul_f32 v[224:225], v[76:77], v[76:77]
    v_pk_mul_f32 v[226:227], v[78:79], v[78:79]
    v_pk_fma_f32 v[224:225], v[224:225], v[212:213], v[210:211]
    v_pk_fma_f32 v[226:227], v[226:227], v[212:213], v[210:211]
    v_pk_mul_f32 v[224:225], v[224:225], v[76:77]
    v_pk_mul_f32 v[226:227], v[226:227], v[78:79]
    v_exp_f32 v224, v224
    v_exp_f32 v225, v225
    v_exp_f32 v226, v226
    v_exp_f32 v227, v227
    v_pk_add_f32 v[224:225], v[224:225], v[214:215]
    v_pk_add_f32 v[226:227], v[226:227], v[214:215]
    v_rcp_f32 v224, v224
    v_rcp_f32 v225, v225
    v_rcp_f32 v226, v226
    v_rcp_f32 v227, v227
    v_pk_fma_f32 v[76:77], v[76:77], v[224:225], v[76:77] neg_lo:[1,0,0] neg_hi:[1,0,0]
    v_pk_fma_f32 v[78:79], v[78:79], v[226:227], v[78:79] neg_lo:[1,0,0] neg_hi:[1,0,0]
    v_pk_add_f32 v[236:237], v[236:237], v[76:77]
    v_pk_fma_f32 v[244:245], v[76:77], v[76:77], v[244:245]
    v_pk_add_f32 v[238:239], v[238:239], v[78:79]
    v_pk_fma_f32 v[246:247], v[78:79], v[78:79], v[246:247]
    v_pk_fma_f32 v[220:221], v[176:177], v[204:205], v[204:205] op_sel:[0,0,1] op_sel_hi:[1,0,1]
    v_pk_fma_f32 v[222:223], v[178:179], v[204:205], v[204:205] op_sel:[0,0,1] op_sel_hi:[1,0,1]
    v_pk_fma_f32 v[80:81], v[80:81], v[184:185], v[220:221]
    v_pk_fma_f32 v[82:83], v[82:83], v[186:187], v[222:223]
    v_pk_mul_f32 v[216:217], v[80:81], v[80:81]
    v_pk_mul_f32 v[218:219], v[82:83], v[82:83]
    v_pk_fma_f32 v[216:217], v[216:217], v[212:213], v[210:211]
    v_pk_fma_f32 v[218:219], v[218:219], v[212:213], v[210:211]
    v_pk_mul_f32 v[216:217], v[216:217], v[80:81]
    v_pk_mul_f32 v[218:219], v[218:219], v[82:83]
    v_exp_f32 v216, v216
    v_exp_f32 v217, v217
    v_exp_f32 v218, v218
    v_exp_f32 v219, v219
    v_pk_add_f32 v[216:217], v[216:217], v[214:215]
    v_pk_add_f32 v[218:219], v[218:219], v[214:215]
    v_rcp_f32 v216, v216
    v_rcp_f32 v217, v217
    v_rcp_f32 v218, v218
    v_rcp_f32 v219, v219
    v_pk_fma_f32 v[80:81], v[80:81], v[216:217], v[80:81] neg_lo:[1,0,0] neg_hi:[1,0,0]
    v_pk_fma_f32 v[82:83], v[82:83], v[218:219], v[82:83] neg_lo:[1,0,0] neg_hi:[1,0,0]
    v_pk_add_f32 v[232:233], v[232:233], v[80:81]
    v_pk_fma_f32 v[240:241], v[80:81], v[80:81], v[240:241]
    v_pk_add_f32 v[234:235], v[234:235], v[82:83]
    v_pk_fma_f32 v[242:243], v[82:83], v[82:83], v[242:243]
    v_pk_fma_f32 v[228:229], v[180:181], v[204:205], v[204:205] op_sel:[0,0,1] op_sel_hi:[1,0,1]
    v_pk_fma_f32 v[230:231], v[182:183], v[204:205], v[204:205] op_sel:[0,0,1] op_sel_hi:[1,0,1]
    v_pk_fma_f32 v[84:85], v[84:85], v[188:189], v[228:229]
    v_pk_fma_f32 v[86:87], v[86:87], v[190:191], v[230:231]
    v_pk_mul_f32 v[224:225], v[84:85], v[84:85]
    v_pk_mul_f32 v[226:227], v[86:87], v[86:87]
    v_pk_fma_f32 v[224:225], v[224:225], v[212:213], v[210:211]
    v_pk_fma_f32 v[226:227], v[226:227], v[212:213], v[210:211]
    v_pk_mul_f32 v[224:225], v[224:225], v[84:85]
    v_pk_mul_f32 v[226:227], v[226:227], v[86:87]
    v_exp_f32 v224, v224
    v_exp_f32 v225, v225
    v_exp_f32 v226, v226
    v_exp_f32 v227, v227
    v_pk_add_f32 v[224:225], v[224:225], v[214:215]
    v_pk_add_f32 v[226:227], v[226:227], v[214:215]
    v_rcp_f32 v224, v224
    v_rcp_f32 v225, v225
    v_rcp_f32 v226, v226
    v_rcp_f32 v227, v227
    v_pk_fma_f32 v[84:85], v[84:85], v[224:225], v[84:85] neg_lo:[1,0,0] neg_hi:[1,0,0]
    v_pk_fma_f32 v[86:87], v[86:87], v[226:227], v[86:87] neg_lo:[1,0,0] neg_hi:[1,0,0]
    v_pk_add_f32 v[236:237], v[236:237], v[84:85]
    v_pk_fma_f32 v[244:245], v[84:85], v[84:85], v[244:245]
    v_pk_add_f32 v[238:239], v[238:239], v[86:87]
    v_pk_fma_f32 v[246:247], v[86:87], v[86:87], v[246:247]
    v_pk_fma_f32 v[220:221], v[176:177], v[206:207], v[206:207] op_sel:[0,0,1] op_sel_hi:[1,0,1]
    v_pk_fma_f32 v[222:223], v[178:179], v[206:207], v[206:207] op_sel:[0,0,1] op_sel_hi:[1,0,1]
    v_pk_fma_f32 v[88:89], v[88:89], v[184:185], v[220:221]
    v_pk_fma_f32 v[90:91], v[90:91], v[186:187], v[222:223]
    v_pk_mul_f32 v[216:217], v[88:89], v[88:89]
    v_pk_mul_f32 v[218:219], v[90:91], v[90:91]
    v_pk_fma_f32 v[216:217], v[216:217], v[212:213], v[210:211]
    v_pk_fma_f32 v[218:219], v[218:219], v[212:213], v[210:211]
    v_pk_mul_f32 v[216:217], v[216:217], v[88:89]
    v_pk_mul_f32 v[218:219], v[218:219], v[90:91]
    v_exp_f32 v216, v216
    v_exp_f32 v217, v217
    v_exp_f32 v218, v218
    v_exp_f32 v219, v219
    v_pk_add_f32 v[216:217], v[216:217], v[214:215]
    v_pk_add_f32 v[218:219], v[218:219], v[214:215]
    v_rcp_f32 v216, v216
    v_rcp_f32 v217, v217
    v_rcp_f32 v218, v218
    v_rcp_f32 v219, v219
    v_pk_fma_f32 v[88:89], v[88:89], v[216:217], v[88:89] neg_lo:[1,0,0] neg_hi:[1,0,0]
    v_pk_fma_f32 v[90:91], v[90:91], v[218:219], v[90:91] neg_lo:[1,0,0] neg_hi:[1,0,0]
    v_pk_add_f32 v[232:233], v[232:233], v[88:89]
    v_pk_fma_f32 v[240:241], v[88:89], v[88:89], v[240:241]
    v_pk_add_f32 v[234:235], v[234:235], v[90:91]
    v_pk_fma_f32 v[242:243], v[90:91], v[90:91], v[242:243]
    v_pk_fma_f32 v[228:229], v[180:181], v[206:207], v[206:207] op_sel:[0,0,1] op_sel_hi:[1,0,1]
    v_pk_fma_f32 v[230:231], v[182:183], v[206:207], v[206:207] op_sel:[0,0,1] op_sel_hi:[1,0,1]
    v_pk_fma_f32 v[92:93], v[92:93], v[188:189], v[228:229]
    v_pk_fma_f32 v[94:95], v[94:95], v[190:191], v[230:231]
    v_pk_mul_f32 v[224:225], v[92:93], v[92:93]
    v_pk_mul_f32 v[226:227], v[94:95], v[94:95]
    v_pk_fma_f32 v[224:225], v[224:225], v[212:213], v[210:211]
    v_pk_fma_f32 v[226:227], v[226:227], v[212:213], v[210:211]
    v_pk_mul_f32 v[224:225], v[224:225], v[92:93]
    v_pk_mul_f32 v[226:227], v[226:227], v[94:95]
    v_exp_f32 v224, v224
    v_exp_f32 v225, v225
    v_exp_f32 v226, v226
    v_exp_f32 v227, v227
    v_pk_add_f32 v[224:225], v[224:225], v[214:215]
    v_pk_add_f32 v[226:227], v[226:227], v[214:215]
    v_rcp_f32 v224, v224
    v_rcp_f32 v225, v225
    v_rcp_f32 v226, v226
    v_rcp_f32 v227, v227
    v_pk_fma_f32 v[92:93], v[92:93], v[224:225], v[92:93] neg_lo:[1,0,0] neg_hi:[1,0,0]
    v_pk_fma_f32 v[94:95], v[94:95], v[226:227], v[94:95] neg_lo:[1,0,0] neg_hi:[1,0,0]
    v_pk_add_f32 v[236:237], v[236:237], v[92:93]
    v_pk_fma_f32 v[244:245], v[92:93], v[92:93], v[244:245]
    v_pk_add_f32 v[238:239], v[238:239], v[94:95]
    v_pk_fma_f32 v[246:247], v[94:95], v[94:95], v[246:247]
    v_pk_fma_f32 v[220:221], v[176:177], v[208:209], v[208:209] op_sel:[0,0,1] op_sel_hi:[1,0,1]
    v_pk_fma_f32 v[222:223], v[178:179], v[208:209], v[208:209] op_sel:[0,0,1] op_sel_hi:[1,0,1]
    v_pk_fma_f32 v[96:97], v[96:97], v[184:185], v[220:221]
    v_pk_fma_f32 v[98:99], v[98:99], v[186:187], v[222:223]
    v_pk_mul_f32 v[216:217], v[96:97], v[96:97]
    v_pk_mul_f32 v[218:219], v[98:99], v[98:99]
    v_pk_fma_f32 v[216:217], v[216:217], v[212:213], v[210:211]
    v_pk_fma_f32 v[218:219], v[218:219], v[212:213], v[210:211]
    v_pk_mul_f32 v[216:217], v[216:217], v[96:97]
    v_pk_mul_f32 v[218:219], v[218:219], v[98:99]
    v_exp_f32 v216, v216
    v_exp_f32 v217, v217
    v_exp_f32 v218, v218
    v_exp_f32 v219, v219
    v_pk_add_f32 v[216:217], v[216:217], v[214:215]
    v_pk_add_f32 v[218:219], v[218:219], v[214:215]
    v_rcp_f32 v216, v216
    v_rcp_f32 v217, v217
    v_rcp_f32 v218, v218
    v_rcp_f32 v219, v219
    v_pk_fma_f32 v[96:97], v[96:97], v[216:217], v[96:97] neg_lo:[1,0,0] neg_hi:[1,0,0]
    v_pk_fma_f32 v[98:99], v[98:99], v[218:219], v[98:99] neg_lo:[1,0,0] neg_hi:[1,0,0]
    v_pk_add_f32 v[232:233], v[232:233], v[96:97]
    v_pk_fma_f32 v[240:241], v[96:97], v[96:97], v[240:241]
    v_pk_add_f32 v[234:235], v[234:235], v[98:99]
    v_pk_fma_f32 v[242:243], v[98:99], v[98:99], v[242:243]
    v_pk_fma_f32 v[228:229], v[180:181], v[208:209], v[208:209] op_sel:[0,0,1] op_sel_hi:[1,0,1]
    v_pk_fma_f32 v[230:231], v[182:183], v[208:209], v[208:209] op_sel:[0,0,1] op_sel_hi:[1,0,1]
    v_pk_fma_f32 v[100:101], v[100:101], v[188:189], v[228:229]
    v_pk_fma_f32 v[102:103], v[102:103], v[190:191], v[230:231]
    v_pk_mul_f32 v[224:225], v[100:101], v[100:101]
    v_pk_mul_f32 v[226:227], v[102:103], v[102:103]
    v_pk_fma_f32 v[224:225], v[224:225], v[212:213], v[210:211]
    v_pk_fma_f32 v[226:227], v[226:227], v[212:213], v[210:211]
    v_pk_mul_f32 v[224:225], v[224:225], v[100:101]
    v_pk_mul_f32 v[226:227], v[226:227], v[102:103]
    v_exp_f32 v224, v224
    v_exp_f32 v225, v225
    v_exp_f32 v226, v226
    v_exp_f32 v227, v227
    v_pk_add_f32 v[224:225], v[224:225], v[214:215]
    v_pk_add_f32 v[226:227], v[226:227], v[214:215]
    v_rcp_f32 v224, v224
    v_rcp_f32 v225, v225
    v_rcp_f32 v226, v226
    v_rcp_f32 v227, v227
    v_pk_fma_f32 v[100:101], v[100:101], v[224:225], v[100:101] neg_lo:[1,0,0] neg_hi:[1,0,0]
    v_pk_fma_f32 v[102:103], v[102:103], v[226:227], v[102:103] neg_lo:[1,0,0] neg_hi:[1,0,0]
    v_pk_add_f32 v[236:237], v[236:237], v[100:101]
    v_pk_fma_f32 v[244:245], v[100:101], v[100:101], v[244:245]
    v_pk_add_f32 v[238:239], v[238:239], v[102:103]
    v_pk_fma_f32 v[246:247], v[102:103], v[102:103], v[246:247]
    s_mov_b32 s50, 0xcccccccc
    s_mov_b32 s51, 0xcccccccc
    v_add_f32_dpp v232, v232, v232 row_ror:8 row_mask:0xf bank_mask:0x3
    v_add_f32_dpp v233, v233, v233 row_ror:8 row_mask:0xf bank_mask:0x3
    v_add_f32_dpp v234, v234, v234 row_ror:8 row_mask:0xf bank_mask:0x3
    v_add_f32_dpp v235, v235, v235 row_ror:8 row_mask:0xf bank_mask:0x3
    v_add_f32_dpp v240, v240, v240 row_ror:8 row_mask:0xf bank_mask:0x3
    v_add_f32_dpp v241, v241, v241 row_ror:8 row_mask:0xf bank_mask:0x3
    v_add_f32_dpp v242, v242, v242 row_ror:8 row_mask:0xf bank_mask:0x3
    v_add_f32_dpp v243, v243, v243 row_ror:8 row_mask:0xf bank_mask:0x3
    v_add_f32_dpp v232, v236, v236 row_ror:8 row_mask:0xf bank_mask:0xc
    v_add_f32_dpp v233, v237, v237 row_ror:8 row_mask:0xf bank_mask:0xc
    v_add_f32_dpp v234, v238, v238 row_ror:8 row_mask:0xf bank_mask:0xc
    v_add_f32_dpp v235, v239, v239 row_ror:8 row_mask:0xf bank_mask:0xc
    v_add_f32_dpp v240, v244, v244 row_ror:8 row_mask:0xf bank_mask:0xc
    v_add_f32_dpp v241, v245, v245 row_ror:8 row_mask:0xf bank_mask:0xc
    v_add_f32_dpp v242, v246, v246 row_ror:8 row_mask:0xf bank_mask:0xc
    v_add_f32_dpp v243, v247, v247 row_ror:8 row_mask:0xf bank_mask:0xc
    v_add_f32_dpp v232, v232, v232 row_shl:4 row_mask:0xf bank_mask:0x5
    v_add_f32_dpp v233, v233, v233 row_shl:4 row_mask:0xf bank_mask:0x5
    v_add_f32_dpp v240, v240, v240 row_shl:4 row_mask:0xf bank_mask:0x5
    v_add_f32_dpp v241, v241, v241 row_shl:4 row_mask:0xf bank_mask:0x5
    v_add_f32_dpp v232, v234, v234 row_shr:4 row_mask:0xf bank_mask:0xa
    v_add_f32_dpp v233, v235, v235 row_shr:4 row_mask:0xf bank_mask:0xa
    v_add_f32_dpp v240, v242, v242 row_shr:4 row_mask:0xf bank_mask:0xa
    v_add_f32_dpp v241, v243, v243 row_shr:4 row_mask:0xf bank_mask:0xa
    s_lshl_b32 s48, s44, 12
    s_add_u32 s48, s48, 0x180000
    s_lshl_b32 s49, s29, 8
    s_add_u32 s49, s49, s48
    v_lshlrev_b32 v30, 2, v1
    v_add_f32_dpp v232, v232, v232 quad_perm:[2,3,0,1] row_mask:0xf bank_mask:0xf
    v_add_f32_dpp v233, v233, v233 quad_perm:[2,3,0,1] row_mask:0xf bank_mask:0xf
    v_add_f32_dpp v240, v240, v240 quad_perm:[2,3,0,1] row_mask:0xf bank_mask:0xf
    v_add_f32_dpp v241, v241, v241 quad_perm:[2,3,0,1] row_mask:0xf bank_mask:0xf
    s_nop 0
    v_cndmask_b32 v232, v232, v233, s[50:51]
    v_cndmask_b32 v233, v240, v241, s[50:51]
    s_nop 1
    v_add_f32_dpp v232, v232, v232 quad_perm:[1,0,3,2] row_mask:0xf bank_mask:0xf
    v_add_f32_dpp v233, v233, v233 quad_perm:[1,0,3,2] row_mask:0xf bank_mask:0xf
    s_mov_b32 exec_lo, 0x55555555
    s_mov_b32 exec_hi, 0x55555555
    buffer_store_dwordx2 v[232:233], v30, s[12:15], s49 offen sc1
    s_mov_b64 exec, -1
    v_mfma_f32_16x16x32_bf16 v[104:107], a[144:147], a[0:3], 0
    ds_read_b128 a[180:183], v18 offset:9216
    v_mfma_f32_16x16x32_bf16 v[108:111], a[144:147], a[4:7], 0
    ds_read_b128 a[184:187], v18 offset:10240
    v_mfma_f32_16x16x32_bf16 v[112:115], a[148:151], a[0:3], 0
    ds_read_b128 a[188:191], v18 offset:11264
    v_mfma_f32_16x16x32_bf16 v[116:119], a[148:151], a[4:7], 0
    ds_read_b128 a[192:195], v18 offset:12288
    v_mfma_f32_16x16x32_bf16 v[120:123], a[152:155], a[0:3], 0
    ds_read_b128 a[196:199], v18 offset:13312
    v_mfma_f32_16x16x32_bf16 v[124:127], a[152:155], a[4:7], 0
    ds_read_b128 a[200:203], v18 offset:14336
    v_mfma_f32_16x16x32_bf16 v[128:131], a[156:159], a[0:3], 0
    ds_read_b128 a[204:207], v18 offset:15360
    v_mfma_f32_16x16x32_bf16 v[132:135], a[156:159], a[4:7], 0
    ds_read_b128 a[208:211], v18 offset:16384
    v_mfma_f32_16x16x32_bf16 v[136:139], a[160:163], a[0:3], 0
    ds_read_b128 a[212:215], v18 offset:17408
    v_mfma_f32_16x16x32_bf16 v[140:143], a[160:163], a[4:7], 0
    v_mfma_f32_16x16x32_bf16 v[144:147], a[164:167], a[0:3], 0
    v_mfma_f32_16x16x32_bf16 v[148:151], a[164:167], a[4:7], 0
    v_mfma_f32_16x16x32_bf16 v[152:155], a[168:171], a[0:3], 0
    v_mfma_f32_16x16x32_bf16 v[156:159], a[168:171], a[4:7], 0
    v_mfma_f32_16x16x32_bf16 v[160:163], a[172:175], a[0:3], 0
    v_mfma_f32_16x16x32_bf16 v[164:167], a[172:175], a[4:7], 0
    v_mfma_f32_16x16x32_bf16 v[168:171], a[176:179], a[0:3], 0
    v_mfma_f32_16x16x32_bf16 v[172:175], a[176:179], a[4:7], 0
    s_waitcnt lgkmcnt(0) vmcnt(29)
    s_barrier
    v_mfma_f32_16x16x32_bf16 v[104:107], a[180:183], a[8:11], v[104:107]
    ds_read_b128 a[144:147], v19 offset:0
    s_add_u32 m0, s55, 102400
    v_mfma_f32_16x16x32_bf16 v[108:111], a[180:183], a[12:15], v[108:111]
    s_mov_b64 exec, s[64:65]
    buffer_load_dwordx4 v6, s[12:15], s54 offen lds
    s_mov_b64 exec, -1
    v_mfma_f32_16x16x32_bf16 v[112:115], a[184:187], a[8:11], v[112:115]
    ds_read_b128 a[148:151], v19 offset:1024
    v_mfma_f32_16x16x32_bf16 v[116:119], a[184:187], a[12:15], v[116:119]
    ds_read_b128 a[152:155], v19 offset:2048
    v_mfma_f32_16x16x32_bf16 v[120:123], a[188:191], a[8:11], v[120:123]
    ds_read_b128 a[156:159], v19 offset:3072
    v_mfma_f32_16x16x32_bf16 v[124:127], a[188:191], a[12:15], v[124:127]
    buffer_load_dwordx4 v6, s[12:15], s54 offen offset:512 lds
    v_mfma_f32_16x16x32_bf16 v[128:131], a[192:195], a[8:11], v[128:131]
    ds_read_b128 a[160:163], v19 offset:4096
    v_mfma_f32_16x16x32_bf16 v[132:135], a[192:195], a[12:15], v[132:135]
    ds_read_b128 a[164:167], v19 offset:5120
    v_mfma_f32_16x16x32_bf16 v[136:139], a[196:199], a[8:11], v[136:139]
    ds_read_b128 a[168:171], v19 offset:6144
    v_mfma_f32_16x16x32_bf16 v[140:143], a[196:199], a[12:15], v[140:143]
    buffer_load_dwordx4 v6, s[12:15], s54 offen offset:1536 lds
    v_mfma_f32_16x16x32_bf16 v[144:147], a[200:203], a[8:11], v[144:147]
    ds_read_b128 a[172:175], v19 offset:7168
    v_mfma_f32_16x16x32_bf16 v[148:151], a[200:203], a[12:15], v[148:151]
    ds_read_b128 a[176:179], v19 offset:8192
    v_mfma_f32_16x16x32_bf16 v[152:155], a[204:207], a[8:11], v[152:155]
    v_mfma_f32_16x16x32_bf16 v[156:159], a[204:207], a[12:15], v[156:159]
    buffer_load_dwordx4 v6, s[12:15], s54 offen offset:2560 lds
    v_mfma_f32_16x16x32_bf16 v[160:163], a[208:211], a[8:11], v[160:163]
    v_mfma_f32_16x16x32_bf16 v[164:167], a[208:211], a[12:15], v[164:167]
    v_mfma_f32_16x16x32_bf16 v[168:171], a[212:215], a[8:11], v[168:171]
    v_mfma_f32_16x16x32_bf16 v[172:175], a[212:215], a[12:15], v[172:175]
    s_waitcnt lgkmcnt(0)
    v_mfma_f32_16x16x32_bf16 v[104:107], a[144:147], a[16:19], v[104:107]
    ds_read_b128 a[180:183], v19 offset:9216
    v_mfma_f32_16x16x32_bf16 v[108:111], a[144:147], a[20:23], v[108:111]
    buffer_load_dwordx4 v6, s[12:15], s54 offen offset:3584 lds
    s_add_u32 s54, s54, 18432
    v_mfma_f32_16x16x32_bf16 v[112:115], a[148:151], a[16:19], v[112:115]
    ds_read_b128 a[184:187], v19 offset:10240
    v_mfma_f32_16x16x32_bf16 v[116:119], a[148:151], a[20:23], v[116:119]
    ds_read_b128 a[188:191], v19 offset:11264
    v_mfma_f32_16x16x32_bf16 v[120:123], a[152:155], a[16:19], v[120:123]
    ds_read_b128 a[192:195], v19 offset:12288
    v_mfma_f32_16x16x32_bf16 v[124:127], a[152:155], a[20:23], v[124:127]
    ds_read_b128 a[196:199], v19 offset:13312
    v_mfma_f32_16x16x32_bf16 v[128:131], a[156:159], a[16:19], v[128:131]
    ds_read_b128 a[200:203], v19 offset:14336
    v_mfma_f32_16x16x32_bf16 v[132:135], a[156:159], a[20:23], v[132:135]
    ds_read_b128 a[204:207], v19 offset:15360
    v_mfma_f32_16x16x32_bf16 v[136:139], a[160:163], a[16:19], v[136:139]
    ds_read_b128 a[208:211], v19 offset:16384
    v_mfma_f32_16x16x32_bf16 v[140:143], a[160:163], a[20:23], v[140:143]
    ds_read_b128 a[212:215], v19 offset:17408
    v_mfma_f32_16x16x32_bf16 v[144:147], a[164:167], a[16:19], v[144:147]
    v_mfma_f32_16x16x32_bf16 v[148:151], a[164:167], a[20:23], v[148:151]
    v_mfma_f32_16x16x32_bf16 v[152:155], a[168:171], a[16:19], v[152:155]
    v_mfma_f32_16x16x32_bf16 v[156:159], a[168:171], a[20:23], v[156:159]
    v_mfma_f32_16x16x32_bf16 v[160:163], a[172:175], a[16:19], v[160:163]
    v_mfma_f32_16x16x32_bf16 v[164:167], a[172:175], a[20:23], v[164:167]
    v_mfma_f32_16x16x32_bf16 v[168:171], a[176:179], a[16:19], v[168:171]
    v_mfma_f32_16x16x32_bf16 v[172:175], a[176:179], a[20:23], v[172:175]
    s_waitcnt lgkmcnt(0) vmcnt(29)
    s_barrier
    v_mfma_f32_16x16x32_bf16 v[104:107], a[180:183], a[24:27], v[104:107]
    ds_read_b128 a[144:147], v13 offset:0
    s_add_u32 m0, s55, 120832
    v_mfma_f32_16x16x32_bf16 v[108:111], a[180:183], a[28:31], v[108:111]
    s_mov_b64 exec, s[64:65]
    buffer_load_dwordx4 v6, s[12:15], s54 offen lds
    s_mov_b64 exec, -1
    v_mfma_f32_16x16x32_bf16 v[112:115], a[184:187], a[24:27], v[112:115]
    ds_read_b128 a[148:151], v13 offset:1024
    v_mfma_f32_16x16x32_bf16 v[116:119], a[184:187], a[28:31], v[116:119]
    ds_read_b128 a[152:155], v13 offset:2048
    v_mfma_f32_16x16x32_bf16 v[120:123], a[188:191], a[24:27], v[120:123]
    ds_read_b128 a[156:159], v13 offset:3072
    v_mfma_f32_16x16x32_bf16 v[124:127], a[188:191], a[28:31], v[124:127]
    buffer_load_dwordx4 v6, s[12:15], s54 offen offset:512 lds
    v_mfma_f32_16x16x32_bf16 v[128:131], a[192:195], a[24:27], v[128:131]
    ds_read_b128 a[160:163], v13 offset:4096
    v_mfma_f32_16x16x32_bf16 v[132:135], a[192:195], a[28:31], v[132:135]
    ds_read_b128 a[164:167], v13 offset:5120
    v_mfma_f32_16x16x32_bf16 v[136:139], a[196:199], a[24:27], v[136:139]
    ds_read_b128 a[168:171], v13 offset:6144
    v_mfma_f32_16x16x32_bf16 v[140:143], a[196:199], a[28:31], v[140:143]
    buffer_load_dwordx4 v6, s[12:15], s54 offen offset:1536 lds
    v_mfma_f32_16x16x32_bf16 v[144:147], a[200:203], a[24:27], v[144:147]
    ds_read_b128 a[172:175], v13 offset:7168
    v_mfma_f32_16x16x32_bf16 v[148:151], a[200:203], a[28:31], v[148:151]
    ds_read_b128 a[176:179], v13 offset:8192
    v_mfma_f32_16x16x32_bf16 v[152:155], a[204:207], a[24:27], v[152:155]
    v_mfma_f32_16x16x32_bf16 v[156:159], a[204:207], a[28:31], v[156:159]
    buffer_load_dwordx4 v6, s[12:15], s54 offen offset:2560 lds
    v_mfma_f32_16x16x32_bf16 v[160:163], a[208:211], a[24:27], v[160:163]
    v_mfma_f32_16x16x32_bf16 v[164:167], a[208:211], a[28:31], v[164:167]
    v_mfma_f32_16x16x32_bf16 v[168:171], a[212:215], a[24:27], v[168:171]
    v_mfma_f32_16x16x32_bf16 v[172:175], a[212:215], a[28:31], v[172:175]
    s_waitcnt lgkmcnt(0)
    v_mfma_f32_16x16x32_bf16 v[104:107], a[144:147], a[32:35], v[104:107]
    ds_read_b128 a[180:183], v13 offset:9216
    v_mfma_f32_16x16x32_bf16 v[108:111], a[144:147], a[36:39], v[108:111]
    buffer_load_dwordx4 v6, s[12:15], s54 offen offset:3584 lds
    s_add_u32 s54, s54, 18432
    v_mfma_f32_16x16x32_bf16 v[112:115], a[148:151], a[32:35], v[112:115]
    ds_read_b128 a[184:187], v13 offset:10240
    v_mfma_f32_16x16x32_bf16 v[116:119], a[148:151], a[36:39], v[116:119]
    ds_read_b128 a[188:191], v13 offset:11264
    v_mfma_f32_16x16x32_bf16 v[120:123], a[152:155], a[32:35], v[120:123]
    ds_read_b128 a[192:195], v13 offset:12288
    v_mfma_f32_16x16x32_bf16 v[124:127], a[152:155], a[36:39], v[124:127]
    ds_read_b128 a[196:199], v13 offset:13312
    v_mfma_f32_16x16x32_bf16 v[128:131], a[156:159], a[32:35], v[128:131]
    ds_read_b128 a[200:203], v13 offset:14336
    v_mfma_f32_16x16x32_bf16 v[132:135], a[156:159], a[36:39], v[132:135]
    ds_read_b128 a[204:207], v13 offset:15360
    v_mfma_f32_16x16x32_bf16 v[136:139], a[160:163], a[32:35], v[136:139]
    ds_read_b128 a[208:211], v13 offset:16384
    v_mfma_f32_16x16x32_bf16 v[140:143], a[160:163], a[36:39], v[140:143]
    ds_read_b128 a[212:215], v13 offset:17408
    v_mfma_f32_16x16x32_bf16 v[144:147], a[164:167], a[32:35], v[144:147]
    v_mfma_f32_16x16x32_bf16 v[148:151], a[164:167], a[36:39], v[148:151]
    v_mfma_f32_16x16x32_bf16 v[152:155], a[168:171], a[32:35], v[152:155]
    v_mfma_f32_16x16x32_bf16 v[156:159], a[168:171], a[36:39], v[156:159]
    v_mfma_f32_16x16x32_bf16 v[160:163], a[172:175], a[32:35], v[160:163]
    v_mfma_f32_16x16x32_bf16 v[164:167], a[172:175], a[36:39], v[164:167]
    v_mfma_f32_16x16x32_bf16 v[168:171], a[176:179], a[32:35], v[168:171]
    v_mfma_f32_16x16x32_bf16 v[172:175], a[176:179], a[36:39], v[172:175]
    s_waitcnt lgkmcnt(0) vmcnt(29)
    s_barrier
    v_mfma_f32_16x16x32_bf16 v[104:107], a[180:183], a[40:43], v[104:107]
    ds_read_b128 a[144:147], v14 offset:0
    v_mfma_f32_16x16x32_bf16 v[108:111], a[180:183], a[44:47], v[108:111]
    ds_read_b128 a[148:151], v14 offset:1024
    v_mfma_f32_16x16x32_bf16 v[112:115], a[184:187], a[40:43], v[112:115]
    ds_read_b128 a[152:155], v14 offset:2048
    v_mfma_f32_16x16x32_bf16 v[116:119], a[184:187], a[44:47], v[116:119]
    ds_read_b128 a[156:159], v14 offset:3072
    v_mfma_f32_16x16x32_bf16 v[120:123], a[188:191], a[40:43], v[120:123]
    ds_read_b128 a[160:163], v14 offset:4096
    v_mfma_f32_16x16x32_bf16 v[124:127], a[188:191], a[44:47], v[124:127]
    ds_read_b128 a[164:167], v14 offset:5120
    v_mfma_f32_16x16x32_bf16 v[128:131], a[192:195], a[40:43], v[128:131]
    ds_read_b128 a[168:171], v14 offset:6144
    v_mfma_f32_16x16x32_bf16 v[132:135], a[192:195], a[44:47], v[132:135]
    ds_read_b128 a[172:175], v14 offset:7168
    v_mfma_f32_16x16x32_bf16 v[136:139], a[196:199], a[40:43], v[136:139]
    ds_read_b128 a[176:179], v14 offset:8192
    v_mfma_f32_16x16x32_bf16 v[140:143], a[196:199], a[44:47], v[140:143]
    v_mfma_f32_16x16x32_bf16 v[144:147], a[200:203], a[40:43], v[144:147]
    v_mfma_f32_16x16x32_bf16 v[148:151], a[200:203], a[44:47], v[148:151]
    v_mfma_f32_16x16x32_bf16 v[152:155], a[204:207], a[40:43], v[152:155]
    v_mfma_f32_16x16x32_bf16 v[156:159], a[204:207], a[44:47], v[156:159]
    v_mfma_f32_16x16x32_bf16 v[160:163], a[208:211], a[40:43], v[160:163]
    v_mfma_f32_16x16x32_bf16 v[164:167], a[208:211], a[44:47], v[164:167]
    v_mfma_f32_16x16x32_bf16 v[168:171], a[212:215], a[40:43], v[168:171]
    v_mfma_f32_16x16x32_bf16 v[172:175], a[212:215], a[44:47], v[172:175]
    s_waitcnt lgkmcnt(0)
    v_mfma_f32_16x16x32_bf16 v[104:107], a[144:147], a[48:51], v[104:107]
    ds_read_b128 a[180:183], v14 offset:9216
    v_mfma_f32_16x16x32_bf16 v[108:111], a[144:147], a[52:55], v[108:111]
    buffer_load_dwordx4 v[232:235], v6, s[12:15], s48 offen offset:0 sc1
    v_mfma_f32_16x16x32_bf16 v[112:115], a[148:151], a[48:51], v[112:115]
    ds_read_b128 a[184:187], v14 offset:10240
    v_mfma_f32_16x16x32_bf16 v[116:119], a[148:151], a[52:55], v[116:119]
    ds_read_b128 a[188:191], v14 offset:11264
    v_mfma_f32_16x16x32_bf16 v[120:123], a[152:155], a[48:51], v[120:123]
    ds_read_b128 a[192:195], v14 offset:12288
    v_mfma_f32_16x16x32_bf16 v[124:127], a[152:155], a[52:55], v[124:127]
    buffer_load_dwordx4 v[236:239], v6, s[12:15], s48 offen offset:1024 sc1
    v_mfma_f32_16x16x32_bf16 v[128:131], a[156:159], a[48:51], v[128:131]
    ds_read_b128 a[196:199], v14 offset:13312
    v_mfma_f32_16x16x32_bf16 v[132:135], a[156:159], a[52:55], v[132:135]
    ds_read_b128 a[200:203], v14 offset:14336
    v_mfma_f32_16x16x32_bf16 v[136:139], a[160:163], a[48:51], v[136:139]
    ds_read_b128 a[204:207], v14 offset:15360
    v_mfma_f32_16x16x32_bf16 v[140:143], a[160:163], a[52:55], v[140:143]
    buffer_load_dwordx4 v[240:243], v6, s[12:15], s48 offen offset:2048 sc1
    v_mfma_f32_16x16x32_bf16 v[144:147], a[164:167], a[48:51], v[144:147]
    ds_read_b128 a[208:211], v14 offset:16384
    v_mfma_f32_16x16x32_bf16 v[148:151], a[164:167], a[52:55], v[148:151]
    ds_read_b128 a[212:215], v14 offset:17408
    v_mfma_f32_16x16x32_bf16 v[152:155], a[168:171], a[48:51], v[152:155]
    v_mfma_f32_16x16x32_bf16 v[156:159], a[168:171], a[52:55], v[156:159]
    buffer_load_dwordx4 v[244:247], v6, s[12:15], s48 offen offset:3072 sc1
    v_mfma_f32_16x16x32_bf16 v[160:163], a[172:175], a[48:51], v[160:163]
    v_mfma_f32_16x16x32_bf16 v[164:167], a[172:175], a[52:55], v[164:167]
    v_mfma_f32_16x16x32_bf16 v[168:171], a[176:179], a[48:51], v[168:171]
    v_mfma_f32_16x16x32_bf16 v[172:175], a[176:179], a[52:55], v[172:175]
    s_waitcnt lgkmcnt(0) vmcnt(28)
    s_barrier
    v_mfma_f32_16x16x32_bf16 v[104:107], a[180:183], a[56:59], v[104:107]
    ds_read_b128 a[144:147], v15 offset:0
    v_mfma_f32_16x16x32_bf16 v[108:111], a[180:183], a[60:63], v[108:111]
    ds_read_b128 a[148:151], v15 offset:1024
    v_mfma_f32_16x16x32_bf16 v[112:115], a[184:187], a[56:59], v[112:115]
    ds_read_b128 a[152:155], v15 offset:2048
    v_mfma_f32_16x16x32_bf16 v[116:119], a[184:187], a[60:63], v[116:119]
    ds_read_b128 a[156:159], v15 offset:3072
    v_mfma_f32_16x16x32_bf16 v[120:123], a[188:191], a[56:59], v[120:123]
    ds_read_b128 a[160:163], v15 offset:4096
    v_mfma_f32_16x16x32_bf16 v[124:127], a[188:191], a[60:63], v[124:127]
    ds_read_b128 a[164:167], v15 offset:5120
    v_mfma_f32_16x16x32_bf16 v[128:131], a[192:195], a[56:59], v[128:131]
    ds_read_b128 a[168:171], v15 offset:6144
    v_mfma_f32_16x16x32_bf16 v[132:135], a[192:195], a[60:63], v[132:135]
    ds_read_b128 a[172:175], v15 offset:7168
    v_mfma_f32_16x16x32_bf16 v[136:139], a[196:199], a[56:59], v[136:139]
    ds_read_b128 a[176:179], v15 offset:8192
    v_mfma_f32_16x16x32_bf16 v[140:143], a[196:199], a[60:63], v[140:143]
    v_mfma_f32_16x16x32_bf16 v[144:147], a[200:203], a[56:59], v[144:147]
    v_mfma_f32_16x16x32_bf16 v[148:151], a[200:203], a[60:63], v[148:151]
    v_mfma_f32_16x16x32_bf16 v[152:155], a[204:207], a[56:59], v[152:155]
    v_mfma_f32_16x16x32_bf16 v[156:159], a[204:207], a[60:63], v[156:159]
    v_mfma_f32_16x16x32_bf16 v[160:163], a[208:211], a[56:59], v[160:163]
    v_mfma_f32_16x16x32_bf16 v[164:167], a[208:211], a[60:63], v[164:167]
    v_mfma_f32_16x16x32_bf16 v[168:171], a[212:215], a[56:59], v[168:171]
    v_mfma_f32_16x16x32_bf16 v[172:175], a[212:215], a[60:63], v[172:175]
    s_waitcnt lgkmcnt(0)
    s_mov_b32 s43, 0x8000
    s_lshl_b32 s50, s29, 6
    s_add_u32 s50, s50, s44
    s_mul_i32 s50, s50, 9216
    s_add_u32 s50, s50, 0x1800000
    s_add_u32 s51, s50, 4096
    s_add_u32 s52, s50, 8192
    v_and_b32 v30, 1, v22
    v_lshl_add_u32 v30, v24, 1, v30
    v_lshl_add_u32 v21, v30, 2, s45
    s_waitcnt vmcnt(0)
    s_branch L4_p1
L4_poll:
    s_sleep 4
    buffer_load_dwordx4 v[232:235], v6, s[12:15], s48 offen offset:0 sc1
    buffer_load_dwordx4 v[236:239], v6, s[12:15], s48 offen offset:1024 sc1
    buffer_load_dwordx4 v[240:243], v6, s[12:15], s48 offen offset:2048 sc1
    buffer_load_dwordx4 v[244:247], v6, s[12:15], s48 offen offset:3072 sc1
    s_waitcnt vmcnt(0)
L4_p1:
    v_max3_u32 v30, v232, v233, v234
    v_max3_u32 v31, v235, v236, v237
    v_max3_u32 v30, v30, v238, v239
    v_max3_u32 v31, v31, v240, v241
    v_max3_u32 v30, v30, v242, v243
    v_max3_u32 v31, v31, v244, v245
    v_max3_u32 v30, v30, v246, v247
    v_max_u32 v30, v30, v31
    v_cmp_eq_u32 vcc, -1, v30
    s_sub_u32 s43, s43, 1
    s_cmp_eq_u32 s43, 0
    s_cbranch_vccz L4_got
    s_cbranch_scc0 L4_poll
L4_got:
    v_pk_add_f32 v[232:233], v[232:233], v[236:237]
    v_pk_add_f32 v[240:241], v[240:241], v[244:245]
    v_pk_add_f32 v[234:235], v[234:235], v[238:239]
    v_pk_add_f32 v[242:243], v[242:243], v[246:247]
    v_pk_add_f32 v[232:233], v[232:233], v[240:241]
    v_pk_add_f32 v[234:235], v[234:235], v[242:243]
    s_nop 1
    v_permlane16_swap_b32 v232, v234
    v_permlane16_swap_b32 v233, v235
    s_nop 1
    v_pk_add_f32 v[232:233], v[232:233], v[234:235]
    v_mov_b32 v234, v232
    v_mov_b32 v235, v233
    s_nop 1
    v_permlane32_swap_b32 v232, v234
    v_permlane32_swap_b32 v233, v235
    s_nop 1
    v_add_f32 v232, v232, v234
    v_add_f32 v233, v233, v235
    v_mul_f32 v232, 0x39e38e39, v232
    v_mul_f32 v233, 0x39e38e39, v233
    v_fma_f32 v233, -v232, v232, v233
    v_max_f32 v233, 0, v233
    v_cvt_pk_bf16_f32 v233, v233, v233
    v_lshlrev_b32 v233, 16, v233
    v_cvt_pk_bf16_f32 v232, v232, v232
    v_lshlrev_b32 v232, 16, v232
    v_add_f32 v233, 0x3727c5ac, v233
    v_cvt_pk_bf16_f32 v233, v233, v233
    v_lshlrev_b32 v233, 16, v233
    v_sqrt_f32 v233, v233
    s_nop 0
    v_cvt_pk_bf16_f32 v233, v233, v233
    v_lshlrev_b32 v233, 16, v233
    v_rcp_f32 v233, v233
    s_nop 0
    v_mul_f32 v232, -v232, v233
    ds_write2_b32 v21, v232, v233 offset0:64 offset1:96
    s_waitcnt lgkmcnt(0)
    ds_read_b128 v[216:219], v20 offset:256
    ds_read_b128 v[220:223], v20 offset:272
    ds_read_b128 v[224:227], v20 offset:384
    ds_read_b128 v[228:231], v20 offset:400
    s_waitcnt lgkmcnt(0)
    v_pk_fma_f32 v[32:33], v[32:33], v[224:225], v[216:217]
    v_pk_fma_f32 v[34:35], v[34:35], v[226:227], v[218:219]
    v_cvt_pk_bf16_f32 v248, v32, v33
    v_cvt_pk_bf16_f32 v249, v34, v35
    v_pk_fma_f32 v[36:37], v[36:37], v[228:229], v[220:221]
    v_pk_fma_f32 v[38:39], v[38:39], v[230:231], v[222:223]
    v_cvt_pk_bf16_f32 v250, v36, v37
    v_cvt_pk_bf16_f32 v251, v38, v39
    buffer_store_dwordx4 v[248:251], v6, s[12:15], s50 offen offset:0 sc1
    v_pk_fma_f32 v[40:41], v[40:41], v[224:225], v[216:217]
    v_pk_fma_f32 v[42:43], v[42:43], v[226:227], v[218:219]
    v_cvt_pk_bf16_f32 v252, v40, v41
    v_cvt_pk_bf16_f32 v253, v42, v43
    v_pk_fma_f32 v[44:45], v[44:45], v[228:229], v[220:221]
    v_pk_fma_f32 v[46:47], v[46:47], v[230:231], v[222:223]
    v_cvt_pk_bf16_f32 v254, v44, v45
    v_cvt_pk_bf16_f32 v255, v46, v47
    buffer_store_dwordx4 v[252:255], v6, s[12:15], s50 offen offset:1024 sc1
    v_pk_fma_f32 v[48:49], v[48:49], v[224:225], v[216:217]
    v_pk_fma_f32 v[50:51], v[50:51], v[226:227], v[218:219]
    v_cvt_pk_bf16_f32 v248, v48, v49
    v_cvt_pk_bf16_f32 v249, v50, v51
    v_pk_fma_f32 v[52:53], v[52:53], v[228:229], v[220:221]
    v_pk_fma_f32 v[54:55], v[54:55], v[230:231], v[222:223]
    v_cvt_pk_bf16_f32 v250, v52, v53
    v_cvt_pk_bf16_f32 v251, v54, v55
    buffer_store_dwordx4 v[248:251], v6, s[12:15], s50 offen offset:2048 sc1
    v_pk_fma_f32 v[56:57], v[56:57], v[224:225], v[216:217]
    v_pk_fma_f32 v[58:59], v[58:59], v[226:227], v[218:219]
    v_cvt_pk_bf16_f32 v252, v56, v57
    v_cvt_pk_bf16_f32 v253, v58, v59
    v_pk_fma_f32 v[60:61], v[60:61], v[228:229], v[220:221]
    v_pk_fma_f32 v[62:63], v[62:63], v[230:231], v[222:223]
    v_cvt_pk_bf16_f32 v254, v60, v61
    v_cvt_pk_bf16_f32 v255, v62, v63
    buffer_store_dwordx4 v[252:255], v6, s[12:15], s50 offen offset:3072 sc1
    v_pk_fma_f32 v[64:65], v[64:65], v[224:225], v[216:217]
    v_pk_fma_f32 v[66:67], v[66:67], v[226:227], v[218:219]
    v_cvt_pk_bf16_f32 v248, v64, v65
    v_cvt_pk_bf16_f32 v249, v66, v67
    v_pk_fma_f32 v[68:69], v[68:69], v[228:229], v[220:221]
    v_pk_fma_f32 v[70:71], v[70:71], v[230:231], v[222:223]
    v_cvt_pk_bf16_f32 v250, v68, v69
    v_cvt_pk_bf16_f32 v251, v70, v71
    buffer_store_dwordx4 v[248:251], v6, s[12:15], s51 offen offset:0 sc1
    v_pk_fma_f32 v[72:73], v[72:73], v[224:225], v[216:217]
    v_pk_fma_f32 v[74:75], v[74:75], v[226:227], v[218:219]
    v_cvt_pk_bf16_f32 v252, v72, v73
    v_cvt_pk_bf16_f32 v253, v74, v75
    v_pk_fma_f32 v[76:77], v[76:77], v[228:229], v[220:221]
    v_pk_fma_f32 v[78:79], v[78:79], v[230:231], v[222:223]
    v_cvt_pk_bf16_f32 v254, v76, v77
    v_cvt_pk_bf16_f32 v255, v78, v79
    buffer_store_dwordx4 v[252:255], v6, s[12:15], s51 offen offset:1024 sc1
    v_pk_fma_f32 v[80:81], v[80:81], v[224:225], v[216:217]
    v_pk_fma_f32 v[82:83], v[82:83], v[226:227], v[218:219]
    v_cvt_pk_bf16_f32 v248, v80, v81
    v_cvt_pk_bf16_f32 v249, v82, v83
    v_pk_fma_f32 v[84:85], v[84:85], v[228:229], v[220:221]
    v_pk_fma_f32 v[86:87], v[86:87], v[230:231], v[222:223]
    v_cvt_pk_bf16_f32 v250, v84, v85
    v_cvt_pk_bf16_f32 v251, v86, v87
    buffer_store_dwordx4 v[248:251], v6, s[12:15], s51 offen offset:2048 sc1
    v_pk_fma_f32 v[88:89], v[88:89], v[224:225], v[216:217]
    v_pk_fma_f32 v[90:91], v[90:91], v[226:227], v[218:219]
    v_cvt_pk_bf16_f32 v252, v88, v89
    v_cvt_pk_bf16_f32 v253, v90, v91
    v_pk_fma_f32 v[92:93], v[92:93], v[228:229], v[220:221]
    v_pk_fma_f32 v[94:95], v[94:95], v[230:231], v[222:223]
    v_cvt_pk_bf16_f32 v254, v92, v93
    v_cvt_pk_bf16_f32 v255, v94, v95
    buffer_store_dwordx4 v[252:255], v6, s[12:15], s51 offen offset:3072 sc1
    v_pk_fma_f32 v[96:97], v[96:97], v[224:225], v[216:217]
    v_pk_fma_f32 v[98:99], v[98:99], v[226:227], v[218:219]
    v_cvt_pk_bf16_f32 v248, v96, v97
    v_cvt_pk_bf16_f32 v249, v98, v99
    v_pk_fma_f32 v[100:101], v[100:101], v[228:229], v[220:221]
    v_pk_fma_f32 v[102:103], v[102:103], v[230:231], v[222:223]
    v_cvt_pk_bf16_f32 v250, v100, v101
    v_cvt_pk_bf16_f32 v251, v102, v103
    buffer_store_dwordx4 v[248:251], v6, s[12:15], s52 offen offset:0 sc1
    s_lshl_b32 s48, s29, 11
    s_add_u32 s48, s48, 0x1c0000
    s_lshl_b32 s49, s28, 7
    s_add_u32 s49, s49, s48
    v_lshlrev_b32 v21, 7, v1
    v_mov_b32 v23, 0
    v_lshlrev_b32 v28, 16, v28
    v_lshlrev_b32 v29, 16, v29
    v_mfma_f32_16x16x32_bf16 v[104:107], a[144:147], a[64:67], v[104:107]
    ds_read_b128 a[180:183], v15 offset:9216
    v_mov_b32 v32, v28
    v_mfma_f32_16x16x32_bf16 v[108:111], a[144:147], a[68:71], v[108:111]
    ds_read_b128 a[184:187], v15 offset:10240
    v_mfma_f32_16x16x32_bf16 v[112:115], a[148:151], a[64:67], v[112:115]
    ds_read_b128 a[188:191], v15 offset:11264
    v_mov_b32 v33, v28
    v_mfma_f32_16x16x32_bf16 v[116:119], a[148:151], a[68:71], v[116:119]
    ds_read_b128 a[192:195], v15 offset:12288
    v_mfma_f32_16x16x32_bf16 v[120:123], a[152:155], a[64:67], v[120:123]
    ds_read_b128 a[196:199], v15 offset:13312
    v_mov_b32 v34, v28
    v_mfma_f32_16x16x32_bf16 v[124:127], a[152:155], a[68:71], v[124:127]
    ds_read_b128 a[200:203], v15 offset:14336
    v_mfma_f32_16x16x32_bf16 v[128:131], a[156:159], a[64:67], v[128:131]
    ds_read_b128 a[204:207], v15 offset:15360
    v_mov_b32 v35, v28
    v_mfma_f32_16x16x32_bf16 v[132:135], a[156:159], a[68:71], v[132:135]
    ds_read_b128 a[208:211], v15 offset:16384
    v_mfma_f32_16x16x32_bf16 v[136:139], a[160:163], a[64:67], v[136:139]
    ds_read_b128 a[212:215], v15 offset:17408
    v_mov_b32 v36, v29
    v_mfma_f32_16x16x32_bf16 v[140:143], a[160:163], a[68:71], v[140:143]
    v_mfma_f32_16x16x32_bf16 v[144:147], a[164:167], a[64:67], v[144:147]
    v_mov_b32 v37, v29
    v_mfma_f32_16x16x32_bf16 v[148:151], a[164:167], a[68:71], v[148:151]
    v_mfma_f32_16x16x32_bf16 v[152:155], a[168:171], a[64:67], v[152:155]
    v_mov_b32 v38, v29
    v_mfma_f32_16x16x32_bf16 v[156:159], a[168:171], a[68:71], v[156:159]
    v_mfma_f32_16x16x32_bf16 v[160:163], a[172:175], a[64:67], v[160:163]
    v_mov_b32 v39, v29
    v_mfma_f32_16x16x32_bf16 v[164:167], a[172:175], a[68:71], v[164:167]
    v_mfma_f32_16x16x32_bf16 v[168:171], a[176:179], a[64:67], v[168:171]
    v_mov_b32 v40, v28
    v_mfma_f32_16x16x32_bf16 v[172:175], a[176:179], a[68:71], v[172:175]
    s_waitcnt lgkmcnt(0) vmcnt(32)
    s_barrier
    v_mfma_f32_16x16x32_bf16 v[104:107], a[180:183], a[72:75], v[104:107]
    ds_read_b128 a[144:147], v16 offset:0
    v_mov_b32 v41, v28
    v_mfma_f32_16x16x32_bf16 v[108:111], a[180:183], a[76:79], v[108:111]
    ds_read_b128 a[148:151], v16 offset:1024
    v_mfma_f32_16x16x32_bf16 v[112:115], a[184:187], a[72:75], v[112:115]
    ds_read_b128 a[152:155], v16 offset:2048
    v_mov_b32 v42, v28
    v_mfma_f32_16x16x32_bf16 v[116:119], a[184:187], a[76:79], v[116:119]
    ds_read_b128 a[156:159], v16 offset:3072
    v_mfma_f32_16x16x32_bf16 v[120:123], a[188:191], a[72:75], v[120:123]
    ds_read_b128 a[160:163], v16 offset:4096
    v_mov_b32 v43, v28
    v_mfma_f32_16x16x32_bf16 v[124:127], a[188:191], a[76:79], v[124:127]
    ds_read_b128 a[164:167], v16 offset:5120
    v_mfma_f32_16x16x32_bf16 v[128:131], a[192:195], a[72:75], v[128:131]
    ds_read_b128 a[168:171], v16 offset:6144
    v_mov_b32 v44, v29
    v_mfma_f32_16x16x32_bf16 v[132:135], a[192:195], a[76:79], v[132:135]
    ds_read_b128 a[172:175], v16 offset:7168
    v_mfma_f32_16x16x32_bf16 v[136:139], a[196:199], a[72:75], v[136:139]
    ds_read_b128 a[176:179], v16 offset:8192
    v_mov_b32 v45, v29
    v_mfma_f32_16x16x32_bf16 v[140:143], a[196:199], a[76:79], v[140:143]
    v_mfma_f32_16x16x32_bf16 v[144:147], a[200:203], a[72:75], v[144:147]
    v_mov_b32 v46, v29
    v_mfma_f32_16x16x32_bf16 v[148:151], a[200:203], a[76:79], v[148:151]
    v_mfma_f32_16x16x32_bf16 v[152:155], a[204:207], a[72:75], v[152:155]
    v_mov_b32 v47, v29
    v_mfma_f32_16x16x32_bf16 v[156:159], a[204:207], a[76:79], v[156:159]
    v_mfma_f32_16x16x32_bf16 v[160:163], a[208:211], a[72:75], v[160:163]
    v_mov_b32 v48, v28
    v_mfma_f32_16x16x32_bf16 v[164:167], a[208:211], a[76:79], v[164:167]
    v_mfma_f32_16x16x32_bf16 v[168:171], a[212:215], a[72:75], v[168:171]
    v_mov_b32 v49, v28
    v_mfma_f32_16x16x32_bf16 v[172:175], a[212:215], a[76:79], v[172:175]
    s_waitcnt lgkmcnt(0)
    v_mfma_f32_16x16x32_bf16 v[104:107], a[144:147], a[80:83], v[104:107]
    ds_read_b128 a[180:183], v16 offset:9216
    v_mov_b32 v50, v28
    v_mfma_f32_16x16x32_bf16 v[108:111], a[144:147], a[84:87], v[108:111]
    ds_read_b128 a[184:187], v16 offset:10240
    v_mfma_f32_16x16x32_bf16 v[112:115], a[148:151], a[80:83], v[112:115]
    ds_read_b128 a[188:191], v16 offset:11264
    v_mov_b32 v51, v28
    v_mfma_f32_16x16x32_bf16 v[116:119], a[148:151], a[84:87], v[116:119]
    ds_read_b128 a[192:195], v16 offset:12288
    v_mfma_f32_16x16x32_bf16 v[120:123], a[152:155], a[80:83], v[120:123]
    ds_read_b128 a[196:199], v16 offset:13312
    v_mov_b32 v52, v29
    v_mfma_f32_16x16x32_bf16 v[124:127], a[152:155], a[84:87], v[124:127]
    ds_read_b128 a[200:203], v16 offset:14336
    v_mfma_f32_16x16x32_bf16 v[128:131], a[156:159], a[80:83], v[128:131]
    ds_read_b128 a[204:207], v16 offset:15360
    v_mov_b32 v53, v29
    v_mfma_f32_16x16x32_bf16 v[132:135], a[156:159], a[84:87], v[132:135]
    ds_read_b128 a[208:211], v16 offset:16384
    v_mfma_f32_16x16x32_bf16 v[136:139], a[160:163], a[80:83], v[136:139]
    ds_read_b128 a[212:215], v16 offset:17408
    v_mov_b32 v54, v29
    v_mfma_f32_16x16x32_bf16 v[140:143], a[160:163], a[84:87], v[140:143]
    v_mfma_f32_16x16x32_bf16 v[144:147], a[164:167], a[80:83], v[144:147]
    v_mov_b32 v55, v29
    v_mfma_f32_16x16x32_bf16 v[148:151], a[164:167], a[84:87], v[148:151]
    v_mfma_f32_16x16x32_bf16 v[152:155], a[168:171], a[80:83], v[152:155]
    v_mov_b32 v56, v28
    v_mfma_f32_16x16x32_bf16 v[156:159], a[168:171], a[84:87], v[156:159]
    v_mfma_f32_16x16x32_bf16 v[160:163], a[172:175], a[80:83], v[160:163]
    v_mov_b32 v57, v28
    v_mfma_f32_16x16x32_bf16 v[164:167], a[172:175], a[84:87], v[164:167]
    v_mfma_f32_16x16x32_bf16 v[168:171], a[176:179], a[80:83], v[168:171]
    v_mov_b32 v58, v28
    v_mfma_f32_16x16x32_bf16 v[172:175], a[176:179], a[84:87], v[172:175]
    s_waitcnt lgkmcnt(0) vmcnt(27)
    s_barrier
    v_mfma_f32_16x16x32_bf16 v[104:107], a[180:183], a[88:91], v[104:107]
    ds_read_b128 a[144:147], v17 offset:0
    v_mov_b32 v59, v28
    v_mfma_f32_16x16x32_bf16 v[108:111], a[180:183], a[92:95], v[108:111]
    ds_read_b128 a[148:151], v17 offset:1024
    v_mfma_f32_16x16x32_bf16 v[112:115], a[184:187], a[88:91], v[112:115]
    ds_read_b128 a[152:155], v17 offset:2048
    v_mov_b32 v60, v29
    v_mfma_f32_16x16x32_bf16 v[116:119], a[184:187], a[92:95], v[116:119]
    ds_read_b128 a[156:159], v17 offset:3072
    v_mfma_f32_16x16x32_bf16 v[120:123], a[188:191], a[88:91], v[120:123]
    ds_read_b128 a[160:163], v17 offset:4096
    v_mov_b32 v61, v29
    v_mfma_f32_16x16x32_bf16 v[124:127], a[188:191], a[92:95], v[124:127]
    ds_read_b128 a[164:167], v17 offset:5120
    v_mfma_f32_16x16x32_bf16 v[128:131], a[192:195], a[88:91], v[128:131]
    ds_read_b128 a[168:171], v17 offset:6144
    v_mov_b32 v62, v29
    v_mfma_f32_16x16x32_bf16 v[132:135], a[192:195], a[92:95], v[132:135]
    ds_read_b128 a[172:175], v17 offset:7168
    v_mfma_f32_16x16x32_bf16 v[136:139], a[196:199], a[88:91], v[136:139]
    ds_read_b128 a[176:179], v17 offset:8192
    v_mov_b32 v63, v29
    v_mfma_f32_16x16x32_bf16 v[140:143], a[196:199], a[92:95], v[140:143]
    v_mfma_f32_16x16x32_bf16 v[144:147], a[200:203], a[88:91], v[144:147]
    v_mov_b32 v64, v28
    v_mfma_f32_16x16x32_bf16 v[148:151], a[200:203], a[92:95], v[148:151]
    v_mfma_f32_16x16x32_bf16 v[152:155], a[204:207], a[88:91], v[152:155]
    v_mov_b32 v65, v28
    v_mfma_f32_16x16x32_bf16 v[156:159], a[204:207], a[92:95], v[156:159]
    v_mfma_f32_16x16x32_bf16 v[160:163], a[208:211], a[88:91], v[160:163]
    v_mov_b32 v66, v28
    v_mfma_f32_16x16x32_bf16 v[164:167], a[208:211], a[92:95], v[164:167]
    v_mfma_f32_16x16x32_bf16 v[168:171], a[212:215], a[88:91], v[168:171]
    v_mov_b32 v67, v28
    v_mfma_f32_16x16x32_bf16 v[172:175], a[212:215], a[92:95], v[172:175]
    s_waitcnt lgkmcnt(0)
    v_mfma_f32_16x16x32_bf16 v[104:107], a[144:147], a[96:99], v[104:107]
    ds_read_b128 a[180:183], v17 offset:9216
    v_mov_b32 v68, v29
    v_mfma_f32_16x16x32_bf16 v[108:111], a[144:147], a[100:103], v[108:111]
    ds_read_b128 a[184:187], v17 offset:10240
    v_mfma_f32_16x16x32_bf16 v[112:115], a[148:151], a[96:99], v[112:115]
    ds_read_b128 a[188:191], v17 offset:11264
    v_mov_b32 v69, v29
    v_mfma_f32_16x16x32_bf16 v[116:119], a[148:151], a[100:103], v[116:119]
    ds_read_b128 a[192:195], v17 offset:12288
    v_mfma_f32_16x16x32_bf16 v[120:123], a[152:155], a[96:99], v[120:123]
    ds_read_b128 a[196:199], v17 offset:13312
    v_mov_b32 v70, v29
    v_mfma_f32_16x16x32_bf16 v[124:127], a[152:155], a[100:103], v[124:127]
    ds_read_b128 a[200:203], v17 offset:14336
    v_mfma_f32_16x16x32_bf16 v[128:131], a[156:159], a[96:99], v[128:131]
    ds_read_b128 a[204:207], v17 offset:15360
    v_mov_b32 v71, v29
    v_mfma_f32_16x16x32_bf16 v[132:135], a[156:159], a[100:103], v[132:135]
    ds_read_b128 a[208:211], v17 offset:16384
    v_mfma_f32_16x16x32_bf16 v[136:139], a[160:163], a[96:99], v[136:139]
    ds_read_b128 a[212:215], v17 offset:17408
    v_mov_b32 v72, v28
    v_mfma_f32_16x16x32_bf16 v[140:143], a[160:163], a[100:103], v[140:143]
    v_mfma_f32_16x16x32_bf16 v[144:147], a[164:167], a[96:99], v[144:147]
    v_mov_b32 v73, v28
    v_mfma_f32_16x16x32_bf16 v[148:151], a[164:167], a[100:103], v[148:151]
    v_mfma_f32_16x16x32_bf16 v[152:155], a[168:171], a[96:99], v[152:155]
    v_mov_b32 v74, v28
    v_mfma_f32_16x16x32_bf16 v[156:159], a[168:171], a[100:103], v[156:159]
    v_mfma_f32_16x16x32_bf16 v[160:163], a[172:175], a[96:99], v[160:163]
    v_mov_b32 v75, v28
    v_mfma_f32_16x16x32_bf16 v[164:167], a[172:175], a[100:103], v[164:167]
    v_mfma_f32_16x16x32_bf16 v[168:171], a[176:179], a[96:99], v[168:171]
    v_mov_b32 v76, v29
    v_mfma_f32_16x16x32_bf16 v[172:175], a[176:179], a[100:103], v[172:175]
    s_waitcnt lgkmcnt(0) vmcnt(18)
    s_barrier
    v_mfma_f32_16x16x32_bf16 v[104:107], a[180:183], a[104:107], v[104:107]
    ds_read_b128 a[144:147], v18 offset:0
    v_mov_b32 v77, v29
    v_mfma_f32_16x16x32_bf16 v[108:111], a[180:183], a[108:111], v[108:111]
    ds_read_b128 a[148:151], v18 offset:1024
    v_mfma_f32_16x16x32_bf16 v[112:115], a[184:187], a[104:107], v[112:115]
    ds_read_b128 a[152:155], v18 offset:2048
    v_mov_b32 v78, v29
    v_mfma_f32_16x16x32_bf16 v[116:119], a[184:187], a[108:111], v[116:119]
    ds_read_b128 a[156:159], v18 offset:3072
    v_mfma_f32_16x16x32_bf16 v[120:123], a[188:191], a[104:107], v[120:123]
    ds_read_b128 a[160:163], v18 offset:4096
    v_mov_b32 v79, v29
    v_mfma_f32_16x16x32_bf16 v[124:127], a[188:191], a[108:111], v[124:127]
    ds_read_b128 a[164:167], v18 offset:5120
    v_mfma_f32_16x16x32_bf16 v[128:131], a[192:195], a[104:107], v[128:131]
    ds_read_b128 a[168:171], v18 offset:6144
    v_mov_b32 v80, v28
    v_mfma_f32_16x16x32_bf16 v[132:135], a[192:195], a[108:111], v[132:135]
    ds_read_b128 a[172:175], v18 offset:7168
    v_mfma_f32_16x16x32_bf16 v[136:139], a[196:199], a[104:107], v[136:139]
    ds_read_b128 a[176:179], v18 offset:8192
    v_mov_b32 v81, v28
    v_mfma_f32_16x16x32_bf16 v[140:143], a[196:199], a[108:111], v[140:143]
    v_mfma_f32_16x16x32_bf16 v[144:147], a[200:203], a[104:107], v[144:147]
    v_mov_b32 v82, v28
    v_mfma_f32_16x16x32_bf16 v[148:151], a[200:203], a[108:111], v[148:151]
    v_mfma_f32_16x16x32_bf16 v[152:155], a[204:207], a[104:107], v[152:155]
    v_mov_b32 v83, v28
    v_mfma_f32_16x16x32_bf16 v[156:159], a[204:207], a[108:111], v[156:159]
    v_mfma_f32_16x16x32_bf16 v[160:163], a[208:211], a[104:107], v[160:163]
    v_mov_b32 v84, v29
    v_mfma_f32_16x16x32_bf16 v[164:167], a[208:211], a[108:111], v[164:167]
    v_mfma_f32_16x16x32_bf16 v[168:171], a[212:215], a[104:107], v[168:171]
    v_mov_b32 v85, v29
    v_mfma_f32_16x16x32_bf16 v[172:175], a[212:215], a[108:111], v[172:175]
    s_waitcnt lgkmcnt(0)
    v_mfma_f32_16x16x32_bf16 v[104:107], a[144:147], a[112:115], v[104:107]
    ds_read_b128 a[180:183], v18 offset:9216
    v_mov_b32 v86, v29
    v_mfma_f32_16x16x32_bf16 v[108:111], a[144:147], a[116:119], v[108:111]
    ds_read_b128 a[184:187], v18 offset:10240
    v_mfma_f32_16x16x32_bf16 v[112:115], a[148:151], a[112:115], v[112:115]
    ds_read_b128 a[188:191], v18 offset:11264
    v_mov_b32 v87, v29
    v_mfma_f32_16x16x32_bf16 v[116:119], a[148:151], a[116:119], v[116:119]
    ds_read_b128 a[192:195], v18 offset:12288
    v_mfma_f32_16x16x32_bf16 v[120:123], a[152:155], a[112:115], v[120:123]
    ds_read_b128 a[196:199], v18 offset:13312
    v_mov_b32 v88, v28
    v_mfma_f32_16x16x32_bf16 v[124:127], a[152:155], a[116:119], v[124:127]
    ds_read_b128 a[200:203], v18 offset:14336
    v_mfma_f32_16x16x32_bf16 v[128:131], a[156:159], a[112:115], v[128:131]
    ds_read_b128 a[204:207], v18 offset:15360
    v_mov_b32 v89, v28
    v_mfma_f32_16x16x32_bf16 v[132:135], a[156:159], a[116:119], v[132:135]
    ds_read_b128 a[208:211], v18 offset:16384
    v_mfma_f32_16x16x32_bf16 v[136:139], a[160:163], a[112:115], v[136:139]
    ds_read_b128 a[212:215], v18 offset:17408
    v_mov_b32 v90, v28
    v_mfma_f32_16x16x32_bf16 v[140:143], a[160:163], a[116:119], v[140:143]
    v_mfma_f32_16x16x32_bf16 v[144:147], a[164:167], a[112:115], v[144:147]
    v_mov_b32 v91, v28
    v_mfma_f32_16x16x32_bf16 v[148:151], a[164:167], a[116:119], v[148:151]
    v_mfma_f32_16x16x32_bf16 v[152:155], a[168:171], a[112:115], v[152:155]
    v_mov_b32 v92, v29
    v_mfma_f32_16x16x32_bf16 v[156:159], a[168:171], a[116:119], v[156:159]
    v_mfma_f32_16x16x32_bf16 v[160:163], a[172:175], a[112:115], v[160:163]
    v_mov_b32 v93, v29
    v_mfma_f32_16x16x32_bf16 v[164:167], a[172:175], a[116:119], v[164:167]
    v_mfma_f32_16x16x32_bf16 v[168:171], a[176:179], a[112:115], v[168:171]
    v_mov_b32 v94, v29
    v_mfma_f32_16x16x32_bf16 v[172:175], a[176:179], a[116:119], v[172:175]
    s_waitcnt lgkmcnt(0) vmcnt(13)
    s_barrier
    v_mfma_f32_16x16x32_bf16 v[104:107], a[180:183], a[120:123], v[104:107]
    ds_read_b128 a[144:147], v19 offset:0
    v_mov_b32 v95, v29
    v_mfma_f32_16x16x32_bf16 v[108:111], a[180:183], a[124:127], v[108:111]
    ds_read_b128 a[148:151], v19 offset:1024
    v_mfma_f32_16x16x32_bf16 v[112:115], a[184:187], a[120:123], v[112:115]
    ds_read_b128 a[152:155], v19 offset:2048
    v_mov_b32 v96, v28
    v_mfma_f32_16x16x32_bf16 v[116:119], a[184:187], a[124:127], v[116:119]
    ds_read_b128 a[156:159], v19 offset:3072
    v_mfma_f32_16x16x32_bf16 v[120:123], a[188:191], a[120:123], v[120:123]
    ds_read_b128 a[160:163], v19 offset:4096
    v_mov_b32 v97, v28
    v_mfma_f32_16x16x32_bf16 v[124:127], a[188:191], a[124:127], v[124:127]
    ds_read_b128 a[164:167], v19 offset:5120
    v_mfma_f32_16x16x32_bf16 v[128:131], a[192:195], a[120:123], v[128:131]
    ds_read_b128 a[168:171], v19 offset:6144
    v_mov_b32 v98, v28
    v_mfma_f32_16x16x32_bf16 v[132:135], a[192:195], a[124:127], v[132:135]
    ds_read_b128 a[172:175], v19 offset:7168
    v_mfma_f32_16x16x32_bf16 v[136:139], a[196:199], a[120:123], v[136:139]
    ds_read_b128 a[176:179], v19 offset:8192
    v_mov_b32 v99, v28
    v_mfma_f32_16x16x32_bf16 v[140:143], a[196:199], a[124:127], v[140:143]
    v_mfma_f32_16x16x32_bf16 v[144:147], a[200:203], a[120:123], v[144:147]
    v_mov_b32 v100, v29
    v_mfma_f32_16x16x32_bf16 v[148:151], a[200:203], a[124:127], v[148:151]
    v_mfma_f32_16x16x32_bf16 v[152:155], a[204:207], a[120:123], v[152:155]
    v_mov_b32 v101, v29
    v_mfma_f32_16x16x32_bf16 v[156:159], a[204:207], a[124:127], v[156:159]
    v_mfma_f32_16x16x32_bf16 v[160:163], a[208:211], a[120:123], v[160:163]
    v_mov_b32 v102, v29
    v_mfma_f32_16x16x32_bf16 v[164:167], a[208:211], a[124:127], v[164:167]
    v_mfma_f32_16x16x32_bf16 v[168:171], a[212:215], a[120:123], v[168:171]
    v_mov_b32 v103, v29
    v_mfma_f32_16x16x32_bf16 v[172:175], a[212:215], a[124:127], v[172:175]
    s_waitcnt lgkmcnt(0)
    v_mfma_f32_16x16x32_bf16 v[104:107], a[144:147], a[128:131], v[104:107]
    ds_read_b128 a[180:183], v19 offset:9216
    v_mfma_f32_16x16x32_bf16 v[108:111], a[144:147], a[132:135], v[108:111]
    ds_read_b128 a[184:187], v19 offset:10240
    v_mfma_f32_16x16x32_bf16 v[112:115], a[148:151], a[128:131], v[112:115]
    ds_read_b128 a[188:191], v19 offset:11264
    v_mfma_f32_16x16x32_bf16 v[116:119], a[148:151], a[132:135], v[116:119]
    ds_read_b128 a[192:195], v19 offset:12288
    v_mfma_f32_16x16x32_bf16 v[120:123], a[152:155], a[128:131], v[120:123]
    ds_read_b128 a[196:199], v19 offset:13312
    v_mfma_f32_16x16x32_bf16 v[124:127], a[152:155], a[132:135], v[124:127]
    ds_read_b128 a[200:203], v19 offset:14336
    v_mfma_f32_16x16x32_bf16 v[128:131], a[156:159], a[128:131], v[128:131]
    ds_read_b128 a[204:207], v19 offset:15360
    v_mfma_f32_16x16x32_bf16 v[132:135], a[156:159], a[132:135], v[132:135]
    ds_read_b128 a[208:211], v19 offset:16384
    v_mfma_f32_16x16x32_bf16 v[136:139], a[160:163], a[128:131], v[136:139]
    ds_read_b128 a[212:215], v19 offset:17408
    v_mfma_f32_16x16x32_bf16 v[140:143], a[160:163], a[132:135], v[140:143]
    v_mfma_f32_16x16x32_bf16 v[144:147], a[164:167], a[128:131], v[144:147]
    v_mfma_f32_16x16x32_bf16 v[148:151], a[164:167], a[132:135], v[148:151]
    v_mfma_f32_16x16x32_bf16 v[152:155], a[168:171], a[128:131], v[152:155]
    v_mfma_f32_16x16x32_bf16 v[156:159], a[168:171], a[132:135], v[156:159]
    v_mfma_f32_16x16x32_bf16 v[160:163], a[172:175], a[128:131], v[160:163]
    v_mfma_f32_16x16x32_bf16 v[164:167], a[172:175], a[132:135], v[164:167]
    v_mfma_f32_16x16x32_bf16 v[168:171], a[176:179], a[128:131], v[168:171]
    v_mfma_f32_16x16x32_bf16 v[172:175], a[176:179], a[132:135], v[172:175]
    s_waitcnt lgkmcnt(0) vmcnt(0)
    s_barrier
    s_cmp_lg_u32 s30, 0
    s_cbranch_scc1 LB_z_s
    s_mov_b64 exec, 1
    buffer_store_dword v23, v23, s[12:15], s49 offen sc1
    s_mov_b64 exec, -1
LB_z_s:
    v_mfma_f32_16x16x32_bf16 v[104:107], a[180:183], a[136:139], v[104:107]
    ds_read2_b32 v[176:177], v26 offset0:0 offset1:32
    v_mfma_f32_16x16x32_bf16 v[108:111], a[180:183], a[140:143], v[108:111]
    ds_read2_b32 v[178:179], v26 offset0:4 offset1:36
    v_mfma_f32_16x16x32_bf16 v[112:115], a[184:187], a[136:139], v[112:115]
    v_mfma_f32_16x16x32_bf16 v[116:119], a[184:187], a[140:143], v[116:119]
    v_mfma_f32_16x16x32_bf16 v[120:123], a[188:191], a[136:139], v[120:123]
    v_mfma_f32_16x16x32_bf16 v[124:127], a[188:191], a[140:143], v[124:127]
    v_mfma_f32_16x16x32_bf16 v[128:131], a[192:195], a[136:139], v[128:131]
    v_mfma_f32_16x16x32_bf16 v[132:135], a[192:195], a[140:143], v[132:135]
    v_mfma_f32_16x16x32_bf16 v[136:139], a[196:199], a[136:139], v[136:139]
    v_mfma_f32_16x16x32_bf16 v[140:143], a[196:199], a[140:143], v[140:143]
    v_mfma_f32_16x16x32_bf16 v[144:147], a[200:203], a[136:139], v[144:147]
    v_mfma_f32_16x16x32_bf16 v[148:151], a[200:203], a[140:143], v[148:151]
    v_mfma_f32_16x16x32_bf16 v[152:155], a[204:207], a[136:139], v[152:155]
    v_mfma_f32_16x16x32_bf16 v[156:159], a[204:207], a[140:143], v[156:159]
    v_mfma_f32_16x16x32_bf16 v[160:163], a[208:211], a[136:139], v[160:163]
    v_mfma_f32_16x16x32_bf16 v[164:167], a[208:211], a[140:143], v[164:167]
    v_mfma_f32_16x16x32_bf16 v[168:171], a[212:215], a[136:139], v[168:171]
    v_mfma_f32_16x16x32_bf16 v[172:175], a[212:215], a[140:143], v[172:175]
    s_waitcnt lgkmcnt(0)
    ds_read_b128 v[192:195], v27 offset:1152
    ds_read_b128 v[196:199], v27 offset:0
    v_add_u32 v9, 16384, v8
    v_add_u32 v13, 16384, v12
    v_add_u32 v10, 32768, v8
    v_add_u32 v14, 32768, v12
    v_add_u32 v11, 49152, v8
    v_add_u32 v15, 49152, v12
    ds_read_b128 v[200:203], v27 offset:1216
    ds_read_b128 v[204:207], v27 offset:64
    s_waitcnt lgkmcnt(2)
    v_pk_fma_f32 v[220:221], v[192:193], v[176:177], v[196:197] op_sel:[0,0,0] op_sel_hi:[1,0,1]
    v_pk_fma_f32 v[222:223], v[194:195], v[176:177], v[198:199] op_sel:[0,0,0] op_sel_hi:[1,0,1]
    v_pk_fma_f32 v[104:105], v[104:105], v[176:177], v[220:221] op_sel:[0,1,0] op_sel_hi:[1,1,1]
    v_pk_fma_f32 v[106:107], v[106:107], v[176:177], v[222:223] op_sel:[0,1,0] op_sel_hi:[1,1,1]
    v_pk_mul_f32 v[216:217], v[104:105], v[104:105]
    v_pk_mul_f32 v[218:219], v[106:107], v[106:107]
    v_pk_fma_f32 v[216:217], v[216:217], v[212:213], v[210:211]
    v_pk_fma_f32 v[218:219], v[218:219], v[212:213], v[210:211]
    v_pk_mul_f32 v[216:217], v[216:217], v[104:105]
    v_pk_mul_f32 v[218:219], v[218:219], v[106:107]
    v_exp_f32 v216, v216
    v_exp_f32 v217, v217
    v_exp_f32 v218, v218
    v_exp_f32 v219, v219
    v_pk_add_f32 v[216:217], v[216:217], v[214:215]
    v_pk_add_f32 v[218:219], v[218:219], v[214:215]
    v_rcp_f32 v216, v216
    v_rcp_f32 v217, v217
    v_rcp_f32 v218, v218
    v_rcp_f32 v219, v219
    v_pk_fma_f32 v[104:105], v[104:105], v[216:217], v[104:105] neg_lo:[1,0,0] neg_hi:[1,0,0]
    v_pk_fma_f32 v[106:107], v[106:107], v[218:219], v[106:107] neg_lo:[1,0,0] neg_hi:[1,0,0]
    s_add_u32 m0, s33, 0
    s_add_u32 s31, s38, s56
    buffer_load_dwordx4 v2, s[8:11], s31 offen offset:0 lds
    buffer_load_dwordx4 v3, s[8:11], s31 offen offset:1024 lds
    v_pk_fma_f32 v[228:229], v[192:193], v[178:179], v[196:197] op_sel:[0,0,0] op_sel_hi:[1,0,1]
    v_pk_fma_f32 v[230:231], v[194:195], v[178:179], v[198:199] op_sel:[0,0,0] op_sel_hi:[1,0,1]
    v_pk_fma_f32 v[108:109], v[108:109], v[178:179], v[228:229] op_sel:[0,1,0] op_sel_hi:[1,1,1]
    v_pk_fma_f32 v[110:111], v[110:111], v[178:179], v[230:231] op_sel:[0,1,0] op_sel_hi:[1,1,1]
    v_pk_mul_f32 v[224:225], v[108:109], v[108:109]
    v_pk_mul_f32 v[226:227], v[110:111], v[110:111]
    v_pk_fma_f32 v[224:225], v[224:225], v[212:213], v[210:211]
    v_pk_fma_f32 v[226:227], v[226:227], v[212:213], v[210:211]
    v_pk_mul_f32 v[224:225], v[224:225], v[108:109]
    v_pk_mul_f32 v[226:227], v[226:227], v[110:111]
    v_exp_f32 v224, v224
    v_exp_f32 v225, v225
    v_exp_f32 v226, v226
    v_exp_f32 v227, v227
    v_pk_add_f32 v[224:225], v[224:225], v[214:215]
    v_pk_add_f32 v[226:227], v[226:227], v[214:215]
    v_rcp_f32 v224, v224
    v_rcp_f32 v225, v225
    v_rcp_f32 v226, v226
    v_rcp_f32 v227, v227
    v_pk_fma_f32 v[108:109], v[108:109], v[224:225], v[108:109] neg_lo:[1,0,0] neg_hi:[1,0,0]
    v_pk_fma_f32 v[110:111], v[110:111], v[226:227], v[110:111] neg_lo:[1,0,0] neg_hi:[1,0,0]
    buffer_load_dwordx4 v4, s[8:11], s31 offen offset:2048 lds
    buffer_load_dwordx4 v5, s[8:11], s31 offen offset:3072 lds
    ds_read_b128 v[192:195], v27 offset:1280
    ds_read_b128 v[196:199], v27 offset:128
    s_waitcnt lgkmcnt(2)
    v_pk_fma_f32 v[220:221], v[200:201], v[176:177], v[204:205] op_sel:[0,0,0] op_sel_hi:[1,0,1]
    v_pk_fma_f32 v[222:223], v[202:203], v[176:177], v[206:207] op_sel:[0,0,0] op_sel_hi:[1,0,1]
    v_pk_fma_f32 v[112:113], v[112:113], v[176:177], v[220:221] op_sel:[0,1,0] op_sel_hi:[1,1,1]
    v_pk_fma_f32 v[114:115], v[114:115], v[176:177], v[222:223] op_sel:[0,1,0] op_sel_hi:[1,1,1]
    v_pk_mul_f32 v[216:217], v[112:113], v[112:113]
    v_pk_mul_f32 v[218:219], v[114:115], v[114:115]
    v_pk_fma_f32 v[216:217], v[216:217], v[212:213], v[210:211]
    v_pk_fma_f32 v[218:219], v[218:219], v[212:213], v[210:211]
    v_pk_mul_f32 v[216:217], v[216:217], v[112:113]
    v_pk_mul_f32 v[218:219], v[218:219], v[114:115]
    v_exp_f32 v216, v216
    v_exp_f32 v217, v217
    v_exp_f32 v218, v218
    v_exp_f32 v219, v219
    v_pk_add_f32 v[216:217], v[216:217], v[214:215]
    v_pk_add_f32 v[218:219], v[218:219], v[214:215]
    v_rcp_f32 v216, v216
    v_rcp_f32 v217, v217
    v_rcp_f32 v218, v218
    v_rcp_f32 v219, v219
    v_pk_fma_f32 v[112:113], v[112:113], v[216:217], v[112:113] neg_lo:[1,0,0] neg_hi:[1,0,0]
    v_pk_fma_f32 v[114:115], v[114:115], v[218:219], v[114:115] neg_lo:[1,0,0] neg_hi:[1,0,0]
    s_add_u32 m0, s33, 16384
    s_add_u32 s31, s38, s57
    buffer_load_dwordx4 v2, s[8:11], s31 offen offset:0 lds
    buffer_load_dwordx4 v3, s[8:11], s31 offen offset:1024 lds
    v_pk_fma_f32 v[228:229], v[200:201], v[178:179], v[204:205] op_sel:[0,0,0] op_sel_hi:[1,0,1]
    v_pk_fma_f32 v[230:231], v[202:203], v[178:179], v[206:207] op_sel:[0,0,0] op_sel_hi:[1,0,1]
    v_pk_fma_f32 v[116:117], v[116:117], v[178:179], v[228:229] op_sel:[0,1,0] op_sel_hi:[1,1,1]
    v_pk_fma_f32 v[118:119], v[118:119], v[178:179], v[230:231] op_sel:[0,1,0] op_sel_hi:[1,1,1]
    v_pk_mul_f32 v[224:225], v[116:117], v[116:117]
    v_pk_mul_f32 v[226:227], v[118:119], v[118:119]
    v_pk_fma_f32 v[224:225], v[224:225], v[212:213], v[210:211]
    v_pk_fma_f32 v[226:227], v[226:227], v[212:213], v[210:211]
    v_pk_mul_f32 v[224:225], v[224:225], v[116:117]
    v_pk_mul_f32 v[226:227], v[226:227], v[118:119]
    v_exp_f32 v224, v224
    v_exp_f32 v225, v225
    v_exp_f32 v226, v226
    v_exp_f32 v227, v227
    v_pk_add_f32 v[224:225], v[224:225], v[214:215]
    v_pk_add_f32 v[226:227], v[226:227], v[214:215]
    v_rcp_f32 v224, v224
    v_rcp_f32 v225, v225
    v_rcp_f32 v226, v226
    v_rcp_f32 v227, v227
    v_pk_fma_f32 v[116:117], v[116:117], v[224:225], v[116:117] neg_lo:[1,0,0] neg_hi:[1,0,0]
    v_pk_fma_f32 v[118:119], v[118:119], v[226:227], v[118:119] neg_lo:[1,0,0] neg_hi:[1,0,0]
    buffer_load_dwordx4 v4, s[8:11], s31 offen offset:2048 lds
    buffer_load_dwordx4 v5, s[8:11], s31 offen offset:3072 lds
    ds_read_b128 v[200:203], v27 offset:1344
    ds_read_b128 v[204:207], v27 offset:192
    s_waitcnt lgkmcnt(2)
    v_pk_fma_f32 v[220:221], v[192:193], v[176:177], v[196:197] op_sel:[0,0,0] op_sel_hi:[1,0,1]
    v_pk_fma_f32 v[222:223], v[194:195], v[176:177], v[198:199] op_sel:[0,0,0] op_sel_hi:[1,0,1]
    v_pk_fma_f32 v[120:121], v[120:121], v[176:177], v[220:221] op_sel:[0,1,0] op_sel_hi:[1,1,1]
    v_pk_fma_f32 v[122:123], v[122:123], v[176:177], v[222:223] op_sel:[0,1,0] op_sel_hi:[1,1,1]
    v_pk_mul_f32 v[216:217], v[120:121], v[120:121]
    v_pk_mul_f32 v[218:219], v[122:123], v[122:123]
    v_pk_fma_f32 v[216:217], v[216:217], v[212:213], v[210:211]
    v_pk_fma_f32 v[218:219], v[218:219], v[212:213], v[210:211]
    v_pk_mul_f32 v[216:217], v[216:217], v[120:121]
    v_pk_mul_f32 v[218:219], v[218:219], v[122:123]
    v_exp_f32 v216, v216
    v_exp_f32 v217, v217
    v_exp_f32 v218, v218
    v_exp_f32 v219, v219
    v_pk_add_f32 v[216:217], v[216:217], v[214:215]
    v_pk_add_f32 v[218:219], v[218:219], v[214:215]
    v_rcp_f32 v216, v216
    v_rcp_f32 v217, v217
    v_rcp_f32 v218, v218
    v_rcp_f32 v219, v219
    v_pk_fma_f32 v[120:121], v[120:121], v[216:217], v[120:121] neg_lo:[1,0,0] neg_hi:[1,0,0]
    v_pk_fma_f32 v[122:123], v[122:123], v[218:219], v[122:123] neg_lo:[1,0,0] neg_hi:[1,0,0]
    s_add_u32 m0, s33, 32768
    s_add_u32 s31, s38, s58
    buffer_load_dwordx4 v2, s[8:11], s31 offen offset:0 lds
    buffer_load_dwordx4 v3, s[8:11], s31 offen offset:1024 lds
    v_pk_fma_f32 v[228:229], v[192:193], v[178:179], v[196:197] op_sel:[0,0,0] op_sel_hi:[1,0,1]
    v_pk_fma_f32 v[230:231], v[194:195], v[178:179], v[198:199] op_sel:[0,0,0] op_sel_hi:[1,0,1]
    v_pk_fma_f32 v[124:125], v[124:125], v[178:179], v[228:229] op_sel:[0,1,0] op_sel_hi:[1,1,1]
    v_pk_fma_f32 v[126:127], v[126:127], v[178:179], v[230:231] op_sel:[0,1,0] op_sel_hi:[1,1,1]
    v_pk_mul_f32 v[224:225], v[124:125], v[124:125]
    v_pk_mul_f32 v[226:227], v[126:127], v[126:127]
    v_pk_fma_f32 v[224:225], v[224:225], v[212:213], v[210:211]
    v_pk_fma_f32 v[226:227], v[226:227], v[212:213], v[210:211]
    v_pk_mul_f32 v[224:225], v[224:225], v[124:125]
    v_pk_mul_f32 v[226:227], v[226:227], v[126:127]
    v_exp_f32 v224, v224
    v_exp_f32 v225, v225
    v_exp_f32 v226, v226
    v_exp_f32 v227, v227
    v_pk_add_f32 v[224:225], v[224:225], v[214:215]
    v_pk_add_f32 v[226:227], v[226:227], v[214:215]
    v_rcp_f32 v224, v224
    v_rcp_f32 v225, v225
    v_rcp_f32 v226, v226
    v_rcp_f32 v227, v227
    v_pk_fma_f32 v[124:125], v[124:125], v[224:225], v[124:125] neg_lo:[1,0,0] neg_hi:[1,0,0]
    v_pk_fma_f32 v[126:127], v[126:127], v[226:227], v[126:127] neg_lo:[1,0,0] neg_hi:[1,0,0]
    buffer_load_dwordx4 v4, s[8:11], s31 offen offset:2048 lds
    buffer_load_dwordx4 v5, s[8:11], s31 offen offset:3072 lds
    ds_read_b128 v[192:195], v27 offset:1408
    ds_read_b128 v[196:199], v27 offset:256
    s_waitcnt lgkmcnt(2)
    v_pk_fma_f32 v[220:221], v[200:201], v[176:177], v[204:205] op_sel:[0,0,0] op_sel_hi:[1,0,1]
    v_pk_fma_f32 v[222:223], v[202:203], v[176:177], v[206:207] op_sel:[0,0,0] op_sel_hi:[1,0,1]
    v_pk_fma_f32 v[128:129], v[128:129], v[176:177], v[220:221] op_sel:[0,1,0] op_sel_hi:[1,1,1]
    v_pk_fma_f32 v[130:131], v[130:131], v[176:177], v[222:223] op_sel:[0,1,0] op_sel_hi:[1,1,1]
    v_pk_mul_f32 v[216:217], v[128:129], v[128:129]
    v_pk_mul_f32 v[218:219], v[130:131], v[130:131]
    v_pk_fma_f32 v[216:217], v[216:217], v[212:213], v[210:211]
    v_pk_fma_f32 v[218:219], v[218:219], v[212:213], v[210:211]
    v_pk_mul_f32 v[216:217], v[216:217], v[128:129]
    v_pk_mul_f32 v[218:219], v[218:219], v[130:131]
    v_exp_f32 v216, v216
    v_exp_f32 v217, v217
    v_exp_f32 v218, v218
    v_exp_f32 v219, v219
    v_pk_add_f32 v[216:217], v[216:217], v[214:215]
    v_pk_add_f32 v[218:219], v[218:219], v[214:215]
    v_rcp_f32 v216, v216
    v_rcp_f32 v217, v217
    v_rcp_f32 v218, v218
    v_rcp_f32 v219, v219
    v_pk_fma_f32 v[128:129], v[128:129], v[216:217], v[128:129] neg_lo:[1,0,0] neg_hi:[1,0,0]
    v_pk_fma_f32 v[130:131], v[130:131], v[218:219], v[130:131] neg_lo:[1,0,0] neg_hi:[1,0,0]
    v_pk_fma_f32 v[228:229], v[200:201], v[178:179], v[204:205] op_sel:[0,0,0] op_sel_hi:[1,0,1]
    v_pk_fma_f32 v[230:231], v[202:203], v[178:179], v[206:207] op_sel:[0,0,0] op_sel_hi:[1,0,1]
    v_pk_fma_f32 v[132:133], v[132:133], v[178:179], v[228:229] op_sel:[0,1,0] op_sel_hi:[1,1,1]
    v_pk_fma_f32 v[134:135], v[134:135], v[178:179], v[230:231] op_sel:[0,1,0] op_sel_hi:[1,1,1]
    v_pk_mul_f32 v[224:225], v[132:133], v[132:133]
    v_pk_mul_f32 v[226:227], v[134:135], v[134:135]
    v_pk_fma_f32 v[224:225], v[224:225], v[212:213], v[210:211]
    v_pk_fma_f32 v[226:227], v[226:227], v[212:213], v[210:211]
    v_pk_mul_f32 v[224:225], v[224:225], v[132:133]
    v_pk_mul_f32 v[226:227], v[226:227], v[134:135]
    v_exp_f32 v224, v224
    v_exp_f32 v225, v225
    v_exp_f32 v226, v226
    v_exp_f32 v227, v227
    v_pk_add_f32 v[224:225], v[224:225], v[214:215]
    v_pk_add_f32 v[226:227], v[226:227], v[214:215]
    v_rcp_f32 v224, v224
    v_rcp_f32 v225, v225
    v_rcp_f32 v226, v226
    v_rcp_f32 v227, v227
    v_pk_fma_f32 v[132:133], v[132:133], v[224:225], v[132:133] neg_lo:[1,0,0] neg_hi:[1,0,0]
    v_pk_fma_f32 v[134:135], v[134:135], v[226:227], v[134:135] neg_lo:[1,0,0] neg_hi:[1,0,0]
    ds_read_b128 v[200:203], v27 offset:1472
    ds_read_b128 v[204:207], v27 offset:320
    s_waitcnt lgkmcnt(2)
    v_pk_fma_f32 v[220:221], v[192:193], v[176:177], v[196:197] op_sel:[0,0,0] op_sel_hi:[1,0,1]
    v_pk_fma_f32 v[222:223], v[194:195], v[176:177], v[198:199] op_sel:[0,0,0] op_sel_hi:[1,0,1]
    v_pk_fma_f32 v[136:137], v[136:137], v[176:177], v[220:221] op_sel:[0,1,0] op_sel_hi:[1,1,1]
    v_pk_fma_f32 v[138:139], v[138:139], v[176:177], v[222:223] op_sel:[0,1,0] op_sel_hi:[1,1,1]
    v_pk_mul_f32 v[216:217], v[136:137], v[136:137]
    v_pk_mul_f32 v[218:219], v[138:139], v[138:139]
    v_pk_fma_f32 v[216:217], v[216:217], v[212:213], v[210:211]
    v_pk_fma_f32 v[218:219], v[218:219], v[212:213], v[210:211]
    v_pk_mul_f32 v[216:217], v[216:217], v[136:137]
    v_pk_mul_f32 v[218:219], v[218:219], v[138:139]
    v_exp_f32 v216, v216
    v_exp_f32 v217, v217
    v_exp_f32 v218, v218
    v_exp_f32 v219, v219
    v_pk_add_f32 v[216:217], v[216:217], v[214:215]
    v_pk_add_f32 v[218:219], v[218:219], v[214:215]
    v_rcp_f32 v216, v216
    v_rcp_f32 v217, v217
    v_rcp_f32 v218, v218
    v_rcp_f32 v219, v219
    v_pk_fma_f32 v[136:137], v[136:137], v[216:217], v[136:137] neg_lo:[1,0,0] neg_hi:[1,0,0]
    v_pk_fma_f32 v[138:139], v[138:139], v[218:219], v[138:139] neg_lo:[1,0,0] neg_hi:[1,0,0]
    v_pk_fma_f32 v[228:229], v[192:193], v[178:179], v[196:197] op_sel:[0,0,0] op_sel_hi:[1,0,1]
    v_pk_fma_f32 v[230:231], v[194:195], v[178:179], v[198:199] op_sel:[0,0,0] op_sel_hi:[1,0,1]
    v_pk_fma_f32 v[140:141], v[140:141], v[178:179], v[228:229] op_sel:[0,1,0] op_sel_hi:[1,1,1]
    v_pk_fma_f32 v[142:143], v[142:143], v[178:179], v[230:231] op_sel:[0,1,0] op_sel_hi:[1,1,1]
    v_pk_mul_f32 v[224:225], v[140:141], v[140:141]
    v_pk_mul_f32 v[226:227], v[142:143], v[142:143]
    v_pk_fma_f32 v[224:225], v[224:225], v[212:213], v[210:211]
    v_pk_fma_f32 v[226:227], v[226:227], v[212:213], v[210:211]
    v_pk_mul_f32 v[224:225], v[224:225], v[140:141]
    v_pk_mul_f32 v[226:227], v[226:227], v[142:143]
    v_exp_f32 v224, v224
    v_exp_f32 v225, v225
    v_exp_f32 v226, v226
    v_exp_f32 v227, v227
    v_pk_add_f32 v[224:225], v[224:225], v[214:215]
    v_pk_add_f32 v[226:227], v[226:227], v[214:215]
    v_rcp_f32 v224, v224
    v_rcp_f32 v225, v225
    v_rcp_f32 v226, v226
    v_rcp_f32 v227, v227
    v_pk_fma_f32 v[140:141], v[140:141], v[224:225], v[140:141] neg_lo:[1,0,0] neg_hi:[1,0,0]
    v_pk_fma_f32 v[142:143], v[142:143], v[226:227], v[142:143] neg_lo:[1,0,0] neg_hi:[1,0,0]
    s_cmp_lg_u32 s30, 1
    s_cbranch_scc1 LB_z_2
    s_mov_b32 s43, 0x4000
    s_mov_b32 exec_lo, 0xffff
    s_mov_b32 exec_hi, 0
    s_branch LB_z_1
LB_z_0:
    s_sleep 4
LB_z_1:
    buffer_load_dword v30, v21, s[12:15], s48 offen sc1
    s_waitcnt vmcnt(0)
    v_cmp_eq_u32 vcc, -1, v30
    s_sub_u32 s43, s43, 1
    s_cmp_eq_u32 s43, 0
    s_cbranch_vccz LB_z_3
    s_cbranch_scc0 LB_z_0
LB_z_3:
    s_mov_b64 exec, -1
LB_z_2:
    s_barrier
    ds_read_b128 v[192:195], v27 offset:1536
    ds_read_b128 v[196:199], v27 offset:384
    s_waitcnt lgkmcnt(2)
    v_pk_fma_f32 v[220:221], v[200:201], v[176:177], v[204:205] op_sel:[0,0,0] op_sel_hi:[1,0,1]
    v_pk_fma_f32 v[222:223], v[202:203], v[176:177], v[206:207] op_sel:[0,0,0] op_sel_hi:[1,0,1]
    v_pk_fma_f32 v[144:145], v[144:145], v[176:177], v[220:221] op_sel:[0,1,0] op_sel_hi:[1,1,1]
    v_pk_fma_f32 v[146:147], v[146:147], v[176:177], v[222:223] op_sel:[0,1,0] op_sel_hi:[1,1,1]
    v_pk_mul_f32 v[216:217], v[144:145], v[144:145]
    v_pk_mul_f32 v[218:219], v[146:147], v[146:147]
    v_pk_fma_f32 v[216:217], v[216:217], v[212:213], v[210:211]
    v_pk_fma_f32 v[218:219], v[218:219], v[212:213], v[210:211]
    v_pk_mul_f32 v[216:217], v[216:217], v[144:145]
    v_pk_mul_f32 v[218:219], v[218:219], v[146:147]
    v_exp_f32 v216, v216
    v_exp_f32 v217, v217
    v_exp_f32 v218, v218
    v_exp_f32 v219, v219
    v_pk_add_f32 v[216:217], v[216:217], v[214:215]
    v_pk_add_f32 v[218:219], v[218:219], v[214:215]
    v_rcp_f32 v216, v216
    v_rcp_f32 v217, v217
    v_rcp_f32 v218, v218
    v_rcp_f32 v219, v219
    v_pk_fma_f32 v[144:145], v[144:145], v[216:217], v[144:145] neg_lo:[1,0,0] neg_hi:[1,0,0]
    v_pk_fma_f32 v[146:147], v[146:147], v[218:219], v[146:147] neg_lo:[1,0,0] neg_hi:[1,0,0]
    s_add_u32 m0, s55, 65536
    s_add_u32 s32, s39, s60
    s_mov_b64 exec, s[64:65]
    buffer_load_dwordx4 v6, s[12:15], s32 offen sc1 lds
    s_mov_b64 exec, -1
    buffer_load_dwordx4 v6, s[12:15], s32 offen offset:512 sc1 lds
    v_pk_fma_f32 v[228:229], v[200:201], v[178:179], v[204:205] op_sel:[0,0,0] op_sel_hi:[1,0,1]
    v_pk_fma_f32 v[230:231], v[202:203], v[178:179], v[206:207] op_sel:[0,0,0] op_sel_hi:[1,0,1]
    v_pk_fma_f32 v[148:149], v[148:149], v[178:179], v[228:229] op_sel:[0,1,0] op_sel_hi:[1,1,1]
    v_pk_fma_f32 v[150:151], v[150:151], v[178:179], v[230:231] op_sel:[0,1,0] op_sel_hi:[1,1,1]
    v_pk_mul_f32 v[224:225], v[148:149], v[148:149]
    v_pk_mul_f32 v[226:227], v[150:151], v[150:151]
    v_pk_fma_f32 v[224:225], v[224:225], v[212:213], v[210:211]
    v_pk_fma_f32 v[226:227], v[226:227], v[212:213], v[210:211]
    v_pk_mul_f32 v[224:225], v[224:225], v[148:149]
    v_pk_mul_f32 v[226:227], v[226:227], v[150:151]
    v_exp_f32 v224, v224
    v_exp_f32 v225, v225
    v_exp_f32 v226, v226
    v_exp_f32 v227, v227
    v_pk_add_f32 v[224:225], v[224:225], v[214:215]
    v_pk_add_f32 v[226:227], v[226:227], v[214:215]
    v_rcp_f32 v224, v224
    v_rcp_f32 v225, v225
    v_rcp_f32 v226, v226
    v_rcp_f32 v227, v227
    v_pk_fma_f32 v[148:149], v[148:149], v[224:225], v[148:149] neg_lo:[1,0,0] neg_hi:[1,0,0]
    v_pk_fma_f32 v[150:151], v[150:151], v[226:227], v[150:151] neg_lo:[1,0,0] neg_hi:[1,0,0]
    buffer_load_dwordx4 v6, s[12:15], s32 offen offset:1536 sc1 lds
    buffer_load_dwordx4 v6, s[12:15], s32 offen offset:2560 sc1 lds
    ds_read_b128 v[200:203], v27 offset:1600
    ds_read_b128 v[204:207], v27 offset:448
    s_waitcnt lgkmcnt(2)
    v_pk_fma_f32 v[220:221], v[192:193], v[176:177], v[196:197] op_sel:[0,0,0] op_sel_hi:[1,0,1]
    v_pk_fma_f32 v[222:223], v[194:195], v[176:177], v[198:199] op_sel:[0,0,0] op_sel_hi:[1,0,1]
    v_pk_fma_f32 v[152:153], v[152:153], v[176:177], v[220:221] op_sel:[0,1,0] op_sel_hi:[1,1,1]
    v_pk_fma_f32 v[154:155], v[154:155], v[176:177], v[222:223] op_sel:[0,1,0] op_sel_hi:[1,1,1]
    v_pk_mul_f32 v[216:217], v[152:153], v[152:153]
    v_pk_mul_f32 v[218:219], v[154:155], v[154:155]
    v_pk_fma_f32 v[216:217], v[216:217], v[212:213], v[210:211]
    v_pk_fma_f32 v[218:219], v[218:219], v[212:213], v[210:211]
    v_pk_mul_f32 v[216:217], v[216:217], v[152:153]
    v_pk_mul_f32 v[218:219], v[218:219], v[154:155]
    v_exp_f32 v216, v216
    v_exp_f32 v217, v217
    v_exp_f32 v218, v218
    v_exp_f32 v219, v219
    v_pk_add_f32 v[216:217], v[216:217], v[214:215]
    v_pk_add_f32 v[218:219], v[218:219], v[214:215]
    v_rcp_f32 v216, v216
    v_rcp_f32 v217, v217
    v_rcp_f32 v218, v218
    v_rcp_f32 v219, v219
    v_pk_fma_f32 v[152:153], v[152:153], v[216:217], v[152:153] neg_lo:[1,0,0] neg_hi:[1,0,0]
    v_pk_fma_f32 v[154:155], v[154:155], v[218:219], v[154:155] neg_lo:[1,0,0] neg_hi:[1,0,0]
    buffer_load_dwordx4 v6, s[12:15], s32 offen offset:3584 sc1 lds
    s_add_u32 m0, s55, 83968
    s_add_u32 s32, s39, s61
    s_mov_b64 exec, s[64:65]
    buffer_load_dwordx4 v6, s[12:15], s32 offen sc1 lds
    s_mov_b64 exec, -1
    v_pk_fma_f32 v[228:229], v[192:193], v[178:179], v[196:197] op_sel:[0,0,0] op_sel_hi:[1,0,1]
    v_pk_fma_f32 v[230:231], v[194:195], v[178:179], v[198:199] op_sel:[0,0,0] op_sel_hi:[1,0,1]
    v_pk_fma_f32 v[156:157], v[156:157], v[178:179], v[228:229] op_sel:[0,1,0] op_sel_hi:[1,1,1]
    v_pk_fma_f32 v[158:159], v[158:159], v[178:179], v[230:231] op_sel:[0,1,0] op_sel_hi:[1,1,1]
    v_pk_mul_f32 v[224:225], v[156:157], v[156:157]
    v_pk_mul_f32 v[226:227], v[158:159], v[158:159]
    v_pk_fma_f32 v[224:225], v[224:225], v[212:213], v[210:211]
    v_pk_fma_f32 v[226:227], v[226:227], v[212:213], v[210:211]
    v_pk_mul_f32 v[224:225], v[224:225], v[156:157]
    v_pk_mul_f32 v[226:227], v[226:227], v[158:159]
    v_exp_f32 v224, v224
    v_exp_f32 v225, v225
    v_exp_f32 v226, v226
    v_exp_f32 v227, v227
    v_pk_add_f32 v[224:225], v[224:225], v[214:215]
    v_pk_add_f32 v[226:227], v[226:227], v[214:215]
    v_rcp_f32 v224, v224
    v_rcp_f32 v225, v225
    v_rcp_f32 v226, v226
    v_rcp_f32 v227, v227
    v_pk_fma_f32 v[156:157], v[156:157], v[224:225], v[156:157] neg_lo:[1,0,0] neg_hi:[1,0,0]
    v_pk_fma_f32 v[158:159], v[158:159], v[226:227], v[158:159] neg_lo:[1,0,0] neg_hi:[1,0,0]
    buffer_load_dwordx4 v6, s[12:15], s32 offen offset:512 sc1 lds
    buffer_load_dwordx4 v6, s[12:15], s32 offen offset:1536 sc1 lds
    ds_read_b128 v[192:195], v27 offset:1664
    ds_read_b128 v[196:199], v27 offset:512
    s_waitcnt lgkmcnt(2)
    v_pk_fma_f32 v[220:221], v[200:201], v[176:177], v[204:205] op_sel:[0,0,0] op_sel_hi:[1,0,1]
    v_pk_fma_f32 v[222:223], v[202:203], v[176:177], v[206:207] op_sel:[0,0,0] op_sel_hi:[1,0,1]
    v_pk_fma_f32 v[160:161], v[160:161], v[176:177], v[220:221] op_sel:[0,1,0] op_sel_hi:[1,1,1]
    v_pk_fma_f32 v[162:163], v[162:163], v[176:177], v[222:223] op_sel:[0,1,0] op_sel_hi:[1,1,1]
    v_pk_mul_f32 v[216:217], v[160:161], v[160:161]
    v_pk_mul_f32 v[218:219], v[162:163], v[162:163]
    v_pk_fma_f32 v[216:217], v[216:217], v[212:213], v[210:211]
    v_pk_fma_f32 v[218:219], v[218:219], v[212:213], v[210:211]
    v_pk_mul_f32 v[216:217], v[216:217], v[160:161]
    v_pk_mul_f32 v[218:219], v[218:219], v[162:163]
    v_exp_f32 v216, v216
    v_exp_f32 v217, v217
    v_exp_f32 v218, v218
    v_exp_f32 v219, v219
    v_pk_add_f32 v[216:217], v[216:217], v[214:215]
    v_pk_add_f32 v[218:219], v[218:219], v[214:215]
    v_rcp_f32 v216, v216
    v_rcp_f32 v217, v217
    v_rcp_f32 v218, v218
    v_rcp_f32 v219, v219
    v_pk_fma_f32 v[160:161], v[160:161], v[216:217], v[160:161] neg_lo:[1,0,0] neg_hi:[1,0,0]
    v_pk_fma_f32 v[162:163], v[162:163], v[218:219], v[162:163] neg_lo:[1,0,0] neg_hi:[1,0,0]
    buffer_load_dwordx4 v6, s[12:15], s32 offen offset:2560 sc1 lds
    buffer_load_dwordx4 v6, s[12:15], s32 offen offset:3584 sc1 lds
    v_pk_fma_f32 v[228:229], v[200:201], v[178:179], v[204:205] op_sel:[0,0,0] op_sel_hi:[1,0,1]
    v_pk_fma_f32 v[230:231], v[202:203], v[178:179], v[206:207] op_sel:[0,0,0] op_sel_hi:[1,0,1]
    v_pk_fma_f32 v[164:165], v[164:165], v[178:179], v[228:229] op_sel:[0,1,0] op_sel_hi:[1,1,1]
    v_pk_fma_f32 v[166:167], v[166:167], v[178:179], v[230:231] op_sel:[0,1,0] op_sel_hi:[1,1,1]
    v_pk_mul_f32 v[224:225], v[164:165], v[164:165]
    v_pk_mul_f32 v[226:227], v[166:167], v[166:167]
    v_pk_fma_f32 v[224:225], v[224:225], v[212:213], v[210:211]
    v_pk_fma_f32 v[226:227], v[226:227], v[212:213], v[210:211]
    v_pk_mul_f32 v[224:225], v[224:225], v[164:165]
    v_pk_mul_f32 v[226:227], v[226:227], v[166:167]
    v_exp_f32 v224, v224
    v_exp_f32 v225, v225
    v_exp_f32 v226, v226
    v_exp_f32 v227, v227
    v_pk_add_f32 v[224:225], v[224:225], v[214:215]
    v_pk_add_f32 v[226:227], v[226:227], v[214:215]
    v_rcp_f32 v224, v224
    v_rcp_f32 v225, v225
    v_rcp_f32 v226, v226
    v_rcp_f32 v227, v227
    v_pk_fma_f32 v[164:165], v[164:165], v[224:225], v[164:165] neg_lo:[1,0,0] neg_hi:[1,0,0]
    v_pk_fma_f32 v[166:167], v[166:167], v[226:227], v[166:167] neg_lo:[1,0,0] neg_hi:[1,0,0]
    s_add_u32 m0, s55, 102400
    s_add_u32 s32, s39, s62
    s_mov_b64 exec, s[64:65]
    buffer_load_dwordx4 v6, s[12:15], s32 offen sc1 lds
    s_mov_b64 exec, -1
    buffer_load_dwordx4 v6, s[12:15], s32 offen offset:512 sc1 lds
    buffer_load_dwordx4 v6, s[12:15], s32 offen offset:1536 sc1 lds
    buffer_load_dwordx4 v6, s[12:15], s32 offen offset:2560 sc1 lds
    buffer_load_dwordx4 v6, s[12:15], s32 offen offset:3584 sc1 lds
    s_add_u32 m0, s55, 120832
    s_add_u32 s32, s39, s63
    s_add_u32 s39, s39, 73728
    s_mov_b64 exec, s[64:65]
    buffer_load_dwordx4 v6, s[12:15], s32 offen sc1 lds
    s_mov_b64 exec, -1
    buffer_load_dwordx4 v6, s[12:15], s32 offen offset:512 sc1 lds
    buffer_load_dwordx4 v6, s[12:15], s32 offen offset:1536 sc1 lds
    buffer_load_dwordx4 v6, s[12:15], s32 offen offset:2560 sc1 lds
    buffer_load_dwordx4 v6, s[12:15], s32 offen offset:3584 sc1 lds
    s_waitcnt vmcnt(10)
    s_barrier
    ds_read_b128 a[216:219], v8 offset:0
    ds_read_b128 a[220:223], v8 offset:2048
    ds_read_b128 a[144:147], v16 offset:0
    ds_read_b128 a[148:151], v16 offset:1024
    ds_read_b128 a[152:155], v16 offset:2048
    ds_read_b128 a[156:159], v16 offset:3072
    ds_read_b128 a[160:163], v16 offset:4096
    ds_read_b128 a[164:167], v16 offset:5120
    ds_read_b128 a[168:171], v16 offset:6144
    ds_read_b128 a[172:175], v16 offset:7168
    ds_read_b128 a[176:179], v16 offset:8192
    s_waitcnt lgkmcnt(0)
    v_pk_fma_f32 v[220:221], v[192:193], v[176:177], v[196:197] op_sel:[0,0,0] op_sel_hi:[1,0,1]
    v_pk_fma_f32 v[222:223], v[194:195], v[176:177], v[198:199] op_sel:[0,0,0] op_sel_hi:[1,0,1]
    v_pk_fma_f32 v[168:169], v[168:169], v[176:177], v[220:221] op_sel:[0,1,0] op_sel_hi:[1,1,1]
    v_pk_fma_f32 v[170:171], v[170:171], v[176:177], v[222:223] op_sel:[0,1,0] op_sel_hi:[1,1,1]
    v_pk_mul_f32 v[216:217], v[168:169], v[168:169]
    v_pk_mul_f32 v[218:219], v[170:171], v[170:171]
    v_pk_fma_f32 v[216:217], v[216:217], v[212:213], v[210:211]
    v_pk_fma_f32 v[218:219], v[218:219], v[212:213], v[210:211]
    v_pk_mul_f32 v[216:217], v[216:217], v[168:169]
    v_pk_mul_f32 v[218:219], v[218:219], v[170:171]
    v_exp_f32 v216, v216
    v_exp_f32 v217, v217
    v_exp_f32 v218, v218
    v_exp_f32 v219, v219
    v_pk_add_f32 v[216:217], v[216:217], v[214:215]
    v_pk_add_f32 v[218:219], v[218:219], v[214:215]
    v_rcp_f32 v216, v216
    v_rcp_f32 v217, v217
    v_rcp_f32 v218, v218
    v_rcp_f32 v219, v219
    v_pk_fma_f32 v[168:169], v[168:169], v[216:217], v[168:169] neg_lo:[1,0,0] neg_hi:[1,0,0]
    v_pk_fma_f32 v[170:171], v[170:171], v[218:219], v[170:171] neg_lo:[1,0,0] neg_hi:[1,0,0]
    v_pk_fma_f32 v[228:229], v[192:193], v[178:179], v[196:197] op_sel:[0,0,0] op_sel_hi:[1,0,1]
    v_pk_fma_f32 v[230:231], v[194:195], v[178:179], v[198:199] op_sel:[0,0,0] op_sel_hi:[1,0,1]
    v_pk_fma_f32 v[172:173], v[172:173], v[178:179], v[228:229] op_sel:[0,1,0] op_sel_hi:[1,1,1]
    v_pk_fma_f32 v[174:175], v[174:175], v[178:179], v[230:231] op_sel:[0,1,0] op_sel_hi:[1,1,1]
    v_pk_mul_f32 v[224:225], v[172:173], v[172:173]
    v_pk_mul_f32 v[226:227], v[174:175], v[174:175]
    v_pk_fma_f32 v[224:225], v[224:225], v[212:213], v[210:211]
    v_pk_fma_f32 v[226:227], v[226:227], v[212:213], v[210:211]
    v_pk_mul_f32 v[224:225], v[224:225], v[172:173]
    v_pk_mul_f32 v[226:227], v[226:227], v[174:175]
    v_exp_f32 v224, v224
    v_exp_f32 v225, v225
    v_exp_f32 v226, v226
    v_exp_f32 v227, v227
    v_pk_add_f32 v[224:225], v[224:225], v[214:215]
    v_pk_add_f32 v[226:227], v[226:227], v[214:215]
    v_rcp_f32 v224, v224
    v_rcp_f32 v225, v225
    v_rcp_f32 v226, v226
    v_rcp_f32 v227, v227
    v_pk_fma_f32 v[172:173], v[172:173], v[224:225], v[172:173] neg_lo:[1,0,0] neg_hi:[1,0,0]
    v_pk_fma_f32 v[174:175], v[174:175], v[226:227], v[174:175] neg_lo:[1,0,0] neg_hi:[1,0,0]
    s_mov_b32 s35, 7
L4_loop:
    v_mfma_f32_16x16x32_bf16 v[32:35], a[144:147], a[216:219], v[32:35]
    ds_read_b128 a[224:227], v12 offset:0
    v_mfma_f32_16x16x32_bf16 v[36:39], a[144:147], a[220:223], v[36:39]
    ds_read_b128 a[228:231], v12 offset:2048
    s_add_u32 m0, s33, 49152
    s_add_u32 s31, s38, s59
    s_add_u32 s38, s38, 512
    v_mfma_f32_16x16x32_bf16 v[40:43], a[148:151], a[216:219], v[40:43]
    buffer_load_dwordx4 v2, s[8:11], s31 offen offset:0 lds
    v_mfma_f32_16x16x32_bf16 v[44:47], a[148:151], a[220:223], v[44:47]
    ds_read_b128 a[180:183], v16 offset:9216
    v_mfma_f32_16x16x32_bf16 v[48:51], a[152:155], a[216:219], v[48:51]
    ds_read_b128 a[184:187], v16 offset:10240
    v_mfma_f32_16x16x32_bf16 v[52:55], a[152:155], a[220:223], v[52:55]
    ds_read_b128 a[188:191], v16 offset:11264
    v_mfma_f32_16x16x32_bf16 v[56:59], a[156:159], a[216:219], v[56:59]
    buffer_load_dwordx4 v3, s[8:11], s31 offen offset:1024 lds
    v_mfma_f32_16x16x32_bf16 v[60:63], a[156:159], a[220:223], v[60:63]
    ds_read_b128 a[192:195], v16 offset:12288
    v_mfma_f32_16x16x32_bf16 v[64:67], a[160:163], a[216:219], v[64:67]
    ds_read_b128 a[196:199], v16 offset:13312
    v_mfma_f32_16x16x32_bf16 v[68:71], a[160:163], a[220:223], v[68:71]
    ds_read_b128 a[200:203], v16 offset:14336
    v_mfma_f32_16x16x32_bf16 v[72:75], a[164:167], a[216:219], v[72:75]
    buffer_load_dwordx4 v4, s[8:11], s31 offen offset:2048 lds
    v_mfma_f32_16x16x32_bf16 v[76:79], a[164:167], a[220:223], v[76:79]
    ds_read_b128 a[204:207], v16 offset:15360
    v_mfma_f32_16x16x32_bf16 v[80:83], a[168:171], a[216:219], v[80:83]
    ds_read_b128 a[208:211], v16 offset:16384
    v_mfma_f32_16x16x32_bf16 v[84:87], a[168:171], a[220:223], v[84:87]
    ds_read_b128 a[212:215], v16 offset:17408
    v_mfma_f32_16x16x32_bf16 v[88:91], a[172:175], a[216:219], v[88:91]
    buffer_load_dwordx4 v5, s[8:11], s31 offen offset:3072 lds
    v_mfma_f32_16x16x32_bf16 v[92:95], a[172:175], a[220:223], v[92:95]
    v_mfma_f32_16x16x32_bf16 v[96:99], a[176:179], a[216:219], v[96:99]
    v_mfma_f32_16x16x32_bf16 v[100:103], a[176:179], a[220:223], v[100:103]
    s_waitcnt lgkmcnt(0) vmcnt(18)
    s_barrier
    v_mfma_f32_16x16x32_bf16 v[32:35], a[180:183], a[224:227], v[32:35]
    ds_read_b128 a[216:219], v9 offset:0
    s_add_u32 m0, s55, 65536
    s_add_u32 s32, s39, s60
    v_mfma_f32_16x16x32_bf16 v[36:39], a[180:183], a[228:231], v[36:39]
    s_mov_b64 exec, s[64:65]
    buffer_load_dwordx4 v6, s[12:15], s32 offen sc1 lds
    s_mov_b64 exec, -1
    v_mfma_f32_16x16x32_bf16 v[40:43], a[184:187], a[224:227], v[40:43]
    ds_read_b128 a[220:223], v9 offset:2048
    v_mfma_f32_16x16x32_bf16 v[44:47], a[184:187], a[228:231], v[44:47]
    ds_read_b128 a[144:147], v17 offset:0
    v_mfma_f32_16x16x32_bf16 v[48:51], a[188:191], a[224:227], v[48:51]
    buffer_load_dwordx4 v6, s[12:15], s32 offen offset:512 sc1 lds
    v_mfma_f32_16x16x32_bf16 v[52:55], a[188:191], a[228:231], v[52:55]
    ds_read_b128 a[148:151], v17 offset:1024
    v_mfma_f32_16x16x32_bf16 v[56:59], a[192:195], a[224:227], v[56:59]
    ds_read_b128 a[152:155], v17 offset:2048
    v_mfma_f32_16x16x32_bf16 v[60:63], a[192:195], a[228:231], v[60:63]
    buffer_load_dwordx4 v6, s[12:15], s32 offen offset:1536 sc1 lds
    v_mfma_f32_16x16x32_bf16 v[64:67], a[196:199], a[224:227], v[64:67]
    ds_read_b128 a[156:159], v17 offset:3072
    v_mfma_f32_16x16x32_bf16 v[68:71], a[196:199], a[228:231], v[68:71]
    ds_read_b128 a[160:163], v17 offset:4096
    v_mfma_f32_16x16x32_bf16 v[72:75], a[200:203], a[224:227], v[72:75]
    ds_read_b128 a[164:167], v17 offset:5120
    v_mfma_f32_16x16x32_bf16 v[76:79], a[200:203], a[228:231], v[76:79]
    buffer_load_dwordx4 v6, s[12:15], s32 offen offset:2560 sc1 lds
    v_mfma_f32_16x16x32_bf16 v[80:83], a[204:207], a[224:227], v[80:83]
    ds_read_b128 a[168:171], v17 offset:6144
    v_mfma_f32_16x16x32_bf16 v[84:87], a[204:207], a[228:231], v[84:87]
    ds_read_b128 a[172:175], v17 offset:7168
    v_mfma_f32_16x16x32_bf16 v[88:91], a[208:211], a[224:227], v[88:91]
    buffer_load_dwordx4 v6, s[12:15], s32 offen offset:3584 sc1 lds
    v_mfma_f32_16x16x32_bf16 v[92:95], a[208:211], a[228:231], v[92:95]
    ds_read_b128 a[176:179], v17 offset:8192
    v_mfma_f32_16x16x32_bf16 v[96:99], a[212:215], a[224:227], v[96:99]
    v_mfma_f32_16x16x32_bf16 v[100:103], a[212:215], a[228:231], v[100:103]
    s_waitcnt lgkmcnt(0)
    v_mfma_f32_16x16x32_bf16 v[32:35], a[144:147], a[216:219], v[32:35]
    ds_read_b128 a[224:227], v13 offset:0
    v_mfma_f32_16x16x32_bf16 v[36:39], a[144:147], a[220:223], v[36:39]
    ds_read_b128 a[228:231], v13 offset:2048
    s_add_u32 m0, s33, 0
    s_add_u32 s31, s38, s56
    v_mfma_f32_16x16x32_bf16 v[40:43], a[148:151], a[216:219], v[40:43]
    buffer_load_dwordx4 v2, s[8:11], s31 offen offset:0 lds
    v_mfma_f32_16x16x32_bf16 v[44:47], a[148:151], a[220:223], v[44:47]
    ds_read_b128 a[180:183], v17 offset:9216
    v_mfma_f32_16x16x32_bf16 v[48:51], a[152:155], a[216:219], v[48:51]
    ds_read_b128 a[184:187], v17 offset:10240
    v_mfma_f32_16x16x32_bf16 v[52:55], a[152:155], a[220:223], v[52:55]
    ds_read_b128 a[188:191], v17 offset:11264
    v_mfma_f32_16x16x32_bf16 v[56:59], a[156:159], a[216:219], v[56:59]
    buffer_load_dwordx4 v3, s[8:11], s31 offen offset:1024 lds
    v_mfma_f32_16x16x32_bf16 v[60:63], a[156:159], a[220:223], v[60:63]
    ds_read_b128 a[192:195], v17 offset:12288
    v_mfma_f32_16x16x32_bf16 v[64:67], a[160:163], a[216:219], v[64:67]
    ds_read_b128 a[196:199], v17 offset:13312
    v_mfma_f32_16x16x32_bf16 v[68:71], a[160:163], a[220:223], v[68:71]
    ds_read_b128 a[200:203], v17 offset:14336
    v_mfma_f32_16x16x32_bf16 v[72:75], a[164:167], a[216:219], v[72:75]
    buffer_load_dwordx4 v4, s[8:11], s31 offen offset:2048 lds
    v_mfma_f32_16x16x32_bf16 v[76:79], a[164:167], a[220:223], v[76:79]
    ds_read_b128 a[204:207], v17 offset:15360
    v_mfma_f32_16x16x32_bf16 v[80:83], a[168:171], a[216:219], v[80:83]
    ds_read_b128 a[208:211], v17 offset:16384
    v_mfma_f32_16x16x32_bf16 v[84:87], a[168:171], a[220:223], v[84:87]
    ds_read_b128 a[212:215], v17 offset:17408
    v_mfma_f32_16x16x32_bf16 v[88:91], a[172:175], a[216:219], v[88:91]
    buffer_load_dwordx4 v5, s[8:11], s31 offen offset:3072 lds
    v_mfma_f32_16x16x32_bf16 v[92:95], a[172:175], a[220:223], v[92:95]
    v_mfma_f32_16x16x32_bf16 v[96:99], a[176:179], a[216:219], v[96:99]
    v_mfma_f32_16x16x32_bf16 v[100:103], a[176:179], a[220:223], v[100:103]
    s_waitcnt lgkmcnt(0) vmcnt(18)
    s_barrier
    v_mfma_f32_16x16x32_bf16 v[32:35], a[180:183], a[224:227], v[32:35]
    ds_read_b128 a[216:219], v10 offset:0
    s_add_u32 m0, s55, 83968
    s_add_u32 s32, s39, s61
    v_mfma_f32_16x16x32_bf16 v[36:39], a[180:183], a[228:231], v[36:39]
    s_mov_b64 exec, s[64:65]
    buffer_load_dwordx4 v6, s[12:15], s32 offen sc1 lds
    s_mov_b64 exec, -1
    v_mfma_f32_16x16x32_bf16 v[40:43], a[184:187], a[224:227], v[40:43]
    ds_read_b128 a[220:223], v10 offset:2048
    v_mfma_f32_16x16x32_bf16 v[44:47], a[184:187], a[228:231], v[44:47]
    ds_read_b128 a[144:147], v18 offset:0
    v_mfma_f32_16x16x32_bf16 v[48:51], a[188:191], a[224:227], v[48:51]
    buffer_load_dwordx4 v6, s[12:15], s32 offen offset:512 sc1 lds
    v_mfma_f32_16x16x32_bf16 v[52:55], a[188:191], a[228:231], v[52:55]
    ds_read_b128 a[148:151], v18 offset:1024
    v_mfma_f32_16x16x32_bf16 v[56:59], a[192:195], a[224:227], v[56:59]
    ds_read_b128 a[152:155], v18 offset:2048
    v_mfma_f32_16x16x32_bf16 v[60:63], a[192:195], a[228:231], v[60:63]
    buffer_load_dwordx4 v6, s[12:15], s32 offen offset:1536 sc1 lds
    v_mfma_f32_16x16x32_bf16 v[64:67], a[196:199], a[224:227], v[64:67]
    ds_read_b128 a[156:159], v18 offset:3072
    v_mfma_f32_16x16x32_bf16 v[68:71], a[196:199], a[228:231], v[68:71]
    ds_read_b128 a[160:163], v18 offset:4096
    v_mfma_f32_16x16x32_bf16 v[72:75], a[200:203], a[224:227], v[72:75]
    ds_read_b128 a[164:167], v18 offset:5120
    v_mfma_f32_16x16x32_bf16 v[76:79], a[200:203], a[228:231], v[76:79]
    buffer_load_dwordx4 v6, s[12:15], s32 offen offset:2560 sc1 lds
    v_mfma_f32_16x16x32_bf16 v[80:83], a[204:207], a[224:227], v[80:83]
    ds_read_b128 a[168:171], v18 offset:6144
    v_mfma_f32_16x16x32_bf16 v[84:87], a[204:207], a[228:231], v[84:87]
    ds_read_b128 a[172:175], v18 offset:7168
    v_mfma_f32_16x16x32_bf16 v[88:91], a[208:211], a[224:227], v[88:91]
    buffer_load_dwordx4 v6, s[12:15], s32 offen offset:3584 sc1 lds
    v_mfma_f32_16x16x32_bf16 v[92:95], a[208:211], a[228:231], v[92:95]
    ds_read_b128 a[176:179], v18 offset:8192
    v_mfma_f32_16x16x32_bf16 v[96:99], a[212:215], a[224:227], v[96:99]
    v_mfma_f32_16x16x32_bf16 v[100:103], a[212:215], a[228:231], v[100:103]
    s_waitcnt lgkmcnt(0)
    v_mfma_f32_16x16x32_bf16 v[32:35], a[144:147], a[216:219], v[32:35]
    ds_read_b128 a[224:227], v14 offset:0
    v_mfma_f32_16x16x32_bf16 v[36:39], a[144:147], a[220:223], v[36:39]
    ds_read_b128 a[228:231], v14 offset:2048
    s_add_u32 m0, s33, 16384
    s_add_u32 s31, s38, s57
    v_mfma_f32_16x16x32_bf16 v[40:43], a[148:151], a[216:219], v[40:43]
    buffer_load_dwordx4 v2, s[8:11], s31 offen offset:0 lds
    v_mfma_f32_16x16x32_bf16 v[44:47], a[148:151], a[220:223], v[44:47]
    ds_read_b128 a[180:183], v18 offset:9216
    v_mfma_f32_16x16x32_bf16 v[48:51], a[152:155], a[216:219], v[48:51]
    ds_read_b128 a[184:187], v18 offset:10240
    v_mfma_f32_16x16x32_bf16 v[52:55], a[152:155], a[220:223], v[52:55]
    ds_read_b128 a[188:191], v18 offset:11264
    v_mfma_f32_16x16x32_bf16 v[56:59], a[156:159], a[216:219], v[56:59]
    buffer_load_dwordx4 v3, s[8:11], s31 offen offset:1024 lds
    v_mfma_f32_16x16x32_bf16 v[60:63], a[156:159], a[220:223], v[60:63]
    ds_read_b128 a[192:195], v18 offset:12288
    v_mfma_f32_16x16x32_bf16 v[64:67], a[160:163], a[216:219], v[64:67]
    ds_read_b128 a[196:199], v18 offset:13312
    v_mfma_f32_16x16x32_bf16 v[68:71], a[160:163], a[220:223], v[68:71]
    ds_read_b128 a[200:203], v18 offset:14336
    v_mfma_f32_16x16x32_bf16 v[72:75], a[164:167], a[216:219], v[72:75]
    buffer_load_dwordx4 v4, s[8:11], s31 offen offset:2048 lds
    v_mfma_f32_16x16x32_bf16 v[76:79], a[164:167], a[220:223], v[76:79]
    ds_read_b128 a[204:207], v18 offset:15360
    v_mfma_f32_16x16x32_bf16 v[80:83], a[168:171], a[216:219], v[80:83]
    ds_read_b128 a[208:211], v18 offset:16384
    v_mfma_f32_16x16x32_bf16 v[84:87], a[168:171], a[220:223], v[84:87]
    ds_read_b128 a[212:215], v18 offset:17408
    v_mfma_f32_16x16x32_bf16 v[88:91], a[172:175], a[216:219], v[88:91]
    buffer_load_dwordx4 v5, s[8:11], s31 offen offset:3072 lds
    v_mfma_f32_16x16x32_bf16 v[92:95], a[172:175], a[220:223], v[92:95]
    v_mfma_f32_16x16x32_bf16 v[96:99], a[176:179], a[216:219], v[96:99]
    v_mfma_f32_16x16x32_bf16 v[100:103], a[176:179], a[220:223], v[100:103]
    s_waitcnt lgkmcnt(0) vmcnt(18)
    s_barrier
    v_mfma_f32_16x16x32_bf16 v[32:35], a[180:183], a[224:227], v[32:35]
    ds_read_b128 a[216:219], v11 offset:0
    s_add_u32 m0, s55, 102400
    s_add_u32 s32, s39, s62
    v_mfma_f32_16x16x32_bf16 v[36:39], a[180:183], a[228:231], v[36:39]
    s_mov_b64 exec, s[64:65]
    buffer_load_dwordx4 v6, s[12:15], s32 offen sc1 lds
    s_mov_b64 exec, -1
    v_mfma_f32_16x16x32_bf16 v[40:43], a[184:187], a[224:227], v[40:43]
    ds_read_b128 a[220:223], v11 offset:2048
    v_mfma_f32_16x16x32_bf16 v[44:47], a[184:187], a[228:231], v[44:47]
    ds_read_b128 a[144:147], v19 offset:0
    v_mfma_f32_16x16x32_bf16 v[48:51], a[188:191], a[224:227], v[48:51]
    buffer_load_dwordx4 v6, s[12:15], s32 offen offset:512 sc1 lds
    v_mfma_f32_16x16x32_bf16 v[52:55], a[188:191], a[228:231], v[52:55]
    ds_read_b128 a[148:151], v19 offset:1024
    v_mfma_f32_16x16x32_bf16 v[56:59], a[192:195], a[224:227], v[56:59]
    ds_read_b128 a[152:155], v19 offset:2048
    v_mfma_f32_16x16x32_bf16 v[60:63], a[192:195], a[228:231], v[60:63]
    buffer_load_dwordx4 v6, s[12:15], s32 offen offset:1536 sc1 lds
    v_mfma_f32_16x16x32_bf16 v[64:67], a[196:199], a[224:227], v[64:67]
    ds_read_b128 a[156:159], v19 offset:3072
    v_mfma_f32_16x16x32_bf16 v[68:71], a[196:199], a[228:231], v[68:71]
    ds_read_b128 a[160:163], v19 offset:4096
    v_mfma_f32_16x16x32_bf16 v[72:75], a[200:203], a[224:227], v[72:75]
    ds_read_b128 a[164:167], v19 offset:5120
    v_mfma_f32_16x16x32_bf16 v[76:79], a[200:203], a[228:231], v[76:79]
    buffer_load_dwordx4 v6, s[12:15], s32 offen offset:2560 sc1 lds
    v_mfma_f32_16x16x32_bf16 v[80:83], a[204:207], a[224:227], v[80:83]
    ds_read_b128 a[168:171], v19 offset:6144
    v_mfma_f32_16x16x32_bf16 v[84:87], a[204:207], a[228:231], v[84:87]
    ds_read_b128 a[172:175], v19 offset:7168
    v_mfma_f32_16x16x32_bf16 v[88:91], a[208:211], a[224:227], v[88:91]
    buffer_load_dwordx4 v6, s[12:15], s32 offen offset:3584 sc1 lds
    v_mfma_f32_16x16x32_bf16 v[92:95], a[208:211], a[228:231], v[92:95]
    ds_read_b128 a[176:179], v19 offset:8192
    v_mfma_f32_16x16x32_bf16 v[96:99], a[212:215], a[224:227], v[96:99]
    v_mfma_f32_16x16x32_bf16 v[100:103], a[212:215], a[228:231], v[100:103]
    s_waitcnt lgkmcnt(0)
    v_mfma_f32_16x16x32_bf16 v[32:35], a[144:147], a[216:219], v[32:35]
    ds_read_b128 a[224:227], v15 offset:0
    v_mfma_f32_16x16x32_bf16 v[36:39], a[144:147], a[220:223], v[36:39]
    ds_read_b128 a[228:231], v15 offset:2048
    s_add_u32 m0, s33, 32768
    s_add_u32 s31, s38, s58
    v_mfma_f32_16x16x32_bf16 v[40:43], a[148:151], a[216:219], v[40:43]
    buffer_load_dwordx4 v2, s[8:11], s31 offen offset:0 lds
    v_mfma_f32_16x16x32_bf16 v[44:47], a[148:151], a[220:223], v[44:47]
    ds_read_b128 a[180:183], v19 offset:9216
    v_mfma_f32_16x16x32_bf16 v[48:51], a[152:155], a[216:219], v[48:51]
    ds_read_b128 a[184:187], v19 offset:10240
    v_mfma_f32_16x16x32_bf16 v[52:55], a[152:155], a[220:223], v[52:55]
    ds_read_b128 a[188:191], v19 offset:11264
    v_mfma_f32_16x16x32_bf16 v[56:59], a[156:159], a[216:219], v[56:59]
    buffer_load_dwordx4 v3, s[8:11], s31 offen offset:1024 lds
    v_mfma_f32_16x16x32_bf16 v[60:63], a[156:159], a[220:223], v[60:63]
    ds_read_b128 a[192:195], v19 offset:12288
    v_mfma_f32_16x16x32_bf16 v[64:67], a[160:163], a[216:219], v[64:67]
    ds_read_b128 a[196:199], v19 offset:13312
    v_mfma_f32_16x16x32_bf16 v[68:71], a[160:163], a[220:223], v[68:71]
    ds_read_b128 a[200:203], v19 offset:14336
    v_mfma_f32_16x16x32_bf16 v[72:75], a[164:167], a[216:219], v[72:75]
    buffer_load_dwordx4 v4, s[8:11], s31 offen offset:2048 lds
    v_mfma_f32_16x16x32_bf16 v[76:79], a[164:167], a[220:223], v[76:79]
    ds_read_b128 a[204:207], v19 offset:15360
    v_mfma_f32_16x16x32_bf16 v[80:83], a[168:171], a[216:219], v[80:83]
    ds_read_b128 a[208:211], v19 offset:16384
    v_mfma_f32_16x16x32_bf16 v[84:87], a[168:171], a[220:223], v[84:87]
    ds_read_b128 a[212:215], v19 offset:17408
    v_mfma_f32_16x16x32_bf16 v[88:91], a[172:175], a[216:219], v[88:91]
    buffer_load_dwordx4 v5, s[8:11], s31 offen offset:3072 lds
    v_mfma_f32_16x16x32_bf16 v[92:95], a[172:175], a[220:223], v[92:95]
    v_mfma_f32_16x16x32_bf16 v[96:99], a[176:179], a[216:219], v[96:99]
    v_mfma_f32_16x16x32_bf16 v[100:103], a[176:179], a[220:223], v[100:103]
    s_waitcnt lgkmcnt(0) vmcnt(18)
    s_barrier
    v_mfma_f32_16x16x32_bf16 v[32:35], a[180:183], a[224:227], v[32:35]
    ds_read_b128 a[216:219], v8 offset:0
    s_add_u32 m0, s55, 120832
    s_add_u32 s32, s39, s63
    s_add_u32 s39, s39, 73728
    v_mfma_f32_16x16x32_bf16 v[36:39], a[180:183], a[228:231], v[36:39]
    s_mov_b64 exec, s[64:65]
    buffer_load_dwordx4 v6, s[12:15], s32 offen sc1 lds
    s_mov_b64 exec, -1
    v_mfma_f32_16x16x32_bf16 v[40:43], a[184:187], a[224:227], v[40:43]
    ds_read_b128 a[220:223], v8 offset:2048
    v_mfma_f32_16x16x32_bf16 v[44:47], a[184:187], a[228:231], v[44:47]
    ds_read_b128 a[144:147], v16 offset:0
    v_mfma_f32_16x16x32_bf16 v[48:51], a[188:191], a[224:227], v[48:51]
    buffer_load_dwordx4 v6, s[12:15], s32 offen offset:512 sc1 lds
    v_mfma_f32_16x16x32_bf16 v[52:55], a[188:191], a[228:231], v[52:55]
    ds_read_b128 a[148:151], v16 offset:1024
    v_mfma_f32_16x16x32_bf16 v[56:59], a[192:195], a[224:227], v[56:59]
    ds_read_b128 a[152:155], v16 offset:2048
    v_mfma_f32_16x16x32_bf16 v[60:63], a[192:195], a[228:231], v[60:63]
    buffer_load_dwordx4 v6, s[12:15], s32 offen offset:1536 sc1 lds
    v_mfma_f32_16x16x32_bf16 v[64:67], a[196:199], a[224:227], v[64:67]
    ds_read_b128 a[156:159], v16 offset:3072
    v_mfma_f32_16x16x32_bf16 v[68:71], a[196:199], a[228:231], v[68:71]
    ds_read_b128 a[160:163], v16 offset:4096
    v_mfma_f32_16x16x32_bf16 v[72:75], a[200:203], a[224:227], v[72:75]
    ds_read_b128 a[164:167], v16 offset:5120
    v_mfma_f32_16x16x32_bf16 v[76:79], a[200:203], a[228:231], v[76:79]
    buffer_load_dwordx4 v6, s[12:15], s32 offen offset:2560 sc1 lds
    v_mfma_f32_16x16x32_bf16 v[80:83], a[204:207], a[224:227], v[80:83]
    ds_read_b128 a[168:171], v16 offset:6144
    v_mfma_f32_16x16x32_bf16 v[84:87], a[204:207], a[228:231], v[84:87]
    ds_read_b128 a[172:175], v16 offset:7168
    v_mfma_f32_16x16x32_bf16 v[88:91], a[208:211], a[224:227], v[88:91]
    buffer_load_dwordx4 v6, s[12:15], s32 offen offset:3584 sc1 lds
    v_mfma_f32_16x16x32_bf16 v[92:95], a[208:211], a[228:231], v[92:95]
    ds_read_b128 a[176:179], v16 offset:8192
    v_mfma_f32_16x16x32_bf16 v[96:99], a[212:215], a[224:227], v[96:99]
    v_mfma_f32_16x16x32_bf16 v[100:103], a[212:215], a[228:231], v[100:103]
    s_waitcnt lgkmcnt(0)
    s_sub_u32 s35, s35, 1
    s_cmp_lg_u32 s35, 0
    s_cbranch_scc1 L4_loop
    v_mfma_f32_16x16x32_bf16 v[32:35], a[144:147], a[216:219], v[32:35]
    ds_read_b128 a[224:227], v12 offset:0
    s_mul_i32 s42, s44, 147456
    s_add_u32 s42, s42, 0x2200000
    v_mfma_f32_16x16x32_bf16 v[36:39], a[144:147], a[220:223], v[36:39]
    ds_read_b128 a[228:231], v12 offset:2048
    s_add_u32 m0, s33, 49152
    s_add_u32 s31, s38, s59
    s_add_u32 s38, s38, 512
    v_mfma_f32_16x16x32_bf16 v[40:43], a[148:151], a[216:219], v[40:43]
    buffer_load_dwordx4 v2, s[8:11], s31 offen offset:0 lds
    s_lshl_b32 s50, s29, 11
    s_add_u32 s50, s50, s42
    v_mfma_f32_16x16x32_bf16 v[44:47], a[148:151], a[220:223], v[44:47]
    ds_read_b128 a[180:183], v16 offset:9216
    v_mfma_f32_16x16x32_bf16 v[48:51], a[152:155], a[216:219], v[48:51]
    ds_read_b128 a[184:187], v16 offset:10240
    s_add_u32 s51, s50, 73728
    s_lshr_b32 s43, s29, 1
    v_mfma_f32_16x16x32_bf16 v[52:55], a[152:155], a[220:223], v[52:55]
    ds_read_b128 a[188:191], v16 offset:11264
    v_mfma_f32_16x16x32_bf16 v[56:59], a[156:159], a[216:219], v[56:59]
    buffer_load_dwordx4 v3, s[8:11], s31 offen offset:1024 lds
    s_mul_i32 s43, s43, 5120
    s_add_u32 s42, s42, s43
    v_mfma_f32_16x16x32_bf16 v[60:63], a[156:159], a[220:223], v[60:63]
    ds_read_b128 a[192:195], v16 offset:12288
    v_mfma_f32_16x16x32_bf16 v[64:67], a[160:163], a[216:219], v[64:67]
    ds_read_b128 a[196:199], v16 offset:13312
    s_add_u32 s42, s42, 32768
    s_and_b32 s43, s29, 1
    v_mfma_f32_16x16x32_bf16 v[68:71], a[160:163], a[220:223], v[68:71]
    ds_read_b128 a[200:203], v16 offset:14336
    v_mfma_f32_16x16x32_bf16 v[72:75], a[164:167], a[216:219], v[72:75]
    buffer_load_dwordx4 v4, s[8:11], s31 offen offset:2048 lds
    s_lshl_b32 s46, s43, 11
    s_add_u32 s52, s42, s46
    v_mfma_f32_16x16x32_bf16 v[76:79], a[164:167], a[220:223], v[76:79]
    ds_read_b128 a[204:207], v16 offset:15360
    v_mfma_f32_16x16x32_bf16 v[80:83], a[168:171], a[216:219], v[80:83]
    ds_read_b128 a[208:211], v16 offset:16384
    s_add_u32 s53, s52, 73728
    s_lshl_b32 s46, s43, 3
    v_mfma_f32_16x16x32_bf16 v[84:87], a[168:171], a[220:223], v[84:87]
    ds_read_b128 a[212:215], v16 offset:17408
    v_mfma_f32_16x16x32_bf16 v[88:91], a[172:175], a[216:219], v[88:91]
    buffer_load_dwordx4 v5, s[8:11], s31 offen offset:3072 lds
    s_add_u32 s18, s42, s46
    s_add_u32 s18, s18, 4096
    v_mfma_f32_16x16x32_bf16 v[92:95], a[172:175], a[220:223], v[92:95]
    v_mfma_f32_16x16x32_bf16 v[96:99], a[176:179], a[216:219], v[96:99]
    s_add_u32 s19, s18, 73728
    v_mfma_f32_16x16x32_bf16 v[100:103], a[176:179], a[220:223], v[100:103]
    s_waitcnt lgkmcnt(0) vmcnt(18)
    s_barrier
    v_mfma_f32_16x16x32_bf16 v[32:35], a[180:183], a[224:227], v[32:35]
    ds_read_b128 a[0:3], v9 offset:0
    v_mfma_f32_16x16x32_bf16 v[36:39], a[180:183], a[228:231], v[36:39]
    s_getpc_b64 s[42:43]
Lpc_LB_p5_301:
    s_add_u32 s42, s42, LB_p5-Lpc_LB_p5_301
    s_addc_u32 s43, s43, (LB_p5-Lpc_LB_p5_301)>>32
    v_lshlrev_b32 v30, 7, v0
    v_min_u32 v30, code_end-LB_p5-4, v30
    global_load_dword v30, v30, s[42:43]
    v_mfma_f32_16x16x32_bf16 v[40:43], a[184:187], a[224:227], v[40:43]
    ds_read_b128 a[4:7], v9 offset:2048
    v_mfma_f32_16x16x32_bf16 v[44:47], a[184:187], a[228:231], v[44:47]
    ds_read_b128 a[8:11], v13 offset:0
    v_mfma_f32_16x16x32_bf16 v[48:51], a[188:191], a[224:227], v[48:51]
    ds_read_b128 a[12:15], v13 offset:2048
    v_mfma_f32_16x16x32_bf16 v[52:55], a[188:191], a[228:231], v[52:55]
    ds_read_b128 a[16:19], v17 offset:0
    v_mfma_f32_16x16x32_bf16 v[56:59], a[192:195], a[224:227], v[56:59]
    ds_read_b128 a[20:23], v17 offset:1024
    v_mfma_f32_16x16x32_bf16 v[60:63], a[192:195], a[228:231], v[60:63]
    ds_read_b128 a[24:27], v17 offset:2048
    v_mfma_f32_16x16x32_bf16 v[64:67], a[196:199], a[224:227], v[64:67]
    ds_read_b128 a[28:31], v17 offset:3072
    v_mfma_f32_16x16x32_bf16 v[68:71], a[196:199], a[228:231], v[68:71]
    ds_read_b128 a[36:39], v17 offset:9216
    v_mfma_f32_16x16x32_bf16 v[72:75], a[200:203], a[224:227], v[72:75]
    ds_read_b128 a[40:43], v17 offset:10240
    v_mfma_f32_16x16x32_bf16 v[76:79], a[200:203], a[228:231], v[76:79]
    ds_read_b128 a[44:47], v17 offset:11264
    v_mfma_f32_16x16x32_bf16 v[80:83], a[204:207], a[224:227], v[80:83]
    ds_read_b128 a[48:51], v17 offset:12288
    v_mfma_f32_16x16x32_bf16 v[84:87], a[204:207], a[228:231], v[84:87]
    v_mfma_f32_16x16x32_bf16 v[88:91], a[208:211], a[224:227], v[88:91]
    v_mfma_f32_16x16x32_bf16 v[92:95], a[208:211], a[228:231], v[92:95]
    v_mfma_f32_16x16x32_bf16 v[96:99], a[212:215], a[224:227], v[96:99]
    v_mfma_f32_16x16x32_bf16 v[100:103], a[212:215], a[228:231], v[100:103]
    s_waitcnt lgkmcnt(0) vmcnt(10)
    s_barrier
    v_mfma_f32_16x16x32_bf16 v[32:35], a[16:19], a[0:3], v[32:35]
    ds_read_b128 a[56:59], v10 offset:0
    v_mfma_f32_16x16x32_bf16 v[36:39], a[16:19], a[4:7], v[36:39]
    ds_read_b128 a[60:63], v10 offset:2048
    v_mfma_f32_16x16x32_bf16 v[40:43], a[20:23], a[0:3], v[40:43]
    ds_read_b128 a[64:67], v14 offset:0
    v_mfma_f32_16x16x32_bf16 v[44:47], a[20:23], a[4:7], v[44:47]
    ds_read_b128 a[68:71], v14 offset:2048
    v_mfma_f32_16x16x32_bf16 v[48:51], a[24:27], a[0:3], v[48:51]
    ds_read_b128 a[72:75], v18 offset:0
    v_mfma_f32_16x16x32_bf16 v[52:55], a[24:27], a[4:7], v[52:55]
    ds_read_b128 a[76:79], v18 offset:1024
    v_mfma_f32_16x16x32_bf16 v[56:59], a[28:31], a[0:3], v[56:59]
    ds_read_b128 a[80:83], v18 offset:2048
    v_mfma_f32_16x16x32_bf16 v[60:63], a[28:31], a[4:7], v[60:63]
    ds_read_b128 a[84:87], v18 offset:3072
    v_mfma_f32_16x16x32_bf16 v[32:35], a[36:39], a[8:11], v[32:35]
    ds_read_b128 a[92:95], v18 offset:9216
    v_mfma_f32_16x16x32_bf16 v[36:39], a[36:39], a[12:15], v[36:39]
    ds_read_b128 a[96:99], v18 offset:10240
    v_mfma_f32_16x16x32_bf16 v[40:43], a[40:43], a[8:11], v[40:43]
    ds_read_b128 a[100:103], v18 offset:11264
    v_mfma_f32_16x16x32_bf16 v[44:47], a[40:43], a[12:15], v[44:47]
    ds_read_b128 a[104:107], v18 offset:12288
    v_mfma_f32_16x16x32_bf16 v[48:51], a[44:47], a[8:11], v[48:51]
    v_mfma_f32_16x16x32_bf16 v[52:55], a[44:47], a[12:15], v[52:55]
    v_mfma_f32_16x16x32_bf16 v[56:59], a[48:51], a[8:11], v[56:59]
    v_mfma_f32_16x16x32_bf16 v[60:63], a[48:51], a[12:15], v[60:63]
    s_waitcnt lgkmcnt(0) vmcnt(1)
    s_barrier
    v_mfma_f32_16x16x32_bf16 v[32:35], a[72:75], a[56:59], v[32:35]
    ds_read_b128 a[0:3], v11 offset:0
    v_mfma_f32_16x16x32_bf16 v[36:39], a[72:75], a[60:63], v[36:39]
    ds_read_b128 a[4:7], v11 offset:2048
    v_mfma_f32_16x16x32_bf16 v[40:43], a[76:79], a[56:59], v[40:43]
    ds_read_b128 a[8:11], v15 offset:0
    v_mfma_f32_16x16x32_bf16 v[44:47], a[76:79], a[60:63], v[44:47]
    ds_read_b128 a[12:15], v15 offset:2048
    v_mfma_f32_16x16x32_bf16 v[48:51], a[80:83], a[56:59], v[48:51]
    ds_read_b128 a[16:19], v19 offset:0
    v_mfma_f32_16x16x32_bf16 v[52:55], a[80:83], a[60:63], v[52:55]
    ds_read_b128 a[20:23], v19 offset:1024
    v_mfma_f32_16x16x32_bf16 v[56:59], a[84:87], a[56:59], v[56:59]
    ds_read_b128 a[24:27], v19 offset:2048
    v_mfma_f32_16x16x32_bf16 v[60:63], a[84:87], a[60:63], v[60:63]
    ds_read_b128 a[28:31], v19 offset:3072
    v_mfma_f32_16x16x32_bf16 v[32:35], a[92:95], a[64:67], v[32:35]
    ds_read_b128 a[36:39], v19 offset:9216
    v_mfma_f32_16x16x32_bf16 v[36:39], a[92:95], a[68:71], v[36:39]
    ds_read_b128 a[40:43], v19 offset:10240
    v_mfma_f32_16x16x32_bf16 v[40:43], a[96:99], a[64:67], v[40:43]
    ds_read_b128 a[44:47], v19 offset:11264
    v_mfma_f32_16x16x32_bf16 v[44:47], a[96:99], a[68:71], v[44:47]
    ds_read_b128 a[48:51], v19 offset:12288
    v_mfma_f32_16x16x32_bf16 v[48:51], a[100:103], a[64:67], v[48:51]
    v_mfma_f32_16x16x32_bf16 v[52:55], a[100:103], a[68:71], v[52:55]
    v_mfma_f32_16x16x32_bf16 v[56:59], a[104:107], a[64:67], v[56:59]
    v_mfma_f32_16x16x32_bf16 v[60:63], a[104:107], a[68:71], v[60:63]
    s_waitcnt lgkmcnt(0)
    v_mfma_f32_16x16x32_bf16 v[32:35], a[16:19], a[0:3], v[32:35]
    ds_read_b128 a[56:59], v9 offset:0
    v_mfma_f32_16x16x32_bf16 v[36:39], a[16:19], a[4:7], v[36:39]
    ds_read_b128 a[60:63], v9 offset:2048
    v_mfma_f32_16x16x32_bf16 v[40:43], a[20:23], a[0:3], v[40:43]
    ds_read_b128 a[64:67], v13 offset:0
    v_mfma_f32_16x16x32_bf16 v[44:47], a[20:23], a[4:7], v[44:47]
    ds_read_b128 a[68:71], v13 offset:2048
    v_mfma_f32_16x16x32_bf16 v[48:51], a[24:27], a[0:3], v[48:51]
    ds_read_b128 a[72:75], v17 offset:4096
    v_mfma_f32_16x16x32_bf16 v[52:55], a[24:27], a[4:7], v[52:55]
    ds_read_b128 a[76:79], v17 offset:5120
    v_mfma_f32_16x16x32_bf16 v[56:59], a[28:31], a[0:3], v[56:59]
    ds_read_b128 a[80:83], v17 offset:6144
    v_mfma_f32_16x16x32_bf16 v[60:63], a[28:31], a[4:7], v[60:63]
    ds_read_b128 a[84:87], v17 offset:7168
    v_mfma_f32_16x16x32_bf16 v[32:35], a[36:39], a[8:11], v[32:35]
    ds_read_b128 a[88:91], v17 offset:8192
    v_mfma_f32_16x16x32_bf16 v[36:39], a[36:39], a[12:15], v[36:39]
    ds_read_b128 a[92:95], v17 offset:13312
    v_mfma_f32_16x16x32_bf16 v[40:43], a[40:43], a[8:11], v[40:43]
    ds_read_b128 a[96:99], v17 offset:14336
    v_mfma_f32_16x16x32_bf16 v[44:47], a[40:43], a[12:15], v[44:47]
    ds_read_b128 a[100:103], v17 offset:15360
    v_mfma_f32_16x16x32_bf16 v[48:51], a[44:47], a[8:11], v[48:51]
    ds_read_b128 a[104:107], v17 offset:16384
    v_mfma_f32_16x16x32_bf16 v[52:55], a[44:47], a[12:15], v[52:55]
    ds_read_b128 a[108:111], v17 offset:17408
    v_mfma_f32_16x16x32_bf16 v[56:59], a[48:51], a[8:11], v[56:59]
    v_mfma_f32_16x16x32_bf16 v[60:63], a[48:51], a[12:15], v[60:63]
    s_waitcnt lgkmcnt(0)
    v_mfma_f32_16x16x32_bf16 v[64:67], a[72:75], a[56:59], v[64:67]
    ds_read_b128 a[0:3], v10 offset:0
    v_mfma_f32_16x16x32_bf16 v[68:71], a[72:75], a[60:63], v[68:71]
    ds_read_b128 a[4:7], v10 offset:2048
    v_mfma_f32_16x16x32_bf16 v[72:75], a[76:79], a[56:59], v[72:75]
    ds_read_b128 a[8:11], v14 offset:0
    v_mfma_f32_16x16x32_bf16 v[76:79], a[76:79], a[60:63], v[76:79]
    ds_read_b128 a[12:15], v14 offset:2048
    v_mfma_f32_16x16x32_bf16 v[80:83], a[80:83], a[56:59], v[80:83]
    ds_read_b128 a[16:19], v18 offset:4096
    v_mfma_f32_16x16x32_bf16 v[84:87], a[80:83], a[60:63], v[84:87]
    ds_read_b128 a[20:23], v18 offset:5120
    v_mfma_f32_16x16x32_bf16 v[88:91], a[84:87], a[56:59], v[88:91]
    ds_read_b128 a[24:27], v18 offset:6144
    v_mul_f32 v32, v32, v104
    v_mfma_f32_16x16x32_bf16 v[92:95], a[84:87], a[60:63], v[92:95]
    ds_read_b128 a[28:31], v18 offset:7168
    v_mul_f32 v33, v33, v105
    v_mfma_f32_16x16x32_bf16 v[96:99], a[88:91], a[56:59], v[96:99]
    ds_read_b128 a[32:35], v18 offset:8192
    v_mul_f32 v34, v34, v106
    v_mfma_f32_16x16x32_bf16 v[100:103], a[88:91], a[60:63], v[100:103]
    ds_read_b128 a[36:39], v18 offset:13312
    v_mul_f32 v35, v35, v107
    v_mfma_f32_16x16x32_bf16 v[64:67], a[92:95], a[64:67], v[64:67]
    ds_read_b128 a[40:43], v18 offset:14336
    v_cvt_pk_bf16_f32 v104, v32, v33
    v_mfma_f32_16x16x32_bf16 v[68:71], a[92:95], a[68:71], v[68:71]
    ds_read_b128 a[44:47], v18 offset:15360
    v_cvt_pk_bf16_f32 v105, v34, v35
    v_mfma_f32_16x16x32_bf16 v[72:75], a[96:99], a[64:67], v[72:75]
    ds_read_b128 a[48:51], v18 offset:16384
    v_mul_f32 v40, v40, v112
    v_mfma_f32_16x16x32_bf16 v[76:79], a[96:99], a[68:71], v[76:79]
    ds_read_b128 a[52:55], v18 offset:17408
    v_mul_f32 v41, v41, v113
    v_mfma_f32_16x16x32_bf16 v[80:83], a[100:103], a[64:67], v[80:83]
    v_mul_f32 v42, v42, v114
    v_mfma_f32_16x16x32_bf16 v[84:87], a[100:103], a[68:71], v[84:87]
    v_mul_f32 v43, v43, v115
    v_mfma_f32_16x16x32_bf16 v[88:91], a[104:107], a[64:67], v[88:91]
    v_cvt_pk_bf16_f32 v106, v40, v41
    v_mfma_f32_16x16x32_bf16 v[92:95], a[104:107], a[68:71], v[92:95]
    v_cvt_pk_bf16_f32 v107, v42, v43
    v_mfma_f32_16x16x32_bf16 v[96:99], a[108:111], a[64:67], v[96:99]
    buffer_store_dwordx4 v[104:107], v6, s[12:15], s50 offen offset:0 sc1
    v_mfma_f32_16x16x32_bf16 v[100:103], a[108:111], a[68:71], v[100:103]
    v_mul_f32 v36, v36, v108
    s_waitcnt lgkmcnt(0)
    v_mfma_f32_16x16x32_bf16 v[64:67], a[16:19], a[0:3], v[64:67]
    ds_read_b128 a[56:59], v11 offset:0
    v_mul_f32 v37, v37, v109
    v_mfma_f32_16x16x32_bf16 v[68:71], a[16:19], a[4:7], v[68:71]
    ds_read_b128 a[60:63], v11 offset:2048
    v_mul_f32 v38, v38, v110
    v_mfma_f32_16x16x32_bf16 v[72:75], a[20:23], a[0:3], v[72:75]
    ds_read_b128 a[64:67], v15 offset:0
    v_mul_f32 v39, v39, v111
    v_mfma_f32_16x16x32_bf16 v[76:79], a[20:23], a[4:7], v[76:79]
    ds_read_b128 a[68:71], v15 offset:2048
    v_cvt_pk_bf16_f32 v108, v36, v37
    v_mfma_f32_16x16x32_bf16 v[80:83], a[24:27], a[0:3], v[80:83]
    ds_read_b128 a[72:75], v19 offset:4096
    v_cvt_pk_bf16_f32 v109, v38, v39
    v_mfma_f32_16x16x32_bf16 v[84:87], a[24:27], a[4:7], v[84:87]
    ds_read_b128 a[76:79], v19 offset:5120
    v_mul_f32 v44, v44, v116
    v_mfma_f32_16x16x32_bf16 v[88:91], a[28:31], a[0:3], v[88:91]
    ds_read_b128 a[80:83], v19 offset:6144
    v_mul_f32 v45, v45, v117
    v_mfma_f32_16x16x32_bf16 v[92:95], a[28:31], a[4:7], v[92:95]
    ds_read_b128 a[84:87], v19 offset:7168
    v_mul_f32 v46, v46, v118
    v_mfma_f32_16x16x32_bf16 v[96:99], a[32:35], a[0:3], v[96:99]
    ds_read_b128 a[88:91], v19 offset:8192
    v_mul_f32 v47, v47, v119
    v_mfma_f32_16x16x32_bf16 v[100:103], a[32:35], a[4:7], v[100:103]
    ds_read_b128 a[92:95], v19 offset:13312
    v_cvt_pk_bf16_f32 v110, v44, v45
    v_mfma_f32_16x16x32_bf16 v[64:67], a[36:39], a[8:11], v[64:67]
    ds_read_b128 a[96:99], v19 offset:14336
    v_cvt_pk_bf16_f32 v111, v46, v47
    v_mfma_f32_16x16x32_bf16 v[68:71], a[36:39], a[12:15], v[68:71]
    ds_read_b128 a[100:103], v19 offset:15360
    buffer_store_dwordx4 v[108:111], v6, s[12:15], s51 offen offset:0 sc1
    v_mfma_f32_16x16x32_bf16 v[72:75], a[40:43], a[8:11], v[72:75]
    ds_read_b128 a[104:107], v19 offset:16384
    v_mul_f32 v48, v48, v120
    v_mfma_f32_16x16x32_bf16 v[76:79], a[40:43], a[12:15], v[76:79]
    ds_read_b128 a[108:111], v19 offset:17408
    v_mul_f32 v49, v49, v121
    v_mul_f32 v50, v50, v122
    v_mfma_f32_16x16x32_bf16 v[80:83], a[44:47], a[8:11], v[80:83]
    v_mul_f32 v51, v51, v123
    v_cvt_pk_bf16_f32 v120, v48, v49
    v_mfma_f32_16x16x32_bf16 v[84:87], a[44:47], a[12:15], v[84:87]
    v_cvt_pk_bf16_f32 v121, v50, v51
    v_mul_f32 v56, v56, v128
    v_mfma_f32_16x16x32_bf16 v[88:91], a[48:51], a[8:11], v[88:91]
    v_mul_f32 v57, v57, v129
    v_mul_f32 v58, v58, v130
    v_mfma_f32_16x16x32_bf16 v[92:95], a[48:51], a[12:15], v[92:95]
    v_mul_f32 v59, v59, v131
    v_cvt_pk_bf16_f32 v122, v56, v57
    v_mfma_f32_16x16x32_bf16 v[96:99], a[52:55], a[8:11], v[96:99]
    v_cvt_pk_bf16_f32 v123, v58, v59
    buffer_store_dwordx4 v[120:123], v6, s[12:15], s50 offen offset:1024 sc1
    v_mfma_f32_16x16x32_bf16 v[100:103], a[52:55], a[12:15], v[100:103]
    v_mul_f32 v52, v52, v124
    v_mul_f32 v53, v53, v125
    s_waitcnt lgkmcnt(0)
    v_mfma_f32_16x16x32_bf16 v[64:67], a[72:75], a[56:59], v[64:67]
    v_mul_f32 v54, v54, v126
    v_mul_f32 v55, v55, v127
    v_mfma_f32_16x16x32_bf16 v[68:71], a[72:75], a[60:63], v[68:71]
    v_cvt_pk_bf16_f32 v124, v52, v53
    v_cvt_pk_bf16_f32 v125, v54, v55
    v_mfma_f32_16x16x32_bf16 v[72:75], a[76:79], a[56:59], v[72:75]
    v_mul_f32 v60, v60, v132
    v_mul_f32 v61, v61, v133
    v_mfma_f32_16x16x32_bf16 v[76:79], a[76:79], a[60:63], v[76:79]
    v_mul_f32 v62, v62, v134
    v_mul_f32 v63, v63, v135
    v_mfma_f32_16x16x32_bf16 v[80:83], a[80:83], a[56:59], v[80:83]
    v_cvt_pk_bf16_f32 v126, v60, v61
    v_cvt_pk_bf16_f32 v127, v62, v63
    v_mfma_f32_16x16x32_bf16 v[84:87], a[80:83], a[60:63], v[84:87]
    buffer_store_dwordx4 v[124:127], v6, s[12:15], s51 offen offset:1024 sc1
    v_mfma_f32_16x16x32_bf16 v[88:91], a[84:87], a[56:59], v[88:91]
    v_mfma_f32_16x16x32_bf16 v[92:95], a[84:87], a[60:63], v[92:95]
    v_mfma_f32_16x16x32_bf16 v[96:99], a[88:91], a[56:59], v[96:99]
    v_mfma_f32_16x16x32_bf16 v[100:103], a[88:91], a[60:63], v[100:103]
    v_mfma_f32_16x16x32_bf16 v[64:67], a[92:95], a[64:67], v[64:67]
    v_mfma_f32_16x16x32_bf16 v[68:71], a[92:95], a[68:71], v[68:71]
    v_mfma_f32_16x16x32_bf16 v[72:75], a[96:99], a[64:67], v[72:75]
    v_mfma_f32_16x16x32_bf16 v[76:79], a[96:99], a[68:71], v[76:79]
    v_mfma_f32_16x16x32_bf16 v[80:83], a[100:103], a[64:67], v[80:83]
    v_mfma_f32_16x16x32_bf16 v[84:87], a[100:103], a[68:71], v[84:87]
    v_mfma_f32_16x16x32_bf16 v[88:91], a[104:107], a[64:67], v[88:91]
    v_mfma_f32_16x16x32_bf16 v[92:95], a[104:107], a[68:71], v[92:95]
    v_mfma_f32_16x16x32_bf16 v[96:99], a[108:111], a[64:67], v[96:99]
    v_mfma_f32_16x16x32_bf16 v[100:103], a[108:111], a[68:71], v[100:103]
LB_p5:
    s_bfe_u32 s26, s2, 0x20001
    s_lshl_b32 s26, s26, 3
    s_lshr_b32 s27, s2, 5
    s_add_u32 s28, s26, s27
    s_and_b32 s26, s2, 1
    s_lshl_b32 s26, s26, 2
    s_bfe_u32 s27, s2, 0x20003
    s_add_u32 s29, s26, s27
    s_mul_i32 s54, s29, 331776
    s_add_u32 s54, s54, s55
    s_add_u32 s54, s54, 0xf00000
    s_barrier
    v_pk_mul_f32 v[64:65], v[64:65], v[136:137]
    v_pk_mul_f32 v[66:67], v[66:67], v[138:139]
    v_cvt_pk_bf16_f32 v136, v64, v65
    v_cvt_pk_bf16_f32 v137, v66, v67
    v_pk_mul_f32 v[72:73], v[72:73], v[144:145]
    v_pk_mul_f32 v[74:75], v[74:75], v[146:147]
    v_cvt_pk_bf16_f32 v138, v72, v73
    v_cvt_pk_bf16_f32 v139, v74, v75
    buffer_store_dwordx4 v[136:139], v6, s[12:15], s52 offen offset:0 sc1
    v_pk_mul_f32 v[80:81], v[80:81], v[152:153]
    v_pk_mul_f32 v[82:83], v[82:83], v[154:155]
    v_cvt_pk_bf16_f32 v152, v80, v81
    v_cvt_pk_bf16_f32 v153, v82, v83
    v_pk_mul_f32 v[88:89], v[88:89], v[160:161]
    v_pk_mul_f32 v[90:91], v[90:91], v[162:163]
    v_cvt_pk_bf16_f32 v154, v88, v89
    v_cvt_pk_bf16_f32 v155, v90, v91
    buffer_store_dwordx4 v[152:155], v6, s[12:15], s52 offen offset:1024 sc1
    v_pk_mul_f32 v[96:97], v[96:97], v[168:169]
    v_pk_mul_f32 v[98:99], v[98:99], v[170:171]
    v_cvt_pk_bf16_f32 v168, v96, v97
    v_cvt_pk_bf16_f32 v169, v98, v99
    buffer_store_dwordx2 v[168:169], v6, s[12:15], s18 offen sc1
    v_pk_mul_f32 v[68:69], v[68:69], v[140:141]
    v_pk_mul_f32 v[70:71], v[70:71], v[142:143]
    v_cvt_pk_bf16_f32 v140, v68, v69
    v_cvt_pk_bf16_f32 v141, v70, v71
    v_pk_mul_f32 v[76:77], v[76:77], v[148:149]
    v_pk_mul_f32 v[78:79], v[78:79], v[150:151]
    v_cvt_pk_bf16_f32 v142, v76, v77
    v_cvt_pk_bf16_f32 v143, v78, v79
    buffer_store_dwordx4 v[140:143], v6, s[12:15], s53 offen offset:0 sc1
    v_pk_mul_f32 v[84:85], v[84:85], v[156:157]
    v_pk_mul_f32 v[86:87], v[86:87], v[158:159]
    v_cvt_pk_bf16_f32 v156, v84, v85
    v_cvt_pk_bf16_f32 v157, v86, v87
    v_pk_mul_f32 v[92:93], v[92:93], v[164:165]
    v_pk_mul_f32 v[94:95], v[94:95], v[166:167]
    v_cvt_pk_bf16_f32 v158, v92, v93
    v_cvt_pk_bf16_f32 v159, v94, v95
    buffer_store_dwordx4 v[156:159], v6, s[12:15], s53 offen offset:1024 sc1
    v_pk_mul_f32 v[100:101], v[100:101], v[172:173]
    v_pk_mul_f32 v[102:103], v[102:103], v[174:175]
    v_cvt_pk_bf16_f32 v172, v100, v101
    v_cvt_pk_bf16_f32 v173, v102, v103
    buffer_store_dwordx2 v[172:173], v6, s[12:15], s19 offen sc1
    v_mov_b32 v2, v6
    v_lshrrev_b32 v4, 4, v1
    s_lshr_b32 s48, s44, 2
    s_lshl_b32 s48, s48, 11
    s_lshr_b32 s43, s49, 11
    s_and_b32 s43, s43, 15
    s_lshl_b32 s43, s43, 7
    s_add_u32 s48, s48, s43
    s_add_u32 s48, s48, 0x1d0000
    s_lshr_b32 s49, s28, 1
    s_lshl_b32 s49, s49, 11
    s_add_u32 s49, s49, 0x1d0000
    v_lshlrev_b32 v20, 7, v1
    v_mov_b32 v21, 0
    s_waitcnt vmcnt(6)
    s_barrier
    s_cmp_lg_u32 s30, 0
    s_cbranch_scc1 LB_y1_s
    s_mov_b64 exec, 1
    buffer_store_dword v21, v21, s[12:15], s48 offen sc1
    s_mov_b64 exec, -1
LB_y1_s:
    s_add_u32 s48, s48, 0x8000
    s_add_u32 m0, s55, 0
    s_mov_b64 exec, s[64:65]
    buffer_load_dwordx4 v6, s[12:15], s54 offen lds
    s_mov_b64 exec, -1
    buffer_load_dwordx4 v6, s[12:15], s54 offen offset:512 lds
    buffer_load_dwordx4 v6, s[12:15], s54 offen offset:1536 lds
    buffer_load_dwordx4 v6, s[12:15], s54 offen offset:2560 lds
    buffer_load_dwordx4 v6, s[12:15], s54 offen offset:3584 lds
    s_add_u32 s54, s54, 18432
    s_add_u32 m0, s55, 18432
    s_mov_b64 exec, s[64:65]
    buffer_load_dwordx4 v6, s[12:15], s54 offen lds
    s_mov_b64 exec, -1
    buffer_load_dwordx4 v6, s[12:15], s54 offen offset:512 lds
    buffer_load_dwordx4 v6, s[12:15], s54 offen offset:1536 lds
    buffer_load_dwordx4 v6, s[12:15], s54 offen offset:2560 lds
    buffer_load_dwordx4 v6, s[12:15], s54 offen offset:3584 lds
    s_add_u32 s54, s54, 18432
    s_add_u32 m0, s55, 36864
    s_mov_b64 exec, s[64:65]
    buffer_load_dwordx4 v6, s[12:15], s54 offen lds
    s_mov_b64 exec, -1
    buffer_load_dwordx4 v6, s[12:15], s54 offen offset:512 lds
    s_lshl_b32 s31, s28, 2
    s_add_u32 s31, s31, s30
    s_and_b32 s40, s31, -2
    s_mul_i32 s40, s40, 73728
    s_and_b32 s35, s30, 1
    s_lshl_b32 s36, s35, 11
    s_add_u32 s40, s40, s36
    s_add_u32 s40, s40, 0x2200000
    s_mul_i32 s31, s31, 18432
    s_mul_i32 s36, s35, 73728
    v_add_u32 v158, s36, v2
    s_sub_u32 s36, 73728, s36
    v_add_u32 v159, s36, v2
    s_mul_i32 s35, s35, 9216
    s_mul_i32 s36, s30, 6144
    v_add_u32 v160, s36, v2
    s_xor_b32 s36, s30, 1
    s_mul_i32 s36, s36, 6144
    v_add_u32 v161, s36, v2
    v_add_u32 v160, 0x10000, v160
    v_add_u32 v161, 0x10000, v161
    s_lshl_b32 s42, s29, 11
    s_add_u32 s42, s42, s31
    s_add_u32 s42, s42, 0x800000
    s_lshr_b32 s43, s29, 2
    s_lshl_b32 s43, s43, 10
    s_and_b32 s44, s29, 3
    s_lshl_b32 s44, s44, 8
    s_add_u32 s43, s43, s44
    s_add_u32 s41, s43, s31
    s_add_u32 s41, s41, 0x804000
    v_and_b32 v5, 15, v1
    v_lshlrev_b32 v5, 4, v5
    v_and_b32 v7, 1, v4
    v_lshl_add_u32 v5, v7, 3, v5
    s_lshl_b32 s45, s30, 10
    s_add_u32 s45, s45, 147456
    s_mul_i32 s44, s29, 288
    s_add_u32 s44, s44, 0x102d00
    v_add_u32 v8, s35, v2
    v_add_u32 v9, 18432, v8
    v_add_u32 v10, 36864, v8
    v_add_u32 v11, 55296, v8
    v_add_u32 v12, 73728, v8
    v_add_u32 v13, 92160, v8
    v_add_u32 v14, 110592, v8
    v_add_u32 v15, 129024, v8
    buffer_load_dwordx4 v6, s[12:15], s54 offen offset:1536 lds
    buffer_load_dwordx4 v6, s[12:15], s54 offen offset:2560 lds
    buffer_load_dwordx4 v6, s[12:15], s54 offen offset:3584 lds
    s_add_u32 s54, s54, 18432
    s_add_u32 m0, s55, 55296
    s_mov_b64 exec, s[64:65]
    buffer_load_dwordx4 v6, s[12:15], s54 offen lds
    s_mov_b64 exec, -1
    buffer_load_dwordx4 v6, s[12:15], s54 offen offset:512 lds
    buffer_load_dwordx4 v6, s[12:15], s54 offen offset:1536 lds
    buffer_load_dwordx4 v6, s[12:15], s54 offen offset:2560 lds
    buffer_load_dwordx4 v6, s[12:15], s54 offen offset:3584 lds
    s_add_u32 s54, s54, 18432
    s_add_u32 m0, s55, 73728
    s_mov_b64 exec, s[64:65]
    buffer_load_dwordx4 v6, s[12:15], s54 offen lds
    s_mov_b64 exec, -1
    buffer_load_dwordx4 v6, s[12:15], s54 offen offset:512 lds
    buffer_load_dwordx4 v6, s[12:15], s54 offen offset:1536 lds
    buffer_load_dwordx4 v6, s[12:15], s54 offen offset:2560 lds
    buffer_load_dwordx4 v6, s[12:15], s54 offen offset:3584 lds
    s_add_u32 s54, s54, 18432
    s_add_u32 m0, s55, 92160
    s_mov_b64 exec, s[64:65]
    buffer_load_dwordx4 v6, s[12:15], s54 offen lds
    s_mov_b64 exec, -1
    buffer_load_dwordx4 v6, s[12:15], s54 offen offset:512 lds
    buffer_load_dwordx4 v6, s[12:15], s54 offen offset:1536 lds
    buffer_load_dwordx4 v6, s[12:15], s54 offen offset:2560 lds
    buffer_load_dwordx4 v6, s[12:15], s54 offen offset:3584 lds
    s_add_u32 s54, s54, 18432
    s_add_u32 m0, s55, 110592
    s_mov_b64 exec, s[64:65]
    buffer_load_dwordx4 v6, s[12:15], s54 offen lds
    s_mov_b64 exec, -1
    buffer_load_dwordx4 v6, s[12:15], s54 offen offset:512 lds
    buffer_load_dwordx4 v6, s[12:15], s54 offen offset:1536 lds
    buffer_load_dwordx4 v6, s[12:15], s54 offen offset:2560 lds
    buffer_load_dwordx4 v6, s[12:15], s54 offen offset:3584 lds
    s_add_u32 s54, s54, 18432
    s_add_u32 m0, s55, 129024
    s_mov_b64 exec, s[64:65]
    buffer_load_dwordx4 v6, s[12:15], s54 offen lds
    s_mov_b64 exec, -1
    buffer_load_dwordx4 v6, s[12:15], s54 offen offset:512 lds
    buffer_load_dwordx4 v6, s[12:15], s54 offen offset:1536 lds
    buffer_load_dwordx4 v6, s[12:15], s54 offen offset:2560 lds
    buffer_load_dwordx4 v6, s[12:15], s54 offen offset:3584 lds
    s_add_u32 s54, s54, 18432
    s_waitcnt vmcnt(30)
    s_barrier
    s_cmp_lg_u32 s30, 0
    s_cbranch_scc1 LB_y_s
    s_mov_b64 exec, 1
    buffer_store_dword v21, v21, s[12:15], s48 offen sc1
    s_mov_b64 exec, -1
LB_y_s:
    ds_read_b128 v[64:67], v8 offset:0
    ds_read_b128 v[68:71], v8 offset:1024
    ds_read_b128 v[72:75], v8 offset:2048
    ds_read_b128 v[76:79], v8 offset:3072
    ds_read_b128 v[96:99], v8 offset:8192
    ds_read_b128 v[80:83], v8 offset:4096
    ds_read_b128 v[84:87], v8 offset:5120
    ds_read_b128 v[88:91], v8 offset:6144
    ds_read_b128 v[92:95], v8 offset:7168
    ds_read_b128 v[100:103], v9 offset:0
    ds_read_b128 v[104:107], v9 offset:1024
    ds_read_b128 v[108:111], v9 offset:2048
    ds_read_b128 v[112:115], v9 offset:3072
    ds_read_b128 v[132:135], v9 offset:8192
    ds_read_b128 v[116:119], v9 offset:4096
    ds_read_b128 v[120:123], v9 offset:5120
    ds_read_b128 v[124:127], v9 offset:6144
    ds_read_b128 v[128:131], v9 offset:7168
    buffer_load_dwordx4 v[184:187], v2, s[12:15], s42 offen
    buffer_load_dwordx4 v[188:191], v2, s[12:15], s42 offen offset:1024
    buffer_load_dwordx2 v[192:193], v5, s[12:15], s41 offen
    s_mov_b32 m0, s45
    s_mov_b32 exec_hi, 0
    buffer_load_dwordx4 v2, s[12:15], s44 offen lds
    s_mov_b64 exec, -1
    s_mov_b32 s8, s22
    s_and_b32 s9, s23, 0xffff
    s_mov_b32 s10, 0x240000
    s_mov_b32 s11, 0x00020000
    v_and_b32 v3, 15, v1
    v_lshrrev_b32 v7, 2, v3
    v_lshlrev_b32 v7, 3, v7
    v_and_b32 v3, 3, v3
    v_add_u32 v3, v3, v7
    s_lshl_b32 s26, s28, 6
    s_lshr_b32 s27, s30, 1
    s_lshl_b32 s27, s27, 5
    s_add_u32 s26, s26, s27
    s_and_b32 s27, s30, 1
    s_lshl_b32 s27, s27, 2
    s_add_u32 s26, s26, s27
    v_add_u32 v3, s26, v3
    v_mul_u32_u24 v3, 1152, v3
    v_lshl_add_u32 v7, v4, 3, v3
    v_lshl_add_u32 v3, v4, 4, v3
    s_mul_i32 s46, s29, 144
    s_mov_b32 s47, 0xffff0000
    s_waitcnt lgkmcnt(0)
    s_cmp_lg_u32 s30, 1
    s_cbranch_scc1 LB_y_2
    s_mov_b32 s43, 0x4000
    s_mov_b32 exec_lo, 0xffff
    s_mov_b32 exec_hi, 0
    s_branch LB_y_1
LB_y_0:
    s_sleep 4
LB_y_1:
    buffer_load_dword v22, v20, s[12:15], s49 offen sc1
    s_waitcnt vmcnt(0)
    v_cmp_eq_u32 vcc, -1, v22
    s_sub_u32 s43, s43, 1
    s_cmp_eq_u32 s43, 0
    s_cbranch_vccz LB_y_3
    s_cbranch_scc0 LB_y_0
LB_y_3:
    s_mov_b64 exec, -1
LB_y_2:
    s_barrier
    s_add_u32 s49, s49, 0x8000
    v_lshlrev_b32 v162, 7, v1
    buffer_load_dwordx4 a[0:3], v158, s[12:15], s40 offen offset:0 sc1
    buffer_load_dwordx4 a[4:7], v159, s[12:15], s40 offen offset:0 sc1
    buffer_load_dwordx4 a[8:11], v158, s[12:15], s40 offen offset:1024 sc1
    buffer_load_dwordx4 a[12:15], v159, s[12:15], s40 offen offset:1024 sc1
    s_add_u32 s40, s40, 4096
    buffer_load_dwordx4 a[16:19], v158, s[12:15], s40 offen offset:0 sc1
    buffer_load_dwordx4 a[20:23], v159, s[12:15], s40 offen offset:0 sc1
    buffer_load_dwordx4 a[24:27], v158, s[12:15], s40 offen offset:1024 sc1
    buffer_load_dwordx4 a[28:31], v159, s[12:15], s40 offen offset:1024 sc1
    s_add_u32 s40, s40, 4096
    buffer_load_dwordx4 a[32:35], v158, s[12:15], s40 offen offset:0 sc1
    buffer_load_dwordx4 a[36:39], v159, s[12:15], s40 offen offset:0 sc1
    buffer_load_dwordx4 a[40:43], v158, s[12:15], s40 offen offset:1024 sc1
    buffer_load_dwordx4 a[44:47], v159, s[12:15], s40 offen offset:1024 sc1
    s_add_u32 s40, s40, 4096
    v_lshl_add_u32 v5, v4, 5, s45
    v_lshl_add_u32 v156, v4, 4, s45
    s_waitcnt vmcnt(8)
    v_mfma_f32_16x16x32_bf16 v[16:19], v[64:67], a[0:3], 0
    v_mfma_f32_16x16x32_bf16 v[40:43], v[64:67], a[4:7], 0
    buffer_load_dwordx4 a[48:51], v158, s[12:15], s40 offen offset:0 sc1
    v_mfma_f32_16x16x32_bf16 v[20:23], v[68:71], a[0:3], 0
    v_mfma_f32_16x16x32_bf16 v[44:47], v[68:71], a[4:7], 0
    buffer_load_dwordx4 a[52:55], v159, s[12:15], s40 offen offset:0 sc1
    v_mfma_f32_16x16x32_bf16 v[24:27], v[72:75], a[0:3], 0
    v_mfma_f32_16x16x32_bf16 v[48:51], v[72:75], a[4:7], 0
    buffer_load_dwordx4 a[56:59], v158, s[12:15], s40 offen offset:1024 sc1
    v_mfma_f32_16x16x32_bf16 v[28:31], v[76:79], a[0:3], 0
    v_mfma_f32_16x16x32_bf16 v[52:55], v[76:79], a[4:7], 0
    buffer_load_dwordx4 a[60:63], v159, s[12:15], s40 offen offset:1024 sc1
    s_add_u32 s40, s40, 4096
    v_mfma_f32_16x16x32_bf16 v[32:35], v[96:99], a[0:3], 0
    v_mfma_f32_16x16x32_bf16 v[56:59], v[96:99], a[4:7], 0
    s_add_u32 m0, s55, 0
    s_mov_b64 exec, s[64:65]
    buffer_load_dwordx4 v6, s[12:15], s54 offen lds
    s_mov_b64 exec, -1
    v_mfma_f32_16x16x32_bf16 v[16:19], v[80:83], a[8:11], v[16:19]
    v_mfma_f32_16x16x32_bf16 v[40:43], v[80:83], a[12:15], v[40:43]
    buffer_load_dwordx4 v6, s[12:15], s54 offen offset:512 lds
    v_mfma_f32_16x16x32_bf16 v[20:23], v[84:87], a[8:11], v[20:23]
    v_mfma_f32_16x16x32_bf16 v[44:47], v[84:87], a[12:15], v[44:47]
    buffer_load_dwordx4 v6, s[12:15], s54 offen offset:1536 lds
    v_mfma_f32_16x16x32_bf16 v[24:27], v[88:91], a[8:11], v[24:27]
    v_mfma_f32_16x16x32_bf16 v[48:51], v[88:91], a[12:15], v[48:51]
    buffer_load_dwordx4 v6, s[12:15], s54 offen offset:2560 lds
    v_mfma_f32_16x16x32_bf16 v[28:31], v[92:95], a[8:11], v[28:31]
    v_mfma_f32_16x16x32_bf16 v[52:55], v[92:95], a[12:15], v[52:55]
    v_mfma_f32_16x16x32_bf16 v[36:39], v[96:99], a[8:11], 0
    v_mfma_f32_16x16x32_bf16 v[60:63], v[96:99], a[12:15], 0
    s_waitcnt vmcnt(12)
    s_barrier
    v_mfma_f32_16x16x32_bf16 v[16:19], v[100:103], a[16:19], v[16:19]
    ds_read_b128 v[64:67], v10 offset:0
    v_mfma_f32_16x16x32_bf16 v[40:43], v[100:103], a[20:23], v[40:43]
    buffer_load_dwordx4 v6, s[12:15], s54 offen offset:3584 lds
    s_add_u32 s54, s54, 18432
    v_mfma_f32_16x16x32_bf16 v[20:23], v[104:107], a[16:19], v[20:23]
    ds_read_b128 v[68:71], v10 offset:1024
    v_mfma_f32_16x16x32_bf16 v[44:47], v[104:107], a[20:23], v[44:47]
    buffer_load_dwordx4 a[64:67], v158, s[12:15], s40 offen offset:0 sc1
    v_mfma_f32_16x16x32_bf16 v[24:27], v[108:111], a[16:19], v[24:27]
    ds_read_b128 v[72:75], v10 offset:2048
    v_mfma_f32_16x16x32_bf16 v[48:51], v[108:111], a[20:23], v[48:51]
    buffer_load_dwordx4 a[68:71], v159, s[12:15], s40 offen offset:0 sc1
    v_mfma_f32_16x16x32_bf16 v[28:31], v[112:115], a[16:19], v[28:31]
    ds_read_b128 v[76:79], v10 offset:3072
    v_mfma_f32_16x16x32_bf16 v[52:55], v[112:115], a[20:23], v[52:55]
    buffer_load_dwordx4 a[72:75], v158, s[12:15], s40 offen offset:1024 sc1
    v_mfma_f32_16x16x32_bf16 v[32:35], v[132:135], a[16:19], v[32:35]
    ds_read_b128 v[96:99], v10 offset:8192
    v_mfma_f32_16x16x32_bf16 v[56:59], v[132:135], a[20:23], v[56:59]
    buffer_load_dwordx4 a[76:79], v159, s[12:15], s40 offen offset:1024 sc1
    s_add_u32 s40, s40, 4096
    v_mfma_f32_16x16x32_bf16 v[16:19], v[116:119], a[24:27], v[16:19]
    ds_read_b128 v[80:83], v10 offset:4096
    v_mfma_f32_16x16x32_bf16 v[40:43], v[116:119], a[28:31], v[40:43]
    s_add_u32 m0, s55, 18432
    s_mov_b64 exec, s[64:65]
    buffer_load_dwordx4 v6, s[12:15], s54 offen lds
    s_mov_b64 exec, -1
    v_mfma_f32_16x16x32_bf16 v[20:23], v[120:123], a[24:27], v[20:23]
    ds_read_b128 v[84:87], v10 offset:5120
    v_mfma_f32_16x16x32_bf16 v[44:47], v[120:123], a[28:31], v[44:47]
    buffer_load_dwordx4 v6, s[12:15], s54 offen offset:512 lds
    v_mfma_f32_16x16x32_bf16 v[24:27], v[124:127], a[24:27], v[24:27]
    ds_read_b128 v[88:91], v10 offset:6144
    v_mfma_f32_16x16x32_bf16 v[48:51], v[124:127], a[28:31], v[48:51]
    buffer_load_dwordx4 v6, s[12:15], s54 offen offset:1536 lds
    v_mfma_f32_16x16x32_bf16 v[28:31], v[128:131], a[24:27], v[28:31]
    ds_read_b128 v[92:95], v10 offset:7168
    v_mfma_f32_16x16x32_bf16 v[52:55], v[128:131], a[28:31], v[52:55]
    v_mfma_f32_16x16x32_bf16 v[36:39], v[132:135], a[24:27], v[36:39]
    v_mfma_f32_16x16x32_bf16 v[60:63], v[132:135], a[28:31], v[60:63]
    s_waitcnt vmcnt(16)
    s_barrier
    s_waitcnt lgkmcnt(7)
    v_mfma_f32_16x16x32_bf16 v[16:19], v[64:67], a[32:35], v[16:19]
    ds_read_b128 v[100:103], v11 offset:0
    v_mfma_f32_16x16x32_bf16 v[40:43], v[64:67], a[36:39], v[40:43]
    buffer_load_dwordx4 v6, s[12:15], s54 offen offset:2560 lds
    v_mfma_f32_16x16x32_bf16 v[20:23], v[68:71], a[32:35], v[20:23]
    ds_read_b128 v[104:107], v11 offset:1024
    v_mfma_f32_16x16x32_bf16 v[44:47], v[68:71], a[36:39], v[44:47]
    buffer_load_dwordx4 v6, s[12:15], s54 offen offset:3584 lds
    s_add_u32 s54, s54, 18432
    s_waitcnt lgkmcnt(7)
    v_mfma_f32_16x16x32_bf16 v[24:27], v[72:75], a[32:35], v[24:27]
    ds_read_b128 v[108:111], v11 offset:2048
    v_mfma_f32_16x16x32_bf16 v[48:51], v[72:75], a[36:39], v[48:51]
    buffer_load_dwordx4 a[80:83], v158, s[12:15], s40 offen offset:0 sc1
    v_mfma_f32_16x16x32_bf16 v[28:31], v[76:79], a[32:35], v[28:31]
    ds_read_b128 v[112:115], v11 offset:3072
    v_mfma_f32_16x16x32_bf16 v[52:55], v[76:79], a[36:39], v[52:55]
    buffer_load_dwordx4 a[84:87], v159, s[12:15], s40 offen offset:0 sc1
    s_waitcnt lgkmcnt(7)
    v_mfma_f32_16x16x32_bf16 v[32:35], v[96:99], a[32:35], v[32:35]
    ds_read_b128 v[132:135], v11 offset:8192
    v_mfma_f32_16x16x32_bf16 v[56:59], v[96:99], a[36:39], v[56:59]
    buffer_load_dwordx4 a[88:91], v158, s[12:15], s40 offen offset:1024 sc1
    v_mfma_f32_16x16x32_bf16 v[16:19], v[80:83], a[40:43], v[16:19]
    ds_read_b128 v[116:119], v11 offset:4096
    v_mfma_f32_16x16x32_bf16 v[40:43], v[80:83], a[44:47], v[40:43]
    buffer_load_dwordx4 a[92:95], v159, s[12:15], s40 offen offset:1024 sc1
    s_add_u32 s40, s40, 4096
    s_waitcnt lgkmcnt(7)
    v_mfma_f32_16x16x32_bf16 v[20:23], v[84:87], a[40:43], v[20:23]
    ds_read_b128 v[120:123], v11 offset:5120
    v_mfma_f32_16x16x32_bf16 v[44:47], v[84:87], a[44:47], v[44:47]
    buffer_load_dwordx4 a[96:99], v158, s[12:15], s40 offen offset:0 sc1
    v_mfma_f32_16x16x32_bf16 v[24:27], v[88:91], a[40:43], v[24:27]
    ds_read_b128 v[124:127], v11 offset:6144
    v_mfma_f32_16x16x32_bf16 v[48:51], v[88:91], a[44:47], v[48:51]
    buffer_load_dwordx4 a[100:103], v159, s[12:15], s40 offen offset:0 sc1
    s_waitcnt lgkmcnt(8)
    v_mfma_f32_16x16x32_bf16 v[28:31], v[92:95], a[40:43], v[28:31]
    ds_read_b128 v[128:131], v11 offset:7168
    v_mfma_f32_16x16x32_bf16 v[52:55], v[92:95], a[44:47], v[52:55]
    v_mfma_f32_16x16x32_bf16 v[36:39], v[96:99], a[40:43], v[36:39]
    v_mfma_f32_16x16x32_bf16 v[60:63], v[96:99], a[44:47], v[60:63]
    s_waitcnt vmcnt(20)
    s_barrier
    s_waitcnt lgkmcnt(7)
    v_mfma_f32_16x16x32_bf16 v[16:19], v[100:103], a[48:51], v[16:19]
    ds_read_b128 v[64:67], v12 offset:0
    v_mfma_f32_16x16x32_bf16 v[40:43], v[100:103], a[52:55], v[40:43]
    buffer_load_dwordx4 a[104:107], v158, s[12:15], s40 offen offset:1024 sc1
    v_mfma_f32_16x16x32_bf16 v[20:23], v[104:107], a[48:51], v[20:23]
    ds_read_b128 v[68:71], v12 offset:1024
    v_mfma_f32_16x16x32_bf16 v[44:47], v[104:107], a[52:55], v[44:47]
    buffer_load_dwordx4 a[108:111], v159, s[12:15], s40 offen offset:1024 sc1
    s_add_u32 s40, s40, 4096
    s_waitcnt lgkmcnt(7)
    v_mfma_f32_16x16x32_bf16 v[24:27], v[108:111], a[48:51], v[24:27]
    ds_read_b128 v[72:75], v12 offset:2048
    v_mfma_f32_16x16x32_bf16 v[48:51], v[108:111], a[52:55], v[48:51]
    buffer_load_dwordx4 a[112:115], v158, s[12:15], s40 offen offset:0 sc1
    v_mfma_f32_16x16x32_bf16 v[28:31], v[112:115], a[48:51], v[28:31]
    ds_read_b128 v[76:79], v12 offset:3072
    v_mfma_f32_16x16x32_bf16 v[52:55], v[112:115], a[52:55], v[52:55]
    buffer_load_dwordx4 a[116:119], v159, s[12:15], s40 offen offset:0 sc1
    s_waitcnt lgkmcnt(7)
    v_mfma_f32_16x16x32_bf16 v[32:35], v[132:135], a[48:51], v[32:35]
    ds_read_b128 v[96:99], v12 offset:8192
    v_mfma_f32_16x16x32_bf16 v[56:59], v[132:135], a[52:55], v[56:59]
    buffer_load_dwordx4 a[120:123], v158, s[12:15], s40 offen offset:1024 sc1
    v_mfma_f32_16x16x32_bf16 v[16:19], v[116:119], a[56:59], v[16:19]
    ds_read_b128 v[80:83], v12 offset:4096
    v_mfma_f32_16x16x32_bf16 v[40:43], v[116:119], a[60:63], v[40:43]
    buffer_load_dwordx4 a[124:127], v159, s[12:15], s40 offen offset:1024 sc1
    s_add_u32 s40, s40, 4096
    s_waitcnt lgkmcnt(7)
    v_mfma_f32_16x16x32_bf16 v[20:23], v[120:123], a[56:59], v[20:23]
    ds_read_b128 v[84:87], v12 offset:5120
    v_mfma_f32_16x16x32_bf16 v[44:47], v[120:123], a[60:63], v[44:47]
    s_add_u32 m0, s55, 36864
    s_mov_b64 exec, s[64:65]
    buffer_load_dwordx4 v6, s[12:15], s54 offen lds
    s_mov_b64 exec, -1
    v_mfma_f32_16x16x32_bf16 v[24:27], v[124:127], a[56:59], v[24:27]
    ds_read_b128 v[88:91], v12 offset:6144
    v_mfma_f32_16x16x32_bf16 v[48:51], v[124:127], a[60:63], v[48:51]
    buffer_load_dwordx4 v6, s[12:15], s54 offen offset:512 lds
    s_waitcnt lgkmcnt(8)
    v_mfma_f32_16x16x32_bf16 v[28:31], v[128:131], a[56:59], v[28:31]
    ds_read_b128 v[92:95], v12 offset:7168
    v_mfma_f32_16x16x32_bf16 v[52:55], v[128:131], a[60:63], v[52:55]
    v_mfma_f32_16x16x32_bf16 v[36:39], v[132:135], a[56:59], v[36:39]
    v_mfma_f32_16x16x32_bf16 v[60:63], v[132:135], a[60:63], v[60:63]
    s_waitcnt vmcnt(19)
    s_barrier
    s_waitcnt lgkmcnt(7)
    v_mfma_f32_16x16x32_bf16 v[16:19], v[64:67], a[64:67], v[16:19]
    ds_read_b128 v[100:103], v13 offset:0
    v_mfma_f32_16x16x32_bf16 v[40:43], v[64:67], a[68:71], v[40:43]
    buffer_load_dwordx4 v6, s[12:15], s54 offen offset:1536 lds
    v_mfma_f32_16x16x32_bf16 v[20:23], v[68:71], a[64:67], v[20:23]
    ds_read_b128 v[104:107], v13 offset:1024
    v_mfma_f32_16x16x32_bf16 v[44:47], v[68:71], a[68:71], v[44:47]
    buffer_load_dwordx4 v6, s[12:15], s54 offen offset:2560 lds
    s_waitcnt lgkmcnt(7)
    v_mfma_f32_16x16x32_bf16 v[24:27], v[72:75], a[64:67], v[24:27]
    ds_read_b128 v[108:111], v13 offset:2048
    v_mfma_f32_16x16x32_bf16 v[48:51], v[72:75], a[68:71], v[48:51]
    buffer_load_dwordx4 v6, s[12:15], s54 offen offset:3584 lds
    s_add_u32 s54, s54, 18432
    v_mfma_f32_16x16x32_bf16 v[28:31], v[76:79], a[64:67], v[28:31]
    ds_read_b128 v[112:115], v13 offset:3072
    v_mfma_f32_16x16x32_bf16 v[52:55], v[76:79], a[68:71], v[52:55]
    s_add_u32 m0, s55, 55296
    s_mov_b64 exec, s[64:65]
    buffer_load_dwordx4 v6, s[12:15], s54 offen lds
    s_mov_b64 exec, -1
    s_waitcnt lgkmcnt(7)
    v_mfma_f32_16x16x32_bf16 v[32:35], v[96:99], a[64:67], v[32:35]
    ds_read_b128 v[132:135], v13 offset:8192
    v_mfma_f32_16x16x32_bf16 v[56:59], v[96:99], a[68:71], v[56:59]
    buffer_load_dwordx4 v6, s[12:15], s54 offen offset:512 lds
    v_mfma_f32_16x16x32_bf16 v[16:19], v[80:83], a[72:75], v[16:19]
    ds_read_b128 v[116:119], v13 offset:4096
    v_mfma_f32_16x16x32_bf16 v[40:43], v[80:83], a[76:79], v[40:43]
    buffer_load_dwordx4 v6, s[12:15], s54 offen offset:1536 lds
    s_waitcnt lgkmcnt(7)
    v_mfma_f32_16x16x32_bf16 v[20:23], v[84:87], a[72:75], v[20:23]
    ds_read_b128 v[120:123], v13 offset:5120
    v_mfma_f32_16x16x32_bf16 v[44:47], v[84:87], a[76:79], v[44:47]
    buffer_load_dwordx4 v6, s[12:15], s54 offen offset:2560 lds
    v_mfma_f32_16x16x32_bf16 v[24:27], v[88:91], a[72:75], v[24:27]
    ds_read_b128 v[124:127], v13 offset:6144
    v_mfma_f32_16x16x32_bf16 v[48:51], v[88:91], a[76:79], v[48:51]
    buffer_load_dwordx4 v6, s[12:15], s54 offen offset:3584 lds
    s_add_u32 s54, s54, 18432
    s_waitcnt lgkmcnt(8)
    v_mfma_f32_16x16x32_bf16 v[28:31], v[92:95], a[72:75], v[28:31]
    ds_read_b128 v[128:131], v13 offset:7168
    v_mfma_f32_16x16x32_bf16 v[52:55], v[92:95], a[76:79], v[52:55]
    v_mfma_f32_16x16x32_bf16 v[36:39], v[96:99], a[72:75], v[36:39]
    v_mfma_f32_16x16x32_bf16 v[60:63], v[96:99], a[76:79], v[60:63]
    s_waitcnt vmcnt(18)
    s_barrier
    s_waitcnt lgkmcnt(7)
    v_mfma_f32_16x16x32_bf16 v[16:19], v[100:103], a[80:83], v[16:19]
    ds_read_b128 v[64:67], v14 offset:0
    v_mfma_f32_16x16x32_bf16 v[40:43], v[100:103], a[84:87], v[40:43]
    s_mov_b64 exec, 0xffff
    buffer_load_dword v157, v162, s[12:15], s49 offen sc1
    s_mov_b64 exec, -1
    v_mfma_f32_16x16x32_bf16 v[20:23], v[104:107], a[80:83], v[20:23]
    ds_read_b128 v[68:71], v14 offset:1024
    v_mfma_f32_16x16x32_bf16 v[44:47], v[104:107], a[84:87], v[44:47]
    s_add_u32 m0, s55, 73728
    s_mov_b64 exec, s[64:65]
    buffer_load_dwordx4 v6, s[12:15], s54 offen lds
    s_mov_b64 exec, -1
    s_waitcnt lgkmcnt(7)
    v_mfma_f32_16x16x32_bf16 v[24:27], v[108:111], a[80:83], v[24:27]
    ds_read_b128 v[72:75], v14 offset:2048
    v_mfma_f32_16x16x32_bf16 v[48:51], v[108:111], a[84:87], v[48:51]
    buffer_load_dwordx4 v6, s[12:15], s54 offen offset:512 lds
    v_mfma_f32_16x16x32_bf16 v[28:31], v[112:115], a[80:83], v[28:31]
    ds_read_b128 v[76:79], v14 offset:3072
    v_mfma_f32_16x16x32_bf16 v[52:55], v[112:115], a[84:87], v[52:55]
    buffer_load_dwordx4 v6, s[12:15], s54 offen offset:1536 lds
    s_waitcnt lgkmcnt(7)
    v_mfma_f32_16x16x32_bf16 v[32:35], v[132:135], a[80:83], v[32:35]
    ds_read_b128 v[96:99], v14 offset:8192
    v_mfma_f32_16x16x32_bf16 v[56:59], v[132:135], a[84:87], v[56:59]
    buffer_load_dwordx4 v6, s[12:15], s54 offen offset:2560 lds
    v_mfma_f32_16x16x32_bf16 v[16:19], v[116:119], a[88:91], v[16:19]
    ds_read_b128 v[80:83], v14 offset:4096
    v_mfma_f32_16x16x32_bf16 v[40:43], v[116:119], a[92:95], v[40:43]
    buffer_load_dwordx4 v6, s[12:15], s54 offen offset:3584 lds
    s_add_u32 s54, s54, 18432
    s_waitcnt lgkmcnt(7)
    v_mfma_f32_16x16x32_bf16 v[20:23], v[120:123], a[88:91], v[20:23]
    ds_read_b128 v[84:87], v14 offset:5120
    v_mfma_f32_16x16x32_bf16 v[44:47], v[120:123], a[92:95], v[44:47]
    v_mfma_f32_16x16x32_bf16 v[24:27], v[124:127], a[88:91], v[24:27]
    ds_read_b128 v[88:91], v14 offset:6144
    v_mfma_f32_16x16x32_bf16 v[48:51], v[124:127], a[92:95], v[48:51]
    s_waitcnt lgkmcnt(8)
    v_mfma_f32_16x16x32_bf16 v[28:31], v[128:131], a[88:91], v[28:31]
    ds_read_b128 v[92:95], v14 offset:7168
    v_mfma_f32_16x16x32_bf16 v[52:55], v[128:131], a[92:95], v[52:55]
    v_mfma_f32_16x16x32_bf16 v[36:39], v[132:135], a[88:91], v[36:39]
    v_mfma_f32_16x16x32_bf16 v[60:63], v[132:135], a[92:95], v[60:63]
    s_waitcnt vmcnt(20)
    s_barrier
    s_mov_b32 s43, 0x4000
    s_mov_b64 exec, 0xffff
    s_waitcnt vmcnt(5)
    s_branch LB_y2_1
LB_y2_0:
    s_sleep 4
    buffer_load_dword v157, v162, s[12:15], s49 offen sc1
    s_waitcnt vmcnt(0)
LB_y2_1:
    v_cmp_eq_u32 vcc, -1, v157
    s_sub_u32 s43, s43, 1
    s_cmp_eq_u32 s43, 0
    s_cbranch_vccz LB_y2_2
    s_cbranch_scc0 LB_y2_0
LB_y2_2:
    s_mov_b64 exec, -1
    s_waitcnt lgkmcnt(7)
    v_mfma_f32_16x16x32_bf16 v[16:19], v[64:67], a[96:99], v[16:19]
    ds_read_b128 v[100:103], v15 offset:0
    v_mfma_f32_16x16x32_bf16 v[40:43], v[64:67], a[100:103], v[40:43]
    buffer_load_dwordx4 a[0:3], v158, s[12:15], s40 offen offset:0 sc1
    v_mfma_f32_16x16x32_bf16 v[20:23], v[68:71], a[96:99], v[20:23]
    ds_read_b128 v[104:107], v15 offset:1024
    v_mfma_f32_16x16x32_bf16 v[44:47], v[68:71], a[100:103], v[44:47]
    buffer_load_dwordx4 a[4:7], v159, s[12:15], s40 offen offset:0 sc1
    s_waitcnt lgkmcnt(7)
    v_mfma_f32_16x16x32_bf16 v[24:27], v[72:75], a[96:99], v[24:27]
    ds_read_b128 v[108:111], v15 offset:2048
    v_mfma_f32_16x16x32_bf16 v[48:51], v[72:75], a[100:103], v[48:51]
    buffer_load_dwordx4 a[8:11], v158, s[12:15], s40 offen offset:1024 sc1
    v_mfma_f32_16x16x32_bf16 v[28:31], v[76:79], a[96:99], v[28:31]
    ds_read_b128 v[112:115], v15 offset:3072
    v_mfma_f32_16x16x32_bf16 v[52:55], v[76:79], a[100:103], v[52:55]
    buffer_load_dwordx4 a[12:15], v159, s[12:15], s40 offen offset:1024 sc1
    s_add_u32 s40, s40, 4096
    s_waitcnt lgkmcnt(7)
    v_mfma_f32_16x16x32_bf16 v[32:35], v[96:99], a[96:99], v[32:35]
    ds_read_b128 v[132:135], v15 offset:8192
    v_mfma_f32_16x16x32_bf16 v[56:59], v[96:99], a[100:103], v[56:59]
    buffer_load_dwordx4 a[16:19], v158, s[12:15], s40 offen offset:0 sc1
    v_mfma_f32_16x16x32_bf16 v[16:19], v[80:83], a[104:107], v[16:19]
    ds_read_b128 v[116:119], v15 offset:4096
    v_mfma_f32_16x16x32_bf16 v[40:43], v[80:83], a[108:111], v[40:43]
    buffer_load_dwordx4 a[20:23], v159, s[12:15], s40 offen offset:0 sc1
    s_waitcnt lgkmcnt(7)
    v_mfma_f32_16x16x32_bf16 v[20:23], v[84:87], a[104:107], v[20:23]
    ds_read_b128 v[120:123], v15 offset:5120
    v_mfma_f32_16x16x32_bf16 v[44:47], v[84:87], a[108:111], v[44:47]
    buffer_load_dwordx4 a[24:27], v158, s[12:15], s40 offen offset:1024 sc1
    v_mfma_f32_16x16x32_bf16 v[24:27], v[88:91], a[104:107], v[24:27]
    ds_read_b128 v[124:127], v15 offset:6144
    v_mfma_f32_16x16x32_bf16 v[48:51], v[88:91], a[108:111], v[48:51]
    buffer_load_dwordx4 a[28:31], v159, s[12:15], s40 offen offset:1024 sc1
    s_add_u32 s40, s40, 4096
    s_waitcnt lgkmcnt(8)
    v_mfma_f32_16x16x32_bf16 v[28:31], v[92:95], a[104:107], v[28:31]
    ds_read_b128 v[128:131], v15 offset:7168
    v_mfma_f32_16x16x32_bf16 v[52:55], v[92:95], a[108:111], v[52:55]
    v_mfma_f32_16x16x32_bf16 v[36:39], v[96:99], a[104:107], v[36:39]
    v_mfma_f32_16x16x32_bf16 v[60:63], v[96:99], a[108:111], v[60:63]
    s_waitcnt vmcnt(24)
    s_barrier
    s_waitcnt lgkmcnt(7)
    v_mfma_f32_16x16x32_bf16 v[16:19], v[100:103], a[112:115], v[16:19]
    ds_read_b128 v[64:67], v8 offset:0
    v_mfma_f32_16x16x32_bf16 v[40:43], v[100:103], a[116:119], v[40:43]
    buffer_load_dwordx4 a[32:35], v158, s[12:15], s40 offen offset:0 sc1
    v_mfma_f32_16x16x32_bf16 v[20:23], v[104:107], a[112:115], v[20:23]
    ds_read_b128 v[68:71], v8 offset:1024
    v_mfma_f32_16x16x32_bf16 v[44:47], v[104:107], a[116:119], v[44:47]
    buffer_load_dwordx4 a[36:39], v159, s[12:15], s40 offen offset:0 sc1
    s_waitcnt lgkmcnt(7)
    v_mfma_f32_16x16x32_bf16 v[24:27], v[108:111], a[112:115], v[24:27]
    ds_read_b128 v[72:75], v8 offset:2048
    v_mfma_f32_16x16x32_bf16 v[48:51], v[108:111], a[116:119], v[48:51]
    buffer_load_dwordx4 a[40:43], v158, s[12:15], s40 offen offset:1024 sc1
    v_mfma_f32_16x16x32_bf16 v[28:31], v[112:115], a[112:115], v[28:31]
    ds_read_b128 v[76:79], v8 offset:3072
    v_mfma_f32_16x16x32_bf16 v[52:55], v[112:115], a[116:119], v[52:55]
    buffer_load_dwordx4 a[44:47], v159, s[12:15], s40 offen offset:1024 sc1
    s_add_u32 s40, s40, 4096
    s_waitcnt lgkmcnt(7)
    v_mfma_f32_16x16x32_bf16 v[32:35], v[132:135], a[112:115], v[32:35]
    ds_read_b128 v[96:99], v8 offset:8192
    v_mfma_f32_16x16x32_bf16 v[56:59], v[132:135], a[116:119], v[56:59]
    buffer_load_dwordx4 a[48:51], v158, s[12:15], s40 offen offset:0 sc1
    v_mfma_f32_16x16x32_bf16 v[16:19], v[116:119], a[120:123], v[16:19]
    ds_read_b128 v[80:83], v8 offset:4096
    v_mfma_f32_16x16x32_bf16 v[40:43], v[116:119], a[124:127], v[40:43]
    buffer_load_dwordx4 a[52:55], v159, s[12:15], s40 offen offset:0 sc1
    s_waitcnt lgkmcnt(7)
    v_mfma_f32_16x16x32_bf16 v[20:23], v[120:123], a[120:123], v[20:23]
    ds_read_b128 v[84:87], v8 offset:5120
    v_mfma_f32_16x16x32_bf16 v[44:47], v[120:123], a[124:127], v[44:47]
    buffer_load_dwordx4 a[56:59], v158, s[12:15], s40 offen offset:1024 sc1
    v_mfma_f32_16x16x32_bf16 v[24:27], v[124:127], a[120:123], v[24:27]
    ds_read_b128 v[88:91], v8 offset:6144
    v_mfma_f32_16x16x32_bf16 v[48:51], v[124:127], a[124:127], v[48:51]
    buffer_load_dwordx4 a[60:63], v159, s[12:15], s40 offen offset:1024 sc1
    s_add_u32 s40, s40, 4096
    s_waitcnt lgkmcnt(8)
    v_mfma_f32_16x16x32_bf16 v[28:31], v[128:131], a[120:123], v[28:31]
    ds_read_b128 v[92:95], v8 offset:7168
    v_mfma_f32_16x16x32_bf16 v[52:55], v[128:131], a[124:127], v[52:55]
    v_mfma_f32_16x16x32_bf16 v[36:39], v[132:135], a[120:123], v[36:39]
    v_mfma_f32_16x16x32_bf16 v[60:63], v[132:135], a[124:127], v[60:63]
    s_waitcnt vmcnt(12)
    s_barrier
    s_waitcnt lgkmcnt(7)
    v_mfma_f32_16x16x32_bf16 v[16:19], v[64:67], a[0:3], v[16:19]
    ds_read_b128 v[100:103], v9 offset:0
    v_mfma_f32_16x16x32_bf16 v[40:43], v[64:67], a[4:7], v[40:43]
    buffer_load_dwordx4 a[64:67], v158, s[12:15], s40 offen offset:0 sc1
    v_mfma_f32_16x16x32_bf16 v[20:23], v[68:71], a[0:3], v[20:23]
    ds_read_b128 v[104:107], v9 offset:1024
    v_mfma_f32_16x16x32_bf16 v[44:47], v[68:71], a[4:7], v[44:47]
    buffer_load_dwordx4 a[68:71], v159, s[12:15], s40 offen offset:0 sc1
    s_waitcnt lgkmcnt(7)
    v_mfma_f32_16x16x32_bf16 v[24:27], v[72:75], a[0:3], v[24:27]
    ds_read_b128 v[108:111], v9 offset:2048
    v_mfma_f32_16x16x32_bf16 v[48:51], v[72:75], a[4:7], v[48:51]
    buffer_load_dwordx4 a[72:75], v158, s[12:15], s40 offen offset:1024 sc1
    v_mfma_f32_16x16x32_bf16 v[28:31], v[76:79], a[0:3], v[28:31]
    ds_read_b128 v[112:115], v9 offset:3072
    v_mfma_f32_16x16x32_bf16 v[52:55], v[76:79], a[4:7], v[52:55]
    buffer_load_dwordx4 a[76:79], v159, s[12:15], s40 offen offset:1024 sc1
    s_add_u32 s40, s40, 4096
    s_waitcnt lgkmcnt(7)
    v_mfma_f32_16x16x32_bf16 v[32:35], v[96:99], a[0:3], v[32:35]
    ds_read_b128 v[132:135], v9 offset:8192
    v_mfma_f32_16x16x32_bf16 v[56:59], v[96:99], a[4:7], v[56:59]
    buffer_load_dwordx4 a[80:83], v158, s[12:15], s40 offen offset:0 sc1
    v_mfma_f32_16x16x32_bf16 v[16:19], v[80:83], a[8:11], v[16:19]
    ds_read_b128 v[116:119], v9 offset:4096
    v_mfma_f32_16x16x32_bf16 v[40:43], v[80:83], a[12:15], v[40:43]
    buffer_load_dwordx4 a[84:87], v159, s[12:15], s40 offen offset:0 sc1
    s_waitcnt lgkmcnt(7)
    v_mfma_f32_16x16x32_bf16 v[20:23], v[84:87], a[8:11], v[20:23]
    ds_read_b128 v[120:123], v9 offset:5120
    v_mfma_f32_16x16x32_bf16 v[44:47], v[84:87], a[12:15], v[44:47]
    buffer_load_dwordx4 a[88:91], v158, s[12:15], s40 offen offset:1024 sc1
    v_mfma_f32_16x16x32_bf16 v[24:27], v[88:91], a[8:11], v[24:27]
    ds_read_b128 v[124:127], v9 offset:6144
    v_mfma_f32_16x16x32_bf16 v[48:51], v[88:91], a[12:15], v[48:51]
    buffer_load_dwordx4 a[92:95], v159, s[12:15], s40 offen offset:1024 sc1
    s_add_u32 s40, s40, 4096
    s_waitcnt lgkmcnt(8)
    v_mfma_f32_16x16x32_bf16 v[28:31], v[92:95], a[8:11], v[28:31]
    ds_read_b128 v[128:131], v9 offset:7168
    v_mfma_f32_16x16x32_bf16 v[52:55], v[92:95], a[12:15], v[52:55]
    v_mfma_f32_16x16x32_bf16 v[36:39], v[96:99], a[8:11], v[36:39]
    v_mfma_f32_16x16x32_bf16 v[60:63], v[96:99], a[12:15], v[60:63]
    s_waitcnt vmcnt(16)
    s_barrier
    s_waitcnt lgkmcnt(7)
    v_mfma_f32_16x16x32_bf16 v[16:19], v[100:103], a[16:19], v[16:19]
    ds_read_b128 v[64:67], v10 offset:0
    v_mfma_f32_16x16x32_bf16 v[40:43], v[100:103], a[20:23], v[40:43]
    s_add_u32 m0, s55, 92160
    s_mov_b64 exec, s[64:65]
    buffer_load_dwordx4 v6, s[12:15], s54 offen lds
    s_mov_b64 exec, -1
    v_mfma_f32_16x16x32_bf16 v[20:23], v[104:107], a[16:19], v[20:23]
    ds_read_b128 v[68:71], v10 offset:1024
    v_mfma_f32_16x16x32_bf16 v[44:47], v[104:107], a[20:23], v[44:47]
    buffer_load_dwordx4 v6, s[12:15], s54 offen offset:512 lds
    s_waitcnt lgkmcnt(7)
    v_mfma_f32_16x16x32_bf16 v[24:27], v[108:111], a[16:19], v[24:27]
    ds_read_b128 v[72:75], v10 offset:2048
    v_mfma_f32_16x16x32_bf16 v[48:51], v[108:111], a[20:23], v[48:51]
    buffer_load_dwordx4 v6, s[12:15], s54 offen offset:1536 lds
    v_mfma_f32_16x16x32_bf16 v[28:31], v[112:115], a[16:19], v[28:31]
    ds_read_b128 v[76:79], v10 offset:3072
    v_mfma_f32_16x16x32_bf16 v[52:55], v[112:115], a[20:23], v[52:55]
    buffer_load_dwordx4 v6, s[12:15], s54 offen offset:2560 lds
    s_waitcnt lgkmcnt(7)
    v_mfma_f32_16x16x32_bf16 v[32:35], v[132:135], a[16:19], v[32:35]
    ds_read_b128 v[96:99], v10 offset:8192
    v_mfma_f32_16x16x32_bf16 v[56:59], v[132:135], a[20:23], v[56:59]
    buffer_load_dwordx4 v6, s[12:15], s54 offen offset:3584 lds
    s_add_u32 s54, s54, 18432
    v_mfma_f32_16x16x32_bf16 v[16:19], v[116:119], a[24:27], v[16:19]
    ds_read_b128 v[80:83], v10 offset:4096
    v_mfma_f32_16x16x32_bf16 v[40:43], v[116:119], a[28:31], v[40:43]
    buffer_load_dwordx4 a[96:99], v158, s[12:15], s40 offen offset:0 sc1
    s_waitcnt lgkmcnt(7)
    v_mfma_f32_16x16x32_bf16 v[20:23], v[120:123], a[24:27], v[20:23]
    ds_read_b128 v[84:87], v10 offset:5120
    v_mfma_f32_16x16x32_bf16 v[44:47], v[120:123], a[28:31], v[44:47]
    buffer_load_dwordx4 a[100:103], v159, s[12:15], s40 offen offset:0 sc1
    v_mfma_f32_16x16x32_bf16 v[24:27], v[124:127], a[24:27], v[24:27]
    ds_read_b128 v[88:91], v10 offset:6144
    v_mfma_f32_16x16x32_bf16 v[48:51], v[124:127], a[28:31], v[48:51]
    buffer_load_dwordx4 a[104:107], v158, s[12:15], s40 offen offset:1024 sc1
    s_waitcnt lgkmcnt(8)
    v_mfma_f32_16x16x32_bf16 v[28:31], v[128:131], a[24:27], v[28:31]
    ds_read_b128 v[92:95], v10 offset:7168
    v_mfma_f32_16x16x32_bf16 v[52:55], v[128:131], a[28:31], v[52:55]
    v_mfma_f32_16x16x32_bf16 v[36:39], v[132:135], a[24:27], v[36:39]
    v_mfma_f32_16x16x32_bf16 v[60:63], v[132:135], a[28:31], v[60:63]
    s_waitcnt vmcnt(20)
    s_barrier
    s_waitcnt lgkmcnt(7)
    v_mfma_f32_16x16x32_bf16 v[16:19], v[64:67], a[32:35], v[16:19]
    ds_read_b128 v[100:103], v11 offset:0
    v_mfma_f32_16x16x32_bf16 v[40:43], v[64:67], a[36:39], v[40:43]
    buffer_load_dwordx4 a[108:111], v159, s[12:15], s40 offen offset:1024 sc1
    s_add_u32 s40, s40, 4096
    v_mfma_f32_16x16x32_bf16 v[20:23], v[68:71], a[32:35], v[20:23]
    ds_read_b128 v[104:107], v11 offset:1024
    v_mfma_f32_16x16x32_bf16 v[44:47], v[68:71], a[36:39], v[44:47]
    s_add_u32 m0, s55, 110592
    s_mov_b64 exec, s[64:65]
    buffer_load_dwordx4 v6, s[12:15], s54 offen lds
    s_mov_b64 exec, -1
    s_waitcnt lgkmcnt(7)
    v_mfma_f32_16x16x32_bf16 v[24:27], v[72:75], a[32:35], v[24:27]
    ds_read_b128 v[108:111], v11 offset:2048
    v_mfma_f32_16x16x32_bf16 v[48:51], v[72:75], a[36:39], v[48:51]
    buffer_load_dwordx4 v6, s[12:15], s54 offen offset:512 lds
    v_mfma_f32_16x16x32_bf16 v[28:31], v[76:79], a[32:35], v[28:31]
    ds_read_b128 v[112:115], v11 offset:3072
    v_mfma_f32_16x16x32_bf16 v[52:55], v[76:79], a[36:39], v[52:55]
    buffer_load_dwordx4 v6, s[12:15], s54 offen offset:1536 lds
    s_waitcnt lgkmcnt(7)
    v_mfma_f32_16x16x32_bf16 v[32:35], v[96:99], a[32:35], v[32:35]
    ds_read_b128 v[132:135], v11 offset:8192
    v_mfma_f32_16x16x32_bf16 v[56:59], v[96:99], a[36:39], v[56:59]
    buffer_load_dwordx4 v6, s[12:15], s54 offen offset:2560 lds
    v_mfma_f32_16x16x32_bf16 v[16:19], v[80:83], a[40:43], v[16:19]
    ds_read_b128 v[116:119], v11 offset:4096
    v_mfma_f32_16x16x32_bf16 v[40:43], v[80:83], a[44:47], v[40:43]
    buffer_load_dwordx4 v6, s[12:15], s54 offen offset:3584 lds
    s_add_u32 s54, s54, 18432
    s_waitcnt lgkmcnt(7)
    v_mfma_f32_16x16x32_bf16 v[20:23], v[84:87], a[40:43], v[20:23]
    ds_read_b128 v[120:123], v11 offset:5120
    v_mfma_f32_16x16x32_bf16 v[44:47], v[84:87], a[44:47], v[44:47]
    buffer_load_dwordx4 a[112:115], v158, s[12:15], s40 offen offset:0 sc1
    v_mfma_f32_16x16x32_bf16 v[24:27], v[88:91], a[40:43], v[24:27]
    ds_read_b128 v[124:127], v11 offset:6144
    v_mfma_f32_16x16x32_bf16 v[48:51], v[88:91], a[44:47], v[48:51]
    buffer_load_dwordx4 a[116:119], v159, s[12:15], s40 offen offset:0 sc1
    s_waitcnt lgkmcnt(8)
    v_mfma_f32_16x16x32_bf16 v[28:31], v[92:95], a[40:43], v[28:31]
    ds_read_b128 v[128:131], v11 offset:7168
    v_mfma_f32_16x16x32_bf16 v[52:55], v[92:95], a[44:47], v[52:55]
    v_mfma_f32_16x16x32_bf16 v[36:39], v[96:99], a[40:43], v[36:39]
    v_mfma_f32_16x16x32_bf16 v[60:63], v[96:99], a[44:47], v[60:63]
    s_waitcnt vmcnt(24)
    s_barrier
    s_waitcnt lgkmcnt(7)
    v_mfma_f32_16x16x32_bf16 v[16:19], v[100:103], a[48:51], v[16:19]
    ds_read_b128 v[64:67], v12 offset:0
    v_mfma_f32_16x16x32_bf16 v[40:43], v[100:103], a[52:55], v[40:43]
    buffer_load_dwordx4 a[120:123], v158, s[12:15], s40 offen offset:1024 sc1
    v_mfma_f32_16x16x32_bf16 v[20:23], v[104:107], a[48:51], v[20:23]
    ds_read_b128 v[68:71], v12 offset:1024
    v_mfma_f32_16x16x32_bf16 v[44:47], v[104:107], a[52:55], v[44:47]
    buffer_load_dwordx4 a[124:127], v159, s[12:15], s40 offen offset:1024 sc1
    s_add_u32 s40, s40, 4096
    s_waitcnt lgkmcnt(7)
    v_mfma_f32_16x16x32_bf16 v[24:27], v[108:111], a[48:51], v[24:27]
    ds_read_b128 v[72:75], v12 offset:2048
    v_mfma_f32_16x16x32_bf16 v[48:51], v[108:111], a[52:55], v[48:51]
    s_add_u32 m0, s55, 129024
    s_mov_b64 exec, s[64:65]
    buffer_load_dwordx4 v6, s[12:15], s54 offen lds
    s_mov_b64 exec, -1
    v_mfma_f32_16x16x32_bf16 v[28:31], v[112:115], a[48:51], v[28:31]
    ds_read_b128 v[76:79], v12 offset:3072
    v_mfma_f32_16x16x32_bf16 v[52:55], v[112:115], a[52:55], v[52:55]
    buffer_load_dwordx4 v6, s[12:15], s54 offen offset:512 lds
    s_waitcnt lgkmcnt(7)
    v_mfma_f32_16x16x32_bf16 v[32:35], v[132:135], a[48:51], v[32:35]
    ds_read_b128 v[96:99], v12 offset:8192
    v_mfma_f32_16x16x32_bf16 v[56:59], v[132:135], a[52:55], v[56:59]
    buffer_load_dwordx4 v6, s[12:15], s54 offen offset:1536 lds
    v_mfma_f32_16x16x32_bf16 v[16:19], v[116:119], a[56:59], v[16:19]
    ds_read_b128 v[80:83], v12 offset:4096
    v_mfma_f32_16x16x32_bf16 v[40:43], v[116:119], a[60:63], v[40:43]
    buffer_load_dwordx4 v6, s[12:15], s54 offen offset:2560 lds
    s_waitcnt lgkmcnt(7)
    v_mfma_f32_16x16x32_bf16 v[20:23], v[120:123], a[56:59], v[20:23]
    ds_read_b128 v[84:87], v12 offset:5120
    v_mfma_f32_16x16x32_bf16 v[44:47], v[120:123], a[60:63], v[44:47]
    buffer_load_dwordx4 v6, s[12:15], s54 offen offset:3584 lds
    s_add_u32 s54, s54, 18432
    v_mfma_f32_16x16x32_bf16 v[24:27], v[124:127], a[56:59], v[24:27]
    ds_read_b128 v[88:91], v12 offset:6144
    v_mfma_f32_16x16x32_bf16 v[48:51], v[124:127], a[60:63], v[48:51]
    buffer_load_dwordx4 a[0:3], v158, s[12:15], s40 offen offset:0 sc1
    s_waitcnt lgkmcnt(8)
    v_mfma_f32_16x16x32_bf16 v[28:31], v[128:131], a[56:59], v[28:31]
    ds_read_b128 v[92:95], v12 offset:7168
    v_mfma_f32_16x16x32_bf16 v[52:55], v[128:131], a[60:63], v[52:55]
    v_mfma_f32_16x16x32_bf16 v[36:39], v[132:135], a[56:59], v[36:39]
    v_mfma_f32_16x16x32_bf16 v[60:63], v[132:135], a[60:63], v[60:63]
    s_waitcnt vmcnt(19)
    s_barrier
    s_waitcnt lgkmcnt(7)
    v_mfma_f32_16x16x32_bf16 v[16:19], v[64:67], a[64:67], v[16:19]
    ds_read_b128 v[100:103], v13 offset:0
    v_mfma_f32_16x16x32_bf16 v[40:43], v[64:67], a[68:71], v[40:43]
    buffer_load_dwordx4 a[4:7], v159, s[12:15], s40 offen offset:0 sc1
    v_mfma_f32_16x16x32_bf16 v[20:23], v[68:71], a[64:67], v[20:23]
    ds_read_b128 v[104:107], v13 offset:1024
    v_mfma_f32_16x16x32_bf16 v[44:47], v[68:71], a[68:71], v[44:47]
    buffer_load_dwordx4 a[8:11], v158, s[12:15], s40 offen offset:1024 sc1
    s_waitcnt lgkmcnt(7)
    v_mfma_f32_16x16x32_bf16 v[24:27], v[72:75], a[64:67], v[24:27]
    ds_read_b128 v[108:111], v13 offset:2048
    v_mfma_f32_16x16x32_bf16 v[48:51], v[72:75], a[68:71], v[48:51]
    buffer_load_dwordx4 a[12:15], v159, s[12:15], s40 offen offset:1024 sc1
    s_add_u32 s40, s40, 4096
    v_mfma_f32_16x16x32_bf16 v[28:31], v[76:79], a[64:67], v[28:31]
    ds_read_b128 v[112:115], v13 offset:3072
    v_mfma_f32_16x16x32_bf16 v[52:55], v[76:79], a[68:71], v[52:55]
    s_add_u32 m0, s55, 0
    s_mov_b64 exec, s[64:65]
    buffer_load_dwordx4 v6, s[12:15], s54 offen lds
    s_mov_b64 exec, -1
    s_waitcnt lgkmcnt(7)
    v_mfma_f32_16x16x32_bf16 v[32:35], v[96:99], a[64:67], v[32:35]
    ds_read_b128 v[132:135], v13 offset:8192
    v_mfma_f32_16x16x32_bf16 v[56:59], v[96:99], a[68:71], v[56:59]
    buffer_load_dwordx4 v6, s[12:15], s54 offen offset:512 lds
    v_mfma_f32_16x16x32_bf16 v[16:19], v[80:83], a[72:75], v[16:19]
    ds_read_b128 v[116:119], v13 offset:4096
    v_mfma_f32_16x16x32_bf16 v[40:43], v[80:83], a[76:79], v[40:43]
    buffer_load_dwordx4 v6, s[12:15], s54 offen offset:1536 lds
    s_waitcnt lgkmcnt(7)
    v_mfma_f32_16x16x32_bf16 v[20:23], v[84:87], a[72:75], v[20:23]
    ds_read_b128 v[120:123], v13 offset:5120
    v_mfma_f32_16x16x32_bf16 v[44:47], v[84:87], a[76:79], v[44:47]
    buffer_load_dwordx4 v6, s[12:15], s54 offen offset:2560 lds
    v_mfma_f32_16x16x32_bf16 v[24:27], v[88:91], a[72:75], v[24:27]
    ds_read_b128 v[124:127], v13 offset:6144
    v_mfma_f32_16x16x32_bf16 v[48:51], v[88:91], a[76:79], v[48:51]
    buffer_load_dwordx4 v6, s[12:15], s54 offen offset:3584 lds
    s_add_u32 s54, s54, 18432
    s_waitcnt lgkmcnt(8)
    v_mfma_f32_16x16x32_bf16 v[28:31], v[92:95], a[72:75], v[28:31]
    ds_read_b128 v[128:131], v13 offset:7168
    v_mfma_f32_16x16x32_bf16 v[52:55], v[92:95], a[76:79], v[52:55]
    v_mfma_f32_16x16x32_bf16 v[36:39], v[96:99], a[72:75], v[36:39]
    v_mfma_f32_16x16x32_bf16 v[60:63], v[96:99], a[76:79], v[60:63]
    s_waitcnt vmcnt(18)
    s_barrier
    s_waitcnt lgkmcnt(7)
    v_mfma_f32_16x16x32_bf16 v[16:19], v[100:103], a[80:83], v[16:19]
    ds_read_b128 v[64:67], v14 offset:0
    v_mfma_f32_16x16x32_bf16 v[40:43], v[100:103], a[84:87], v[40:43]
    buffer_load_dwordx4 a[16:19], v158, s[12:15], s40 offen offset:0 sc1
    v_mfma_f32_16x16x32_bf16 v[20:23], v[104:107], a[80:83], v[20:23]
    ds_read_b128 v[68:71], v14 offset:1024
    v_mfma_f32_16x16x32_bf16 v[44:47], v[104:107], a[84:87], v[44:47]
    buffer_load_dwordx4 a[20:23], v159, s[12:15], s40 offen offset:0 sc1
    s_waitcnt lgkmcnt(7)
    v_mfma_f32_16x16x32_bf16 v[24:27], v[108:111], a[80:83], v[24:27]
    ds_read_b128 v[72:75], v14 offset:2048
    v_mfma_f32_16x16x32_bf16 v[48:51], v[108:111], a[84:87], v[48:51]
    buffer_load_dwordx4 a[24:27], v158, s[12:15], s40 offen offset:1024 sc1
    v_mfma_f32_16x16x32_bf16 v[28:31], v[112:115], a[80:83], v[28:31]
    ds_read_b128 v[76:79], v14 offset:3072
    v_mfma_f32_16x16x32_bf16 v[52:55], v[112:115], a[84:87], v[52:55]
    buffer_load_dwordx4 a[28:31], v159, s[12:15], s40 offen offset:1024 sc1
    s_add_u32 s40, s40, 4096
    s_waitcnt lgkmcnt(7)
    v_mfma_f32_16x16x32_bf16 v[32:35], v[132:135], a[80:83], v[32:35]
    ds_read_b128 v[96:99], v14 offset:8192
    v_mfma_f32_16x16x32_bf16 v[56:59], v[132:135], a[84:87], v[56:59]
    s_add_u32 m0, s55, 18432
    s_mov_b64 exec, s[64:65]
    buffer_load_dwordx4 v6, s[12:15], s54 offen lds
    s_mov_b64 exec, -1
    v_mfma_f32_16x16x32_bf16 v[16:19], v[116:119], a[88:91], v[16:19]
    ds_read_b128 v[80:83], v14 offset:4096
    v_mfma_f32_16x16x32_bf16 v[40:43], v[116:119], a[92:95], v[40:43]
    buffer_load_dwordx4 v6, s[12:15], s54 offen offset:512 lds
    s_waitcnt lgkmcnt(7)
    v_mfma_f32_16x16x32_bf16 v[20:23], v[120:123], a[88:91], v[20:23]
    ds_read_b128 v[84:87], v14 offset:5120
    v_mfma_f32_16x16x32_bf16 v[44:47], v[120:123], a[92:95], v[44:47]
    buffer_load_dwordx4 v6, s[12:15], s54 offen offset:1536 lds
    v_mfma_f32_16x16x32_bf16 v[24:27], v[124:127], a[88:91], v[24:27]
    ds_read_b128 v[88:91], v14 offset:6144
    v_mfma_f32_16x16x32_bf16 v[48:51], v[124:127], a[92:95], v[48:51]
    buffer_load_dwordx4 v6, s[12:15], s54 offen offset:2560 lds
    s_waitcnt lgkmcnt(8)
    v_mfma_f32_16x16x32_bf16 v[28:31], v[128:131], a[88:91], v[28:31]
    ds_read_b128 v[92:95], v14 offset:7168
    v_mfma_f32_16x16x32_bf16 v[52:55], v[128:131], a[92:95], v[52:55]
    v_mfma_f32_16x16x32_bf16 v[36:39], v[132:135], a[88:91], v[36:39]
    v_mfma_f32_16x16x32_bf16 v[60:63], v[132:135], a[92:95], v[60:63]
    s_waitcnt vmcnt(17)
    s_barrier
    s_waitcnt lgkmcnt(7)
    v_mfma_f32_16x16x32_bf16 v[16:19], v[64:67], a[96:99], v[16:19]
    ds_read_b128 v[100:103], v15 offset:0
    v_mfma_f32_16x16x32_bf16 v[40:43], v[64:67], a[100:103], v[40:43]
    buffer_load_dwordx4 v6, s[12:15], s54 offen offset:3584 lds
    s_add_u32 s54, s54, 18432
    v_mfma_f32_16x16x32_bf16 v[20:23], v[68:71], a[96:99], v[20:23]
    ds_read_b128 v[104:107], v15 offset:1024
    v_mfma_f32_16x16x32_bf16 v[44:47], v[68:71], a[100:103], v[44:47]
    s_waitcnt lgkmcnt(7)
    v_mfma_f32_16x16x32_bf16 v[24:27], v[72:75], a[96:99], v[24:27]
    ds_read_b128 v[108:111], v15 offset:2048
    v_mfma_f32_16x16x32_bf16 v[48:51], v[72:75], a[100:103], v[48:51]
    v_mfma_f32_16x16x32_bf16 v[28:31], v[76:79], a[96:99], v[28:31]
    ds_read_b128 v[112:115], v15 offset:3072
    v_mfma_f32_16x16x32_bf16 v[52:55], v[76:79], a[100:103], v[52:55]
    s_waitcnt lgkmcnt(7)
    v_mfma_f32_16x16x32_bf16 v[32:35], v[96:99], a[96:99], v[32:35]
    ds_read_b128 v[132:135], v15 offset:8192
    v_mfma_f32_16x16x32_bf16 v[56:59], v[96:99], a[100:103], v[56:59]
    v_mfma_f32_16x16x32_bf16 v[16:19], v[80:83], a[104:107], v[16:19]
    ds_read_b128 v[116:119], v15 offset:4096
    v_mfma_f32_16x16x32_bf16 v[40:43], v[80:83], a[108:111], v[40:43]
    s_waitcnt lgkmcnt(7)
    v_mfma_f32_16x16x32_bf16 v[20:23], v[84:87], a[104:107], v[20:23]
    ds_read_b128 v[120:123], v15 offset:5120
    v_mfma_f32_16x16x32_bf16 v[44:47], v[84:87], a[108:111], v[44:47]
    v_mfma_f32_16x16x32_bf16 v[24:27], v[88:91], a[104:107], v[24:27]
    ds_read_b128 v[124:127], v15 offset:6144
    v_mfma_f32_16x16x32_bf16 v[48:51], v[88:91], a[108:111], v[48:51]
    s_waitcnt lgkmcnt(8)
    v_mfma_f32_16x16x32_bf16 v[28:31], v[92:95], a[104:107], v[28:31]
    ds_read_b128 v[128:131], v15 offset:7168
    v_mfma_f32_16x16x32_bf16 v[52:55], v[92:95], a[108:111], v[52:55]
    v_mfma_f32_16x16x32_bf16 v[36:39], v[96:99], a[104:107], v[36:39]
    v_mfma_f32_16x16x32_bf16 v[60:63], v[96:99], a[108:111], v[60:63]
    s_waitcnt vmcnt(9)
    s_barrier
    s_waitcnt lgkmcnt(7)
    v_mfma_f32_16x16x32_bf16 v[16:19], v[100:103], a[112:115], v[16:19]
    ds_read_b128 v[64:67], v8 offset:0
    v_mfma_f32_16x16x32_bf16 v[40:43], v[100:103], a[116:119], v[40:43]
    v_mfma_f32_16x16x32_bf16 v[20:23], v[104:107], a[112:115], v[20:23]
    ds_read_b128 v[68:71], v8 offset:1024
    v_mfma_f32_16x16x32_bf16 v[44:47], v[104:107], a[116:119], v[44:47]
    s_waitcnt lgkmcnt(7)
    v_mfma_f32_16x16x32_bf16 v[24:27], v[108:111], a[112:115], v[24:27]
    ds_read_b128 v[72:75], v8 offset:2048
    v_mfma_f32_16x16x32_bf16 v[48:51], v[108:111], a[116:119], v[48:51]
    v_mfma_f32_16x16x32_bf16 v[28:31], v[112:115], a[112:115], v[28:31]
    ds_read_b128 v[76:79], v8 offset:3072
    v_mfma_f32_16x16x32_bf16 v[52:55], v[112:115], a[116:119], v[52:55]
    s_waitcnt lgkmcnt(7)
    v_mfma_f32_16x16x32_bf16 v[32:35], v[132:135], a[112:115], v[32:35]
    ds_read_b128 v[96:99], v8 offset:8192
    v_mfma_f32_16x16x32_bf16 v[56:59], v[132:135], a[116:119], v[56:59]
    v_mfma_f32_16x16x32_bf16 v[16:19], v[116:119], a[120:123], v[16:19]
    ds_read_b128 v[80:83], v8 offset:4096
    v_mfma_f32_16x16x32_bf16 v[40:43], v[116:119], a[124:127], v[40:43]
    s_waitcnt lgkmcnt(7)
    v_mfma_f32_16x16x32_bf16 v[20:23], v[120:123], a[120:123], v[20:23]
    ds_read_b128 v[84:87], v8 offset:5120
    v_mfma_f32_16x16x32_bf16 v[44:47], v[120:123], a[124:127], v[44:47]
    v_mfma_f32_16x16x32_bf16 v[24:27], v[124:127], a[120:123], v[24:27]
    ds_read_b128 v[88:91], v8 offset:6144
    v_mfma_f32_16x16x32_bf16 v[48:51], v[124:127], a[124:127], v[48:51]
    s_waitcnt lgkmcnt(8)
    v_mfma_f32_16x16x32_bf16 v[28:31], v[128:131], a[120:123], v[28:31]
    ds_read_b128 v[92:95], v8 offset:7168
    v_mfma_f32_16x16x32_bf16 v[52:55], v[128:131], a[124:127], v[52:55]
    v_mfma_f32_16x16x32_bf16 v[36:39], v[132:135], a[120:123], v[36:39]
    v_mfma_f32_16x16x32_bf16 v[60:63], v[132:135], a[124:127], v[60:63]
    s_waitcnt vmcnt(0)
    s_barrier
    s_waitcnt lgkmcnt(7)
    v_mfma_f32_16x16x32_bf16 v[16:19], v[64:67], a[0:3], v[16:19]
    ds_read_b128 v[100:103], v9 offset:0
    v_mfma_f32_16x16x32_bf16 v[40:43], v[64:67], a[4:7], v[40:43]
    v_mfma_f32_16x16x32_bf16 v[20:23], v[68:71], a[0:3], v[20:23]
    ds_read_b128 v[104:107], v9 offset:1024
    v_mfma_f32_16x16x32_bf16 v[44:47], v[68:71], a[4:7], v[44:47]
    s_waitcnt lgkmcnt(7)
    v_mfma_f32_16x16x32_bf16 v[24:27], v[72:75], a[0:3], v[24:27]
    ds_read_b128 v[108:111], v9 offset:2048
    v_mfma_f32_16x16x32_bf16 v[48:51], v[72:75], a[4:7], v[48:51]
    v_mfma_f32_16x16x32_bf16 v[28:31], v[76:79], a[0:3], v[28:31]
    ds_read_b128 v[112:115], v9 offset:3072
    v_mfma_f32_16x16x32_bf16 v[52:55], v[76:79], a[4:7], v[52:55]
    s_waitcnt lgkmcnt(7)
    v_mfma_f32_16x16x32_bf16 v[32:35], v[96:99], a[0:3], v[32:35]
    ds_read_b128 v[132:135], v9 offset:8192
    v_mfma_f32_16x16x32_bf16 v[56:59], v[96:99], a[4:7], v[56:59]
    v_mfma_f32_16x16x32_bf16 v[16:19], v[80:83], a[8:11], v[16:19]
    ds_read_b128 v[116:119], v9 offset:4096
    v_mfma_f32_16x16x32_bf16 v[40:43], v[80:83], a[12:15], v[40:43]
    s_waitcnt lgkmcnt(7)
    v_mfma_f32_16x16x32_bf16 v[20:23], v[84:87], a[8:11], v[20:23]
    ds_read_b128 v[120:123], v9 offset:5120
    v_mfma_f32_16x16x32_bf16 v[44:47], v[84:87], a[12:15], v[44:47]
    v_mfma_f32_16x16x32_bf16 v[24:27], v[88:91], a[8:11], v[24:27]
    ds_read_b128 v[124:127], v9 offset:6144
    v_mfma_f32_16x16x32_bf16 v[48:51], v[88:91], a[12:15], v[48:51]
    s_waitcnt lgkmcnt(8)
    v_mfma_f32_16x16x32_bf16 v[28:31], v[92:95], a[8:11], v[28:31]
    ds_read_b128 v[128:131], v9 offset:7168
    v_mfma_f32_16x16x32_bf16 v[52:55], v[92:95], a[12:15], v[52:55]
    v_mfma_f32_16x16x32_bf16 v[36:39], v[96:99], a[8:11], v[36:39]
    v_mfma_f32_16x16x32_bf16 v[60:63], v[96:99], a[12:15], v[60:63]
    s_waitcnt vmcnt(5)
    s_waitcnt lgkmcnt(7)
    v_mfma_f32_16x16x32_bf16 v[16:19], v[100:103], a[16:19], v[16:19]
    ds_read_b128 v[164:167], v5 offset:0
    v_mfma_f32_16x16x32_bf16 v[40:43], v[100:103], a[20:23], v[40:43]
    v_mfma_f32_16x16x32_bf16 v[20:23], v[104:107], a[16:19], v[20:23]
    ds_read_b128 v[168:171], v5 offset:16
    v_mfma_f32_16x16x32_bf16 v[44:47], v[104:107], a[20:23], v[44:47]
    s_waitcnt lgkmcnt(7)
    v_mfma_f32_16x16x32_bf16 v[24:27], v[108:111], a[16:19], v[24:27]
    ds_read_b128 v[172:175], v5 offset:128
    v_mfma_f32_16x16x32_bf16 v[48:51], v[108:111], a[20:23], v[48:51]
    v_mfma_f32_16x16x32_bf16 v[28:31], v[112:115], a[16:19], v[28:31]
    ds_read_b128 v[176:179], v5 offset:144
    v_mfma_f32_16x16x32_bf16 v[52:55], v[112:115], a[20:23], v[52:55]
    s_waitcnt lgkmcnt(7)
    v_mfma_f32_16x16x32_bf16 v[32:35], v[132:135], a[16:19], v[32:35]
    ds_read_b128 v[180:183], v156 offset:256
    v_mfma_f32_16x16x32_bf16 v[56:59], v[132:135], a[20:23], v[56:59]
    v_mfma_f32_16x16x32_bf16 v[16:19], v[116:119], a[24:27], v[16:19]
    v_mfma_f32_16x16x32_bf16 v[40:43], v[116:119], a[28:31], v[40:43]
    s_waitcnt lgkmcnt(6)
    v_mfma_f32_16x16x32_bf16 v[20:23], v[120:123], a[24:27], v[20:23]
    v_mfma_f32_16x16x32_bf16 v[44:47], v[120:123], a[28:31], v[44:47]
    v_mfma_f32_16x16x32_bf16 v[24:27], v[124:127], a[24:27], v[24:27]
    v_mfma_f32_16x16x32_bf16 v[48:51], v[124:127], a[28:31], v[48:51]
    s_waitcnt lgkmcnt(5)
    v_mfma_f32_16x16x32_bf16 v[28:31], v[128:131], a[24:27], v[28:31]
    v_mfma_f32_16x16x32_bf16 v[52:55], v[128:131], a[28:31], v[52:55]
    v_mfma_f32_16x16x32_bf16 v[36:39], v[132:135], a[24:27], v[36:39]
    v_mfma_f32_16x16x32_bf16 v[60:63], v[132:135], a[28:31], v[60:63]
    s_nop 3
    ds_write_b128 v160, v[40:43] offset:8192
    ds_write_b128 v160, v[44:47] offset:9216
    ds_write_b128 v160, v[48:51] offset:10240
    ds_write_b128 v160, v[52:55] offset:11264
    ds_write_b128 v160, v[56:59] offset:12288
    ds_write_b128 v160, v[60:63] offset:13312
    s_waitcnt lgkmcnt(0)
    s_barrier
    ds_read_b128 v[40:43], v161 offset:8192
    ds_read_b128 v[44:47], v161 offset:9216
    ds_read_b128 v[48:51], v161 offset:10240
    ds_read_b128 v[52:55], v161 offset:11264
    ds_read_b128 v[56:59], v161 offset:12288
    ds_read_b128 v[60:63], v161 offset:13312
    s_waitcnt lgkmcnt(0)
    v_pk_add_f32 v[36:37], v[36:37], v[60:61]
    v_pk_add_f32 v[38:39], v[38:39], v[62:63]
    v_pk_add_f32 v[32:33], v[32:33], v[56:57]
    v_pk_add_f32 v[34:35], v[34:35], v[58:59]
    v_pk_add_f32 v[16:17], v[16:17], v[40:41]
    v_pk_add_f32 v[18:19], v[18:19], v[42:43]
    v_pk_add_f32 v[20:21], v[20:21], v[44:45]
    v_pk_add_f32 v[22:23], v[22:23], v[46:47]
    v_pk_add_f32 v[24:25], v[24:25], v[48:49]
    v_pk_add_f32 v[26:27], v[26:27], v[50:51]
    v_pk_add_f32 v[28:29], v[28:29], v[52:53]
    v_pk_add_f32 v[30:31], v[30:31], v[54:55]
    v_mov_b32 v64, v36
    v_mov_b32 v65, v37
    v_mov_b32 v66, v38
    v_mov_b32 v67, v39
    s_nop 0
    v_permlane32_swap_b32 v36, v64
    v_permlane32_swap_b32 v37, v65
    v_permlane32_swap_b32 v38, v66
    v_permlane32_swap_b32 v39, v67
    s_nop 0
    v_pk_add_f32 v[32:33], v[32:33], v[64:65]
    v_pk_add_f32 v[34:35], v[34:35], v[66:67]
    v_lshlrev_b32 v68, 16, v184
    v_and_b32 v69, s47, v184
    v_pk_fma_f32 v[68:69], v[16:17], v[164:165], v[68:69]
    v_cvt_pk_bf16_f32 v196, v68, v69
    v_lshlrev_b32 v70, 16, v185
    v_and_b32 v71, s47, v185
    v_pk_fma_f32 v[70:71], v[18:19], v[166:167], v[70:71]
    v_cvt_pk_bf16_f32 v197, v70, v71
    v_lshlrev_b32 v68, 16, v186
    v_and_b32 v69, s47, v186
    v_pk_fma_f32 v[68:69], v[20:21], v[168:169], v[68:69]
    v_cvt_pk_bf16_f32 v198, v68, v69
    v_lshlrev_b32 v70, 16, v187
    v_and_b32 v71, s47, v187
    v_pk_fma_f32 v[70:71], v[22:23], v[170:171], v[70:71]
    v_cvt_pk_bf16_f32 v199, v70, v71
    v_lshlrev_b32 v68, 16, v188
    v_and_b32 v69, s47, v188
    v_pk_fma_f32 v[68:69], v[24:25], v[172:173], v[68:69]
    v_cvt_pk_bf16_f32 v200, v68, v69
    v_lshlrev_b32 v70, 16, v189
    v_and_b32 v71, s47, v189
    v_pk_fma_f32 v[70:71], v[26:27], v[174:175], v[70:71]
    v_cvt_pk_bf16_f32 v201, v70, v71
    v_lshlrev_b32 v68, 16, v190
    v_and_b32 v69, s47, v190
    v_pk_fma_f32 v[68:69], v[28:29], v[176:177], v[68:69]
    v_cvt_pk_bf16_f32 v202, v68, v69
    v_lshlrev_b32 v70, 16, v191
    v_and_b32 v71, s47, v191
    v_pk_fma_f32 v[70:71], v[30:31], v[178:179], v[70:71]
    v_cvt_pk_bf16_f32 v203, v70, v71
    v_lshlrev_b32 v68, 16, v192
    v_and_b32 v69, s47, v192
    v_pk_fma_f32 v[68:69], v[32:33], v[180:181], v[68:69]
    v_cvt_pk_bf16_f32 v204, v68, v69
    v_lshlrev_b32 v70, 16, v193
    v_and_b32 v71, s47, v193
    v_pk_fma_f32 v[70:71], v[34:35], v[182:183], v[70:71]
    v_cvt_pk_bf16_f32 v205, v70, v71
    buffer_store_dwordx4 v[196:199], v3, s[8:11], s46 offen
    buffer_store_dwordx4 v[200:203], v3, s[8:11], s46 offen offset:64
    s_mov_b32 exec_hi, 0
    buffer_store_dwordx2 v[204:205], v7, s[8:11], s46 offen offset:128
LB_end:
    s_endpgm
code_end:
    s_endpgm
.section .rodata,"a"
.p2align 6
.amdhsa_kernel k0_kernel
  .amdhsa_next_free_vgpr 64
  .amdhsa_next_free_sgpr 102
  .amdhsa_accum_offset 64
  .amdhsa_group_segment_fixed_size 0
  .amdhsa_kernarg_size 104
  .amdhsa_user_sgpr_count 2
  .amdhsa_user_sgpr_kernarg_segment_ptr 1
  .amdhsa_system_sgpr_workgroup_id_x 1
  .amdhsa_float_denorm_mode_32 3
  .amdhsa_float_denorm_mode_16_64 3
.end_amdhsa_kernel
.p2align 6
.amdhsa_kernel k1_kernel
  .amdhsa_next_free_vgpr 256
  .amdhsa_next_free_sgpr 102
  .amdhsa_accum_offset 160
  .amdhsa_group_segment_fixed_size 0
  .amdhsa_kernarg_size 104
  .amdhsa_user_sgpr_count 2
  .amdhsa_user_sgpr_kernarg_segment_ptr 1
  .amdhsa_system_sgpr_workgroup_id_x 1
  .amdhsa_float_denorm_mode_32 3
  .amdhsa_float_denorm_mode_16_64 3
.end_amdhsa_kernel
.p2align 6
.amdhsa_kernel kb_kernel
  .amdhsa_next_free_vgpr 492
  .amdhsa_next_free_sgpr 102
  .amdhsa_accum_offset 256
  .amdhsa_group_segment_fixed_size 0
  .amdhsa_kernarg_size 104
  .amdhsa_user_sgpr_count 2
  .amdhsa_user_sgpr_kernarg_segment_ptr 1
  .amdhsa_system_sgpr_workgroup_id_x 1
  .amdhsa_float_denorm_mode_32 3
  .amdhsa_float_denorm_mode_16_64 3
.end_amdhsa_kernel
```
